```python
import torch

def _softmax(x, axis=-1):
    return torch.softmax(x, dim=axis)
def _gelu(x):
    return torch.nn.functional.gelu(x, approximate="tanh")
def _silu(x):
    return torch.nn.functional.silu(x)
def _sigmoid(x):
    return torch.sigmoid(x)
def _layernorm(x, axis=-1, eps=1e-5):
    m = x.mean(dim=axis, keepdim=True)
    v = x.var(dim=axis, keepdim=True, unbiased=False)
    return (x - m) / torch.sqrt(v + eps)
def _scatter_add(tgt, idx, src, axis=0):
    return tgt.clone().index_add_(axis, idx, src)
def _segment_sum(src, seg, n):
    out = torch.zeros((n,) + src.shape[1:], dtype=src.dtype)
    return out.index_add_(0, seg, src)
def _pad(x, pw):
    flat = tuple(v for pair in reversed(pw) for v in pair)
    return torch.nn.functional.pad(x, flat)

kernel_name = 'recurrent_scan__sliding_block_cached__swiglu_ffn__prompt'

def setup_inputs():

    _w = (lambda a: (lambda t: t.to(torch.bfloat16) if t.is_floating_point() else t)(torch.as_tensor(a)))
    def _A_setup():
        B, Sq, D = 1, 2048, 640
        Hq, Hkv, Sk, Dh = 32, 32, 2048, 128
        assert Hq % Hkv == 0, (Hq, Hkv)
        return {
            "x": _w((lambda *s: torch.randn(*s, dtype=torch.bfloat16) * 0.05)(B, Sq, D)),
            "k_cache": _w((lambda *s: torch.randn(*s, dtype=torch.bfloat16) * 0.8)(B, Hkv, Sk, Dh)),
            "v_cache": _w((lambda *s: torch.randn(*s, dtype=torch.bfloat16) * 0.2)(B, Hkv, Sk, Dh)),
            "wq": _w((lambda *s: torch.randn(*s, dtype=torch.bfloat16) * 0.8)(D, Hq * Dh) * (D ** -0.5)),
            "wo": _w((lambda *s: torch.randn(*s, dtype=torch.bfloat16) * 0.2)(Hq * Dh, D) * ((Hq * Dh) ** -0.5)),
        }
    _A_in = _A_setup()

    def _B_setup():
        B, S, D, F = 1, 2048, 640, 1728
        return {
            "x": _w((lambda *s: torch.randn(*s, dtype=torch.bfloat16) * 0.05)(B, S, D)),
            "w_gate": _w((lambda *s: torch.randn(*s, dtype=torch.bfloat16) * 0.1)(D, F)),
            "w_up": _w((lambda *s: torch.randn(*s, dtype=torch.bfloat16) * 0.1)(D, F)),
            "w_down": _w((lambda *s: torch.randn(*s, dtype=torch.bfloat16) * 0.1)(F, D)),
        }
    _B_in = _B_setup()

    return {
        "A_x": _A_in["x"],
        "A_k_cache": _A_in["k_cache"],
        "A_v_cache": _A_in["v_cache"],
        "A_wq": _A_in["wq"],
        "A_wo": _A_in["wo"],
        "B_x": _B_in["x"],
        "B_w_gate": _B_in["w_gate"],
        "B_w_up": _B_in["w_up"],
        "B_w_down": _B_in["w_down"],
    }

def reference(A_x, A_k_cache, A_v_cache, A_wq, A_wo, B_x, B_w_gate, B_w_up, B_w_down):
    def _A_ref(x, k_cache, v_cache, wq, wo):
        B, Sq, D = x.shape
        Hq, Dh = 32, 128
        Hkv, Sk = k_cache.shape[1], k_cache.shape[2]
        W = min(4096, max(256, Sk // 4))
        rep = Hq // Hkv
        q = (lambda x, *d: x.permute(*d))((x @ wq).reshape(B, Sq, Hq, Dh), 0, 2, 1, 3)
        k = (lambda x, n, axis: torch.repeat_interleave(x, n, dim=axis))(k_cache[:, :, Sk - W:, :], rep, axis=1)
        v = (lambda x, n, axis: torch.repeat_interleave(x, n, dim=axis))(v_cache[:, :, Sk - W:, :], rep, axis=1)
        scores = torch.einsum("bhqd,bhkd->bhqk", q, k) * (Dh ** -0.5)
        p = _softmax(scores, axis=-1)
        o = torch.einsum("bhqk,bhkd->bhqd", p, v)
        return (lambda x, *d: x.permute(*d))(o, 0, 2, 1, 3).reshape(B, Sq, Hq * Dh) @ wo

    def _B_ref(x, w_gate, w_up, w_down):
        g = _silu(x @ w_gate)
        u = x @ w_up
        return (g * u) @ w_down

    x = A_x
    xn = _layernorm(x, axis=-1)
    s = _A_ref(xn, A_k_cache, A_v_cache, A_wq, A_wo)
    g = _silu(_B_ref(xn, B_w_gate, B_w_up, B_w_down))
    return x + s * g
```

```asm
; @launch grid=(256,1,1) block=(512,1,1) lds=163840
.amdgcn_target "amdgcn-amd-amdhsa--gfx950"
.text
.globl recurrent_scan__sliding_block_cached__swiglu_ffn__prompt_kernel
.p2align 8
.type recurrent_scan__sliding_block_cached__swiglu_ffn__prompt_kernel,@function
recurrent_scan__sliding_block_cached__swiglu_ffn__prompt_kernel:
  s_load_dwordx16 s[76:91], s[0:1], 0
  s_load_dwordx8 s[92:99], s[0:1], 64
  s_cmp_ge_u32 s2, 256
  s_cbranch_scc1 L_k1_end
  v_lshrrev_b32 v1, 6, v0
  v_and_b32 v175, 63, v0
  v_readfirstlane_b32 s40, v1
  s_bfe_u32 s5, s2, 0x20001
  s_bfe_u32 s65, s2, 0x30003
  s_lshl_b32 s64, s5, 3
  s_add_u32 s41, s64, s65
  s_sub_u32 s3, s41, s5
  s_cmp_eq_u32 s65, 7
  s_cselect_b32 s3, 27, s3
  s_and_b32 s64, s2, 1
  s_lshl_b32 s64, s64, 2
  s_lshr_b32 s42, s2, 6
  s_add_u32 s42, s42, s64
  s_mov_b32 s46, 0xffff0000
  v_lshrrev_b32 v1, 3, v175
  v_mul_u32_u24 v2, 1280, v1
  v_lshrrev_b32 v240, 4, v175
  v_and_b32 v4, 7, v175
  v_xor_b32 v5, v4, v240
  v_lshl_add_u32 v156, v5, 4, v2
  v_xor_b32 v157, 64, v156
  v_add_u32 v157, 9216, v157
  v_add_u32 v158, 18432, v156
  v_add_u32 v159, 18432, v157
  s_movk_i32 s64, 3456
  s_cmp_lt_u32 s40, 4
  s_cselect_b32 s64, 8192, s64
  s_cselect_b32 s65, 2, 1
  s_lshl_b32 s43, s64, 5
  s_cmp_ge_u32 s40, 6
  s_cselect_b32 s66, 4, 0
  s_and_b32 s67, s40, 1
  s_lshl_b32 s67, s67, 4
  v_add_u32 v6, s67, v1
  v_mul_lo_u32 v6, v6, s64
  v_and_b32 v7, 1, v240
  v_lshlrev_b32 v7, s65, v7
  v_add_u32 v7, s66, v7
  v_xor_b32 v7, v7, v4
  v_lshl_add_u32 v160, v7, 4, v6
  s_lshl_b32 s68, s64, 3
  s_sub_u32 s68, s68, 1024
  v_add_u32 v161, s68, v160
  s_lshl_b32 s47, s40, 11
  s_lshl_b32 s48, s40, 12
  s_add_u32 s48, s48, 65536
  s_and_b32 s69, s2, 1
  s_mul_i32 s45, s69, 640
  s_mul_i32 s69, s69, 10
  s_mul_i32 s44, s69, s43
  s_mul_i32 s69, s41, 1280
  v_lshl_add_u32 v236, v175, 4, s69
  v_lshl_add_u32 v237, v175, 2, s69
  s_waitcnt lgkmcnt(0)
  s_lshl_b32 s69, s42, 3
  s_add_u32 s69, s69, s40
  s_mul_i32 s69, s69, 40960
  s_add_u32 s8, s76, s69
  s_addc_u32 s9, s77, 0
  s_mov_b32 s10, 40960
  s_mov_b32 s11, 0x20000
  s_cmp_ge_u32 s40, 6
  s_cselect_b32 s70, s90, s88
  s_cselect_b32 s71, s91, s89
  s_lshl_b32 s72, s3, 7
  s_sub_u32 s73, 2211840, s72
  s_cmp_lt_u32 s3, 27
  s_cselect_b32 s73, s73, 0
  s_cselect_b32 s72, s72, 0
  s_lshl_b32 s74, s41, 8
  s_lshr_b32 s75, s40, 1
  s_lshl_b32 s75, s75, 7
  s_add_u32 s74, s74, s75
  s_sub_u32 s75, 5242880, s74
  s_cmp_lt_u32 s40, 4
  s_cselect_b32 s70, s82, s70
  s_cselect_b32 s71, s83, s71
  s_cselect_b32 s72, s74, s72
  s_cselect_b32 s14, s75, s73
  s_add_u32 s12, s70, s72
  s_addc_u32 s13, s71, 0
  s_mov_b32 s15, 0x20000
  s_add_u32 m0, s47, 0
  s_nop 0
  buffer_load_dwordx4 v160, s[12:15], s44 offen lds
  buffer_load_dwordx4 v161, s[12:15], s44 offen offset:1024 lds
  s_add_u32 s44, s44, s43
  s_add_u32 m0, s48, 0
  s_nop 0
  buffer_load_dwordx4 v156, s[8:11], s45 offen offset:0 lds
  buffer_load_dwordx4 v157, s[8:11], s45 offen offset:1024 lds
  buffer_load_dwordx4 v158, s[8:11], s45 offen offset:2048 lds
  buffer_load_dwordx4 v159, s[8:11], s45 offen offset:3072 lds
  s_add_u32 s45, s45, 128
  s_cmp_lg_u32 s40, 7
  s_cbranch_scc1 L_nocpf
  s_getpc_b64 s[70:71]
L_pc0:
  s_bfe_u32 s72, s2, 0x50003
  s_lshl_b32 s72, s72, 12
  v_lshl_add_u32 v8, v175, 6, s72
  v_min_u32 v8, L_k1_end-L_pc0, v8
  v_mov_b32 v9, s71
  v_add_co_u32 v8, vcc, s70, v8
  v_addc_co_u32 v9, vcc, 0, v9, vcc
  global_load_dword v224, v[8:9], off
L_nocpf:
  v_bfe_u32 v241, v175, 2, 2
  v_and_b32 v242, 3, v175
  v_lshrrev_b32 v243, 5, v175
  v_and_b32 v244, 31, v175
  v_and_b32 v245, 1, v240
  v_lshrrev_b32 v13, 1, v241
  v_lshl_add_u32 v14, v243, 3, v241
  v_lshlrev_b32 v14, 7, v14
  v_lshl_add_u32 v15, v13, 6, v14
  v_lshl_add_u32 v15, v245, 5, v15
  v_and_b32 v16, 1, v242
  v_lshl_add_u32 v15, v16, 4, v15
  v_lshrrev_b32 v17, 1, v242
  v_lshl_add_u32 v15, v17, 3, v15
  v_mul_u32_u24 v18, 4160, v245
  v_add3_u32 v18, v18, v14, 0
  v_lshl_add_u32 v18, v13, 5, v18
  v_lshl_add_u32 v18, v242, 3, v18
  v_add_u32 v18, 8192, v18
  s_and_b32 s64, s40, 3
  s_xor_b32 s65, s64, 0
  s_and_b32 s66, s65, 1
  s_lshl_b32 s66, s66, 6
  s_lshr_b32 s67, s65, 1
  s_lshl_b32 s67, s67, 12
  s_or_b32 s66, s66, s67
  v_xor_b32 v144, s66, v15
  s_lshl_b32 s67, s65, 5
  v_xor_b32 v148, s67, v18
  s_lshl_b32 s68, s3, 1
  s_lshr_b32 s69, s65, 1
  s_add_u32 s68, s68, s69
  s_add_u32 s68, s68, 128
  s_lshl_b32 s68, s68, 13
  s_and_b32 s69, s65, 1
  s_lshl_b32 s69, s69, 9
  s_add_u32 s52, s68, s69
  s_mul_i32 s68, s5, 24
  s_add_u32 s68, s68, s41
  s_lshl_b32 s68, s68, 13
  s_add_u32 s60, s68, 0
  s_xor_b32 s65, s64, 1
  s_and_b32 s66, s65, 1
  s_lshl_b32 s66, s66, 6
  s_lshr_b32 s67, s65, 1
  s_lshl_b32 s67, s67, 12
  s_or_b32 s66, s66, s67
  v_xor_b32 v145, s66, v15
  s_lshl_b32 s67, s65, 5
  v_xor_b32 v149, s67, v18
  s_lshl_b32 s68, s3, 1
  s_lshr_b32 s69, s65, 1
  s_add_u32 s68, s68, s69
  s_add_u32 s68, s68, 128
  s_lshl_b32 s68, s68, 13
  s_and_b32 s69, s65, 1
  s_lshl_b32 s69, s69, 9
  s_add_u32 s53, s68, s69
  s_mul_i32 s68, s5, 24
  s_add_u32 s68, s68, s41
  s_lshl_b32 s68, s68, 13
  s_add_u32 s61, s68, 65536
  s_xor_b32 s65, s64, 2
  s_and_b32 s66, s65, 1
  s_lshl_b32 s66, s66, 6
  s_lshr_b32 s67, s65, 1
  s_lshl_b32 s67, s67, 12
  s_or_b32 s66, s66, s67
  v_xor_b32 v146, s66, v15
  s_lshl_b32 s67, s65, 5
  v_xor_b32 v150, s67, v18
  s_lshl_b32 s68, s3, 1
  s_lshr_b32 s69, s65, 1
  s_add_u32 s68, s68, s69
  s_add_u32 s68, s68, 128
  s_lshl_b32 s68, s68, 13
  s_and_b32 s69, s65, 1
  s_lshl_b32 s69, s69, 9
  s_add_u32 s54, s68, s69
  s_mul_i32 s68, s5, 24
  s_add_u32 s68, s68, s41
  s_lshl_b32 s68, s68, 13
  s_add_u32 s62, s68, 131072
  s_xor_b32 s65, s64, 3
  s_and_b32 s66, s65, 1
  s_lshl_b32 s66, s66, 6
  s_lshr_b32 s67, s65, 1
  s_lshl_b32 s67, s67, 12
  s_or_b32 s66, s66, s67
  v_xor_b32 v147, s66, v15
  s_lshl_b32 s67, s65, 5
  v_xor_b32 v151, s67, v18
  s_lshl_b32 s68, s3, 1
  s_lshr_b32 s69, s65, 1
  s_add_u32 s68, s68, s69
  s_add_u32 s68, s68, 128
  s_lshl_b32 s68, s68, 13
  s_and_b32 s69, s65, 1
  s_lshl_b32 s69, s69, 9
  s_add_u32 s55, s68, s69
  s_mul_i32 s68, s5, 24
  s_add_u32 s68, s68, s41
  s_lshl_b32 s68, s68, 13
  s_add_u32 s63, s68, 196608
  s_cmp_lt_u32 s40, 4
  s_cbranch_scc1 L_noswap
  v_swap_b32 v144, v148
  v_swap_b32 v145, v149
  v_swap_b32 v146, v150
  v_swap_b32 v147, v151
L_noswap:
  s_nop 1
  v_bfe_u32 v246, v175, 1, 3
  v_xor_b32 v246, v246, v243
  v_lshlrev_b32 v246, 4, v246
  v_lshl_add_u32 v246, v244, 7, v246
  v_add_u32 v152, s48, v246
  v_xor_b32 v153, 32, v152
  v_xor_b32 v154, 64, v152
  v_xor_b32 v155, 96, v152
  v_mov_b32 v162, 0
  v_mov_b32 v163, 0
  v_mov_b32 v164, 0
  s_add_u32 m0, s47, 16384
  s_nop 0
  buffer_load_dwordx4 v160, s[12:15], s44 offen lds
  buffer_load_dwordx4 v161, s[12:15], s44 offen offset:1024 lds
  s_add_u32 s44, s44, s43
  s_add_u32 m0, s47, 32768
  s_nop 0
  buffer_load_dwordx4 v160, s[12:15], s44 offen lds
  buffer_load_dwordx4 v161, s[12:15], s44 offen offset:1024 lds
  s_add_u32 s44, s44, s43
  s_mov_b32 s4, 0x4e800000
  s_waitcnt vmcnt(4)
  s_barrier
  ds_read_b128 v[128:131], v152 offset:0
  ds_read_b64_tr_b16 v[136:137], v144 offset:0
  ds_read_b64_tr_b16 v[138:139], v144 offset:512
  ds_read_b64_tr_b16 v[196:197], v145 offset:0
  ds_read_b64_tr_b16 v[198:199], v145 offset:512
  ds_read_b64_tr_b16 v[200:201], v146 offset:0
  ds_read_b64_tr_b16 v[202:203], v146 offset:512
  ds_read_b64_tr_b16 v[204:205], v147 offset:0
  ds_read_b64_tr_b16 v[206:207], v147 offset:512
  ds_read_b64_tr_b16 v[208:209], v148 offset:0
  ds_read_b64_tr_b16 v[210:211], v148 offset:512
  ds_read_b64_tr_b16 v[212:213], v149 offset:0
  ds_read_b64_tr_b16 v[214:215], v149 offset:512
  ds_read_b64_tr_b16 v[216:217], v150 offset:0
  ds_read_b64_tr_b16 v[218:219], v150 offset:512
  ds_read_b64_tr_b16 v[220:221], v151 offset:0
  ds_read_b64_tr_b16 v[222:223], v151 offset:512
  s_waitcnt lgkmcnt(14)
  v_mfma_f32_32x32x16_bf16 v[0:15], v[136:139], v[128:131], 0
  ds_read_b128 v[132:135], v153 offset:0
  ds_read_b64_tr_b16 v[140:141], v144 offset:2048
  ds_read_b64_tr_b16 v[142:143], v144 offset:2560
  v_and_b32 v246, 15, v175
  v_xor_b32 v246, v246, v243
  v_lshlrev_b32 v246, 4, v246
  s_and_b32 s59, s42, 3
  s_cmp_eq_u32 s59, 0
  s_cselect_b64 vcc, -1, 0
  s_waitcnt lgkmcnt(15)
  v_mfma_f32_32x32x16_bf16 v[16:31], v[196:199], v[128:131], 0
  ds_read_b64_tr_b16 v[196:197], v145 offset:2048
  ds_read_b64_tr_b16 v[198:199], v145 offset:2560
  s_add_u32 m0, s48, 32768
  s_nop 0
  buffer_load_dwordx4 v156, s[8:11], s45 offen offset:0 lds
  buffer_load_dwordx4 v157, s[8:11], s45 offen offset:1024 lds
  buffer_load_dwordx4 v158, s[8:11], s45 offen offset:2048 lds
  buffer_load_dwordx4 v159, s[8:11], s45 offen offset:3072 lds
  s_add_u32 s45, s45, 128
  v_lshl_add_u32 v246, v244, 8, v246
  s_lshl_b32 s65, s64, 6
  s_add_u32 s65, s65, 131072
  v_xor_b32 v176, s65, v246
  s_waitcnt lgkmcnt(15)
  v_mfma_f32_32x32x16_bf16 v[32:47], v[200:203], v[128:131], 0
  ds_read_b64_tr_b16 v[200:201], v146 offset:2048
  ds_read_b64_tr_b16 v[202:203], v146 offset:2560
  v_xor_b32 v177, 32, v176
  v_xor_b32 v178, 64, v176
  v_xor_b32 v179, 96, v176
  s_cbranch_vccz L_cs_0_0
  v_lshlrev_b32 v167, 16, v136
  v_and_b32 v168, s46, v136
  v_add_f32 v164, v164, v167
  v_add_f32 v164, v164, v168
  v_lshlrev_b32 v167, 16, v137
  v_and_b32 v168, s46, v137
  v_add_f32 v164, v164, v167
  v_add_f32 v164, v164, v168
L_cs_0_0:
  s_waitcnt lgkmcnt(15)
  v_mfma_f32_32x32x16_bf16 v[48:63], v[204:207], v[128:131], 0
  ds_read_b64_tr_b16 v[204:205], v147 offset:2048
  ds_read_b64_tr_b16 v[206:207], v147 offset:2560
  v_xor_b32 v180, 128, v176
  v_xor_b32 v181, 160, v176
  v_xor_b32 v182, 192, v176
  s_waitcnt lgkmcnt(15)
  v_mfma_f32_32x32x16_bf16 v[64:79], v[208:211], v[128:131], 0
  ds_read_b64_tr_b16 v[208:209], v148 offset:2048
  ds_read_b64_tr_b16 v[210:211], v148 offset:2560
  s_add_u32 m0, s47, 49152
  s_nop 0
  buffer_load_dwordx4 v160, s[12:15], s44 offen lds
  buffer_load_dwordx4 v161, s[12:15], s44 offen offset:1024 lds
  s_add_u32 s44, s44, s43
  v_xor_b32 v183, 224, v176
  v_lshl_add_u32 v246, v243, 2, v241
  v_lshlrev_b32 v246, 8, v246
  s_waitcnt lgkmcnt(15)
  v_mfma_f32_32x32x16_bf16 v[80:95], v[212:215], v[128:131], 0
  ds_read_b64_tr_b16 v[212:213], v149 offset:2048
  ds_read_b64_tr_b16 v[214:215], v149 offset:2560
  v_lshl_add_u32 v246, v241, 6, v246
  v_lshl_add_u32 v246, v245, 5, v246
  v_lshl_add_u32 v246, v242, 3, v246
  v_add_u32 v184, 147456, v246
  s_cbranch_vccz L_cs_0_1
  v_lshlrev_b32 v167, 16, v138
  v_and_b32 v168, s46, v138
  v_add_f32 v164, v164, v167
  v_add_f32 v164, v164, v168
  v_lshlrev_b32 v167, 16, v139
  v_and_b32 v168, s46, v139
  v_add_f32 v164, v164, v167
  v_add_f32 v164, v164, v168
L_cs_0_1:
  s_waitcnt lgkmcnt(15)
  v_mfma_f32_32x32x16_bf16 v[96:111], v[216:219], v[128:131], 0
  ds_read_b64_tr_b16 v[216:217], v150 offset:2048
  ds_read_b64_tr_b16 v[218:219], v150 offset:2560
  v_xor_b32 v185, 64, v184
  v_xor_b32 v186, 128, v184
  v_xor_b32 v187, 192, v184
  s_waitcnt lgkmcnt(15)
  v_mfma_f32_32x32x16_bf16 v[112:127], v[220:223], v[128:131], 0
  ds_read_b64_tr_b16 v[220:221], v151 offset:2048
  ds_read_b64_tr_b16 v[222:223], v151 offset:2560
  s_lshl_b32 s49, s40, 11
  v_and_b32 v246, 15, v175
  v_lshl_add_u32 v247, v240, 8, s49
  s_waitcnt vmcnt(8)
  s_barrier
  s_waitcnt lgkmcnt(14)
  v_mfma_f32_32x32x16_bf16 v[0:15], v[140:143], v[132:135], v[0:15]
  ds_read_b128 v[128:131], v154 offset:0
  ds_read_b64_tr_b16 v[136:137], v144 offset:16384
  ds_read_b64_tr_b16 v[138:139], v144 offset:16896
  s_and_b32 s66, s40, 1
  s_lshl_b32 s66, s66, 3
  v_add_u32 v248, s66, v240
  s_waitcnt lgkmcnt(15)
  v_mfma_f32_32x32x16_bf16 v[16:31], v[196:199], v[132:135], v[16:31]
  ds_read_b64_tr_b16 v[196:197], v145 offset:16384
  ds_read_b64_tr_b16 v[198:199], v145 offset:16896
  v_xor_b32 v248, v248, v246
  v_lshl_add_u32 v171, v248, 4, v247
  v_xor_b32 v172, 64, v171
  v_lshlrev_b32 v248, 2, v240
  s_waitcnt lgkmcnt(15)
  v_mfma_f32_32x32x16_bf16 v[32:47], v[200:203], v[132:135], v[32:47]
  ds_read_b64_tr_b16 v[200:201], v146 offset:16384
  ds_read_b64_tr_b16 v[202:203], v146 offset:16896
  v_xor_b32 v248, v248, v246
  v_lshl_add_u32 v173, v248, 4, v247
  v_lshl_add_u32 v248, v243, 4, v246
  s_cbranch_vccz L_cs_1_0
  v_lshlrev_b32 v167, 16, v140
  v_and_b32 v168, s46, v140
  v_add_f32 v164, v164, v167
  v_add_f32 v164, v164, v168
  v_lshlrev_b32 v167, 16, v141
  v_and_b32 v168, s46, v141
  v_add_f32 v164, v164, v167
  v_add_f32 v164, v164, v168
L_cs_1_0:
  s_waitcnt lgkmcnt(15)
  v_mfma_f32_32x32x16_bf16 v[48:63], v[204:207], v[132:135], v[48:63]
  ds_read_b64_tr_b16 v[204:205], v147 offset:16384
  ds_read_b64_tr_b16 v[206:207], v147 offset:16896
  v_lshlrev_b32 v248, 4, v248
  v_lshl_add_u32 v174, v245, 10, v248
  s_lshl_b32 s66, s41, 19
  s_waitcnt lgkmcnt(15)
  v_mfma_f32_32x32x16_bf16 v[64:79], v[208:211], v[132:135], v[64:79]
  ds_read_b64_tr_b16 v[208:209], v148 offset:16384
  ds_read_b64_tr_b16 v[210:211], v148 offset:16896
  s_add_u32 s66, s66, 393216
  s_add_u32 s16, s78, s66
  s_addc_u32 s17, s79, 0
  s_waitcnt lgkmcnt(15)
  v_mfma_f32_32x32x16_bf16 v[80:95], v[212:215], v[132:135], v[80:95]
  ds_read_b64_tr_b16 v[212:213], v149 offset:16384
  ds_read_b64_tr_b16 v[214:215], v149 offset:16896
  s_mov_b32 s18, 131072
  s_mov_b32 s19, 0x20000
  s_add_u32 s20, s80, s66
  s_addc_u32 s21, s81, 0
  s_cbranch_vccz L_cs_1_1
  v_lshlrev_b32 v167, 16, v142
  v_and_b32 v168, s46, v142
  v_add_f32 v164, v164, v167
  v_add_f32 v164, v164, v168
  v_lshlrev_b32 v167, 16, v143
  v_and_b32 v168, s46, v143
  v_add_f32 v164, v164, v167
  v_add_f32 v164, v164, v168
L_cs_1_1:
  s_waitcnt lgkmcnt(15)
  v_mfma_f32_32x32x16_bf16 v[96:111], v[216:219], v[132:135], v[96:111]
  ds_read_b64_tr_b16 v[216:217], v150 offset:16384
  ds_read_b64_tr_b16 v[218:219], v150 offset:16896
  s_mov_b32 s22, 131072
  s_mov_b32 s23, 0x20000
  s_mov_b32 s50, 0
  s_waitcnt lgkmcnt(15)
  v_mfma_f32_32x32x16_bf16 v[112:127], v[220:223], v[132:135], v[112:127]
  ds_read_b64_tr_b16 v[220:221], v151 offset:16384
  ds_read_b64_tr_b16 v[222:223], v151 offset:16896
  s_mov_b32 s51, 0
  s_lshl_b32 s66, s42, 1
  s_lshr_b32 s67, s40, 2
  s_waitcnt lgkmcnt(14)
  v_mfma_f32_32x32x16_bf16 v[0:15], v[136:139], v[128:131], v[0:15]
  ds_read_b128 v[132:135], v155 offset:0
  ds_read_b64_tr_b16 v[140:141], v144 offset:18432
  ds_read_b64_tr_b16 v[142:143], v144 offset:18944
  s_add_u32 s66, s66, s67
  s_mul_i32 s66, s66, 1490944
  s_and_b32 s67, s40, 3
  s_lshl_b32 s67, s67, 11
  s_waitcnt lgkmcnt(15)
  v_mfma_f32_32x32x16_bf16 v[16:31], v[196:199], v[128:131], v[16:31]
  ds_read_b64_tr_b16 v[196:197], v145 offset:18432
  ds_read_b64_tr_b16 v[198:199], v145 offset:18944
  buffer_load_dwordx4 v[228:231], v236, s[8:11], 0 offen
  buffer_load_dword v232, v237, s[8:11], 0 offen offset:1024
  s_add_u32 s66, s66, s67
  s_add_u32 s24, s98, s66
  s_addc_u32 s25, s99, 0
  s_waitcnt lgkmcnt(15)
  v_mfma_f32_32x32x16_bf16 v[32:47], v[200:203], v[128:131], v[32:47]
  ds_read_b64_tr_b16 v[200:201], v146 offset:18432
  ds_read_b64_tr_b16 v[202:203], v146 offset:18944
  s_mov_b32 s26, 1490944
  s_mov_b32 s27, 0x20000
  s_mov_b32 s28, s24
  s_cbranch_vccz L_cs_2_0
  v_lshlrev_b32 v167, 16, v136
  v_and_b32 v168, s46, v136
  v_add_f32 v164, v164, v167
  v_add_f32 v164, v164, v168
  v_lshlrev_b32 v167, 16, v137
  v_and_b32 v168, s46, v137
  v_add_f32 v164, v164, v167
  v_add_f32 v164, v164, v168
L_cs_2_0:
  s_waitcnt lgkmcnt(15)
  v_mfma_f32_32x32x16_bf16 v[48:63], v[204:207], v[128:131], v[48:63]
  ds_read_b64_tr_b16 v[204:205], v147 offset:18432
  ds_read_b64_tr_b16 v[206:207], v147 offset:18944
  s_mov_b32 s29, s25
  s_mov_b32 s31, 0x20000
  s_cmp_lt_u32 s3, 27
  s_cselect_b32 s30, 1490944, 0
  s_waitcnt lgkmcnt(15)
  v_mfma_f32_32x32x16_bf16 v[64:79], v[208:211], v[128:131], v[64:79]
  ds_read_b64_tr_b16 v[208:209], v148 offset:18432
  ds_read_b64_tr_b16 v[210:211], v148 offset:18944
  s_bfe_u32 s66, s2, 0x30003
  s_lshr_b32 s67, s66, 2
  s_lshl_b32 s64, s42, 1
  s_waitcnt lgkmcnt(15)
  v_mfma_f32_32x32x16_bf16 v[80:95], v[212:215], v[128:131], v[80:95]
  ds_read_b64_tr_b16 v[212:213], v149 offset:18432
  ds_read_b64_tr_b16 v[214:215], v149 offset:18944
  s_add_u32 s64, s64, s67
  s_and_b32 s67, s66, 3
  s_lshl_b32 s65, s66, 2
  s_cbranch_vccz L_cs_2_1
  v_lshlrev_b32 v167, 16, v138
  v_and_b32 v168, s46, v138
  v_add_f32 v164, v164, v167
  v_add_f32 v164, v164, v168
  v_lshlrev_b32 v167, 16, v139
  v_and_b32 v168, s46, v139
  v_add_f32 v164, v164, v167
  v_add_f32 v164, v164, v168
L_cs_2_1:
  s_waitcnt lgkmcnt(15)
  v_mfma_f32_32x32x16_bf16 v[96:111], v[216:219], v[128:131], v[96:111]
  ds_read_b64_tr_b16 v[216:217], v150 offset:18432
  ds_read_b64_tr_b16 v[218:219], v150 offset:18944
  s_mov_b32 s78, 2621440
  s_mov_b32 s79, 0x20000
  s_mul_i32 s66, s67, 320
  s_waitcnt lgkmcnt(15)
  v_mfma_f32_32x32x16_bf16 v[112:127], v[220:223], v[128:131], v[112:127]
  ds_read_b64_tr_b16 v[220:221], v151 offset:18432
  ds_read_b64_tr_b16 v[222:223], v151 offset:18944
  s_add_u32 s32, s92, s66
  s_addc_u32 s33, s93, 0
  s_sub_u32 s34, 2211840, s66
  s_waitcnt vmcnt(8)
  s_barrier
  s_waitcnt lgkmcnt(14)
  v_mfma_f32_32x32x16_bf16 v[0:15], v[140:143], v[132:135], v[0:15]
  s_waitcnt vmcnt(4)
  ds_read_b128 v[128:131], v152 offset:32768
  ds_read_b64_tr_b16 v[136:137], v144 offset:32768
  ds_read_b64_tr_b16 v[138:139], v144 offset:33280
  s_mov_b32 s35, 0x20000
  s_add_u32 s36, s84, s66
  s_addc_u32 s37, s85, 0
  s_sub_u32 s38, 5242880, s66
  s_waitcnt lgkmcnt(15)
  v_mfma_f32_32x32x16_bf16 v[16:31], v[196:199], v[132:135], v[16:31]
  ds_read_b64_tr_b16 v[196:197], v145 offset:32768
  ds_read_b64_tr_b16 v[198:199], v145 offset:33280
  s_add_u32 m0, s47, 0
  s_nop 0
  buffer_load_dwordx4 v160, s[12:15], s44 offen lds
  buffer_load_dwordx4 v161, s[12:15], s44 offen offset:1024 lds
  s_add_u32 s44, s44, s43
  s_mov_b32 s39, 0x20000
  s_mul_i32 s66, s64, 1490944
  s_waitcnt lgkmcnt(15)
  v_mfma_f32_32x32x16_bf16 v[32:47], v[200:203], v[132:135], v[32:47]
  ds_read_b64_tr_b16 v[200:201], v146 offset:32768
  ds_read_b64_tr_b16 v[202:203], v146 offset:33280
  s_add_u32 s84, s98, s66
  s_addc_u32 s85, s99, 0
  s_mov_b32 s86, 1490944
  s_mov_b32 s87, 0x20000
  s_cbranch_vccz L_cs_3_0
  v_lshlrev_b32 v167, 16, v140
  v_and_b32 v168, s46, v140
  v_add_f32 v164, v164, v167
  v_add_f32 v164, v164, v168
  v_lshlrev_b32 v167, 16, v141
  v_and_b32 v168, s46, v141
  v_add_f32 v164, v164, v167
  v_add_f32 v164, v164, v168
L_cs_3_0:
  s_waitcnt lgkmcnt(15)
  v_mfma_f32_32x32x16_bf16 v[48:63], v[204:207], v[132:135], v[48:63]
  ds_read_b64_tr_b16 v[204:205], v147 offset:32768
  ds_read_b64_tr_b16 v[206:207], v147 offset:33280
  s_lshl_b32 s66, s64, 2
  s_add_u32 s66, s66, s67
  s_mul_i32 s66, s66, 163840
  s_waitcnt lgkmcnt(15)
  v_mfma_f32_32x32x16_bf16 v[64:79], v[208:211], v[132:135], v[64:79]
  ds_read_b64_tr_b16 v[208:209], v148 offset:32768
  ds_read_b64_tr_b16 v[210:211], v148 offset:33280
  s_add_u32 m0, s48, 0
  s_nop 0
  buffer_load_dwordx4 v156, s[8:11], s45 offen offset:0 lds
  buffer_load_dwordx4 v157, s[8:11], s45 offen offset:1024 lds
  buffer_load_dwordx4 v158, s[8:11], s45 offen offset:2048 lds
  buffer_load_dwordx4 v159, s[8:11], s45 offen offset:3072 lds
  s_add_u32 s45, s45, 128
  s_mul_i32 s67, s40, 1280
  s_add_u32 s66, s66, s67
  s_add_u32 s66, s66, 67108864
  s_waitcnt lgkmcnt(15)
  v_mfma_f32_32x32x16_bf16 v[80:95], v[212:215], v[132:135], v[80:95]
  ds_read_b64_tr_b16 v[212:213], v149 offset:32768
  ds_read_b64_tr_b16 v[214:215], v149 offset:33280
  s_add_u32 s88, s98, s66
  s_addc_u32 s89, s99, 0
  s_mov_b32 s90, 10649600
  s_mov_b32 s91, 0x20000
  s_cbranch_vccz L_cs_3_1
  v_lshlrev_b32 v167, 16, v142
  v_and_b32 v168, s46, v142
  v_add_f32 v164, v164, v167
  v_add_f32 v164, v164, v168
  v_lshlrev_b32 v167, 16, v143
  v_and_b32 v168, s46, v143
  v_add_f32 v164, v164, v167
  v_add_f32 v164, v164, v168
L_cs_3_1:
  s_waitcnt lgkmcnt(15)
  v_mfma_f32_32x32x16_bf16 v[96:111], v[216:219], v[132:135], v[96:111]
  ds_read_b64_tr_b16 v[216:217], v150 offset:32768
  ds_read_b64_tr_b16 v[218:219], v150 offset:33280
  s_mov_b32 s92, s94
  s_mov_b32 s93, s95
  s_mov_b32 s94, 2621440
  s_waitcnt lgkmcnt(15)
  v_mfma_f32_32x32x16_bf16 v[112:127], v[220:223], v[132:135], v[112:127]
  ds_read_b64_tr_b16 v[220:221], v151 offset:32768
  ds_read_b64_tr_b16 v[222:223], v151 offset:33280
  s_mov_b32 s95, 0x20000
  s_lshl_b32 s66, s42, 2
  s_add_u32 s66, s66, s5
  s_waitcnt lgkmcnt(14)
  v_mfma_f32_32x32x16_bf16 v[0:15], v[136:139], v[128:131], v[0:15]
  ds_read_b128 v[132:135], v153 offset:32768
  ds_read_b64_tr_b16 v[140:141], v144 offset:34816
  ds_read_b64_tr_b16 v[142:143], v144 offset:35328
  s_lshl_b32 s66, s66, 7
  s_add_u32 s66, s66, 50331648
  s_add_u32 s68, s98, s66
  s_addc_u32 s69, s99, 0
  s_waitcnt lgkmcnt(15)
  v_mfma_f32_32x32x16_bf16 v[16:31], v[196:199], v[128:131], v[16:31]
  ds_read_b64_tr_b16 v[196:197], v145 offset:34816
  ds_read_b64_tr_b16 v[198:199], v145 offset:35328
  s_mov_b32 s70, 96
  s_mov_b32 s71, 0x20000
  s_add_u32 s80, s98, 50397184
  s_addc_u32 s81, s99, 0
  s_waitcnt lgkmcnt(15)
  v_mfma_f32_32x32x16_bf16 v[32:47], v[200:203], v[128:131], v[32:47]
  ds_read_b64_tr_b16 v[200:201], v146 offset:34816
  ds_read_b64_tr_b16 v[202:203], v146 offset:35328
  s_mov_b32 s82, 327680
  s_mov_b32 s83, 0x20000
  s_cbranch_vccz L_cs_4_0
  v_lshlrev_b32 v167, 16, v136
  v_and_b32 v168, s46, v136
  v_add_f32 v164, v164, v167
  v_add_f32 v164, v164, v168
  v_lshlrev_b32 v167, 16, v137
  v_and_b32 v168, s46, v137
  v_add_f32 v164, v164, v167
  v_add_f32 v164, v164, v168
L_cs_4_0:
  s_waitcnt lgkmcnt(15)
  v_mfma_f32_32x32x16_bf16 v[48:63], v[204:207], v[128:131], v[48:63]
  ds_read_b64_tr_b16 v[204:205], v147 offset:34816
  ds_read_b64_tr_b16 v[206:207], v147 offset:35328
  s_mov_b32 s72, s96
  s_mov_b32 s73, s97
  s_mov_b32 s74, 256
  s_mov_b32 s75, 0x20000
  s_waitcnt lgkmcnt(15)
  v_mfma_f32_32x32x16_bf16 v[64:79], v[208:211], v[128:131], v[64:79]
  ds_read_b64_tr_b16 v[208:209], v148 offset:34816
  ds_read_b64_tr_b16 v[210:211], v148 offset:35328
  s_lshr_b32 s66, s2, 6
  s_lshl_b32 s66, s66, 5
  s_add_u32 s66, s66, s65
  s_waitcnt lgkmcnt(15)
  v_mfma_f32_32x32x16_bf16 v[80:95], v[212:215], v[128:131], v[80:95]
  ds_read_b64_tr_b16 v[212:213], v149 offset:34816
  ds_read_b64_tr_b16 v[214:215], v149 offset:35328
  s_lshl_b32 s66, s66, 1
  s_add_u32 s66, s66, s40
  s_mul_i32 s96, s66, 5120
  s_cbranch_vccz L_cs_4_1
  v_lshlrev_b32 v167, 16, v138
  v_and_b32 v168, s46, v138
  v_add_f32 v164, v164, v167
  v_add_f32 v164, v164, v168
  v_lshlrev_b32 v167, 16, v139
  v_and_b32 v168, s46, v139
  v_add_f32 v164, v164, v167
  v_add_f32 v164, v164, v168
L_cs_4_1:
  s_waitcnt lgkmcnt(15)
  v_mfma_f32_32x32x16_bf16 v[96:111], v[216:219], v[128:131], v[96:111]
  ds_read_b64_tr_b16 v[216:217], v150 offset:34816
  ds_read_b64_tr_b16 v[218:219], v150 offset:35328
  s_mul_i32 s97, s66, 2240
  s_mul_i32 s66, s5, 1310720
  s_add_u32 s96, s96, s66
  s_waitcnt lgkmcnt(15)
  v_mfma_f32_32x32x16_bf16 v[112:127], v[220:223], v[128:131], v[112:127]
  ds_read_b64_tr_b16 v[220:221], v151 offset:34816
  ds_read_b64_tr_b16 v[222:223], v151 offset:35328
  s_mul_i32 s66, s5, 14
  s_min_u32 s66, s66, 40
  s_mul_i32 s66, s66, 40960
  s_add_u32 s97, s97, s66
  s_waitcnt vmcnt(8)
  s_barrier
  s_waitcnt lgkmcnt(14)
  v_mfma_f32_32x32x16_bf16 v[0:15], v[140:143], v[132:135], v[0:15]
  ds_read_b128 v[128:131], v154 offset:32768
  ds_read_b64_tr_b16 v[136:137], v144 offset:49152
  ds_read_b64_tr_b16 v[138:139], v144 offset:49664
  s_and_b32 s66, s65, 12
  s_mul_i32 s66, s66, 80
  s_sub_u32 s96, s96, s66
  s_and_b32 s59, s42, 3
  s_cmp_eq_u32 s59, 1
  s_cselect_b64 vcc, -1, 0
  s_waitcnt lgkmcnt(15)
  v_mfma_f32_32x32x16_bf16 v[16:31], v[196:199], v[132:135], v[16:31]
  ds_read_b64_tr_b16 v[196:197], v145 offset:49152
  ds_read_b64_tr_b16 v[198:199], v145 offset:49664
  s_add_u32 m0, s47, 16384
  s_nop 0
  buffer_load_dwordx4 v160, s[12:15], s44 offen lds
  buffer_load_dwordx4 v161, s[12:15], s44 offen offset:1024 lds
  s_add_u32 s44, s44, s43
  s_sub_u32 s97, s97, s66
  v_lshlrev_b32 v248, 5, v175
  v_add_u32 v248, s65, v248
  s_waitcnt lgkmcnt(15)
  v_mfma_f32_32x32x16_bf16 v[32:47], v[200:203], v[132:135], v[32:47]
  ds_read_b64_tr_b16 v[200:201], v146 offset:49152
  ds_read_b64_tr_b16 v[202:203], v146 offset:49664
  v_mov_b32 v249, 0
  buffer_store_dword v249, v248, s[68:71], 0 offen sc1
  v_mul_u32_u24 v248, 10240, v241
  s_cbranch_vccz L_cs_5_0
  v_lshlrev_b32 v167, 16, v140
  v_and_b32 v168, s46, v140
  v_add_f32 v164, v164, v167
  v_add_f32 v164, v164, v168
  v_lshlrev_b32 v167, 16, v141
  v_and_b32 v168, s46, v141
  v_add_f32 v164, v164, v167
  v_add_f32 v164, v164, v168
L_cs_5_0:
  s_waitcnt lgkmcnt(15)
  v_mfma_f32_32x32x16_bf16 v[48:63], v[204:207], v[132:135], v[48:63]
  ds_read_b64_tr_b16 v[204:205], v147 offset:49152
  ds_read_b64_tr_b16 v[206:207], v147 offset:49664
  v_lshl_add_u32 v248, v240, 6, v248
  v_lshl_add_u32 v248, v242, 4, v248
  s_mul_i32 s66, s5, 40960
  v_add_u32 v248, s66, v248
  s_waitcnt lgkmcnt(15)
  v_mfma_f32_32x32x16_bf16 v[64:79], v[208:211], v[132:135], v[64:79]
  ds_read_b64_tr_b16 v[208:209], v148 offset:49152
  ds_read_b64_tr_b16 v[210:211], v148 offset:49664
  v_bfrev_b32 v249, 2
  v_cmp_eq_u32 s[58:59], s5, v241
  s_nop 1
  v_cndmask_b32 v169, v248, v249, s[58:59]
  s_waitcnt lgkmcnt(15)
  v_mfma_f32_32x32x16_bf16 v[80:95], v[212:215], v[132:135], v[80:95]
  ds_read_b64_tr_b16 v[212:213], v149 offset:49152
  ds_read_b64_tr_b16 v[214:215], v149 offset:49664
  s_lshl_b32 s66, s5, 2
  s_lshl_b32 s56, 0x000f000f, s66
  s_not_b32 s56, s56
  s_cbranch_vccz L_cs_5_1
  v_lshlrev_b32 v167, 16, v142
  v_and_b32 v168, s46, v142
  v_add_f32 v164, v164, v167
  v_add_f32 v164, v164, v168
  v_lshlrev_b32 v167, 16, v143
  v_and_b32 v168, s46, v143
  v_add_f32 v164, v164, v167
  v_add_f32 v164, v164, v168
L_cs_5_1:
  s_waitcnt lgkmcnt(15)
  v_mfma_f32_32x32x16_bf16 v[96:111], v[216:219], v[132:135], v[96:111]
  ds_read_b64_tr_b16 v[216:217], v150 offset:49152
  ds_read_b64_tr_b16 v[218:219], v150 offset:49664
  s_mov_b32 s57, s56
  s_mov_b32 s3, 10485760
  s_and_b32 s66, s40, 3
  s_waitcnt lgkmcnt(15)
  v_mfma_f32_32x32x16_bf16 v[112:127], v[220:223], v[132:135], v[112:127]
  ds_read_b64_tr_b16 v[220:221], v151 offset:49152
  ds_read_b64_tr_b16 v[222:223], v151 offset:49664
  s_mul_i32 s66, s66, 20480
  v_add_u32 v248, 0, v175
  v_mul_u32_u24 v249, 3277, v248
  v_lshrrev_b32 v249, 16, v249
  s_waitcnt lgkmcnt(14)
  v_mfma_f32_32x32x16_bf16 v[0:15], v[136:139], v[128:131], v[0:15]
  ds_read_b128 v[132:135], v155 offset:32768
  ds_read_b64_tr_b16 v[140:141], v144 offset:51200
  ds_read_b64_tr_b16 v[142:143], v144 offset:51712
  v_mul_u32_u24 v250, 20, v249
  v_sub_u32 v248, v248, v250
  v_bfe_u32 v250, v249, 2, 1
  s_waitcnt lgkmcnt(15)
  v_mfma_f32_32x32x16_bf16 v[16:31], v[196:199], v[128:131], v[16:31]
  ds_read_b64_tr_b16 v[196:197], v145 offset:51200
  ds_read_b64_tr_b16 v[198:199], v145 offset:51712
  v_xor_b32 v248, v248, v250
  v_mul_u32_u24 v249, 1280, v249
  v_lshl_add_u32 v248, v248, 4, v249
  s_waitcnt lgkmcnt(15)
  v_mfma_f32_32x32x16_bf16 v[32:47], v[200:203], v[128:131], v[32:47]
  ds_read_b64_tr_b16 v[200:201], v146 offset:51200
  ds_read_b64_tr_b16 v[202:203], v146 offset:51712
  s_sub_u32 s67, s66, 0
  v_add_u32 v188, s67, v248
  v_add_u32 v248, 64, v175
  v_mul_u32_u24 v249, 3277, v248
  s_cbranch_vccz L_cs_6_0
  v_lshlrev_b32 v167, 16, v136
  v_and_b32 v168, s46, v136
  v_add_f32 v164, v164, v167
  v_add_f32 v164, v164, v168
  v_lshlrev_b32 v167, 16, v137
  v_and_b32 v168, s46, v137
  v_add_f32 v164, v164, v167
  v_add_f32 v164, v164, v168
L_cs_6_0:
  s_waitcnt lgkmcnt(15)
  v_mfma_f32_32x32x16_bf16 v[48:63], v[204:207], v[128:131], v[48:63]
  ds_read_b64_tr_b16 v[204:205], v147 offset:51200
  ds_read_b64_tr_b16 v[206:207], v147 offset:51712
  v_lshrrev_b32 v249, 16, v249
  v_mul_u32_u24 v250, 20, v249
  v_sub_u32 v248, v248, v250
  s_waitcnt lgkmcnt(15)
  v_mfma_f32_32x32x16_bf16 v[64:79], v[208:211], v[128:131], v[64:79]
  ds_read_b64_tr_b16 v[208:209], v148 offset:51200
  ds_read_b64_tr_b16 v[210:211], v148 offset:51712
  v_bfe_u32 v250, v249, 2, 1
  v_xor_b32 v248, v248, v250
  v_mul_u32_u24 v249, 1280, v249
  s_waitcnt lgkmcnt(15)
  v_mfma_f32_32x32x16_bf16 v[80:95], v[212:215], v[128:131], v[80:95]
  ds_read_b64_tr_b16 v[212:213], v149 offset:51200
  ds_read_b64_tr_b16 v[214:215], v149 offset:51712
  v_lshl_add_u32 v248, v248, 4, v249
  s_sub_u32 s67, s66, 1024
  v_add_u32 v189, s67, v248
  s_cbranch_vccz L_cs_6_1
  v_lshlrev_b32 v167, 16, v138
  v_and_b32 v168, s46, v138
  v_add_f32 v164, v164, v167
  v_add_f32 v164, v164, v168
  v_lshlrev_b32 v167, 16, v139
  v_and_b32 v168, s46, v139
  v_add_f32 v164, v164, v167
  v_add_f32 v164, v164, v168
L_cs_6_1:
  s_waitcnt lgkmcnt(15)
  v_mfma_f32_32x32x16_bf16 v[96:111], v[216:219], v[128:131], v[96:111]
  ds_read_b64_tr_b16 v[216:217], v150 offset:51200
  ds_read_b64_tr_b16 v[218:219], v150 offset:51712
  v_add_u32 v248, 128, v175
  v_mul_u32_u24 v249, 3277, v248
  v_lshrrev_b32 v249, 16, v249
  v_mul_u32_u24 v250, 20, v249
  s_waitcnt lgkmcnt(15)
  v_mfma_f32_32x32x16_bf16 v[112:127], v[220:223], v[128:131], v[112:127]
  ds_read_b64_tr_b16 v[220:221], v151 offset:51200
  ds_read_b64_tr_b16 v[222:223], v151 offset:51712
  v_sub_u32 v248, v248, v250
  v_bfe_u32 v250, v249, 2, 1
  v_xor_b32 v248, v248, v250
  s_waitcnt vmcnt(7)
  s_barrier
  s_waitcnt lgkmcnt(14)
  v_mfma_f32_32x32x16_bf16 v[0:15], v[140:143], v[132:135], v[0:15]
  s_waitcnt vmcnt(3)
  ds_read_b128 v[128:131], v152 offset:0
  ds_read_b64_tr_b16 v[136:137], v144 offset:0
  ds_read_b64_tr_b16 v[138:139], v144 offset:512
  v_mul_u32_u24 v249, 1280, v249
  v_lshl_add_u32 v248, v248, 4, v249
  s_sub_u32 s67, s66, 2048
  s_waitcnt lgkmcnt(15)
  v_mfma_f32_32x32x16_bf16 v[16:31], v[196:199], v[132:135], v[16:31]
  ds_read_b64_tr_b16 v[196:197], v145 offset:0
  ds_read_b64_tr_b16 v[198:199], v145 offset:512
  s_add_u32 m0, s47, 32768
  s_nop 0
  buffer_load_dwordx4 v160, s[12:15], s44 offen lds
  buffer_load_dwordx4 v161, s[12:15], s44 offen offset:1024 lds
  s_add_u32 s44, s44, s43
  v_add_u32 v190, s67, v248
  v_add_u32 v248, 192, v175
  v_mul_u32_u24 v249, 3277, v248
  s_waitcnt lgkmcnt(15)
  v_mfma_f32_32x32x16_bf16 v[32:47], v[200:203], v[132:135], v[32:47]
  ds_read_b64_tr_b16 v[200:201], v146 offset:0
  ds_read_b64_tr_b16 v[202:203], v146 offset:512
  v_lshrrev_b32 v249, 16, v249
  v_mul_u32_u24 v250, 20, v249
  v_sub_u32 v248, v248, v250
  v_bfe_u32 v250, v249, 2, 1
  s_cbranch_vccz L_cs_7_0
  v_lshlrev_b32 v167, 16, v140
  v_and_b32 v168, s46, v140
  v_add_f32 v164, v164, v167
  v_add_f32 v164, v164, v168
  v_lshlrev_b32 v167, 16, v141
  v_and_b32 v168, s46, v141
  v_add_f32 v164, v164, v167
  v_add_f32 v164, v164, v168
L_cs_7_0:
  s_waitcnt lgkmcnt(15)
  v_mfma_f32_32x32x16_bf16 v[48:63], v[204:207], v[132:135], v[48:63]
  ds_read_b64_tr_b16 v[204:205], v147 offset:0
  ds_read_b64_tr_b16 v[206:207], v147 offset:512
  v_xor_b32 v248, v248, v250
  v_mul_u32_u24 v249, 1280, v249
  v_lshl_add_u32 v248, v248, 4, v249
  s_waitcnt lgkmcnt(15)
  v_mfma_f32_32x32x16_bf16 v[64:79], v[208:211], v[132:135], v[64:79]
  ds_read_b64_tr_b16 v[208:209], v148 offset:0
  ds_read_b64_tr_b16 v[210:211], v148 offset:512
  s_add_u32 m0, s48, 32768
  s_nop 0
  buffer_load_dwordx4 v156, s[8:11], s45 offen offset:0 lds
  buffer_load_dwordx4 v157, s[8:11], s45 offen offset:1024 lds
  buffer_load_dwordx4 v158, s[8:11], s45 offen offset:2048 lds
  buffer_load_dwordx4 v159, s[8:11], s45 offen offset:3072 lds
  s_add_u32 s45, s45, 128
  s_sub_u32 s67, s66, 0
  v_add_u32 v191, s67, v248
  v_add_u32 v248, 256, v175
  s_waitcnt lgkmcnt(15)
  v_mfma_f32_32x32x16_bf16 v[80:95], v[212:215], v[132:135], v[80:95]
  ds_read_b64_tr_b16 v[212:213], v149 offset:0
  ds_read_b64_tr_b16 v[214:215], v149 offset:512
  v_mul_u32_u24 v249, 3277, v248
  v_lshrrev_b32 v249, 16, v249
  v_mul_u32_u24 v250, 20, v249
  s_cbranch_vccz L_cs_7_1
  v_lshlrev_b32 v167, 16, v142
  v_and_b32 v168, s46, v142
  v_add_f32 v164, v164, v167
  v_add_f32 v164, v164, v168
  v_lshlrev_b32 v167, 16, v143
  v_and_b32 v168, s46, v143
  v_add_f32 v164, v164, v167
  v_add_f32 v164, v164, v168
L_cs_7_1:
  s_waitcnt lgkmcnt(15)
  v_mfma_f32_32x32x16_bf16 v[96:111], v[216:219], v[132:135], v[96:111]
  ds_read_b64_tr_b16 v[216:217], v150 offset:0
  ds_read_b64_tr_b16 v[218:219], v150 offset:512
  v_sub_u32 v248, v248, v250
  v_bfe_u32 v250, v249, 2, 1
  v_xor_b32 v248, v248, v250
  v_mul_u32_u24 v249, 1280, v249
  s_waitcnt lgkmcnt(15)
  v_mfma_f32_32x32x16_bf16 v[112:127], v[220:223], v[132:135], v[112:127]
  ds_read_b64_tr_b16 v[220:221], v151 offset:0
  ds_read_b64_tr_b16 v[222:223], v151 offset:512
  v_lshl_add_u32 v248, v248, 4, v249
  s_sub_u32 s67, s66, 1024
  v_add_u32 v170, s67, v248
  s_waitcnt lgkmcnt(14)
  v_mfma_f32_32x32x16_bf16 v[0:15], v[136:139], v[128:131], v[0:15]
  ds_read_b128 v[132:135], v153 offset:0
  ds_read_b64_tr_b16 v[140:141], v144 offset:2048
  ds_read_b64_tr_b16 v[142:143], v144 offset:2560
  v_lshlrev_b32 v165, 16, v228
  s_waitcnt lgkmcnt(15)
  v_mfma_f32_32x32x16_bf16 v[16:31], v[196:199], v[128:131], v[16:31]
  ds_read_b64_tr_b16 v[196:197], v145 offset:2048
  ds_read_b64_tr_b16 v[198:199], v145 offset:2560
  v_and_b32 v166, s46, v228
  s_waitcnt lgkmcnt(15)
  v_mfma_f32_32x32x16_bf16 v[32:47], v[200:203], v[128:131], v[32:47]
  ds_read_b64_tr_b16 v[200:201], v146 offset:2048
  ds_read_b64_tr_b16 v[202:203], v146 offset:2560
  v_add_f32 v162, v162, v165
  s_cbranch_vccz L_cs_8_0
  v_lshlrev_b32 v167, 16, v136
  v_and_b32 v168, s46, v136
  v_add_f32 v164, v164, v167
  v_add_f32 v164, v164, v168
  v_lshlrev_b32 v167, 16, v137
  v_and_b32 v168, s46, v137
  v_add_f32 v164, v164, v167
  v_add_f32 v164, v164, v168
L_cs_8_0:
  s_waitcnt lgkmcnt(15)
  v_mfma_f32_32x32x16_bf16 v[48:63], v[204:207], v[128:131], v[48:63]
  ds_read_b64_tr_b16 v[204:205], v147 offset:2048
  ds_read_b64_tr_b16 v[206:207], v147 offset:2560
  v_fmac_f32 v163, v165, v165
  v_add_f32 v162, v162, v166
  s_waitcnt lgkmcnt(15)
  v_mfma_f32_32x32x16_bf16 v[64:79], v[208:211], v[128:131], v[64:79]
  ds_read_b64_tr_b16 v[208:209], v148 offset:2048
  ds_read_b64_tr_b16 v[210:211], v148 offset:2560
  v_fmac_f32 v163, v166, v166
  s_waitcnt lgkmcnt(15)
  v_mfma_f32_32x32x16_bf16 v[80:95], v[212:215], v[128:131], v[80:95]
  ds_read_b64_tr_b16 v[212:213], v149 offset:2048
  ds_read_b64_tr_b16 v[214:215], v149 offset:2560
  v_lshlrev_b32 v165, 16, v229
  s_cbranch_vccz L_cs_8_1
  v_lshlrev_b32 v167, 16, v138
  v_and_b32 v168, s46, v138
  v_add_f32 v164, v164, v167
  v_add_f32 v164, v164, v168
  v_lshlrev_b32 v167, 16, v139
  v_and_b32 v168, s46, v139
  v_add_f32 v164, v164, v167
  v_add_f32 v164, v164, v168
L_cs_8_1:
  s_waitcnt lgkmcnt(15)
  v_mfma_f32_32x32x16_bf16 v[96:111], v[216:219], v[128:131], v[96:111]
  ds_read_b64_tr_b16 v[216:217], v150 offset:2048
  ds_read_b64_tr_b16 v[218:219], v150 offset:2560
  v_and_b32 v166, s46, v229
  s_waitcnt lgkmcnt(15)
  v_mfma_f32_32x32x16_bf16 v[112:127], v[220:223], v[128:131], v[112:127]
  ds_read_b64_tr_b16 v[220:221], v151 offset:2048
  ds_read_b64_tr_b16 v[222:223], v151 offset:2560
  v_add_f32 v162, v162, v165
  s_waitcnt vmcnt(7)
  s_barrier
  s_waitcnt lgkmcnt(14)
  v_mfma_f32_32x32x16_bf16 v[0:15], v[140:143], v[132:135], v[0:15]
  ds_read_b128 v[128:131], v154 offset:0
  ds_read_b64_tr_b16 v[136:137], v144 offset:16384
  ds_read_b64_tr_b16 v[138:139], v144 offset:16896
  v_fmac_f32 v163, v165, v165
  s_waitcnt lgkmcnt(15)
  v_mfma_f32_32x32x16_bf16 v[16:31], v[196:199], v[132:135], v[16:31]
  ds_read_b64_tr_b16 v[196:197], v145 offset:16384
  ds_read_b64_tr_b16 v[198:199], v145 offset:16896
  s_add_u32 m0, s47, 49152
  s_nop 0
  buffer_load_dwordx4 v160, s[12:15], s44 offen lds
  buffer_load_dwordx4 v161, s[12:15], s44 offen offset:1024 lds
  s_add_u32 s44, s44, s43
  v_add_f32 v162, v162, v166
  s_waitcnt lgkmcnt(15)
  v_mfma_f32_32x32x16_bf16 v[32:47], v[200:203], v[132:135], v[32:47]
  ds_read_b64_tr_b16 v[200:201], v146 offset:16384
  ds_read_b64_tr_b16 v[202:203], v146 offset:16896
  v_fmac_f32 v163, v166, v166
  v_lshlrev_b32 v165, 16, v230
  s_cbranch_vccz L_cs_9_0
  v_lshlrev_b32 v167, 16, v140
  v_and_b32 v168, s46, v140
  v_add_f32 v164, v164, v167
  v_add_f32 v164, v164, v168
  v_lshlrev_b32 v167, 16, v141
  v_and_b32 v168, s46, v141
  v_add_f32 v164, v164, v167
  v_add_f32 v164, v164, v168
L_cs_9_0:
  s_waitcnt lgkmcnt(15)
  v_mfma_f32_32x32x16_bf16 v[48:63], v[204:207], v[132:135], v[48:63]
  ds_read_b64_tr_b16 v[204:205], v147 offset:16384
  ds_read_b64_tr_b16 v[206:207], v147 offset:16896
  v_and_b32 v166, s46, v230
  s_waitcnt lgkmcnt(15)
  v_mfma_f32_32x32x16_bf16 v[64:79], v[208:211], v[132:135], v[64:79]
  ds_read_b64_tr_b16 v[208:209], v148 offset:16384
  ds_read_b64_tr_b16 v[210:211], v148 offset:16896
  v_add_f32 v162, v162, v165
  s_waitcnt lgkmcnt(15)
  v_mfma_f32_32x32x16_bf16 v[80:95], v[212:215], v[132:135], v[80:95]
  ds_read_b64_tr_b16 v[212:213], v149 offset:16384
  ds_read_b64_tr_b16 v[214:215], v149 offset:16896
  v_fmac_f32 v163, v165, v165
  s_cbranch_vccz L_cs_9_1
  v_lshlrev_b32 v167, 16, v142
  v_and_b32 v168, s46, v142
  v_add_f32 v164, v164, v167
  v_add_f32 v164, v164, v168
  v_lshlrev_b32 v167, 16, v143
  v_and_b32 v168, s46, v143
  v_add_f32 v164, v164, v167
  v_add_f32 v164, v164, v168
L_cs_9_1:
  s_waitcnt lgkmcnt(15)
  v_mfma_f32_32x32x16_bf16 v[96:111], v[216:219], v[132:135], v[96:111]
  ds_read_b64_tr_b16 v[216:217], v150 offset:16384
  ds_read_b64_tr_b16 v[218:219], v150 offset:16896
  v_add_f32 v162, v162, v166
  s_waitcnt lgkmcnt(15)
  v_mfma_f32_32x32x16_bf16 v[112:127], v[220:223], v[132:135], v[112:127]
  ds_read_b64_tr_b16 v[220:221], v151 offset:16384
  ds_read_b64_tr_b16 v[222:223], v151 offset:16896
  v_fmac_f32 v163, v166, v166
  s_waitcnt lgkmcnt(14)
  v_mfma_f32_32x32x16_bf16 v[0:15], v[136:139], v[128:131], v[0:15]
  ds_read_b128 v[132:135], v155 offset:0
  ds_read_b64_tr_b16 v[140:141], v144 offset:18432
  ds_read_b64_tr_b16 v[142:143], v144 offset:18944
  v_lshlrev_b32 v165, 16, v231
  s_and_b32 s59, s42, 3
  s_cmp_eq_u32 s59, 2
  s_cselect_b64 vcc, -1, 0
  s_waitcnt lgkmcnt(15)
  v_mfma_f32_32x32x16_bf16 v[16:31], v[196:199], v[128:131], v[16:31]
  ds_read_b64_tr_b16 v[196:197], v145 offset:18432
  ds_read_b64_tr_b16 v[198:199], v145 offset:18944
  v_and_b32 v166, s46, v231
  v_add_f32 v162, v162, v165
  s_waitcnt lgkmcnt(15)
  v_mfma_f32_32x32x16_bf16 v[32:47], v[200:203], v[128:131], v[32:47]
  ds_read_b64_tr_b16 v[200:201], v146 offset:18432
  ds_read_b64_tr_b16 v[202:203], v146 offset:18944
  v_fmac_f32 v163, v165, v165
  s_cbranch_vccz L_cs_10_0
  v_lshlrev_b32 v167, 16, v136
  v_and_b32 v168, s46, v136
  v_add_f32 v164, v164, v167
  v_add_f32 v164, v164, v168
  v_lshlrev_b32 v167, 16, v137
  v_and_b32 v168, s46, v137
  v_add_f32 v164, v164, v167
  v_add_f32 v164, v164, v168
L_cs_10_0:
  s_waitcnt lgkmcnt(15)
  v_mfma_f32_32x32x16_bf16 v[48:63], v[204:207], v[128:131], v[48:63]
  ds_read_b64_tr_b16 v[204:205], v147 offset:18432
  ds_read_b64_tr_b16 v[206:207], v147 offset:18944
  v_add_f32 v162, v162, v166
  s_waitcnt lgkmcnt(15)
  v_mfma_f32_32x32x16_bf16 v[64:79], v[208:211], v[128:131], v[64:79]
  ds_read_b64_tr_b16 v[208:209], v148 offset:18432
  ds_read_b64_tr_b16 v[210:211], v148 offset:18944
  v_fmac_f32 v163, v166, v166
  s_waitcnt lgkmcnt(15)
  v_mfma_f32_32x32x16_bf16 v[80:95], v[212:215], v[128:131], v[80:95]
  ds_read_b64_tr_b16 v[212:213], v149 offset:18432
  ds_read_b64_tr_b16 v[214:215], v149 offset:18944
  v_lshlrev_b32 v165, 16, v232
  s_cbranch_vccz L_cs_10_1
  v_lshlrev_b32 v167, 16, v138
  v_and_b32 v168, s46, v138
  v_add_f32 v164, v164, v167
  v_add_f32 v164, v164, v168
  v_lshlrev_b32 v167, 16, v139
  v_and_b32 v168, s46, v139
  v_add_f32 v164, v164, v167
  v_add_f32 v164, v164, v168
L_cs_10_1:
  s_waitcnt lgkmcnt(15)
  v_mfma_f32_32x32x16_bf16 v[96:111], v[216:219], v[128:131], v[96:111]
  ds_read_b64_tr_b16 v[216:217], v150 offset:18432
  ds_read_b64_tr_b16 v[218:219], v150 offset:18944
  v_and_b32 v166, s46, v232
  s_waitcnt lgkmcnt(15)
  v_mfma_f32_32x32x16_bf16 v[112:127], v[220:223], v[128:131], v[112:127]
  ds_read_b64_tr_b16 v[220:221], v151 offset:18432
  ds_read_b64_tr_b16 v[222:223], v151 offset:18944
  v_add_f32 v162, v162, v165
  s_waitcnt vmcnt(6)
  s_barrier
  s_waitcnt lgkmcnt(14)
  v_mfma_f32_32x32x16_bf16 v[0:15], v[140:143], v[132:135], v[0:15]
  s_waitcnt vmcnt(2)
  ds_read_b128 v[128:131], v152 offset:32768
  ds_read_b64_tr_b16 v[136:137], v144 offset:32768
  ds_read_b64_tr_b16 v[138:139], v144 offset:33280
  v_fmac_f32 v163, v165, v165
  v_add_f32 v162, v162, v166
  s_waitcnt lgkmcnt(15)
  v_mfma_f32_32x32x16_bf16 v[16:31], v[196:199], v[132:135], v[16:31]
  ds_read_b64_tr_b16 v[196:197], v145 offset:32768
  ds_read_b64_tr_b16 v[198:199], v145 offset:33280
  s_add_u32 m0, s47, 0
  s_nop 0
  buffer_load_dwordx4 v160, s[12:15], s44 offen lds
  buffer_load_dwordx4 v161, s[12:15], s44 offen offset:1024 lds
  s_add_u32 s44, s44, s43
  v_fmac_f32 v163, v166, v166
  s_waitcnt lgkmcnt(15)
  v_mfma_f32_32x32x16_bf16 v[32:47], v[200:203], v[132:135], v[32:47]
  ds_read_b64_tr_b16 v[200:201], v146 offset:32768
  ds_read_b64_tr_b16 v[202:203], v146 offset:33280
  v_add_f32_dpp v162, v162, v162 row_ror:1 row_mask:0xf bank_mask:0xf
  s_cbranch_vccz L_cs_11_0
  v_lshlrev_b32 v167, 16, v140
  v_and_b32 v168, s46, v140
  v_add_f32 v164, v164, v167
  v_add_f32 v164, v164, v168
  v_lshlrev_b32 v167, 16, v141
  v_and_b32 v168, s46, v141
  v_add_f32 v164, v164, v167
  v_add_f32 v164, v164, v168
L_cs_11_0:
  s_waitcnt lgkmcnt(15)
  v_mfma_f32_32x32x16_bf16 v[48:63], v[204:207], v[132:135], v[48:63]
  ds_read_b64_tr_b16 v[204:205], v147 offset:32768
  ds_read_b64_tr_b16 v[206:207], v147 offset:33280
  v_add_f32_dpp v163, v163, v163 row_ror:1 row_mask:0xf bank_mask:0xf
  s_waitcnt lgkmcnt(15)
  v_mfma_f32_32x32x16_bf16 v[64:79], v[208:211], v[132:135], v[64:79]
  ds_read_b64_tr_b16 v[208:209], v148 offset:32768
  ds_read_b64_tr_b16 v[210:211], v148 offset:33280
  s_add_u32 m0, s48, 0
  s_nop 0
  buffer_load_dwordx4 v156, s[8:11], s45 offen offset:0 lds
  buffer_load_dwordx4 v157, s[8:11], s45 offen offset:1024 lds
  buffer_load_dwordx4 v158, s[8:11], s45 offen offset:2048 lds
  buffer_load_dwordx4 v159, s[8:11], s45 offen offset:3072 lds
  s_add_u32 s45, s45, 128
  s_bitcmp1_b32 s2, 0
  s_cselect_b32 s45, 0, s45
  v_add_f32_dpp v162, v162, v162 row_ror:2 row_mask:0xf bank_mask:0xf
  s_waitcnt lgkmcnt(15)
  v_mfma_f32_32x32x16_bf16 v[80:95], v[212:215], v[132:135], v[80:95]
  ds_read_b64_tr_b16 v[212:213], v149 offset:32768
  ds_read_b64_tr_b16 v[214:215], v149 offset:33280
  v_add_f32_dpp v163, v163, v163 row_ror:2 row_mask:0xf bank_mask:0xf
  s_cbranch_vccz L_cs_11_1
  v_lshlrev_b32 v167, 16, v142
  v_and_b32 v168, s46, v142
  v_add_f32 v164, v164, v167
  v_add_f32 v164, v164, v168
  v_lshlrev_b32 v167, 16, v143
  v_and_b32 v168, s46, v143
  v_add_f32 v164, v164, v167
  v_add_f32 v164, v164, v168
L_cs_11_1:
  s_waitcnt lgkmcnt(15)
  v_mfma_f32_32x32x16_bf16 v[96:111], v[216:219], v[132:135], v[96:111]
  ds_read_b64_tr_b16 v[216:217], v150 offset:32768
  ds_read_b64_tr_b16 v[218:219], v150 offset:33280
  v_add_f32_dpp v162, v162, v162 row_ror:4 row_mask:0xf bank_mask:0xf
  s_waitcnt lgkmcnt(15)
  v_mfma_f32_32x32x16_bf16 v[112:127], v[220:223], v[132:135], v[112:127]
  ds_read_b64_tr_b16 v[220:221], v151 offset:32768
  ds_read_b64_tr_b16 v[222:223], v151 offset:33280
  v_add_f32_dpp v163, v163, v163 row_ror:4 row_mask:0xf bank_mask:0xf
  s_waitcnt lgkmcnt(14)
  v_mfma_f32_32x32x16_bf16 v[0:15], v[136:139], v[128:131], v[0:15]
  ds_read_b128 v[132:135], v153 offset:32768
  ds_read_b64_tr_b16 v[140:141], v144 offset:34816
  ds_read_b64_tr_b16 v[142:143], v144 offset:35328
  v_add_f32_dpp v162, v162, v162 row_ror:8 row_mask:0xf bank_mask:0xf
  v_add_f32_dpp v163, v163, v163 row_ror:8 row_mask:0xf bank_mask:0xf
  s_waitcnt lgkmcnt(15)
  v_mfma_f32_32x32x16_bf16 v[16:31], v[196:199], v[128:131], v[16:31]
  ds_read_b64_tr_b16 v[196:197], v145 offset:34816
  ds_read_b64_tr_b16 v[198:199], v145 offset:35328
  v_mov_b32 v165, v162
  s_waitcnt lgkmcnt(15)
  v_mfma_f32_32x32x16_bf16 v[32:47], v[200:203], v[128:131], v[32:47]
  ds_read_b64_tr_b16 v[200:201], v146 offset:34816
  ds_read_b64_tr_b16 v[202:203], v146 offset:35328
  v_mov_b32 v166, v163
  s_cbranch_vccz L_cs_12_0
  v_lshlrev_b32 v167, 16, v136
  v_and_b32 v168, s46, v136
  v_add_f32 v164, v164, v167
  v_add_f32 v164, v164, v168
  v_lshlrev_b32 v167, 16, v137
  v_and_b32 v168, s46, v137
  v_add_f32 v164, v164, v167
  v_add_f32 v164, v164, v168
L_cs_12_0:
  s_waitcnt lgkmcnt(15)
  v_mfma_f32_32x32x16_bf16 v[48:63], v[204:207], v[128:131], v[48:63]
  ds_read_b64_tr_b16 v[204:205], v147 offset:34816
  ds_read_b64_tr_b16 v[206:207], v147 offset:35328
  v_permlane16_swap_b32 v165, v162
  s_waitcnt lgkmcnt(15)
  v_mfma_f32_32x32x16_bf16 v[64:79], v[208:211], v[128:131], v[64:79]
  ds_read_b64_tr_b16 v[208:209], v148 offset:34816
  ds_read_b64_tr_b16 v[210:211], v148 offset:35328
  v_permlane16_swap_b32 v166, v163
  s_waitcnt lgkmcnt(15)
  v_mfma_f32_32x32x16_bf16 v[80:95], v[212:215], v[128:131], v[80:95]
  ds_read_b64_tr_b16 v[212:213], v149 offset:34816
  ds_read_b64_tr_b16 v[214:215], v149 offset:35328
  v_add_f32 v162, v162, v165
  s_cbranch_vccz L_cs_12_1
  v_lshlrev_b32 v167, 16, v138
  v_and_b32 v168, s46, v138
  v_add_f32 v164, v164, v167
  v_add_f32 v164, v164, v168
  v_lshlrev_b32 v167, 16, v139
  v_and_b32 v168, s46, v139
  v_add_f32 v164, v164, v167
  v_add_f32 v164, v164, v168
L_cs_12_1:
  s_waitcnt lgkmcnt(15)
  v_mfma_f32_32x32x16_bf16 v[96:111], v[216:219], v[128:131], v[96:111]
  ds_read_b64_tr_b16 v[216:217], v150 offset:34816
  ds_read_b64_tr_b16 v[218:219], v150 offset:35328
  v_add_f32 v163, v163, v166
  s_waitcnt lgkmcnt(15)
  v_mfma_f32_32x32x16_bf16 v[112:127], v[220:223], v[128:131], v[112:127]
  ds_read_b64_tr_b16 v[220:221], v151 offset:34816
  ds_read_b64_tr_b16 v[222:223], v151 offset:35328
  v_mov_b32 v165, v162
  v_mov_b32 v166, v163
  s_waitcnt vmcnt(6)
  s_barrier
  s_waitcnt lgkmcnt(14)
  v_mfma_f32_32x32x16_bf16 v[0:15], v[140:143], v[132:135], v[0:15]
  ds_read_b128 v[128:131], v154 offset:32768
  ds_read_b64_tr_b16 v[136:137], v144 offset:49152
  ds_read_b64_tr_b16 v[138:139], v144 offset:49664
  v_permlane32_swap_b32 v165, v162
  s_waitcnt lgkmcnt(15)
  v_mfma_f32_32x32x16_bf16 v[16:31], v[196:199], v[132:135], v[16:31]
  ds_read_b64_tr_b16 v[196:197], v145 offset:49152
  ds_read_b64_tr_b16 v[198:199], v145 offset:49664
  s_add_u32 m0, s47, 16384
  s_nop 0
  buffer_load_dwordx4 v160, s[12:15], s44 offen lds
  buffer_load_dwordx4 v161, s[12:15], s44 offen offset:1024 lds
  s_add_u32 s44, s44, s43
  s_bitcmp1_b32 s2, 0
  s_cselect_b32 s44, 0, s44
  v_permlane32_swap_b32 v166, v163
  s_waitcnt lgkmcnt(15)
  v_mfma_f32_32x32x16_bf16 v[32:47], v[200:203], v[132:135], v[32:47]
  ds_read_b64_tr_b16 v[200:201], v146 offset:49152
  ds_read_b64_tr_b16 v[202:203], v146 offset:49664
  v_add_f32 v162, v162, v165
  s_cbranch_vccz L_cs_13_0
  v_lshlrev_b32 v167, 16, v140
  v_and_b32 v168, s46, v140
  v_add_f32 v164, v164, v167
  v_add_f32 v164, v164, v168
  v_lshlrev_b32 v167, 16, v141
  v_and_b32 v168, s46, v141
  v_add_f32 v164, v164, v167
  v_add_f32 v164, v164, v168
L_cs_13_0:
  s_waitcnt lgkmcnt(15)
  v_mfma_f32_32x32x16_bf16 v[48:63], v[204:207], v[132:135], v[48:63]
  ds_read_b64_tr_b16 v[204:205], v147 offset:49152
  ds_read_b64_tr_b16 v[206:207], v147 offset:49664
  v_add_f32 v163, v163, v166
  s_waitcnt lgkmcnt(15)
  v_mfma_f32_32x32x16_bf16 v[64:79], v[208:211], v[132:135], v[64:79]
  ds_read_b64_tr_b16 v[208:209], v148 offset:49152
  ds_read_b64_tr_b16 v[210:211], v148 offset:49664
  v_mul_f32 v162, 0x3acccccd, v162
  s_waitcnt lgkmcnt(15)
  v_mfma_f32_32x32x16_bf16 v[80:95], v[212:215], v[132:135], v[80:95]
  ds_read_b64_tr_b16 v[212:213], v149 offset:49152
  ds_read_b64_tr_b16 v[214:215], v149 offset:49664
  v_mul_f32 v163, 0x3acccccd, v163
  s_cbranch_vccz L_cs_13_1
  v_lshlrev_b32 v167, 16, v142
  v_and_b32 v168, s46, v142
  v_add_f32 v164, v164, v167
  v_add_f32 v164, v164, v168
  v_lshlrev_b32 v167, 16, v143
  v_and_b32 v168, s46, v143
  v_add_f32 v164, v164, v167
  v_add_f32 v164, v164, v168
L_cs_13_1:
  s_waitcnt lgkmcnt(15)
  v_mfma_f32_32x32x16_bf16 v[96:111], v[216:219], v[132:135], v[96:111]
  ds_read_b64_tr_b16 v[216:217], v150 offset:49152
  ds_read_b64_tr_b16 v[218:219], v150 offset:49664
  v_fma_f32 v163, -v162, v162, v163
  v_max_f32 v163, 0, v163
  s_waitcnt lgkmcnt(15)
  v_mfma_f32_32x32x16_bf16 v[112:127], v[220:223], v[132:135], v[112:127]
  ds_read_b64_tr_b16 v[220:221], v151 offset:49152
  ds_read_b64_tr_b16 v[222:223], v151 offset:49664
  v_cvt_pk_bf16_f32 v236, -v162, -v162
  s_waitcnt lgkmcnt(14)
  v_mfma_f32_32x32x16_bf16 v[0:15], v[136:139], v[128:131], v[0:15]
  ds_read_b128 v[132:135], v155 offset:32768
  ds_read_b64_tr_b16 v[140:141], v144 offset:51200
  ds_read_b64_tr_b16 v[142:143], v144 offset:51712
  v_cvt_pk_bf16_f32 v165, v163, v163
  s_waitcnt lgkmcnt(15)
  v_mfma_f32_32x32x16_bf16 v[16:31], v[196:199], v[128:131], v[16:31]
  ds_read_b64_tr_b16 v[196:197], v145 offset:51200
  ds_read_b64_tr_b16 v[198:199], v145 offset:51712
  v_and_b32 v165, s46, v165
  s_waitcnt lgkmcnt(15)
  v_mfma_f32_32x32x16_bf16 v[32:47], v[200:203], v[128:131], v[32:47]
  ds_read_b64_tr_b16 v[200:201], v146 offset:51200
  ds_read_b64_tr_b16 v[202:203], v146 offset:51712
  v_add_f32 v165, 0x3727c5ac, v165
  s_cbranch_vccz L_cs_14_0
  v_lshlrev_b32 v167, 16, v136
  v_and_b32 v168, s46, v136
  v_add_f32 v164, v164, v167
  v_add_f32 v164, v164, v168
  v_lshlrev_b32 v167, 16, v137
  v_and_b32 v168, s46, v137
  v_add_f32 v164, v164, v167
  v_add_f32 v164, v164, v168
L_cs_14_0:
  s_waitcnt lgkmcnt(15)
  v_mfma_f32_32x32x16_bf16 v[48:63], v[204:207], v[128:131], v[48:63]
  ds_read_b64_tr_b16 v[204:205], v147 offset:51200
  ds_read_b64_tr_b16 v[206:207], v147 offset:51712
  v_cvt_pk_bf16_f32 v165, v165, v165
  s_waitcnt lgkmcnt(15)
  v_mfma_f32_32x32x16_bf16 v[64:79], v[208:211], v[128:131], v[64:79]
  ds_read_b64_tr_b16 v[208:209], v148 offset:51200
  ds_read_b64_tr_b16 v[210:211], v148 offset:51712
  v_and_b32 v165, s46, v165
  s_waitcnt lgkmcnt(15)
  v_mfma_f32_32x32x16_bf16 v[80:95], v[212:215], v[128:131], v[80:95]
  ds_read_b64_tr_b16 v[212:213], v149 offset:51200
  ds_read_b64_tr_b16 v[214:215], v149 offset:51712
  v_sqrt_f32 v165, v165
  s_nop 0
  v_cvt_pk_bf16_f32 v165, v165, v165
  s_cbranch_vccz L_cs_14_1
  v_lshlrev_b32 v167, 16, v138
  v_and_b32 v168, s46, v138
  v_add_f32 v164, v164, v167
  v_add_f32 v164, v164, v168
  v_lshlrev_b32 v167, 16, v139
  v_and_b32 v168, s46, v139
  v_add_f32 v164, v164, v167
  v_add_f32 v164, v164, v168
L_cs_14_1:
  s_waitcnt lgkmcnt(15)
  v_mfma_f32_32x32x16_bf16 v[96:111], v[216:219], v[128:131], v[96:111]
  ds_read_b64_tr_b16 v[216:217], v150 offset:51200
  ds_read_b64_tr_b16 v[218:219], v150 offset:51712
  v_and_b32 v165, s46, v165
  s_waitcnt lgkmcnt(15)
  v_mfma_f32_32x32x16_bf16 v[112:127], v[220:223], v[128:131], v[112:127]
  ds_read_b64_tr_b16 v[220:221], v151 offset:51200
  ds_read_b64_tr_b16 v[222:223], v151 offset:51712
  v_rcp_f32 v166, v165
  s_waitcnt vmcnt(6)
  s_barrier
  s_waitcnt lgkmcnt(14)
  v_mfma_f32_32x32x16_bf16 v[0:15], v[140:143], v[132:135], v[0:15]
  s_waitcnt vmcnt(2)
  ds_read_b128 v[128:131], v152 offset:0
  ds_read_b64_tr_b16 v[136:137], v144 offset:0
  ds_read_b64_tr_b16 v[138:139], v144 offset:512
  v_mul_f32 v239, v165, v165
  s_and_b32 s59, s42, 3
  s_cmp_eq_u32 s59, 3
  s_cselect_b64 vcc, -1, 0
  s_waitcnt lgkmcnt(15)
  v_mfma_f32_32x32x16_bf16 v[16:31], v[196:199], v[132:135], v[16:31]
  ds_read_b64_tr_b16 v[196:197], v145 offset:0
  ds_read_b64_tr_b16 v[198:199], v145 offset:512
  s_add_u32 m0, s47, 32768
  s_nop 0
  buffer_load_dwordx4 v160, s[12:15], s44 offen lds
  buffer_load_dwordx4 v161, s[12:15], s44 offen offset:1024 lds
  s_add_u32 s44, s44, s43
  v_mul_f32 v237, 0x3e0293ee, v166
  s_waitcnt lgkmcnt(15)
  v_mfma_f32_32x32x16_bf16 v[32:47], v[200:203], v[132:135], v[32:47]
  ds_read_b64_tr_b16 v[200:201], v146 offset:0
  ds_read_b64_tr_b16 v[202:203], v146 offset:512
  v_mul_f32 v238, 0xbfb8aa3b, v166
  s_cbranch_vccz L_cs_15_0
  v_lshlrev_b32 v167, 16, v140
  v_and_b32 v168, s46, v140
  v_add_f32 v164, v164, v167
  v_add_f32 v164, v164, v168
  v_lshlrev_b32 v167, 16, v141
  v_and_b32 v168, s46, v141
  v_add_f32 v164, v164, v167
  v_add_f32 v164, v164, v168
L_cs_15_0:
  s_waitcnt lgkmcnt(15)
  v_mfma_f32_32x32x16_bf16 v[48:63], v[204:207], v[132:135], v[48:63]
  ds_read_b64_tr_b16 v[204:205], v147 offset:0
  ds_read_b64_tr_b16 v[206:207], v147 offset:512
  s_lshl_b32 s64, s42, 3
  s_waitcnt lgkmcnt(15)
  v_mfma_f32_32x32x16_bf16 v[64:79], v[208:211], v[132:135], v[64:79]
  ds_read_b64_tr_b16 v[208:209], v148 offset:0
  ds_read_b64_tr_b16 v[210:211], v148 offset:512
  s_add_u32 m0, s48, 32768
  s_nop 0
  buffer_load_dwordx4 v156, s[8:11], s45 offen offset:0 lds
  buffer_load_dwordx4 v157, s[8:11], s45 offen offset:1024 lds
  buffer_load_dwordx4 v158, s[8:11], s45 offen offset:2048 lds
  buffer_load_dwordx4 v159, s[8:11], s45 offen offset:3072 lds
  s_add_u32 s45, s45, 128
  s_add_u32 s64, s64, s40
  s_lshl_b32 s64, s64, 9
  s_waitcnt lgkmcnt(15)
  v_mfma_f32_32x32x16_bf16 v[80:95], v[212:215], v[132:135], v[80:95]
  ds_read_b64_tr_b16 v[212:213], v149 offset:0
  ds_read_b64_tr_b16 v[214:215], v149 offset:512
  v_lshl_add_u32 v165, v175, 24, s64
  s_cbranch_vccz L_cs_15_1
  v_lshlrev_b32 v167, 16, v142
  v_and_b32 v168, s46, v142
  v_add_f32 v164, v164, v167
  v_add_f32 v164, v164, v168
  v_lshlrev_b32 v167, 16, v143
  v_and_b32 v168, s46, v143
  v_add_f32 v164, v164, v167
  v_add_f32 v164, v164, v168
L_cs_15_1:
  s_waitcnt lgkmcnt(15)
  v_mfma_f32_32x32x16_bf16 v[96:111], v[216:219], v[132:135], v[96:111]
  ds_read_b64_tr_b16 v[216:217], v150 offset:0
  ds_read_b64_tr_b16 v[218:219], v150 offset:512
  s_lshl_b32 s64, s41, 4
  s_waitcnt lgkmcnt(15)
  v_mfma_f32_32x32x16_bf16 v[112:127], v[220:223], v[132:135], v[112:127]
  ds_read_b64_tr_b16 v[220:221], v151 offset:0
  ds_read_b64_tr_b16 v[222:223], v151 offset:512
  buffer_store_dwordx4 v[236:239], v165, s[80:83], s64 offen sc1
  s_waitcnt lgkmcnt(14)
  v_mfma_f32_32x32x16_bf16 v[0:15], v[136:139], v[128:131], v[0:15]
  ds_read_b128 v[132:135], v153 offset:0
  ds_read_b64_tr_b16 v[140:141], v144 offset:2048
  ds_read_b64_tr_b16 v[142:143], v144 offset:2560
  s_waitcnt lgkmcnt(15)
  v_mfma_f32_32x32x16_bf16 v[16:31], v[196:199], v[128:131], v[16:31]
  ds_read_b64_tr_b16 v[196:197], v145 offset:2048
  ds_read_b64_tr_b16 v[198:199], v145 offset:2560
  s_waitcnt lgkmcnt(15)
  v_mfma_f32_32x32x16_bf16 v[32:47], v[200:203], v[128:131], v[32:47]
  ds_read_b64_tr_b16 v[200:201], v146 offset:2048
  ds_read_b64_tr_b16 v[202:203], v146 offset:2560
  s_cbranch_vccz L_cs_16_0
  v_lshlrev_b32 v167, 16, v136
  v_and_b32 v168, s46, v136
  v_add_f32 v164, v164, v167
  v_add_f32 v164, v164, v168
  v_lshlrev_b32 v167, 16, v137
  v_and_b32 v168, s46, v137
  v_add_f32 v164, v164, v167
  v_add_f32 v164, v164, v168
L_cs_16_0:
  s_waitcnt lgkmcnt(15)
  v_mfma_f32_32x32x16_bf16 v[48:63], v[204:207], v[128:131], v[48:63]
  ds_read_b64_tr_b16 v[204:205], v147 offset:2048
  ds_read_b64_tr_b16 v[206:207], v147 offset:2560
  s_waitcnt lgkmcnt(15)
  v_mfma_f32_32x32x16_bf16 v[64:79], v[208:211], v[128:131], v[64:79]
  ds_read_b64_tr_b16 v[208:209], v148 offset:2048
  ds_read_b64_tr_b16 v[210:211], v148 offset:2560
  s_waitcnt lgkmcnt(15)
  v_mfma_f32_32x32x16_bf16 v[80:95], v[212:215], v[128:131], v[80:95]
  ds_read_b64_tr_b16 v[212:213], v149 offset:2048
  ds_read_b64_tr_b16 v[214:215], v149 offset:2560
  s_cbranch_vccz L_cs_16_1
  v_lshlrev_b32 v167, 16, v138
  v_and_b32 v168, s46, v138
  v_add_f32 v164, v164, v167
  v_add_f32 v164, v164, v168
  v_lshlrev_b32 v167, 16, v139
  v_and_b32 v168, s46, v139
  v_add_f32 v164, v164, v167
  v_add_f32 v164, v164, v168
L_cs_16_1:
  s_waitcnt lgkmcnt(15)
  v_mfma_f32_32x32x16_bf16 v[96:111], v[216:219], v[128:131], v[96:111]
  ds_read_b64_tr_b16 v[216:217], v150 offset:2048
  ds_read_b64_tr_b16 v[218:219], v150 offset:2560
  s_waitcnt lgkmcnt(15)
  v_mfma_f32_32x32x16_bf16 v[112:127], v[220:223], v[128:131], v[112:127]
  ds_read_b64_tr_b16 v[220:221], v151 offset:2048
  ds_read_b64_tr_b16 v[222:223], v151 offset:2560
  s_waitcnt vmcnt(7)
  s_barrier
  s_waitcnt lgkmcnt(14)
  v_mfma_f32_32x32x16_bf16 v[0:15], v[140:143], v[132:135], v[0:15]
  ds_read_b128 v[128:131], v154 offset:0
  ds_read_b64_tr_b16 v[136:137], v144 offset:16384
  ds_read_b64_tr_b16 v[138:139], v144 offset:16896
  s_waitcnt lgkmcnt(15)
  v_mfma_f32_32x32x16_bf16 v[16:31], v[196:199], v[132:135], v[16:31]
  ds_read_b64_tr_b16 v[196:197], v145 offset:16384
  ds_read_b64_tr_b16 v[198:199], v145 offset:16896
  s_add_u32 m0, s47, 49152
  s_nop 0
  buffer_load_dwordx4 v160, s[12:15], s44 offen lds
  buffer_load_dwordx4 v161, s[12:15], s44 offen offset:1024 lds
  s_add_u32 s44, s44, s43
  s_waitcnt lgkmcnt(15)
  v_mfma_f32_32x32x16_bf16 v[32:47], v[200:203], v[132:135], v[32:47]
  ds_read_b64_tr_b16 v[200:201], v146 offset:16384
  ds_read_b64_tr_b16 v[202:203], v146 offset:16896
  s_cbranch_vccz L_cs_17_0
  v_lshlrev_b32 v167, 16, v140
  v_and_b32 v168, s46, v140
  v_add_f32 v164, v164, v167
  v_add_f32 v164, v164, v168
  v_lshlrev_b32 v167, 16, v141
  v_and_b32 v168, s46, v141
  v_add_f32 v164, v164, v167
  v_add_f32 v164, v164, v168
L_cs_17_0:
  s_waitcnt lgkmcnt(15)
  v_mfma_f32_32x32x16_bf16 v[48:63], v[204:207], v[132:135], v[48:63]
  ds_read_b64_tr_b16 v[204:205], v147 offset:16384
  ds_read_b64_tr_b16 v[206:207], v147 offset:16896
  s_waitcnt lgkmcnt(15)
  v_mfma_f32_32x32x16_bf16 v[64:79], v[208:211], v[132:135], v[64:79]
  ds_read_b64_tr_b16 v[208:209], v148 offset:16384
  ds_read_b64_tr_b16 v[210:211], v148 offset:16896
  s_waitcnt lgkmcnt(15)
  v_mfma_f32_32x32x16_bf16 v[80:95], v[212:215], v[132:135], v[80:95]
  ds_read_b64_tr_b16 v[212:213], v149 offset:16384
  ds_read_b64_tr_b16 v[214:215], v149 offset:16896
  s_cbranch_vccz L_cs_17_1
  v_lshlrev_b32 v167, 16, v142
  v_and_b32 v168, s46, v142
  v_add_f32 v164, v164, v167
  v_add_f32 v164, v164, v168
  v_lshlrev_b32 v167, 16, v143
  v_and_b32 v168, s46, v143
  v_add_f32 v164, v164, v167
  v_add_f32 v164, v164, v168
L_cs_17_1:
  s_waitcnt lgkmcnt(15)
  v_mfma_f32_32x32x16_bf16 v[96:111], v[216:219], v[132:135], v[96:111]
  ds_read_b64_tr_b16 v[216:217], v150 offset:16384
  ds_read_b64_tr_b16 v[218:219], v150 offset:16896
  s_waitcnt lgkmcnt(15)
  v_mfma_f32_32x32x16_bf16 v[112:127], v[220:223], v[132:135], v[112:127]
  ds_read_b64_tr_b16 v[220:221], v151 offset:16384
  ds_read_b64_tr_b16 v[222:223], v151 offset:16896
  s_waitcnt lgkmcnt(14)
  v_mfma_f32_32x32x16_bf16 v[0:15], v[136:139], v[128:131], v[0:15]
  ds_read_b128 v[132:135], v155 offset:0
  ds_read_b64_tr_b16 v[140:141], v144 offset:18432
  ds_read_b64_tr_b16 v[142:143], v144 offset:18944
  s_waitcnt lgkmcnt(15)
  v_mfma_f32_32x32x16_bf16 v[16:31], v[196:199], v[128:131], v[16:31]
  ds_read_b64_tr_b16 v[196:197], v145 offset:18432
  ds_read_b64_tr_b16 v[198:199], v145 offset:18944
  s_waitcnt lgkmcnt(15)
  v_mfma_f32_32x32x16_bf16 v[32:47], v[200:203], v[128:131], v[32:47]
  ds_read_b64_tr_b16 v[200:201], v146 offset:18432
  ds_read_b64_tr_b16 v[202:203], v146 offset:18944
  s_cbranch_vccz L_cs_18_0
  v_lshlrev_b32 v167, 16, v136
  v_and_b32 v168, s46, v136
  v_add_f32 v164, v164, v167
  v_add_f32 v164, v164, v168
  v_lshlrev_b32 v167, 16, v137
  v_and_b32 v168, s46, v137
  v_add_f32 v164, v164, v167
  v_add_f32 v164, v164, v168
L_cs_18_0:
  s_waitcnt lgkmcnt(15)
  v_mfma_f32_32x32x16_bf16 v[48:63], v[204:207], v[128:131], v[48:63]
  ds_read_b64_tr_b16 v[204:205], v147 offset:18432
  ds_read_b64_tr_b16 v[206:207], v147 offset:18944
  s_waitcnt lgkmcnt(15)
  v_mfma_f32_32x32x16_bf16 v[64:79], v[208:211], v[128:131], v[64:79]
  ds_read_b64_tr_b16 v[208:209], v148 offset:18432
  ds_read_b64_tr_b16 v[210:211], v148 offset:18944
  s_waitcnt lgkmcnt(15)
  v_mfma_f32_32x32x16_bf16 v[80:95], v[212:215], v[128:131], v[80:95]
  ds_read_b64_tr_b16 v[212:213], v149 offset:18432
  ds_read_b64_tr_b16 v[214:215], v149 offset:18944
  s_cbranch_vccz L_cs_18_1
  v_lshlrev_b32 v167, 16, v138
  v_and_b32 v168, s46, v138
  v_add_f32 v164, v164, v167
  v_add_f32 v164, v164, v168
  v_lshlrev_b32 v167, 16, v139
  v_and_b32 v168, s46, v139
  v_add_f32 v164, v164, v167
  v_add_f32 v164, v164, v168
L_cs_18_1:
  s_waitcnt lgkmcnt(15)
  v_mfma_f32_32x32x16_bf16 v[96:111], v[216:219], v[128:131], v[96:111]
  ds_read_b64_tr_b16 v[216:217], v150 offset:18432
  ds_read_b64_tr_b16 v[218:219], v150 offset:18944
  s_waitcnt lgkmcnt(15)
  v_mfma_f32_32x32x16_bf16 v[112:127], v[220:223], v[128:131], v[112:127]
  ds_read_b64_tr_b16 v[220:221], v151 offset:18432
  ds_read_b64_tr_b16 v[222:223], v151 offset:18944
  s_waitcnt vmcnt(7)
  s_barrier
  s_waitcnt lgkmcnt(14)
  v_mfma_f32_32x32x16_bf16 v[0:15], v[140:143], v[132:135], v[0:15]
  s_waitcnt vmcnt(3)
  ds_read_b128 v[128:131], v152 offset:32768
  ds_read_b64_tr_b16 v[136:137], v144 offset:32768
  ds_read_b64_tr_b16 v[138:139], v144 offset:33280
  s_waitcnt lgkmcnt(15)
  v_mfma_f32_32x32x16_bf16 v[16:31], v[196:199], v[132:135], v[16:31]
  ds_read_b64_tr_b16 v[196:197], v145 offset:32768
  ds_read_b64_tr_b16 v[198:199], v145 offset:33280
  s_add_u32 m0, s47, 0
  s_nop 0
  buffer_load_dwordx4 v160, s[12:15], s44 offen lds
  buffer_load_dwordx4 v161, s[12:15], s44 offen offset:1024 lds
  s_add_u32 s44, s44, s43
  s_waitcnt lgkmcnt(15)
  v_mfma_f32_32x32x16_bf16 v[32:47], v[200:203], v[132:135], v[32:47]
  ds_read_b64_tr_b16 v[200:201], v146 offset:32768
  ds_read_b64_tr_b16 v[202:203], v146 offset:33280
  s_cbranch_vccz L_cs_19_0
  v_lshlrev_b32 v167, 16, v140
  v_and_b32 v168, s46, v140
  v_add_f32 v164, v164, v167
  v_add_f32 v164, v164, v168
  v_lshlrev_b32 v167, 16, v141
  v_and_b32 v168, s46, v141
  v_add_f32 v164, v164, v167
  v_add_f32 v164, v164, v168
L_cs_19_0:
  s_waitcnt lgkmcnt(15)
  v_mfma_f32_32x32x16_bf16 v[48:63], v[204:207], v[132:135], v[48:63]
  ds_read_b64_tr_b16 v[204:205], v147 offset:32768
  ds_read_b64_tr_b16 v[206:207], v147 offset:33280
  s_waitcnt lgkmcnt(15)
  v_mfma_f32_32x32x16_bf16 v[64:79], v[208:211], v[132:135], v[64:79]
  ds_read_b64_tr_b16 v[208:209], v148 offset:32768
  ds_read_b64_tr_b16 v[210:211], v148 offset:33280
  s_add_u32 m0, s48, 0
  s_nop 0
  buffer_load_dwordx4 v156, s[8:11], s45 offen offset:0 lds
  buffer_load_dwordx4 v157, s[8:11], s45 offen offset:1024 lds
  buffer_load_dwordx4 v158, s[8:11], s45 offen offset:2048 lds
  buffer_load_dwordx4 v159, s[8:11], s45 offen offset:3072 lds
  s_add_u32 s45, s45, 128
  s_waitcnt lgkmcnt(15)
  v_mfma_f32_32x32x16_bf16 v[80:95], v[212:215], v[132:135], v[80:95]
  ds_read_b64_tr_b16 v[212:213], v149 offset:32768
  ds_read_b64_tr_b16 v[214:215], v149 offset:33280
  s_cbranch_vccz L_cs_19_1
  v_lshlrev_b32 v167, 16, v142
  v_and_b32 v168, s46, v142
  v_add_f32 v164, v164, v167
  v_add_f32 v164, v164, v168
  v_lshlrev_b32 v167, 16, v143
  v_and_b32 v168, s46, v143
  v_add_f32 v164, v164, v167
  v_add_f32 v164, v164, v168
L_cs_19_1:
  s_waitcnt lgkmcnt(15)
  v_mfma_f32_32x32x16_bf16 v[96:111], v[216:219], v[132:135], v[96:111]
  ds_read_b64_tr_b16 v[216:217], v150 offset:32768
  ds_read_b64_tr_b16 v[218:219], v150 offset:33280
  s_waitcnt lgkmcnt(15)
  v_mfma_f32_32x32x16_bf16 v[112:127], v[220:223], v[132:135], v[112:127]
  ds_read_b64_tr_b16 v[220:221], v151 offset:32768
  ds_read_b64_tr_b16 v[222:223], v151 offset:33280
  s_waitcnt lgkmcnt(14)
  v_mfma_f32_32x32x16_bf16 v[0:15], v[136:139], v[128:131], v[0:15]
  ds_read_b128 v[132:135], v153 offset:32768
  ds_read_b64_tr_b16 v[140:141], v144 offset:34816
  ds_read_b64_tr_b16 v[142:143], v144 offset:35328
  v_mov_b32 v167, v164
  s_nop 1
  v_permlane32_swap_b32 v167, v164
  s_waitcnt lgkmcnt(15)
  v_mfma_f32_32x32x16_bf16 v[16:31], v[196:199], v[128:131], v[16:31]
  ds_read_b64_tr_b16 v[196:197], v145 offset:34816
  ds_read_b64_tr_b16 v[198:199], v145 offset:35328
  v_add_f32 v164, v164, v167
  v_cvt_pk_bf16_f32 v167, v164, v164
  v_and_b32 v167, s46, v167
  s_waitcnt lgkmcnt(15)
  v_mfma_f32_32x32x16_bf16 v[32:47], v[200:203], v[128:131], v[32:47]
  ds_read_b64_tr_b16 v[200:201], v146 offset:34816
  ds_read_b64_tr_b16 v[202:203], v146 offset:35328
  v_sub_f32 v168, v164, v167
  v_cvt_pk_bf16_f32 v164, v167, v168
  s_waitcnt lgkmcnt(15)
  v_mfma_f32_32x32x16_bf16 v[48:63], v[204:207], v[128:131], v[48:63]
  ds_read_b64_tr_b16 v[204:205], v147 offset:34816
  ds_read_b64_tr_b16 v[206:207], v147 offset:35328
  v_lshrrev_b32 v167, 5, v175
  v_lshlrev_b32 v167, 28, v167
  s_waitcnt lgkmcnt(15)
  v_mfma_f32_32x32x16_bf16 v[64:79], v[208:211], v[128:131], v[64:79]
  ds_read_b64_tr_b16 v[208:209], v148 offset:34816
  ds_read_b64_tr_b16 v[210:211], v148 offset:35328
  v_and_b32 v168, 31, v175
  v_lshl_add_u32 v167, v168, 5, v167
  s_lshl_b32 s64, s41, 3
  s_waitcnt lgkmcnt(15)
  v_mfma_f32_32x32x16_bf16 v[80:95], v[212:215], v[128:131], v[80:95]
  ds_read_b64_tr_b16 v[212:213], v149 offset:34816
  ds_read_b64_tr_b16 v[214:215], v149 offset:35328
  s_add_u32 s64, s64, s40
  s_lshl_b32 s64, s64, 8
  s_waitcnt lgkmcnt(15)
  v_mfma_f32_32x32x16_bf16 v[96:111], v[216:219], v[128:131], v[96:111]
  ds_read_b64_tr_b16 v[216:217], v150 offset:34816
  ds_read_b64_tr_b16 v[218:219], v150 offset:35328
  s_add_u32 s64, s64, s42
  s_lshl_b32 s64, s64, 2
  s_add_u32 s64, s64, 65536
  s_waitcnt lgkmcnt(15)
  v_mfma_f32_32x32x16_bf16 v[112:127], v[220:223], v[128:131], v[112:127]
  ds_read_b64_tr_b16 v[220:221], v151 offset:34816
  ds_read_b64_tr_b16 v[222:223], v151 offset:35328
  v_add_u32 v167, s64, v167
  buffer_store_dword v164, v167, s[80:83], 0 offen sc1
  s_waitcnt vmcnt(7)
  s_barrier
  s_waitcnt lgkmcnt(14)
  v_mfma_f32_32x32x16_bf16 v[0:15], v[140:143], v[132:135], v[0:15]
  ds_read_b128 v[128:131], v154 offset:32768
  ds_read_b64_tr_b16 v[136:137], v144 offset:49152
  ds_read_b64_tr_b16 v[138:139], v144 offset:49664
  s_waitcnt lgkmcnt(15)
  v_mfma_f32_32x32x16_bf16 v[16:31], v[196:199], v[132:135], v[16:31]
  ds_read_b64_tr_b16 v[196:197], v145 offset:49152
  ds_read_b64_tr_b16 v[198:199], v145 offset:49664
  s_add_u32 m0, s47, 16384
  s_nop 0
  buffer_load_dwordx4 v160, s[12:15], s44 offen lds
  buffer_load_dwordx4 v161, s[12:15], s44 offen offset:1024 lds
  s_add_u32 s44, s44, s43
  s_waitcnt lgkmcnt(15)
  v_mfma_f32_32x32x16_bf16 v[32:47], v[200:203], v[132:135], v[32:47]
  ds_read_b64_tr_b16 v[200:201], v146 offset:49152
  ds_read_b64_tr_b16 v[202:203], v146 offset:49664
  s_waitcnt lgkmcnt(15)
  v_mfma_f32_32x32x16_bf16 v[48:63], v[204:207], v[132:135], v[48:63]
  ds_read_b64_tr_b16 v[204:205], v147 offset:49152
  ds_read_b64_tr_b16 v[206:207], v147 offset:49664
  s_waitcnt lgkmcnt(15)
  v_mfma_f32_32x32x16_bf16 v[64:79], v[208:211], v[132:135], v[64:79]
  ds_read_b64_tr_b16 v[208:209], v148 offset:49152
  ds_read_b64_tr_b16 v[210:211], v148 offset:49664
  s_waitcnt lgkmcnt(15)
  v_mfma_f32_32x32x16_bf16 v[80:95], v[212:215], v[132:135], v[80:95]
  ds_read_b64_tr_b16 v[212:213], v149 offset:49152
  ds_read_b64_tr_b16 v[214:215], v149 offset:49664
  s_add_u32 m0, s49, 131072
  s_nop 0
  buffer_load_dwordx4 v171, s[16:19], s50 offen lds
  buffer_load_dwordx4 v172, s[16:19], s50 offen offset:1024 lds
  s_add_u32 s50, s50, 16384
  s_waitcnt lgkmcnt(15)
  v_mfma_f32_32x32x16_bf16 v[96:111], v[216:219], v[132:135], v[96:111]
  ds_read_b64_tr_b16 v[216:217], v150 offset:49152
  ds_read_b64_tr_b16 v[218:219], v150 offset:49664
  s_add_u32 m0, s49, 147456
  s_nop 0
  buffer_load_dwordx4 v173, s[20:23], s51 offen lds
  buffer_load_dwordx4 v173, s[20:23], s51 offen offset:1024 lds
  s_add_u32 s51, s51, 16384
  s_waitcnt lgkmcnt(15)
  v_mfma_f32_32x32x16_bf16 v[112:127], v[220:223], v[132:135], v[112:127]
  ds_read_b64_tr_b16 v[220:221], v151 offset:49152
  ds_read_b64_tr_b16 v[222:223], v151 offset:49664
  s_waitcnt lgkmcnt(14)
  v_mfma_f32_32x32x16_bf16 v[0:15], v[136:139], v[128:131], v[0:15]
  ds_read_b128 v[132:135], v155 offset:32768
  ds_read_b64_tr_b16 v[140:141], v144 offset:51200
  ds_read_b64_tr_b16 v[142:143], v144 offset:51712
  s_waitcnt lgkmcnt(15)
  v_mfma_f32_32x32x16_bf16 v[16:31], v[196:199], v[128:131], v[16:31]
  ds_read_b64_tr_b16 v[196:197], v145 offset:51200
  ds_read_b64_tr_b16 v[198:199], v145 offset:51712
  s_waitcnt lgkmcnt(15)
  v_mfma_f32_32x32x16_bf16 v[32:47], v[200:203], v[128:131], v[32:47]
  ds_read_b64_tr_b16 v[200:201], v146 offset:51200
  ds_read_b64_tr_b16 v[202:203], v146 offset:51712
  s_waitcnt lgkmcnt(15)
  v_mfma_f32_32x32x16_bf16 v[48:63], v[204:207], v[128:131], v[48:63]
  ds_read_b64_tr_b16 v[204:205], v147 offset:51200
  ds_read_b64_tr_b16 v[206:207], v147 offset:51712
  s_waitcnt lgkmcnt(15)
  v_mfma_f32_32x32x16_bf16 v[64:79], v[208:211], v[128:131], v[64:79]
  ds_read_b64_tr_b16 v[208:209], v148 offset:51200
  ds_read_b64_tr_b16 v[210:211], v148 offset:51712
  s_waitcnt lgkmcnt(15)
  v_mfma_f32_32x32x16_bf16 v[80:95], v[212:215], v[128:131], v[80:95]
  ds_read_b64_tr_b16 v[212:213], v149 offset:51200
  ds_read_b64_tr_b16 v[214:215], v149 offset:51712
  s_waitcnt lgkmcnt(15)
  v_mfma_f32_32x32x16_bf16 v[96:111], v[216:219], v[128:131], v[96:111]
  ds_read_b64_tr_b16 v[216:217], v150 offset:51200
  ds_read_b64_tr_b16 v[218:219], v150 offset:51712
  s_waitcnt lgkmcnt(15)
  v_mfma_f32_32x32x16_bf16 v[112:127], v[220:223], v[128:131], v[112:127]
  ds_read_b64_tr_b16 v[220:221], v151 offset:51200
  ds_read_b64_tr_b16 v[222:223], v151 offset:51712
  s_waitcnt vmcnt(11)
  s_waitcnt vmcnt(6)
  s_barrier
  s_cmp_lg_u32 s40, 0
  s_cbranch_scc1 L_sig_arr
  v_mov_b32 v165, 1
  s_mov_b64 exec, 1
  buffer_atomic_add v165, off, s[72:75], 0 sc1
  s_mov_b64 exec, -1
L_sig_arr:
  s_waitcnt lgkmcnt(14)
  v_mfma_f32_32x32x16_bf16 v[0:15], v[140:143], v[132:135], v[0:15]
  ds_read_b128 v[128:131], v152 offset:0
  ds_read_b64_tr_b16 v[136:137], v144 offset:0
  ds_read_b64_tr_b16 v[138:139], v144 offset:512
  s_waitcnt lgkmcnt(15)
  v_mfma_f32_32x32x16_bf16 v[16:31], v[196:199], v[132:135], v[16:31]
  ds_read_b64_tr_b16 v[196:197], v145 offset:0
  ds_read_b64_tr_b16 v[198:199], v145 offset:512
  s_add_u32 m0, s47, 32768
  s_nop 0
  buffer_load_dwordx4 v160, s[12:15], s44 offen lds
  buffer_load_dwordx4 v161, s[12:15], s44 offen offset:1024 lds
  s_add_u32 s44, s44, s43
  s_waitcnt lgkmcnt(15)
  v_mfma_f32_32x32x16_bf16 v[32:47], v[200:203], v[132:135], v[32:47]
  ds_read_b64_tr_b16 v[200:201], v146 offset:0
  ds_read_b64_tr_b16 v[202:203], v146 offset:512
  s_waitcnt lgkmcnt(15)
  v_mfma_f32_32x32x16_bf16 v[48:63], v[204:207], v[132:135], v[48:63]
  ds_read_b64_tr_b16 v[204:205], v147 offset:0
  ds_read_b64_tr_b16 v[206:207], v147 offset:512
  s_waitcnt lgkmcnt(15)
  v_mfma_f32_32x32x16_bf16 v[64:79], v[208:211], v[132:135], v[64:79]
  ds_read_b64_tr_b16 v[208:209], v148 offset:0
  ds_read_b64_tr_b16 v[210:211], v148 offset:512
  s_add_u32 m0, s48, 32768
  s_nop 0
  buffer_load_dwordx4 v156, s[8:11], s45 offen offset:0 lds
  buffer_load_dwordx4 v157, s[8:11], s45 offen offset:1024 lds
  buffer_load_dwordx4 v158, s[8:11], s45 offen offset:2048 lds
  buffer_load_dwordx4 v159, s[8:11], s45 offen offset:3072 lds
  s_add_u32 s45, s45, 128
  s_waitcnt lgkmcnt(15)
  v_mfma_f32_32x32x16_bf16 v[80:95], v[212:215], v[132:135], v[80:95]
  ds_read_b64_tr_b16 v[212:213], v149 offset:0
  ds_read_b64_tr_b16 v[214:215], v149 offset:512
  s_waitcnt lgkmcnt(15)
  v_mfma_f32_32x32x16_bf16 v[96:111], v[216:219], v[132:135], v[96:111]
  ds_read_b64_tr_b16 v[216:217], v150 offset:0
  ds_read_b64_tr_b16 v[218:219], v150 offset:512
  s_waitcnt lgkmcnt(15)
  v_mfma_f32_32x32x16_bf16 v[112:127], v[220:223], v[132:135], v[112:127]
  ds_read_b64_tr_b16 v[220:221], v151 offset:0
  ds_read_b64_tr_b16 v[222:223], v151 offset:512
  s_waitcnt lgkmcnt(14)
  v_mfma_f32_32x32x16_bf16 v[0:15], v[136:139], v[128:131], v[0:15]
  ds_read_b128 v[132:135], v153 offset:0
  ds_read_b64_tr_b16 v[140:141], v144 offset:2048
  ds_read_b64_tr_b16 v[142:143], v144 offset:2560
  s_waitcnt lgkmcnt(15)
  v_mfma_f32_32x32x16_bf16 v[16:31], v[196:199], v[128:131], v[16:31]
  ds_read_b64_tr_b16 v[196:197], v145 offset:2048
  ds_read_b64_tr_b16 v[198:199], v145 offset:2560
  s_waitcnt lgkmcnt(15)
  v_mfma_f32_32x32x16_bf16 v[32:47], v[200:203], v[128:131], v[32:47]
  ds_read_b64_tr_b16 v[200:201], v146 offset:2048
  ds_read_b64_tr_b16 v[202:203], v146 offset:2560
  s_waitcnt lgkmcnt(15)
  v_mfma_f32_32x32x16_bf16 v[48:63], v[204:207], v[128:131], v[48:63]
  ds_read_b64_tr_b16 v[204:205], v147 offset:2048
  ds_read_b64_tr_b16 v[206:207], v147 offset:2560
  s_waitcnt lgkmcnt(15)
  v_mfma_f32_32x32x16_bf16 v[64:79], v[208:211], v[128:131], v[64:79]
  ds_read_b64_tr_b16 v[208:209], v148 offset:2048
  ds_read_b64_tr_b16 v[210:211], v148 offset:2560
  s_waitcnt lgkmcnt(15)
  v_mfma_f32_32x32x16_bf16 v[80:95], v[212:215], v[128:131], v[80:95]
  ds_read_b64_tr_b16 v[212:213], v149 offset:2048
  ds_read_b64_tr_b16 v[214:215], v149 offset:2560
  s_waitcnt lgkmcnt(15)
  v_mfma_f32_32x32x16_bf16 v[96:111], v[216:219], v[128:131], v[96:111]
  ds_read_b64_tr_b16 v[216:217], v150 offset:2048
  ds_read_b64_tr_b16 v[218:219], v150 offset:2560
  s_waitcnt lgkmcnt(15)
  v_mfma_f32_32x32x16_bf16 v[112:127], v[220:223], v[128:131], v[112:127]
  ds_read_b64_tr_b16 v[220:221], v151 offset:2048
  ds_read_b64_tr_b16 v[222:223], v151 offset:2560
  s_waitcnt vmcnt(10)
  s_barrier
  s_waitcnt lgkmcnt(14)
  v_mfma_f32_32x32x16_bf16 v[0:15], v[140:143], v[132:135], v[0:15]
  ds_read_b128 v[128:131], v154 offset:0
  ds_read_b64_tr_b16 v[136:137], v144 offset:16384
  ds_read_b64_tr_b16 v[138:139], v144 offset:16896
  s_waitcnt lgkmcnt(15)
  v_mfma_f32_32x32x16_bf16 v[16:31], v[196:199], v[132:135], v[16:31]
  ds_read_b64_tr_b16 v[196:197], v145 offset:16384
  ds_read_b64_tr_b16 v[198:199], v145 offset:16896
  s_add_u32 m0, s47, 49152
  s_nop 0
  buffer_load_dwordx4 v160, s[12:15], s44 offen lds
  buffer_load_dwordx4 v161, s[12:15], s44 offen offset:1024 lds
  s_add_u32 s44, s44, s43
  s_waitcnt lgkmcnt(15)
  v_mfma_f32_32x32x16_bf16 v[32:47], v[200:203], v[132:135], v[32:47]
  ds_read_b64_tr_b16 v[200:201], v146 offset:16384
  ds_read_b64_tr_b16 v[202:203], v146 offset:16896
  s_waitcnt lgkmcnt(15)
  v_mfma_f32_32x32x16_bf16 v[48:63], v[204:207], v[132:135], v[48:63]
  ds_read_b64_tr_b16 v[204:205], v147 offset:16384
  ds_read_b64_tr_b16 v[206:207], v147 offset:16896
  s_waitcnt lgkmcnt(15)
  v_mfma_f32_32x32x16_bf16 v[64:79], v[208:211], v[132:135], v[64:79]
  ds_read_b64_tr_b16 v[208:209], v148 offset:16384
  ds_read_b64_tr_b16 v[210:211], v148 offset:16896
  s_waitcnt lgkmcnt(15)
  v_mfma_f32_32x32x16_bf16 v[80:95], v[212:215], v[132:135], v[80:95]
  ds_read_b64_tr_b16 v[212:213], v149 offset:16384
  ds_read_b64_tr_b16 v[214:215], v149 offset:16896
  s_waitcnt lgkmcnt(15)
  v_mfma_f32_32x32x16_bf16 v[96:111], v[216:219], v[132:135], v[96:111]
  ds_read_b64_tr_b16 v[216:217], v150 offset:16384
  ds_read_b64_tr_b16 v[218:219], v150 offset:16896
  s_waitcnt lgkmcnt(15)
  v_mfma_f32_32x32x16_bf16 v[112:127], v[220:223], v[132:135], v[112:127]
  ds_read_b64_tr_b16 v[220:221], v151 offset:16384
  ds_read_b64_tr_b16 v[222:223], v151 offset:16896
  s_waitcnt lgkmcnt(14)
  v_mfma_f32_32x32x16_bf16 v[0:15], v[136:139], v[128:131], v[0:15]
  ds_read_b128 v[132:135], v155 offset:0
  ds_read_b64_tr_b16 v[140:141], v144 offset:18432
  ds_read_b64_tr_b16 v[142:143], v144 offset:18944
  s_waitcnt lgkmcnt(15)
  v_mfma_f32_32x32x16_bf16 v[16:31], v[196:199], v[128:131], v[16:31]
  ds_read_b64_tr_b16 v[196:197], v145 offset:18432
  ds_read_b64_tr_b16 v[198:199], v145 offset:18944
  s_waitcnt lgkmcnt(15)
  v_mfma_f32_32x32x16_bf16 v[32:47], v[200:203], v[128:131], v[32:47]
  ds_read_b64_tr_b16 v[200:201], v146 offset:18432
  ds_read_b64_tr_b16 v[202:203], v146 offset:18944
  s_waitcnt lgkmcnt(15)
  v_mfma_f32_32x32x16_bf16 v[48:63], v[204:207], v[128:131], v[48:63]
  ds_read_b64_tr_b16 v[204:205], v147 offset:18432
  ds_read_b64_tr_b16 v[206:207], v147 offset:18944
  s_waitcnt lgkmcnt(15)
  v_mfma_f32_32x32x16_bf16 v[64:79], v[208:211], v[128:131], v[64:79]
  ds_read_b64_tr_b16 v[208:209], v148 offset:18432
  ds_read_b64_tr_b16 v[210:211], v148 offset:18944
  s_waitcnt lgkmcnt(15)
  v_mfma_f32_32x32x16_bf16 v[80:95], v[212:215], v[128:131], v[80:95]
  ds_read_b64_tr_b16 v[212:213], v149 offset:18432
  ds_read_b64_tr_b16 v[214:215], v149 offset:18944
  s_waitcnt lgkmcnt(15)
  v_mfma_f32_32x32x16_bf16 v[96:111], v[216:219], v[128:131], v[96:111]
  ds_read_b64_tr_b16 v[216:217], v150 offset:18432
  ds_read_b64_tr_b16 v[218:219], v150 offset:18944
  s_waitcnt lgkmcnt(15)
  v_mfma_f32_32x32x16_bf16 v[112:127], v[220:223], v[128:131], v[112:127]
  ds_read_b64_tr_b16 v[220:221], v151 offset:18432
  ds_read_b64_tr_b16 v[222:223], v151 offset:18944
  s_waitcnt vmcnt(6)
  s_barrier
  s_waitcnt lgkmcnt(14)
  v_mfma_f32_32x32x16_bf16 v[0:15], v[140:143], v[132:135], v[0:15]
  s_waitcnt vmcnt(2)
  ds_read_b128 v[128:131], v152 offset:32768
  ds_read_b64_tr_b16 v[136:137], v144 offset:32768
  ds_read_b64_tr_b16 v[138:139], v144 offset:33280
  s_waitcnt lgkmcnt(15)
  v_mfma_f32_32x32x16_bf16 v[16:31], v[196:199], v[132:135], v[16:31]
  ds_read_b64_tr_b16 v[196:197], v145 offset:32768
  ds_read_b64_tr_b16 v[198:199], v145 offset:33280
  s_add_u32 m0, s47, 0
  s_nop 0
  buffer_load_dwordx4 v160, s[12:15], s44 offen lds
  buffer_load_dwordx4 v161, s[12:15], s44 offen offset:1024 lds
  s_add_u32 s44, s44, s43
  s_waitcnt lgkmcnt(15)
  v_mfma_f32_32x32x16_bf16 v[32:47], v[200:203], v[132:135], v[32:47]
  ds_read_b64_tr_b16 v[200:201], v146 offset:32768
  ds_read_b64_tr_b16 v[202:203], v146 offset:33280
  s_waitcnt lgkmcnt(15)
  v_mfma_f32_32x32x16_bf16 v[48:63], v[204:207], v[132:135], v[48:63]
  ds_read_b64_tr_b16 v[204:205], v147 offset:32768
  ds_read_b64_tr_b16 v[206:207], v147 offset:33280
  s_waitcnt lgkmcnt(15)
  v_mfma_f32_32x32x16_bf16 v[64:79], v[208:211], v[132:135], v[64:79]
  ds_read_b64_tr_b16 v[208:209], v148 offset:32768
  ds_read_b64_tr_b16 v[210:211], v148 offset:33280
  s_add_u32 m0, s48, 0
  s_nop 0
  buffer_load_dwordx4 v156, s[8:11], s45 offen offset:0 lds
  buffer_load_dwordx4 v157, s[8:11], s45 offen offset:1024 lds
  buffer_load_dwordx4 v158, s[8:11], s45 offen offset:2048 lds
  buffer_load_dwordx4 v159, s[8:11], s45 offen offset:3072 lds
  s_add_u32 s45, s45, 128
  s_waitcnt lgkmcnt(15)
  v_mfma_f32_32x32x16_bf16 v[80:95], v[212:215], v[132:135], v[80:95]
  ds_read_b64_tr_b16 v[212:213], v149 offset:32768
  ds_read_b64_tr_b16 v[214:215], v149 offset:33280
  s_waitcnt lgkmcnt(15)
  v_mfma_f32_32x32x16_bf16 v[96:111], v[216:219], v[132:135], v[96:111]
  ds_read_b64_tr_b16 v[216:217], v150 offset:32768
  ds_read_b64_tr_b16 v[218:219], v150 offset:33280
  s_waitcnt lgkmcnt(15)
  v_mfma_f32_32x32x16_bf16 v[112:127], v[220:223], v[132:135], v[112:127]
  ds_read_b64_tr_b16 v[220:221], v151 offset:32768
  ds_read_b64_tr_b16 v[222:223], v151 offset:33280
  s_waitcnt lgkmcnt(14)
  v_mfma_f32_32x32x16_bf16 v[0:15], v[136:139], v[128:131], v[0:15]
  ds_read_b128 v[132:135], v153 offset:32768
  ds_read_b64_tr_b16 v[140:141], v144 offset:34816
  ds_read_b64_tr_b16 v[142:143], v144 offset:35328
  s_waitcnt lgkmcnt(15)
  v_mfma_f32_32x32x16_bf16 v[16:31], v[196:199], v[128:131], v[16:31]
  ds_read_b64_tr_b16 v[196:197], v145 offset:34816
  ds_read_b64_tr_b16 v[198:199], v145 offset:35328
  s_waitcnt lgkmcnt(15)
  v_mfma_f32_32x32x16_bf16 v[32:47], v[200:203], v[128:131], v[32:47]
  ds_read_b64_tr_b16 v[200:201], v146 offset:34816
  ds_read_b64_tr_b16 v[202:203], v146 offset:35328
  s_waitcnt lgkmcnt(15)
  v_mfma_f32_32x32x16_bf16 v[48:63], v[204:207], v[128:131], v[48:63]
  ds_read_b64_tr_b16 v[204:205], v147 offset:34816
  ds_read_b64_tr_b16 v[206:207], v147 offset:35328
  s_waitcnt lgkmcnt(15)
  v_mfma_f32_32x32x16_bf16 v[64:79], v[208:211], v[128:131], v[64:79]
  ds_read_b64_tr_b16 v[208:209], v148 offset:34816
  ds_read_b64_tr_b16 v[210:211], v148 offset:35328
  s_waitcnt lgkmcnt(15)
  v_mfma_f32_32x32x16_bf16 v[80:95], v[212:215], v[128:131], v[80:95]
  ds_read_b64_tr_b16 v[212:213], v149 offset:34816
  ds_read_b64_tr_b16 v[214:215], v149 offset:35328
  s_waitcnt lgkmcnt(15)
  v_mfma_f32_32x32x16_bf16 v[96:111], v[216:219], v[128:131], v[96:111]
  ds_read_b64_tr_b16 v[216:217], v150 offset:34816
  ds_read_b64_tr_b16 v[218:219], v150 offset:35328
  s_waitcnt lgkmcnt(15)
  v_mfma_f32_32x32x16_bf16 v[112:127], v[220:223], v[128:131], v[112:127]
  ds_read_b64_tr_b16 v[220:221], v151 offset:34816
  ds_read_b64_tr_b16 v[222:223], v151 offset:35328
  s_waitcnt vmcnt(6)
  s_barrier
  s_waitcnt lgkmcnt(14)
  v_mfma_f32_32x32x16_bf16 v[0:15], v[140:143], v[132:135], v[0:15]
  ds_read_b128 v[128:131], v154 offset:32768
  ds_read_b64_tr_b16 v[136:137], v144 offset:49152
  ds_read_b64_tr_b16 v[138:139], v144 offset:49664
  s_waitcnt lgkmcnt(15)
  v_mfma_f32_32x32x16_bf16 v[16:31], v[196:199], v[132:135], v[16:31]
  ds_read_b64_tr_b16 v[196:197], v145 offset:49152
  ds_read_b64_tr_b16 v[198:199], v145 offset:49664
  s_add_u32 m0, s47, 16384
  s_nop 0
  buffer_load_dwordx4 v160, s[12:15], s44 offen lds
  buffer_load_dwordx4 v161, s[12:15], s44 offen offset:1024 lds
  s_add_u32 s44, s44, s43
  s_waitcnt lgkmcnt(15)
  v_mfma_f32_32x32x16_bf16 v[32:47], v[200:203], v[132:135], v[32:47]
  ds_read_b64_tr_b16 v[200:201], v146 offset:49152
  ds_read_b64_tr_b16 v[202:203], v146 offset:49664
  s_waitcnt lgkmcnt(15)
  v_mfma_f32_32x32x16_bf16 v[48:63], v[204:207], v[132:135], v[48:63]
  ds_read_b64_tr_b16 v[204:205], v147 offset:49152
  ds_read_b64_tr_b16 v[206:207], v147 offset:49664
  s_waitcnt lgkmcnt(15)
  v_mfma_f32_32x32x16_bf16 v[64:79], v[208:211], v[132:135], v[64:79]
  ds_read_b64_tr_b16 v[208:209], v148 offset:49152
  ds_read_b64_tr_b16 v[210:211], v148 offset:49664
  s_waitcnt lgkmcnt(15)
  v_mfma_f32_32x32x16_bf16 v[80:95], v[212:215], v[132:135], v[80:95]
  ds_read_b64_tr_b16 v[212:213], v149 offset:49152
  ds_read_b64_tr_b16 v[214:215], v149 offset:49664
  s_waitcnt lgkmcnt(15)
  v_mfma_f32_32x32x16_bf16 v[96:111], v[216:219], v[132:135], v[96:111]
  ds_read_b64_tr_b16 v[216:217], v150 offset:49152
  ds_read_b64_tr_b16 v[218:219], v150 offset:49664
  s_waitcnt lgkmcnt(15)
  v_mfma_f32_32x32x16_bf16 v[112:127], v[220:223], v[132:135], v[112:127]
  ds_read_b64_tr_b16 v[220:221], v151 offset:49152
  ds_read_b64_tr_b16 v[222:223], v151 offset:49664
  s_waitcnt lgkmcnt(14)
  v_mfma_f32_32x32x16_bf16 v[0:15], v[136:139], v[128:131], v[0:15]
  ds_read_b128 v[132:135], v155 offset:32768
  ds_read_b64_tr_b16 v[140:141], v144 offset:51200
  ds_read_b64_tr_b16 v[142:143], v144 offset:51712
  s_waitcnt lgkmcnt(15)
  v_mfma_f32_32x32x16_bf16 v[16:31], v[196:199], v[128:131], v[16:31]
  ds_read_b64_tr_b16 v[196:197], v145 offset:51200
  ds_read_b64_tr_b16 v[198:199], v145 offset:51712
  s_waitcnt lgkmcnt(15)
  v_mfma_f32_32x32x16_bf16 v[32:47], v[200:203], v[128:131], v[32:47]
  ds_read_b64_tr_b16 v[200:201], v146 offset:51200
  ds_read_b64_tr_b16 v[202:203], v146 offset:51712
  s_waitcnt lgkmcnt(15)
  v_mfma_f32_32x32x16_bf16 v[48:63], v[204:207], v[128:131], v[48:63]
  ds_read_b64_tr_b16 v[204:205], v147 offset:51200
  ds_read_b64_tr_b16 v[206:207], v147 offset:51712
  s_waitcnt lgkmcnt(15)
  v_mfma_f32_32x32x16_bf16 v[64:79], v[208:211], v[128:131], v[64:79]
  ds_read_b64_tr_b16 v[208:209], v148 offset:51200
  ds_read_b64_tr_b16 v[210:211], v148 offset:51712
  s_waitcnt lgkmcnt(15)
  v_mfma_f32_32x32x16_bf16 v[80:95], v[212:215], v[128:131], v[80:95]
  ds_read_b64_tr_b16 v[212:213], v149 offset:51200
  ds_read_b64_tr_b16 v[214:215], v149 offset:51712
  s_waitcnt lgkmcnt(15)
  v_mfma_f32_32x32x16_bf16 v[96:111], v[216:219], v[128:131], v[96:111]
  ds_read_b64_tr_b16 v[216:217], v150 offset:51200
  ds_read_b64_tr_b16 v[218:219], v150 offset:51712
  s_waitcnt lgkmcnt(15)
  v_mfma_f32_32x32x16_bf16 v[112:127], v[220:223], v[128:131], v[112:127]
  ds_read_b64_tr_b16 v[220:221], v151 offset:51200
  ds_read_b64_tr_b16 v[222:223], v151 offset:51712
  s_waitcnt vmcnt(6)
  s_barrier
  s_waitcnt lgkmcnt(14)
  v_mfma_f32_32x32x16_bf16 v[0:15], v[140:143], v[132:135], v[0:15]
  s_waitcnt vmcnt(2)
  ds_read_b128 v[128:131], v152 offset:0
  ds_read_b64_tr_b16 v[136:137], v144 offset:0
  ds_read_b64_tr_b16 v[138:139], v144 offset:512
  s_waitcnt lgkmcnt(15)
  v_mfma_f32_32x32x16_bf16 v[16:31], v[196:199], v[132:135], v[16:31]
  ds_read_b64_tr_b16 v[196:197], v145 offset:0
  ds_read_b64_tr_b16 v[198:199], v145 offset:512
  s_add_u32 m0, s47, 32768
  s_nop 0
  buffer_load_dwordx4 v160, s[12:15], s44 offen lds
  buffer_load_dwordx4 v161, s[12:15], s44 offen offset:1024 lds
  s_add_u32 s44, s44, s43
  s_waitcnt lgkmcnt(15)
  v_mfma_f32_32x32x16_bf16 v[32:47], v[200:203], v[132:135], v[32:47]
  ds_read_b64_tr_b16 v[200:201], v146 offset:0
  ds_read_b64_tr_b16 v[202:203], v146 offset:512
  s_waitcnt lgkmcnt(15)
  v_mfma_f32_32x32x16_bf16 v[48:63], v[204:207], v[132:135], v[48:63]
  ds_read_b64_tr_b16 v[204:205], v147 offset:0
  ds_read_b64_tr_b16 v[206:207], v147 offset:512
  s_waitcnt lgkmcnt(15)
  v_mfma_f32_32x32x16_bf16 v[64:79], v[208:211], v[132:135], v[64:79]
  ds_read_b64_tr_b16 v[208:209], v148 offset:0
  ds_read_b64_tr_b16 v[210:211], v148 offset:512
  s_add_u32 m0, s48, 32768
  s_nop 0
  buffer_load_dwordx4 v156, s[8:11], s45 offen offset:0 lds
  buffer_load_dwordx4 v157, s[8:11], s45 offen offset:1024 lds
  buffer_load_dwordx4 v158, s[8:11], s45 offen offset:2048 lds
  buffer_load_dwordx4 v159, s[8:11], s45 offen offset:3072 lds
  s_add_u32 s45, s45, 128
  s_waitcnt lgkmcnt(15)
  v_mfma_f32_32x32x16_bf16 v[80:95], v[212:215], v[132:135], v[80:95]
  ds_read_b64_tr_b16 v[212:213], v149 offset:0
  ds_read_b64_tr_b16 v[214:215], v149 offset:512
  s_waitcnt lgkmcnt(15)
  v_mfma_f32_32x32x16_bf16 v[96:111], v[216:219], v[132:135], v[96:111]
  ds_read_b64_tr_b16 v[216:217], v150 offset:0
  ds_read_b64_tr_b16 v[218:219], v150 offset:512
  s_waitcnt lgkmcnt(15)
  v_mfma_f32_32x32x16_bf16 v[112:127], v[220:223], v[132:135], v[112:127]
  ds_read_b64_tr_b16 v[220:221], v151 offset:0
  ds_read_b64_tr_b16 v[222:223], v151 offset:512
  s_waitcnt lgkmcnt(14)
  v_mfma_f32_32x32x16_bf16 v[0:15], v[136:139], v[128:131], v[0:15]
  ds_read_b128 v[132:135], v153 offset:0
  ds_read_b64_tr_b16 v[140:141], v144 offset:2048
  ds_read_b64_tr_b16 v[142:143], v144 offset:2560
  s_waitcnt lgkmcnt(15)
  v_mfma_f32_32x32x16_bf16 v[16:31], v[196:199], v[128:131], v[16:31]
  ds_read_b64_tr_b16 v[196:197], v145 offset:2048
  ds_read_b64_tr_b16 v[198:199], v145 offset:2560
  s_waitcnt lgkmcnt(15)
  v_mfma_f32_32x32x16_bf16 v[32:47], v[200:203], v[128:131], v[32:47]
  ds_read_b64_tr_b16 v[200:201], v146 offset:2048
  ds_read_b64_tr_b16 v[202:203], v146 offset:2560
  s_waitcnt lgkmcnt(15)
  v_mfma_f32_32x32x16_bf16 v[48:63], v[204:207], v[128:131], v[48:63]
  ds_read_b64_tr_b16 v[204:205], v147 offset:2048
  ds_read_b64_tr_b16 v[206:207], v147 offset:2560
  s_waitcnt lgkmcnt(15)
  v_mfma_f32_32x32x16_bf16 v[64:79], v[208:211], v[128:131], v[64:79]
  ds_read_b64_tr_b16 v[208:209], v148 offset:2048
  ds_read_b64_tr_b16 v[210:211], v148 offset:2560
  s_waitcnt lgkmcnt(15)
  v_mfma_f32_32x32x16_bf16 v[80:95], v[212:215], v[128:131], v[80:95]
  ds_read_b64_tr_b16 v[212:213], v149 offset:2048
  ds_read_b64_tr_b16 v[214:215], v149 offset:2560
  s_waitcnt lgkmcnt(15)
  v_mfma_f32_32x32x16_bf16 v[96:111], v[216:219], v[128:131], v[96:111]
  ds_read_b64_tr_b16 v[216:217], v150 offset:2048
  ds_read_b64_tr_b16 v[218:219], v150 offset:2560
  s_waitcnt lgkmcnt(15)
  v_mfma_f32_32x32x16_bf16 v[112:127], v[220:223], v[128:131], v[112:127]
  ds_read_b64_tr_b16 v[220:221], v151 offset:2048
  ds_read_b64_tr_b16 v[222:223], v151 offset:2560
  s_waitcnt vmcnt(6)
  s_barrier
  s_waitcnt lgkmcnt(14)
  v_mfma_f32_32x32x16_bf16 v[0:15], v[140:143], v[132:135], v[0:15]
  ds_read_b128 v[128:131], v154 offset:0
  ds_read_b64_tr_b16 v[136:137], v144 offset:16384
  ds_read_b64_tr_b16 v[138:139], v144 offset:16896
  s_waitcnt lgkmcnt(15)
  v_mfma_f32_32x32x16_bf16 v[16:31], v[196:199], v[132:135], v[16:31]
  ds_read_b64_tr_b16 v[196:197], v145 offset:16384
  ds_read_b64_tr_b16 v[198:199], v145 offset:16896
  s_add_u32 m0, s47, 49152
  s_nop 0
  buffer_load_dwordx4 v160, s[12:15], s44 offen lds
  buffer_load_dwordx4 v161, s[12:15], s44 offen offset:1024 lds
  s_add_u32 s44, s44, s43
  s_waitcnt lgkmcnt(15)
  v_mfma_f32_32x32x16_bf16 v[32:47], v[200:203], v[132:135], v[32:47]
  ds_read_b64_tr_b16 v[200:201], v146 offset:16384
  ds_read_b64_tr_b16 v[202:203], v146 offset:16896
  buffer_load_dword v166, off, s[72:75], 0 offset:0 sc1
  s_waitcnt lgkmcnt(15)
  v_mfma_f32_32x32x16_bf16 v[48:63], v[204:207], v[132:135], v[48:63]
  ds_read_b64_tr_b16 v[204:205], v147 offset:16384
  ds_read_b64_tr_b16 v[206:207], v147 offset:16896
  s_waitcnt lgkmcnt(15)
  v_mfma_f32_32x32x16_bf16 v[64:79], v[208:211], v[132:135], v[64:79]
  ds_read_b64_tr_b16 v[208:209], v148 offset:16384
  ds_read_b64_tr_b16 v[210:211], v148 offset:16896
  s_waitcnt lgkmcnt(15)
  v_mfma_f32_32x32x16_bf16 v[80:95], v[212:215], v[132:135], v[80:95]
  ds_read_b64_tr_b16 v[212:213], v149 offset:16384
  ds_read_b64_tr_b16 v[214:215], v149 offset:16896
  s_waitcnt lgkmcnt(15)
  v_mfma_f32_32x32x16_bf16 v[96:111], v[216:219], v[132:135], v[96:111]
  ds_read_b64_tr_b16 v[216:217], v150 offset:16384
  ds_read_b64_tr_b16 v[218:219], v150 offset:16896
  s_waitcnt lgkmcnt(15)
  v_mfma_f32_32x32x16_bf16 v[112:127], v[220:223], v[132:135], v[112:127]
  ds_read_b64_tr_b16 v[220:221], v151 offset:16384
  ds_read_b64_tr_b16 v[222:223], v151 offset:16896
  s_waitcnt lgkmcnt(14)
  v_mfma_f32_32x32x16_bf16 v[0:15], v[136:139], v[128:131], v[0:15]
  ds_read_b128 v[132:135], v155 offset:0
  ds_read_b64_tr_b16 v[140:141], v144 offset:18432
  ds_read_b64_tr_b16 v[142:143], v144 offset:18944
  s_waitcnt lgkmcnt(15)
  v_mfma_f32_32x32x16_bf16 v[16:31], v[196:199], v[128:131], v[16:31]
  ds_read_b64_tr_b16 v[196:197], v145 offset:18432
  ds_read_b64_tr_b16 v[198:199], v145 offset:18944
  s_waitcnt lgkmcnt(15)
  v_mfma_f32_32x32x16_bf16 v[32:47], v[200:203], v[128:131], v[32:47]
  ds_read_b64_tr_b16 v[200:201], v146 offset:18432
  ds_read_b64_tr_b16 v[202:203], v146 offset:18944
  s_waitcnt lgkmcnt(15)
  v_mfma_f32_32x32x16_bf16 v[48:63], v[204:207], v[128:131], v[48:63]
  ds_read_b64_tr_b16 v[204:205], v147 offset:18432
  ds_read_b64_tr_b16 v[206:207], v147 offset:18944
  s_waitcnt lgkmcnt(15)
  v_mfma_f32_32x32x16_bf16 v[64:79], v[208:211], v[128:131], v[64:79]
  ds_read_b64_tr_b16 v[208:209], v148 offset:18432
  ds_read_b64_tr_b16 v[210:211], v148 offset:18944
  s_waitcnt lgkmcnt(15)
  v_mfma_f32_32x32x16_bf16 v[80:95], v[212:215], v[128:131], v[80:95]
  ds_read_b64_tr_b16 v[212:213], v149 offset:18432
  ds_read_b64_tr_b16 v[214:215], v149 offset:18944
  s_waitcnt lgkmcnt(15)
  v_mfma_f32_32x32x16_bf16 v[96:111], v[216:219], v[128:131], v[96:111]
  ds_read_b64_tr_b16 v[216:217], v150 offset:18432
  ds_read_b64_tr_b16 v[218:219], v150 offset:18944
  s_waitcnt lgkmcnt(15)
  v_mfma_f32_32x32x16_bf16 v[112:127], v[220:223], v[128:131], v[112:127]
  ds_read_b64_tr_b16 v[220:221], v151 offset:18432
  ds_read_b64_tr_b16 v[222:223], v151 offset:18944
  s_waitcnt vmcnt(7)
  s_barrier
  s_waitcnt lgkmcnt(14)
  v_mfma_f32_32x32x16_bf16 v[0:15], v[140:143], v[132:135], v[0:15]
  s_waitcnt vmcnt(3)
  ds_read_b128 v[128:131], v152 offset:32768
  ds_read_b64_tr_b16 v[136:137], v144 offset:32768
  ds_read_b64_tr_b16 v[138:139], v144 offset:33280
  s_waitcnt lgkmcnt(15)
  v_mfma_f32_32x32x16_bf16 v[16:31], v[196:199], v[132:135], v[16:31]
  ds_read_b64_tr_b16 v[196:197], v145 offset:32768
  ds_read_b64_tr_b16 v[198:199], v145 offset:33280
  s_add_u32 m0, s49, 0
  s_nop 0
  buffer_load_dwordx4 v171, s[16:19], s50 offen lds
  buffer_load_dwordx4 v172, s[16:19], s50 offen offset:1024 lds
  s_add_u32 s50, s50, 16384
  s_waitcnt lgkmcnt(15)
  v_mfma_f32_32x32x16_bf16 v[32:47], v[200:203], v[132:135], v[32:47]
  ds_read_b64_tr_b16 v[200:201], v146 offset:32768
  ds_read_b64_tr_b16 v[202:203], v146 offset:33280
  s_waitcnt vmcnt(2)
  v_cmp_ne_u32 vcc, 256, v166
  s_nop 1
  s_and_b32 s64, vcc_lo, 0x1
  s_cbranch_scc1 L_spin_st
L_ok_st:
  s_waitcnt lgkmcnt(15)
  v_mfma_f32_32x32x16_bf16 v[48:63], v[204:207], v[132:135], v[48:63]
  ds_read_b64_tr_b16 v[204:205], v147 offset:32768
  ds_read_b64_tr_b16 v[206:207], v147 offset:33280
  s_lshl_b32 s64, s42, 3
  s_add_u32 s64, s64, s40
  s_lshl_b32 s64, s64, 9
  v_and_b32 v168, 31, v175
  v_lshl_add_u32 v167, v168, 4, s64
  buffer_load_dwordx4 v[162:165], v167, s[80:83], 0 offen sc1
  v_lshrrev_b32 v167, 5, v175
  v_lshl_add_u32 v167, v168, 1, v167
  s_lshl_b32 s64, s41, 13
  s_add_u32 s64, s64, 65536
  v_lshl_add_u32 v167, v167, 4, s64
  s_waitcnt lgkmcnt(15)
  v_mfma_f32_32x32x16_bf16 v[64:79], v[208:211], v[132:135], v[64:79]
  ds_read_b64_tr_b16 v[208:209], v148 offset:32768
  ds_read_b64_tr_b16 v[210:211], v148 offset:33280
  s_xor_b32 s64, s40, 0
  s_lshl_b32 s64, s64, 10
  buffer_load_dwordx4 v[224:227], v167, s[80:83], s64 offen sc1
  s_waitcnt lgkmcnt(15)
  v_mfma_f32_32x32x16_bf16 v[80:95], v[212:215], v[132:135], v[80:95]
  ds_read_b64_tr_b16 v[212:213], v149 offset:32768
  ds_read_b64_tr_b16 v[214:215], v149 offset:33280
  s_xor_b32 s64, s40, 1
  s_lshl_b32 s64, s64, 10
  buffer_load_dwordx4 v[228:231], v167, s[80:83], s64 offen sc1
  s_waitcnt lgkmcnt(15)
  v_mfma_f32_32x32x16_bf16 v[96:111], v[216:219], v[132:135], v[96:111]
  ds_read_b64_tr_b16 v[216:217], v150 offset:32768
  ds_read_b64_tr_b16 v[218:219], v150 offset:33280
  s_xor_b32 s64, s40, 2
  s_lshl_b32 s64, s64, 10
  buffer_load_dwordx4 v[232:235], v167, s[80:83], s64 offen sc1
  s_waitcnt lgkmcnt(15)
  v_mfma_f32_32x32x16_bf16 v[112:127], v[220:223], v[132:135], v[112:127]
  ds_read_b64_tr_b16 v[220:221], v151 offset:32768
  ds_read_b64_tr_b16 v[222:223], v151 offset:33280
  s_xor_b32 s64, s40, 3
  s_lshl_b32 s64, s64, 10
  buffer_load_dwordx4 v[236:239], v167, s[80:83], s64 offen sc1
  s_waitcnt lgkmcnt(14)
  v_mfma_f32_32x32x16_bf16 v[0:15], v[136:139], v[128:131], v[0:15]
  ds_read_b128 v[132:135], v153 offset:32768
  ds_read_b64_tr_b16 v[140:141], v144 offset:34816
  ds_read_b64_tr_b16 v[142:143], v144 offset:35328
  s_xor_b32 s64, s40, 4
  s_lshl_b32 s64, s64, 10
  buffer_load_dwordx4 v[240:243], v167, s[80:83], s64 offen sc1
  s_waitcnt lgkmcnt(15)
  v_mfma_f32_32x32x16_bf16 v[16:31], v[196:199], v[128:131], v[16:31]
  ds_read_b64_tr_b16 v[196:197], v145 offset:34816
  ds_read_b64_tr_b16 v[198:199], v145 offset:35328
  s_waitcnt lgkmcnt(15)
  v_mfma_f32_32x32x16_bf16 v[32:47], v[200:203], v[128:131], v[32:47]
  ds_read_b64_tr_b16 v[200:201], v146 offset:34816
  ds_read_b64_tr_b16 v[202:203], v146 offset:35328
  s_xor_b32 s64, s40, 5
  s_lshl_b32 s64, s64, 10
  buffer_load_dwordx4 v[244:247], v167, s[80:83], s64 offen sc1
  s_waitcnt lgkmcnt(15)
  v_mfma_f32_32x32x16_bf16 v[48:63], v[204:207], v[128:131], v[48:63]
  ds_read_b64_tr_b16 v[204:205], v147 offset:34816
  ds_read_b64_tr_b16 v[206:207], v147 offset:35328
  s_waitcnt lgkmcnt(15)
  v_mfma_f32_32x32x16_bf16 v[64:79], v[208:211], v[128:131], v[64:79]
  ds_read_b64_tr_b16 v[208:209], v148 offset:34816
  ds_read_b64_tr_b16 v[210:211], v148 offset:35328
  s_xor_b32 s64, s40, 6
  s_lshl_b32 s64, s64, 10
  buffer_load_dwordx4 v[248:251], v167, s[80:83], s64 offen sc1
  s_waitcnt lgkmcnt(15)
  v_mfma_f32_32x32x16_bf16 v[80:95], v[212:215], v[128:131], v[80:95]
  ds_read_b64_tr_b16 v[212:213], v149 offset:34816
  ds_read_b64_tr_b16 v[214:215], v149 offset:35328
  s_waitcnt lgkmcnt(15)
  v_mfma_f32_32x32x16_bf16 v[96:111], v[216:219], v[128:131], v[96:111]
  ds_read_b64_tr_b16 v[216:217], v150 offset:34816
  ds_read_b64_tr_b16 v[218:219], v150 offset:35328
  s_xor_b32 s64, s40, 7
  s_lshl_b32 s64, s64, 10
  buffer_load_dwordx4 v[252:255], v167, s[80:83], s64 offen sc1
  s_waitcnt lgkmcnt(15)
  v_mfma_f32_32x32x16_bf16 v[112:127], v[220:223], v[128:131], v[112:127]
  ds_read_b64_tr_b16 v[220:221], v151 offset:34816
  ds_read_b64_tr_b16 v[222:223], v151 offset:35328
  s_barrier
  s_waitcnt lgkmcnt(14)
  v_mfma_f32_32x32x16_bf16 v[0:15], v[140:143], v[132:135], v[0:15]
  ds_read_b128 v[128:131], v154 offset:32768
  ds_read_b64_tr_b16 v[136:137], v144 offset:49152
  ds_read_b64_tr_b16 v[138:139], v144 offset:49664
  s_waitcnt lgkmcnt(15)
  v_mfma_f32_32x32x16_bf16 v[16:31], v[196:199], v[132:135], v[16:31]
  ds_read_b64_tr_b16 v[196:197], v145 offset:49152
  ds_read_b64_tr_b16 v[198:199], v145 offset:49664
  s_add_u32 m0, s49, 16384
  s_nop 0
  buffer_load_dwordx4 v171, s[16:19], s50 offen lds
  buffer_load_dwordx4 v172, s[16:19], s50 offen offset:1024 lds
  s_add_u32 s50, s50, 16384
  s_waitcnt lgkmcnt(15)
  v_mfma_f32_32x32x16_bf16 v[32:47], v[200:203], v[132:135], v[32:47]
  ds_read_b64_tr_b16 v[200:201], v146 offset:49152
  ds_read_b64_tr_b16 v[202:203], v146 offset:49664
  s_waitcnt lgkmcnt(15)
  v_mfma_f32_32x32x16_bf16 v[48:63], v[204:207], v[132:135], v[48:63]
  ds_read_b64_tr_b16 v[204:205], v147 offset:49152
  ds_read_b64_tr_b16 v[206:207], v147 offset:49664
  s_add_u32 m0, s49, 65536
  s_nop 0
  buffer_load_dwordx4 v173, s[20:23], s51 offen lds
  buffer_load_dwordx4 v173, s[20:23], s51 offen offset:1024 lds
  s_add_u32 s51, s51, 16384
  s_waitcnt lgkmcnt(15)
  v_mfma_f32_32x32x16_bf16 v[64:79], v[208:211], v[132:135], v[64:79]
  ds_read_b64_tr_b16 v[208:209], v148 offset:49152
  ds_read_b64_tr_b16 v[210:211], v148 offset:49664
  s_waitcnt lgkmcnt(15)
  v_mfma_f32_32x32x16_bf16 v[80:95], v[212:215], v[132:135], v[80:95]
  ds_read_b64_tr_b16 v[212:213], v149 offset:49152
  ds_read_b64_tr_b16 v[214:215], v149 offset:49664
  s_waitcnt lgkmcnt(15)
  v_mfma_f32_32x32x16_bf16 v[96:111], v[216:219], v[132:135], v[96:111]
  ds_read_b64_tr_b16 v[216:217], v150 offset:49152
  ds_read_b64_tr_b16 v[218:219], v150 offset:49664
  s_waitcnt lgkmcnt(15)
  v_mfma_f32_32x32x16_bf16 v[112:127], v[220:223], v[132:135], v[112:127]
  ds_read_b64_tr_b16 v[220:221], v151 offset:49152
  ds_read_b64_tr_b16 v[222:223], v151 offset:49664
  s_waitcnt lgkmcnt(14)
  v_mfma_f32_32x32x16_bf16 v[0:15], v[136:139], v[128:131], v[0:15]
  ds_read_b128 v[132:135], v155 offset:32768
  ds_read_b64_tr_b16 v[140:141], v144 offset:51200
  ds_read_b64_tr_b16 v[142:143], v144 offset:51712
  s_waitcnt lgkmcnt(15)
  v_mfma_f32_32x32x16_bf16 v[16:31], v[196:199], v[128:131], v[16:31]
  ds_read_b64_tr_b16 v[196:197], v145 offset:51200
  ds_read_b64_tr_b16 v[198:199], v145 offset:51712
  s_waitcnt lgkmcnt(15)
  v_mfma_f32_32x32x16_bf16 v[32:47], v[200:203], v[128:131], v[32:47]
  ds_read_b64_tr_b16 v[200:201], v146 offset:51200
  ds_read_b64_tr_b16 v[202:203], v146 offset:51712
  s_waitcnt lgkmcnt(15)
  v_mfma_f32_32x32x16_bf16 v[48:63], v[204:207], v[128:131], v[48:63]
  ds_read_b64_tr_b16 v[204:205], v147 offset:51200
  ds_read_b64_tr_b16 v[206:207], v147 offset:51712
  s_waitcnt lgkmcnt(15)
  v_mfma_f32_32x32x16_bf16 v[64:79], v[208:211], v[128:131], v[64:79]
  ds_read_b64_tr_b16 v[208:209], v148 offset:51200
  ds_read_b64_tr_b16 v[210:211], v148 offset:51712
  s_waitcnt lgkmcnt(15)
  v_mfma_f32_32x32x16_bf16 v[80:95], v[212:215], v[128:131], v[80:95]
  ds_read_b64_tr_b16 v[212:213], v149 offset:51200
  ds_read_b64_tr_b16 v[214:215], v149 offset:51712
  s_waitcnt lgkmcnt(15)
  v_mfma_f32_32x32x16_bf16 v[96:111], v[216:219], v[128:131], v[96:111]
  ds_read_b64_tr_b16 v[216:217], v150 offset:51200
  ds_read_b64_tr_b16 v[218:219], v150 offset:51712
  s_waitcnt lgkmcnt(15)
  v_mfma_f32_32x32x16_bf16 v[112:127], v[220:223], v[128:131], v[112:127]
  ds_read_b64_tr_b16 v[220:221], v151 offset:51200
  ds_read_b64_tr_b16 v[222:223], v151 offset:51712
  s_waitcnt lgkmcnt(14)
  v_mfma_f32_32x32x16_bf16 v[0:15], v[140:143], v[132:135], v[0:15]
  v_mov_b32 v160, v170
  v_mov_b32 v161, v169
  s_waitcnt lgkmcnt(12)
  v_mfma_f32_32x32x16_bf16 v[16:31], v[196:199], v[132:135], v[16:31]
  s_waitcnt lgkmcnt(10)
  v_mfma_f32_32x32x16_bf16 v[32:47], v[200:203], v[132:135], v[32:47]
  s_waitcnt lgkmcnt(8)
  v_mfma_f32_32x32x16_bf16 v[48:63], v[204:207], v[132:135], v[48:63]
  s_waitcnt lgkmcnt(6)
  v_mfma_f32_32x32x16_bf16 v[64:79], v[208:211], v[132:135], v[64:79]
  s_waitcnt lgkmcnt(4)
  v_mfma_f32_32x32x16_bf16 v[80:95], v[212:215], v[132:135], v[80:95]
  s_waitcnt lgkmcnt(2)
  v_mfma_f32_32x32x16_bf16 v[96:111], v[216:219], v[132:135], v[96:111]
  s_waitcnt lgkmcnt(0)
  v_mfma_f32_32x32x16_bf16 v[112:127], v[220:223], v[132:135], v[112:127]
  s_waitcnt vmcnt(12)
  v_mov_b32 v128, v162
  v_mov_b32 v129, v162
  v_mov_b32 v130, v162
  v_mov_b32 v131, v162
  s_cmp_ge_u32 s40, 4
  s_cbranch_scc1 L_grpB
  s_waitcnt vmcnt(11)
  v_mfma_f32_32x32x16_bf16 v[0:15], v[224:227], v[128:131], v[0:15]
  s_waitcnt vmcnt(10)
  v_mfma_f32_32x32x16_bf16 v[16:31], v[228:231], v[128:131], v[16:31]
  s_waitcnt vmcnt(9)
  v_mfma_f32_32x32x16_bf16 v[32:47], v[232:235], v[128:131], v[32:47]
  s_waitcnt vmcnt(8)
  v_mfma_f32_32x32x16_bf16 v[48:63], v[236:239], v[128:131], v[48:63]
  s_waitcnt vmcnt(7)
  v_mfma_f32_32x32x16_bf16 v[64:79], v[240:243], v[128:131], v[64:79]
  s_waitcnt vmcnt(6)
  v_mfma_f32_32x32x16_bf16 v[80:95], v[244:247], v[128:131], v[80:95]
  s_waitcnt vmcnt(5)
  v_mfma_f32_32x32x16_bf16 v[96:111], v[248:251], v[128:131], v[96:111]
  s_waitcnt vmcnt(4)
  v_mfma_f32_32x32x16_bf16 v[112:127], v[252:255], v[128:131], v[112:127]
  v_pk_mul_f32 v[0:1], v[0:1], v[162:163] op_sel:[0,1] op_sel_hi:[1,1]
  v_pk_mul_f32 v[2:3], v[2:3], v[162:163] op_sel:[0,1] op_sel_hi:[1,1]
  v_cvt_pk_bf16_f32 v224, v0, v1
  v_cvt_pk_bf16_f32 v225, v2, v3
  v_pk_mul_f32 v[4:5], v[4:5], v[162:163] op_sel:[0,1] op_sel_hi:[1,1]
  v_pk_mul_f32 v[6:7], v[6:7], v[162:163] op_sel:[0,1] op_sel_hi:[1,1]
  v_cvt_pk_bf16_f32 v226, v4, v5
  v_cvt_pk_bf16_f32 v227, v6, v7
  v_pk_mul_f32 v[8:9], v[8:9], v[162:163] op_sel:[0,1] op_sel_hi:[1,1]
  v_pk_mul_f32 v[10:11], v[10:11], v[162:163] op_sel:[0,1] op_sel_hi:[1,1]
  v_cvt_pk_bf16_f32 v228, v8, v9
  v_cvt_pk_bf16_f32 v229, v10, v11
  v_pk_mul_f32 v[12:13], v[12:13], v[162:163] op_sel:[0,1] op_sel_hi:[1,1]
  v_pk_mul_f32 v[14:15], v[14:15], v[162:163] op_sel:[0,1] op_sel_hi:[1,1]
  v_cvt_pk_bf16_f32 v230, v12, v13
  v_cvt_pk_bf16_f32 v231, v14, v15
  v_pk_mul_f32 v[16:17], v[16:17], v[162:163] op_sel:[0,1] op_sel_hi:[1,1]
  v_pk_mul_f32 v[18:19], v[18:19], v[162:163] op_sel:[0,1] op_sel_hi:[1,1]
  v_cvt_pk_bf16_f32 v232, v16, v17
  v_cvt_pk_bf16_f32 v233, v18, v19
  v_pk_mul_f32 v[20:21], v[20:21], v[162:163] op_sel:[0,1] op_sel_hi:[1,1]
  v_pk_mul_f32 v[22:23], v[22:23], v[162:163] op_sel:[0,1] op_sel_hi:[1,1]
  v_cvt_pk_bf16_f32 v234, v20, v21
  v_cvt_pk_bf16_f32 v235, v22, v23
  v_pk_mul_f32 v[24:25], v[24:25], v[162:163] op_sel:[0,1] op_sel_hi:[1,1]
  v_pk_mul_f32 v[26:27], v[26:27], v[162:163] op_sel:[0,1] op_sel_hi:[1,1]
  v_cvt_pk_bf16_f32 v236, v24, v25
  v_cvt_pk_bf16_f32 v237, v26, v27
  v_pk_mul_f32 v[28:29], v[28:29], v[162:163] op_sel:[0,1] op_sel_hi:[1,1]
  v_pk_mul_f32 v[30:31], v[30:31], v[162:163] op_sel:[0,1] op_sel_hi:[1,1]
  v_cvt_pk_bf16_f32 v238, v28, v29
  v_cvt_pk_bf16_f32 v239, v30, v31
  v_pk_mul_f32 v[32:33], v[32:33], v[162:163] op_sel:[0,1] op_sel_hi:[1,1]
  v_pk_mul_f32 v[34:35], v[34:35], v[162:163] op_sel:[0,1] op_sel_hi:[1,1]
  v_cvt_pk_bf16_f32 v240, v32, v33
  v_cvt_pk_bf16_f32 v241, v34, v35
  v_pk_mul_f32 v[36:37], v[36:37], v[162:163] op_sel:[0,1] op_sel_hi:[1,1]
  v_pk_mul_f32 v[38:39], v[38:39], v[162:163] op_sel:[0,1] op_sel_hi:[1,1]
  v_cvt_pk_bf16_f32 v242, v36, v37
  v_cvt_pk_bf16_f32 v243, v38, v39
  v_pk_mul_f32 v[40:41], v[40:41], v[162:163] op_sel:[0,1] op_sel_hi:[1,1]
  v_pk_mul_f32 v[42:43], v[42:43], v[162:163] op_sel:[0,1] op_sel_hi:[1,1]
  v_cvt_pk_bf16_f32 v244, v40, v41
  v_cvt_pk_bf16_f32 v245, v42, v43
  v_pk_mul_f32 v[44:45], v[44:45], v[162:163] op_sel:[0,1] op_sel_hi:[1,1]
  v_pk_mul_f32 v[46:47], v[46:47], v[162:163] op_sel:[0,1] op_sel_hi:[1,1]
  v_cvt_pk_bf16_f32 v246, v44, v45
  v_cvt_pk_bf16_f32 v247, v46, v47
  v_pk_mul_f32 v[48:49], v[48:49], v[162:163] op_sel:[0,1] op_sel_hi:[1,1]
  v_pk_mul_f32 v[50:51], v[50:51], v[162:163] op_sel:[0,1] op_sel_hi:[1,1]
  v_cvt_pk_bf16_f32 v248, v48, v49
  v_cvt_pk_bf16_f32 v249, v50, v51
  v_pk_mul_f32 v[52:53], v[52:53], v[162:163] op_sel:[0,1] op_sel_hi:[1,1]
  v_pk_mul_f32 v[54:55], v[54:55], v[162:163] op_sel:[0,1] op_sel_hi:[1,1]
  v_cvt_pk_bf16_f32 v250, v52, v53
  v_cvt_pk_bf16_f32 v251, v54, v55
  v_pk_mul_f32 v[56:57], v[56:57], v[162:163] op_sel:[0,1] op_sel_hi:[1,1]
  v_pk_mul_f32 v[58:59], v[58:59], v[162:163] op_sel:[0,1] op_sel_hi:[1,1]
  v_cvt_pk_bf16_f32 v252, v56, v57
  v_cvt_pk_bf16_f32 v253, v58, v59
  v_pk_mul_f32 v[60:61], v[60:61], v[162:163] op_sel:[0,1] op_sel_hi:[1,1]
  v_pk_mul_f32 v[62:63], v[62:63], v[162:163] op_sel:[0,1] op_sel_hi:[1,1]
  v_cvt_pk_bf16_f32 v254, v60, v61
  v_cvt_pk_bf16_f32 v255, v62, v63
  ds_read_b128 v[192:195], v176 offset:0
  ds_read_b128 v[196:199], v176 offset:8192
  ds_read_b128 v[200:203], v177 offset:0
  ds_read_b128 v[204:207], v177 offset:8192
  ds_read_b128 v[208:211], v178 offset:0
  ds_read_b128 v[212:215], v178 offset:8192
  ds_read_b128 v[216:219], v179 offset:0
  ds_read_b128 v[220:223], v179 offset:8192
  v_pk_mul_f32 v[146:147], v[64:65], v[164:165] op_sel_hi:[1,0]
  v_pk_mul_f32 v[148:149], v[66:67], v[164:165] op_sel_hi:[1,0]
  v_exp_f32 v146, v146
  v_exp_f32 v147, v147
  v_exp_f32 v148, v148
  v_exp_f32 v149, v149
  v_pk_mul_f32 v[64:65], v[64:65], v[72:73]
  v_pk_mul_f32 v[66:67], v[66:67], v[74:75]
  v_pk_fma_f32 v[146:147], v[146:147], v[164:165], v[164:165] op_sel:[0,1,1] op_sel_hi:[1,1,1]
  v_pk_fma_f32 v[148:149], v[148:149], v[164:165], v[164:165] op_sel:[0,1,1] op_sel_hi:[1,1,1]
  v_rcp_f32 v146, v146
  v_rcp_f32 v147, v147
  v_rcp_f32 v148, v148
  v_rcp_f32 v149, v149
  v_pk_mul_f32 v[146:147], v[146:147], v[64:65]
  v_pk_mul_f32 v[148:149], v[148:149], v[66:67]
  v_cvt_pk_bf16_f32 v72, v146, v147
  v_cvt_pk_bf16_f32 v73, v148, v149
  v_pk_mul_f32 v[146:147], v[68:69], v[164:165] op_sel_hi:[1,0]
  v_pk_mul_f32 v[148:149], v[70:71], v[164:165] op_sel_hi:[1,0]
  v_exp_f32 v146, v146
  v_exp_f32 v147, v147
  v_exp_f32 v148, v148
  v_exp_f32 v149, v149
  v_pk_mul_f32 v[68:69], v[68:69], v[76:77]
  v_pk_mul_f32 v[70:71], v[70:71], v[78:79]
  v_pk_fma_f32 v[146:147], v[146:147], v[164:165], v[164:165] op_sel:[0,1,1] op_sel_hi:[1,1,1]
  v_pk_fma_f32 v[148:149], v[148:149], v[164:165], v[164:165] op_sel:[0,1,1] op_sel_hi:[1,1,1]
  v_rcp_f32 v146, v146
  v_rcp_f32 v147, v147
  v_rcp_f32 v148, v148
  v_rcp_f32 v149, v149
  v_pk_mul_f32 v[146:147], v[146:147], v[68:69]
  v_pk_mul_f32 v[148:149], v[148:149], v[70:71]
  v_cvt_pk_bf16_f32 v74, v146, v147
  v_cvt_pk_bf16_f32 v75, v148, v149
  buffer_store_dwordx4 v[72:75], v174, s[28:31], s52 offen sc1
  v_pk_mul_f32 v[146:147], v[80:81], v[164:165] op_sel_hi:[1,0]
  v_pk_mul_f32 v[148:149], v[82:83], v[164:165] op_sel_hi:[1,0]
  v_exp_f32 v146, v146
  v_exp_f32 v147, v147
  v_exp_f32 v148, v148
  v_exp_f32 v149, v149
  v_pk_mul_f32 v[80:81], v[80:81], v[88:89]
  v_pk_mul_f32 v[82:83], v[82:83], v[90:91]
  v_pk_fma_f32 v[146:147], v[146:147], v[164:165], v[164:165] op_sel:[0,1,1] op_sel_hi:[1,1,1]
  v_pk_fma_f32 v[148:149], v[148:149], v[164:165], v[164:165] op_sel:[0,1,1] op_sel_hi:[1,1,1]
  v_rcp_f32 v146, v146
  v_rcp_f32 v147, v147
  v_rcp_f32 v148, v148
  v_rcp_f32 v149, v149
  v_pk_mul_f32 v[146:147], v[146:147], v[80:81]
  v_pk_mul_f32 v[148:149], v[148:149], v[82:83]
  v_cvt_pk_bf16_f32 v88, v146, v147
  v_cvt_pk_bf16_f32 v89, v148, v149
  v_pk_mul_f32 v[146:147], v[84:85], v[164:165] op_sel_hi:[1,0]
  v_pk_mul_f32 v[148:149], v[86:87], v[164:165] op_sel_hi:[1,0]
  v_exp_f32 v146, v146
  v_exp_f32 v147, v147
  v_exp_f32 v148, v148
  v_exp_f32 v149, v149
  v_pk_mul_f32 v[84:85], v[84:85], v[92:93]
  v_pk_mul_f32 v[86:87], v[86:87], v[94:95]
  v_pk_fma_f32 v[146:147], v[146:147], v[164:165], v[164:165] op_sel:[0,1,1] op_sel_hi:[1,1,1]
  v_pk_fma_f32 v[148:149], v[148:149], v[164:165], v[164:165] op_sel:[0,1,1] op_sel_hi:[1,1,1]
  v_rcp_f32 v146, v146
  v_rcp_f32 v147, v147
  v_rcp_f32 v148, v148
  v_rcp_f32 v149, v149
  v_pk_mul_f32 v[146:147], v[146:147], v[84:85]
  v_pk_mul_f32 v[148:149], v[148:149], v[86:87]
  v_cvt_pk_bf16_f32 v90, v146, v147
  v_cvt_pk_bf16_f32 v91, v148, v149
  buffer_store_dwordx4 v[88:91], v174, s[28:31], s53 offen sc1
  v_pk_mul_f32 v[146:147], v[96:97], v[164:165] op_sel_hi:[1,0]
  v_pk_mul_f32 v[148:149], v[98:99], v[164:165] op_sel_hi:[1,0]
  v_exp_f32 v146, v146
  v_exp_f32 v147, v147
  v_exp_f32 v148, v148
  v_exp_f32 v149, v149
  v_pk_mul_f32 v[96:97], v[96:97], v[104:105]
  v_pk_mul_f32 v[98:99], v[98:99], v[106:107]
  v_pk_fma_f32 v[146:147], v[146:147], v[164:165], v[164:165] op_sel:[0,1,1] op_sel_hi:[1,1,1]
  v_pk_fma_f32 v[148:149], v[148:149], v[164:165], v[164:165] op_sel:[0,1,1] op_sel_hi:[1,1,1]
  v_rcp_f32 v146, v146
  v_rcp_f32 v147, v147
  v_rcp_f32 v148, v148
  v_rcp_f32 v149, v149
  v_pk_mul_f32 v[146:147], v[146:147], v[96:97]
  v_pk_mul_f32 v[148:149], v[148:149], v[98:99]
  v_cvt_pk_bf16_f32 v104, v146, v147
  v_cvt_pk_bf16_f32 v105, v148, v149
  v_pk_mul_f32 v[146:147], v[100:101], v[164:165] op_sel_hi:[1,0]
  v_pk_mul_f32 v[148:149], v[102:103], v[164:165] op_sel_hi:[1,0]
  v_exp_f32 v146, v146
  v_exp_f32 v147, v147
  v_exp_f32 v148, v148
  v_exp_f32 v149, v149
  v_pk_mul_f32 v[100:101], v[100:101], v[108:109]
  v_pk_mul_f32 v[102:103], v[102:103], v[110:111]
  v_pk_fma_f32 v[146:147], v[146:147], v[164:165], v[164:165] op_sel:[0,1,1] op_sel_hi:[1,1,1]
  v_pk_fma_f32 v[148:149], v[148:149], v[164:165], v[164:165] op_sel:[0,1,1] op_sel_hi:[1,1,1]
  v_rcp_f32 v146, v146
  v_rcp_f32 v147, v147
  v_rcp_f32 v148, v148
  v_rcp_f32 v149, v149
  v_pk_mul_f32 v[146:147], v[146:147], v[100:101]
  v_pk_mul_f32 v[148:149], v[148:149], v[102:103]
  v_cvt_pk_bf16_f32 v106, v146, v147
  v_cvt_pk_bf16_f32 v107, v148, v149
  buffer_store_dwordx4 v[104:107], v174, s[28:31], s54 offen sc1
  v_pk_mul_f32 v[146:147], v[112:113], v[164:165] op_sel_hi:[1,0]
  v_pk_mul_f32 v[148:149], v[114:115], v[164:165] op_sel_hi:[1,0]
  v_exp_f32 v146, v146
  v_exp_f32 v147, v147
  v_exp_f32 v148, v148
  v_exp_f32 v149, v149
  v_pk_mul_f32 v[112:113], v[112:113], v[120:121]
  v_pk_mul_f32 v[114:115], v[114:115], v[122:123]
  v_pk_fma_f32 v[146:147], v[146:147], v[164:165], v[164:165] op_sel:[0,1,1] op_sel_hi:[1,1,1]
  v_pk_fma_f32 v[148:149], v[148:149], v[164:165], v[164:165] op_sel:[0,1,1] op_sel_hi:[1,1,1]
  v_rcp_f32 v146, v146
  v_rcp_f32 v147, v147
  v_rcp_f32 v148, v148
  v_rcp_f32 v149, v149
  v_pk_mul_f32 v[146:147], v[146:147], v[112:113]
  v_pk_mul_f32 v[148:149], v[148:149], v[114:115]
  v_cvt_pk_bf16_f32 v120, v146, v147
  v_cvt_pk_bf16_f32 v121, v148, v149
  v_pk_mul_f32 v[146:147], v[116:117], v[164:165] op_sel_hi:[1,0]
  v_pk_mul_f32 v[148:149], v[118:119], v[164:165] op_sel_hi:[1,0]
  v_exp_f32 v146, v146
  v_exp_f32 v147, v147
  v_exp_f32 v148, v148
  v_exp_f32 v149, v149
  v_pk_mul_f32 v[116:117], v[116:117], v[124:125]
  v_pk_mul_f32 v[118:119], v[118:119], v[126:127]
  v_pk_fma_f32 v[146:147], v[146:147], v[164:165], v[164:165] op_sel:[0,1,1] op_sel_hi:[1,1,1]
  v_pk_fma_f32 v[148:149], v[148:149], v[164:165], v[164:165] op_sel:[0,1,1] op_sel_hi:[1,1,1]
  v_rcp_f32 v146, v146
  v_rcp_f32 v147, v147
  v_rcp_f32 v148, v148
  v_rcp_f32 v149, v149
  v_pk_mul_f32 v[146:147], v[146:147], v[116:117]
  v_pk_mul_f32 v[148:149], v[148:149], v[118:119]
  v_cvt_pk_bf16_f32 v122, v146, v147
  v_cvt_pk_bf16_f32 v123, v148, v149
  buffer_store_dwordx4 v[120:123], v174, s[28:31], s55 offen sc1
  s_setprio 0
  s_waitcnt lgkmcnt(7)
  v_mfma_f32_32x32x16_bf16 v[0:15], v[192:195], v[224:227], 0
  ds_read_b128 v[192:195], v180 offset:0
  s_waitcnt lgkmcnt(7)
  v_mfma_f32_32x32x16_bf16 v[16:31], v[196:199], v[224:227], 0
  ds_read_b128 v[196:199], v180 offset:8192
  s_waitcnt lgkmcnt(7)
  v_mfma_f32_32x32x16_bf16 v[0:15], v[200:203], v[228:231], v[0:15]
  ds_read_b128 v[200:203], v181 offset:0
  s_waitcnt lgkmcnt(7)
  v_mfma_f32_32x32x16_bf16 v[16:31], v[204:207], v[228:231], v[16:31]
  ds_read_b128 v[204:207], v181 offset:8192
  s_waitcnt lgkmcnt(7)
  v_mfma_f32_32x32x16_bf16 v[0:15], v[208:211], v[232:235], v[0:15]
  ds_read_b128 v[208:211], v182 offset:0
  s_waitcnt lgkmcnt(7)
  v_mfma_f32_32x32x16_bf16 v[16:31], v[212:215], v[232:235], v[16:31]
  ds_read_b128 v[212:215], v182 offset:8192
  s_waitcnt lgkmcnt(7)
  v_mfma_f32_32x32x16_bf16 v[0:15], v[216:219], v[236:239], v[0:15]
  ds_read_b128 v[216:219], v183 offset:0
  s_waitcnt lgkmcnt(7)
  v_mfma_f32_32x32x16_bf16 v[16:31], v[220:223], v[236:239], v[16:31]
  ds_read_b128 v[220:223], v183 offset:8192
  s_waitcnt lgkmcnt(7)
  v_mfma_f32_32x32x16_bf16 v[0:15], v[192:195], v[240:243], v[0:15]
  s_barrier
  v_subrev_u32 v176, 131072, v176
  v_subrev_u32 v177, 131072, v177
  v_subrev_u32 v178, 131072, v178
  v_subrev_u32 v179, 131072, v179
  v_subrev_u32 v180, 131072, v180
  v_subrev_u32 v181, 131072, v181
  v_subrev_u32 v182, 131072, v182
  v_subrev_u32 v183, 131072, v183
  ds_read_b128 v[192:195], v176 offset:0
  s_waitcnt lgkmcnt(7)
  v_mfma_f32_32x32x16_bf16 v[16:31], v[196:199], v[240:243], v[16:31]
  ds_read_b128 v[196:199], v176 offset:8192
  s_add_u32 m0, s49, 81920
  s_waitcnt lgkmcnt(7)
  v_mfma_f32_32x32x16_bf16 v[0:15], v[200:203], v[244:247], v[0:15]
  ds_read_b128 v[200:203], v177 offset:0
  buffer_load_dwordx4 v173, s[20:23], s51 offen lds
  s_waitcnt lgkmcnt(7)
  v_mfma_f32_32x32x16_bf16 v[16:31], v[204:207], v[244:247], v[16:31]
  ds_read_b128 v[204:207], v177 offset:8192
  buffer_load_dwordx4 v173, s[20:23], s51 offen offset:1024 lds
  s_waitcnt lgkmcnt(7)
  v_mfma_f32_32x32x16_bf16 v[0:15], v[208:211], v[248:251], v[0:15]
  ds_read_b128 v[208:211], v178 offset:0
  s_add_u32 s51, s51, 16384
  s_add_u32 m0, s49, 32768
  s_waitcnt lgkmcnt(7)
  v_mfma_f32_32x32x16_bf16 v[16:31], v[212:215], v[248:251], v[16:31]
  ds_read_b128 v[212:215], v178 offset:8192
  buffer_load_dwordx4 v171, s[16:19], s50 offen lds
  s_waitcnt lgkmcnt(7)
  v_mfma_f32_32x32x16_bf16 v[0:15], v[216:219], v[252:255], v[0:15]
  ds_read_b128 v[216:219], v179 offset:0
  buffer_load_dwordx4 v172, s[16:19], s50 offen offset:1024 lds
  s_waitcnt lgkmcnt(7)
  v_mfma_f32_32x32x16_bf16 v[16:31], v[220:223], v[252:255], v[16:31]
  ds_read_b128 v[220:223], v179 offset:8192
  s_add_u32 s50, s50, 16384
  s_nop 5
  v_max3_f32 v169, v0, v1, v2
  v_max3_f32 v169, v169, v3, v4
  v_max3_f32 v169, v169, v5, v6
  v_max3_f32 v169, v169, v7, v8
  v_max3_f32 v169, v169, v9, v10
  v_max3_f32 v169, v169, v11, v12
  v_max3_f32 v169, v169, v13, v14
  v_max3_f32 v169, v169, v15, v16
  v_max3_f32 v169, v169, v17, v18
  v_max3_f32 v169, v169, v19, v20
  v_max3_f32 v169, v169, v21, v22
  v_max3_f32 v169, v169, v23, v24
  v_max3_f32 v169, v169, v25, v26
  v_max3_f32 v169, v169, v27, v28
  v_max3_f32 v169, v169, v29, v30
  v_max_f32 v169, v169, v31
  v_mov_b32 v170, v169
  s_nop 1
  v_permlane32_swap_b32 v170, v169
  v_max_f32 v169, v169, v170
  v_sub_f32 v128, 0, v169
  v_sub_f32 v129, 0, v169
  v_pk_mov_b32 v[130:131], v[128:129], v[128:129]
  v_pk_mov_b32 v[132:133], v[128:129], v[128:129]
  v_pk_mov_b32 v[134:135], v[128:129], v[128:129]
  v_pk_mov_b32 v[136:137], v[128:129], v[128:129]
  v_pk_mov_b32 v[138:139], v[128:129], v[128:129]
  v_pk_mov_b32 v[140:141], v[128:129], v[128:129]
  v_pk_mov_b32 v[142:143], v[128:129], v[128:129]
  v_pk_add_f32 v[0:1], v[0:1], v[128:129]
  v_pk_add_f32 v[2:3], v[2:3], v[128:129]
  v_pk_add_f32 v[4:5], v[4:5], v[128:129]
  v_pk_add_f32 v[6:7], v[6:7], v[128:129]
  v_pk_add_f32 v[8:9], v[8:9], v[128:129]
  v_pk_add_f32 v[10:11], v[10:11], v[128:129]
  v_pk_add_f32 v[12:13], v[12:13], v[128:129]
  v_pk_add_f32 v[14:15], v[14:15], v[128:129]
  v_pk_add_f32 v[16:17], v[16:17], v[128:129]
  v_pk_add_f32 v[18:19], v[18:19], v[128:129]
  v_pk_add_f32 v[20:21], v[20:21], v[128:129]
  v_pk_add_f32 v[22:23], v[22:23], v[128:129]
  v_pk_add_f32 v[24:25], v[24:25], v[128:129]
  v_pk_add_f32 v[26:27], v[26:27], v[128:129]
  v_pk_add_f32 v[28:29], v[28:29], v[128:129]
  v_pk_add_f32 v[30:31], v[30:31], v[128:129]
  v_mov_b32 v162, 0
  s_setprio 1
  s_waitcnt lgkmcnt(7)
  v_mfma_f32_32x32x16_bf16 v[32:47], v[192:195], v[224:227], v[128:143]
  ds_read_b128 v[192:195], v180 offset:0
  v_exp_f32 v165, v0
  v_exp_f32 v166, v1
  s_nop 0
  v_add_f32 v163, v165, v166
  v_cvt_pk_bf16_f32 v144, v165, v166
  s_waitcnt lgkmcnt(7)
  v_mfma_f32_32x32x16_bf16 v[48:63], v[196:199], v[224:227], v[128:143]
  ds_read_b128 v[196:199], v180 offset:8192
  v_exp_f32 v167, v2
  v_exp_f32 v168, v3
  v_add_f32 v163, v163, v167
  v_add_f32 v163, v163, v168
  v_cvt_pk_bf16_f32 v145, v167, v168
  s_waitcnt lgkmcnt(7)
  v_mfma_f32_32x32x16_bf16 v[32:47], v[200:203], v[228:231], v[32:47]
  ds_read_b128 v[200:203], v181 offset:0
  v_exp_f32 v165, v4
  v_exp_f32 v166, v5
  v_add_f32 v163, v163, v165
  v_add_f32 v163, v163, v166
  v_cvt_pk_bf16_f32 v146, v165, v166
  s_waitcnt lgkmcnt(7)
  v_mfma_f32_32x32x16_bf16 v[48:63], v[204:207], v[228:231], v[48:63]
  ds_read_b128 v[204:207], v181 offset:8192
  v_exp_f32 v167, v6
  v_exp_f32 v168, v7
  v_add_f32 v163, v163, v167
  v_add_f32 v163, v163, v168
  v_cvt_pk_bf16_f32 v147, v167, v168
  s_waitcnt lgkmcnt(7)
  v_mfma_f32_32x32x16_bf16 v[32:47], v[208:211], v[232:235], v[32:47]
  ds_read_b128 v[208:211], v182 offset:0
  v_exp_f32 v165, v8
  v_exp_f32 v166, v9
  v_add_f32 v163, v163, v165
  v_add_f32 v163, v163, v166
  v_cvt_pk_bf16_f32 v148, v165, v166
  s_waitcnt lgkmcnt(7)
  v_mfma_f32_32x32x16_bf16 v[48:63], v[212:215], v[232:235], v[48:63]
  ds_read_b128 v[212:215], v182 offset:8192
  v_exp_f32 v167, v10
  v_exp_f32 v168, v11
  v_add_f32 v163, v163, v167
  v_add_f32 v163, v163, v168
  v_cvt_pk_bf16_f32 v149, v167, v168
  s_waitcnt lgkmcnt(7)
  v_mfma_f32_32x32x16_bf16 v[32:47], v[216:219], v[236:239], v[32:47]
  ds_read_b128 v[216:219], v183 offset:0
  v_exp_f32 v165, v12
  v_exp_f32 v166, v13
  v_add_f32 v163, v163, v165
  v_add_f32 v163, v163, v166
  v_cvt_pk_bf16_f32 v150, v165, v166
  s_waitcnt lgkmcnt(7)
  v_mfma_f32_32x32x16_bf16 v[48:63], v[220:223], v[236:239], v[48:63]
  ds_read_b128 v[220:223], v183 offset:8192
  v_exp_f32 v167, v14
  v_exp_f32 v168, v15
  v_add_f32 v163, v163, v167
  v_add_f32 v163, v163, v168
  v_cvt_pk_bf16_f32 v151, v167, v168
  s_waitcnt lgkmcnt(7)
  v_mfma_f32_32x32x16_bf16 v[32:47], v[192:195], v[240:243], v[32:47]
  ds_read_b64_tr_b16 v[192:193], v184 offset:0
  ds_read_b64_tr_b16 v[194:195], v184 offset:2048
  v_exp_f32 v165, v16
  v_exp_f32 v166, v17
  v_add_f32 v163, v163, v165
  v_add_f32 v163, v163, v166
  v_cvt_pk_bf16_f32 v152, v165, v166
  s_waitcnt lgkmcnt(8)
  v_mfma_f32_32x32x16_bf16 v[48:63], v[196:199], v[240:243], v[48:63]
  ds_read_b64_tr_b16 v[196:197], v185 offset:0
  ds_read_b64_tr_b16 v[198:199], v185 offset:2048
  v_exp_f32 v167, v18
  v_exp_f32 v168, v19
  v_add_f32 v163, v163, v167
  v_add_f32 v163, v163, v168
  v_cvt_pk_bf16_f32 v153, v167, v168
  s_waitcnt lgkmcnt(9)
  v_mfma_f32_32x32x16_bf16 v[32:47], v[200:203], v[244:247], v[32:47]
  ds_read_b64_tr_b16 v[200:201], v186 offset:0
  ds_read_b64_tr_b16 v[202:203], v186 offset:2048
  v_exp_f32 v165, v20
  v_exp_f32 v166, v21
  v_add_f32 v163, v163, v165
  v_add_f32 v163, v163, v166
  v_cvt_pk_bf16_f32 v154, v165, v166
  s_waitcnt lgkmcnt(10)
  v_mfma_f32_32x32x16_bf16 v[48:63], v[204:207], v[244:247], v[48:63]
  ds_read_b64_tr_b16 v[204:205], v187 offset:0
  ds_read_b64_tr_b16 v[206:207], v187 offset:2048
  v_exp_f32 v167, v22
  v_exp_f32 v168, v23
  v_add_f32 v163, v163, v167
  v_add_f32 v163, v163, v168
  v_cvt_pk_bf16_f32 v155, v167, v168
  s_waitcnt lgkmcnt(11)
  v_mfma_f32_32x32x16_bf16 v[32:47], v[208:211], v[248:251], v[32:47]
  ds_read_b64_tr_b16 v[208:209], v184 offset:4096
  ds_read_b64_tr_b16 v[210:211], v184 offset:6144
  v_exp_f32 v165, v24
  v_exp_f32 v166, v25
  v_add_f32 v163, v163, v165
  v_add_f32 v163, v163, v166
  v_cvt_pk_bf16_f32 v156, v165, v166
  s_waitcnt lgkmcnt(12)
  v_mfma_f32_32x32x16_bf16 v[48:63], v[212:215], v[248:251], v[48:63]
  ds_read_b64_tr_b16 v[212:213], v185 offset:4096
  ds_read_b64_tr_b16 v[214:215], v185 offset:6144
  v_exp_f32 v167, v26
  v_exp_f32 v168, v27
  v_add_f32 v163, v163, v167
  v_add_f32 v163, v163, v168
  v_cvt_pk_bf16_f32 v157, v167, v168
  s_waitcnt lgkmcnt(13)
  v_mfma_f32_32x32x16_bf16 v[32:47], v[216:219], v[252:255], v[32:47]
  ds_read_b64_tr_b16 v[216:217], v186 offset:4096
  ds_read_b64_tr_b16 v[218:219], v186 offset:6144
  v_exp_f32 v165, v28
  v_exp_f32 v166, v29
  v_add_f32 v163, v163, v165
  v_add_f32 v163, v163, v166
  v_cvt_pk_bf16_f32 v158, v165, v166
  s_waitcnt lgkmcnt(14)
  v_mfma_f32_32x32x16_bf16 v[48:63], v[220:223], v[252:255], v[48:63]
  ds_read_b64_tr_b16 v[220:221], v187 offset:4096
  ds_read_b64_tr_b16 v[222:223], v187 offset:6144
  v_exp_f32 v167, v30
  v_exp_f32 v168, v31
  v_add_f32 v163, v163, v167
  v_add_f32 v163, v163, v168
  v_cvt_pk_bf16_f32 v159, v167, v168
  v_add_f32 v162, v162, v163
  s_setprio 0
  s_waitcnt lgkmcnt(14)
  v_mfma_f32_32x32x16_bf16 v[64:79], v[192:195], v[144:147], 0
  ds_read_b64_tr_b16 v[192:193], v184 offset:8192
  ds_read_b64_tr_b16 v[194:195], v184 offset:10240
  s_waitcnt lgkmcnt(14)
  v_mfma_f32_32x32x16_bf16 v[80:95], v[196:199], v[144:147], 0
  ds_read_b64_tr_b16 v[196:197], v185 offset:8192
  ds_read_b64_tr_b16 v[198:199], v185 offset:10240
  s_waitcnt lgkmcnt(14)
  v_mfma_f32_32x32x16_bf16 v[96:111], v[200:203], v[144:147], 0
  ds_read_b64_tr_b16 v[200:201], v186 offset:8192
  ds_read_b64_tr_b16 v[202:203], v186 offset:10240
  s_waitcnt lgkmcnt(14)
  v_mfma_f32_32x32x16_bf16 v[112:127], v[204:207], v[144:147], 0
  ds_read_b64_tr_b16 v[204:205], v187 offset:8192
  ds_read_b64_tr_b16 v[206:207], v187 offset:10240
  s_waitcnt lgkmcnt(14)
  v_mfma_f32_32x32x16_bf16 v[64:79], v[208:211], v[148:151], v[64:79]
  ds_read_b64_tr_b16 v[208:209], v184 offset:12288
  ds_read_b64_tr_b16 v[210:211], v184 offset:14336
  v_exp_f32 v165, v32
  v_exp_f32 v166, v33
  s_waitcnt lgkmcnt(14)
  v_mfma_f32_32x32x16_bf16 v[80:95], v[212:215], v[148:151], v[80:95]
  ds_read_b64_tr_b16 v[212:213], v185 offset:12288
  ds_read_b64_tr_b16 v[214:215], v185 offset:14336
  v_add_f32 v163, v165, v166
  v_cvt_pk_bf16_f32 v144, v165, v166
  s_waitcnt lgkmcnt(14)
  v_mfma_f32_32x32x16_bf16 v[96:111], v[216:219], v[148:151], v[96:111]
  ds_read_b64_tr_b16 v[216:217], v186 offset:12288
  ds_read_b64_tr_b16 v[218:219], v186 offset:14336
  v_exp_f32 v167, v34
  v_exp_f32 v168, v35
  s_waitcnt lgkmcnt(14)
  v_mfma_f32_32x32x16_bf16 v[112:127], v[220:223], v[148:151], v[112:127]
  ds_read_b64_tr_b16 v[220:221], v187 offset:12288
  ds_read_b64_tr_b16 v[222:223], v187 offset:14336
  v_add_f32 v163, v163, v167
  v_add_f32 v163, v163, v168
  v_cvt_pk_bf16_f32 v145, v167, v168
  s_waitcnt lgkmcnt(14)
  v_mfma_f32_32x32x16_bf16 v[64:79], v[192:195], v[152:155], v[64:79]
  s_waitcnt vmcnt(10)
  s_waitcnt vmcnt(8)
  s_barrier
  ds_read_b128 v[192:195], v176 offset:16384
  v_exp_f32 v165, v36
  v_exp_f32 v166, v37
  s_waitcnt lgkmcnt(13)
  v_mfma_f32_32x32x16_bf16 v[80:95], v[196:199], v[152:155], v[80:95]
  ds_read_b128 v[196:199], v176 offset:24576
  s_add_u32 m0, s49, 49152
  s_nop 0
  buffer_load_dwordx4 v171, s[16:19], s50 offen lds
  buffer_load_dwordx4 v172, s[16:19], s50 offen offset:1024 lds
  s_add_u32 s50, s50, 16384
  v_add_f32 v163, v163, v165
  v_add_f32 v163, v163, v166
  v_cvt_pk_bf16_f32 v146, v165, v166
  s_waitcnt lgkmcnt(12)
  v_mfma_f32_32x32x16_bf16 v[96:111], v[200:203], v[152:155], v[96:111]
  ds_read_b128 v[200:203], v177 offset:16384
  s_add_u32 m0, s49, 98304
  s_nop 0
  buffer_load_dwordx4 v173, s[20:23], s51 offen lds
  buffer_load_dwordx4 v173, s[20:23], s51 offen offset:1024 lds
  s_add_u32 s51, s51, 16384
  v_exp_f32 v167, v38
  v_exp_f32 v168, v39
  s_waitcnt lgkmcnt(11)
  v_mfma_f32_32x32x16_bf16 v[112:127], v[204:207], v[152:155], v[112:127]
  ds_read_b128 v[204:207], v177 offset:24576
  v_add_f32 v163, v163, v167
  v_add_f32 v163, v163, v168
  v_cvt_pk_bf16_f32 v147, v167, v168
  s_waitcnt lgkmcnt(10)
  v_mfma_f32_32x32x16_bf16 v[64:79], v[208:211], v[156:159], v[64:79]
  ds_read_b128 v[208:211], v178 offset:16384
  v_exp_f32 v165, v40
  v_exp_f32 v166, v41
  s_waitcnt lgkmcnt(9)
  v_mfma_f32_32x32x16_bf16 v[80:95], v[212:215], v[156:159], v[80:95]
  ds_read_b128 v[212:215], v178 offset:24576
  v_add_f32 v163, v163, v165
  v_add_f32 v163, v163, v166
  v_cvt_pk_bf16_f32 v148, v165, v166
  s_waitcnt lgkmcnt(8)
  v_mfma_f32_32x32x16_bf16 v[96:111], v[216:219], v[156:159], v[96:111]
  ds_read_b128 v[216:219], v179 offset:16384
  v_exp_f32 v167, v42
  v_exp_f32 v168, v43
  s_waitcnt lgkmcnt(7)
  v_mfma_f32_32x32x16_bf16 v[112:127], v[220:223], v[156:159], v[112:127]
  ds_read_b128 v[220:223], v179 offset:24576
  v_add_f32 v163, v163, v167
  v_add_f32 v163, v163, v168
  v_cvt_pk_bf16_f32 v149, v167, v168
  s_setprio 1
  s_waitcnt lgkmcnt(7)
  v_mfma_f32_32x32x16_bf16 v[0:15], v[192:195], v[224:227], v[128:143]
  ds_read_b128 v[192:195], v180 offset:16384
  v_exp_f32 v165, v44
  v_exp_f32 v166, v45
  s_waitcnt lgkmcnt(7)
  v_mfma_f32_32x32x16_bf16 v[16:31], v[196:199], v[224:227], v[128:143]
  ds_read_b128 v[196:199], v180 offset:24576
  v_add_f32 v163, v163, v165
  v_add_f32 v163, v163, v166
  v_cvt_pk_bf16_f32 v150, v165, v166
  v_exp_f32 v167, v46
  s_waitcnt lgkmcnt(7)
  v_mfma_f32_32x32x16_bf16 v[0:15], v[200:203], v[228:231], v[0:15]
  ds_read_b128 v[200:203], v181 offset:16384
  v_exp_f32 v168, v47
  v_add_f32 v163, v163, v167
  v_add_f32 v163, v163, v168
  s_waitcnt lgkmcnt(7)
  v_mfma_f32_32x32x16_bf16 v[16:31], v[204:207], v[228:231], v[16:31]
  ds_read_b128 v[204:207], v181 offset:24576
  v_cvt_pk_bf16_f32 v151, v167, v168
  v_exp_f32 v165, v48
  v_exp_f32 v166, v49
  s_waitcnt lgkmcnt(7)
  v_mfma_f32_32x32x16_bf16 v[0:15], v[208:211], v[232:235], v[0:15]
  ds_read_b128 v[208:211], v182 offset:16384
  v_add_f32 v163, v163, v165
  v_add_f32 v163, v163, v166
  v_cvt_pk_bf16_f32 v152, v165, v166
  s_waitcnt lgkmcnt(7)
  v_mfma_f32_32x32x16_bf16 v[16:31], v[212:215], v[232:235], v[16:31]
  ds_read_b128 v[212:215], v182 offset:24576
  v_exp_f32 v167, v50
  v_exp_f32 v168, v51
  v_add_f32 v163, v163, v167
  s_waitcnt lgkmcnt(7)
  v_mfma_f32_32x32x16_bf16 v[0:15], v[216:219], v[236:239], v[0:15]
  ds_read_b128 v[216:219], v183 offset:16384
  v_add_f32 v163, v163, v168
  v_cvt_pk_bf16_f32 v153, v167, v168
  v_exp_f32 v165, v52
  s_waitcnt lgkmcnt(7)
  v_mfma_f32_32x32x16_bf16 v[16:31], v[220:223], v[236:239], v[16:31]
  ds_read_b128 v[220:223], v183 offset:24576
  v_exp_f32 v166, v53
  v_add_f32 v163, v163, v165
  v_add_f32 v163, v163, v166
  v_cvt_pk_bf16_f32 v154, v165, v166
  s_waitcnt lgkmcnt(7)
  v_mfma_f32_32x32x16_bf16 v[0:15], v[192:195], v[240:243], v[0:15]
  v_subrev_u32 v184, 81920, v184
  v_subrev_u32 v185, 81920, v185
  v_subrev_u32 v186, 81920, v186
  v_subrev_u32 v187, 81920, v187
  ds_read_b64_tr_b16 v[192:193], v184 offset:0
  ds_read_b64_tr_b16 v[194:195], v184 offset:2048
  v_exp_f32 v167, v54
  v_exp_f32 v168, v55
  s_waitcnt lgkmcnt(8)
  v_mfma_f32_32x32x16_bf16 v[16:31], v[196:199], v[240:243], v[16:31]
  ds_read_b64_tr_b16 v[196:197], v185 offset:0
  ds_read_b64_tr_b16 v[198:199], v185 offset:2048
  v_add_f32 v163, v163, v167
  v_add_f32 v163, v163, v168
  v_cvt_pk_bf16_f32 v155, v167, v168
  v_exp_f32 v165, v56
  s_waitcnt lgkmcnt(9)
  v_mfma_f32_32x32x16_bf16 v[0:15], v[200:203], v[244:247], v[0:15]
  ds_read_b64_tr_b16 v[200:201], v186 offset:0
  ds_read_b64_tr_b16 v[202:203], v186 offset:2048
  v_exp_f32 v166, v57
  v_add_f32 v163, v163, v165
  v_add_f32 v163, v163, v166
  s_waitcnt lgkmcnt(10)
  v_mfma_f32_32x32x16_bf16 v[16:31], v[204:207], v[244:247], v[16:31]
  ds_read_b64_tr_b16 v[204:205], v187 offset:0
  ds_read_b64_tr_b16 v[206:207], v187 offset:2048
  v_cvt_pk_bf16_f32 v156, v165, v166
  v_exp_f32 v167, v58
  v_exp_f32 v168, v59
  s_waitcnt lgkmcnt(11)
  v_mfma_f32_32x32x16_bf16 v[0:15], v[208:211], v[248:251], v[0:15]
  ds_read_b64_tr_b16 v[208:209], v184 offset:4096
  ds_read_b64_tr_b16 v[210:211], v184 offset:6144
  v_add_f32 v163, v163, v167
  v_add_f32 v163, v163, v168
  v_cvt_pk_bf16_f32 v157, v167, v168
  s_waitcnt lgkmcnt(12)
  v_mfma_f32_32x32x16_bf16 v[16:31], v[212:215], v[248:251], v[16:31]
  ds_read_b64_tr_b16 v[212:213], v185 offset:4096
  ds_read_b64_tr_b16 v[214:215], v185 offset:6144
  v_exp_f32 v165, v60
  v_exp_f32 v166, v61
  v_add_f32 v163, v163, v165
  s_waitcnt lgkmcnt(13)
  v_mfma_f32_32x32x16_bf16 v[0:15], v[216:219], v[252:255], v[0:15]
  ds_read_b64_tr_b16 v[216:217], v186 offset:4096
  ds_read_b64_tr_b16 v[218:219], v186 offset:6144
  v_add_f32 v163, v163, v166
  v_cvt_pk_bf16_f32 v158, v165, v166
  v_exp_f32 v167, v62
  s_waitcnt lgkmcnt(14)
  v_mfma_f32_32x32x16_bf16 v[16:31], v[220:223], v[252:255], v[16:31]
  ds_read_b64_tr_b16 v[220:221], v187 offset:4096
  ds_read_b64_tr_b16 v[222:223], v187 offset:6144
  v_exp_f32 v168, v63
  v_add_f32 v163, v163, v167
  v_add_f32 v163, v163, v168
  v_cvt_pk_bf16_f32 v159, v167, v168
  v_cmp_nle_f32 vcc, v163, s4
  s_nop 4
  s_cbranch_vccnz L_fb_0_1
L_ret_0_1:
  v_add_f32 v162, v162, v163
  s_setprio 0
  s_waitcnt lgkmcnt(14)
  v_mfma_f32_32x32x16_bf16 v[64:79], v[192:195], v[144:147], v[64:79]
  ds_read_b64_tr_b16 v[192:193], v184 offset:8192
  ds_read_b64_tr_b16 v[194:195], v184 offset:10240
  v_mov_b32 v166, -1
  v_mov_b32 v167, -1
  v_mov_b32 v168, -1
  v_mov_b32 v169, -1
  s_waitcnt lgkmcnt(14)
  v_mfma_f32_32x32x16_bf16 v[80:95], v[196:199], v[144:147], v[80:95]
  ds_read_b64_tr_b16 v[196:197], v185 offset:8192
  ds_read_b64_tr_b16 v[198:199], v185 offset:10240
  buffer_store_dwordx4 v[166:169], v161, s[88:91], 0 offen offset:0 sc1
  s_waitcnt lgkmcnt(14)
  v_mfma_f32_32x32x16_bf16 v[96:111], v[200:203], v[144:147], v[96:111]
  ds_read_b64_tr_b16 v[200:201], v186 offset:8192
  ds_read_b64_tr_b16 v[202:203], v186 offset:10240
  buffer_store_dwordx4 v[166:169], v161, s[88:91], s3 offen offset:0 sc1
  s_waitcnt lgkmcnt(14)
  v_mfma_f32_32x32x16_bf16 v[112:127], v[204:207], v[144:147], v[112:127]
  ds_read_b64_tr_b16 v[204:205], v187 offset:8192
  ds_read_b64_tr_b16 v[206:207], v187 offset:10240
  s_waitcnt lgkmcnt(14)
  v_mfma_f32_32x32x16_bf16 v[64:79], v[208:211], v[148:151], v[64:79]
  ds_read_b64_tr_b16 v[208:209], v184 offset:12288
  ds_read_b64_tr_b16 v[210:211], v184 offset:14336
  v_exp_f32 v165, v0
  v_exp_f32 v166, v1
  s_waitcnt lgkmcnt(14)
  v_mfma_f32_32x32x16_bf16 v[80:95], v[212:215], v[148:151], v[80:95]
  ds_read_b64_tr_b16 v[212:213], v185 offset:12288
  ds_read_b64_tr_b16 v[214:215], v185 offset:14336
  v_add_f32 v163, v165, v166
  v_cvt_pk_bf16_f32 v144, v165, v166
  s_waitcnt lgkmcnt(14)
  v_mfma_f32_32x32x16_bf16 v[96:111], v[216:219], v[148:151], v[96:111]
  ds_read_b64_tr_b16 v[216:217], v186 offset:12288
  ds_read_b64_tr_b16 v[218:219], v186 offset:14336
  v_exp_f32 v167, v2
  v_exp_f32 v168, v3
  s_waitcnt lgkmcnt(14)
  v_mfma_f32_32x32x16_bf16 v[112:127], v[220:223], v[148:151], v[112:127]
  ds_read_b64_tr_b16 v[220:221], v187 offset:12288
  ds_read_b64_tr_b16 v[222:223], v187 offset:14336
  v_add_f32 v163, v163, v167
  v_add_f32 v163, v163, v168
  v_cvt_pk_bf16_f32 v145, v167, v168
  s_waitcnt lgkmcnt(14)
  v_mfma_f32_32x32x16_bf16 v[64:79], v[192:195], v[152:155], v[64:79]
  s_waitcnt vmcnt(6)
  s_barrier
  s_cmp_lg_u32 s40, 0
  s_cbranch_scc1 L_sig_h
  v_mov_b32 v169, 1
  s_mov_b64 exec, 1
  buffer_store_dword v169, off, s[68:71], s65 sc1
  s_mov_b64 exec, -1
L_sig_h:
  ds_read_b128 v[192:195], v176 offset:32768
  v_exp_f32 v165, v4
  v_exp_f32 v166, v5
  s_waitcnt lgkmcnt(13)
  v_mfma_f32_32x32x16_bf16 v[80:95], v[196:199], v[152:155], v[80:95]
  ds_read_b128 v[196:199], v176 offset:40960
  s_add_u32 m0, s49, 0
  s_nop 0
  buffer_load_dwordx4 v171, s[16:19], s50 offen lds
  buffer_load_dwordx4 v172, s[16:19], s50 offen offset:1024 lds
  s_add_u32 s50, s50, 16384
  s_add_u32 m0, s49, 114688
  s_nop 0
  buffer_load_dwordx4 v173, s[20:23], s51 offen lds
  v_add_f32 v163, v163, v165
  v_add_f32 v163, v163, v166
  v_cvt_pk_bf16_f32 v146, v165, v166
  s_waitcnt lgkmcnt(12)
  v_mfma_f32_32x32x16_bf16 v[96:111], v[200:203], v[152:155], v[96:111]
  ds_read_b128 v[200:203], v177 offset:32768
  buffer_load_dwordx4 v173, s[20:23], s51 offen offset:1024 lds
  s_add_u32 s51, s51, 16384
  s_add_u32 m0, s49, 16384
  s_nop 0
  buffer_load_dwordx4 v171, s[16:19], s50 offen lds
  buffer_load_dwordx4 v172, s[16:19], s50 offen offset:1024 lds
  s_add_u32 s50, s50, 16384
  v_exp_f32 v167, v6
  v_exp_f32 v168, v7
  s_waitcnt lgkmcnt(11)
  v_mfma_f32_32x32x16_bf16 v[112:127], v[204:207], v[152:155], v[112:127]
  ds_read_b128 v[204:207], v177 offset:40960
  v_add_f32 v163, v163, v167
  v_add_f32 v163, v163, v168
  v_cvt_pk_bf16_f32 v147, v167, v168
  v_lshl_add_u32 v170, v175, 4, s97
  s_waitcnt lgkmcnt(10)
  v_mfma_f32_32x32x16_bf16 v[64:79], v[208:211], v[156:159], v[64:79]
  ds_read_b128 v[208:211], v178 offset:32768
  v_exp_f32 v165, v8
  v_exp_f32 v166, v9
  s_mov_b32 m0, 131072
  s_waitcnt lgkmcnt(9)
  v_mfma_f32_32x32x16_bf16 v[80:95], v[212:215], v[156:159], v[80:95]
  ds_read_b128 v[212:215], v178 offset:40960
  v_add_f32 v163, v163, v165
  v_add_f32 v163, v163, v166
  v_cvt_pk_bf16_f32 v148, v165, v166
  buffer_load_dwordx4 v170, s[32:35], 0 offen offset:0 lds
  buffer_load_dwordx4 v170, s[32:35], 0 offen offset:1024 lds
  s_waitcnt lgkmcnt(8)
  v_mfma_f32_32x32x16_bf16 v[96:111], v[216:219], v[156:159], v[96:111]
  ds_read_b128 v[216:219], v179 offset:32768
  v_exp_f32 v167, v10
  v_exp_f32 v168, v11
  buffer_load_dwordx4 v170, s[32:35], 0 offen offset:2048 lds
  s_waitcnt lgkmcnt(7)
  v_mfma_f32_32x32x16_bf16 v[112:127], v[220:223], v[156:159], v[112:127]
  ds_read_b128 v[220:223], v179 offset:40960
  v_add_f32 v163, v163, v167
  v_add_f32 v163, v163, v168
  v_cvt_pk_bf16_f32 v149, v167, v168
  s_add_u32 s97, s97, 3072
  s_setprio 1
  s_waitcnt lgkmcnt(7)
  v_mfma_f32_32x32x16_bf16 v[32:47], v[192:195], v[224:227], v[128:143]
  ds_read_b128 v[192:195], v180 offset:32768
  v_exp_f32 v165, v12
  v_exp_f32 v166, v13
  s_waitcnt lgkmcnt(7)
  v_mfma_f32_32x32x16_bf16 v[48:63], v[196:199], v[224:227], v[128:143]
  ds_read_b128 v[196:199], v180 offset:40960
  v_add_f32 v163, v163, v165
  v_add_f32 v163, v163, v166
  v_cvt_pk_bf16_f32 v150, v165, v166
  v_exp_f32 v167, v14
  s_waitcnt lgkmcnt(7)
  v_mfma_f32_32x32x16_bf16 v[32:47], v[200:203], v[228:231], v[32:47]
  ds_read_b128 v[200:203], v181 offset:32768
  v_exp_f32 v168, v15
  v_add_f32 v163, v163, v167
  v_add_f32 v163, v163, v168
  s_waitcnt lgkmcnt(7)
  v_mfma_f32_32x32x16_bf16 v[48:63], v[204:207], v[228:231], v[48:63]
  ds_read_b128 v[204:207], v181 offset:40960
  v_cvt_pk_bf16_f32 v151, v167, v168
  v_exp_f32 v165, v16
  v_exp_f32 v166, v17
  s_waitcnt lgkmcnt(7)
  v_mfma_f32_32x32x16_bf16 v[32:47], v[208:211], v[232:235], v[32:47]
  ds_read_b128 v[208:211], v182 offset:32768
  v_add_f32 v163, v163, v165
  v_add_f32 v163, v163, v166
  v_cvt_pk_bf16_f32 v152, v165, v166
  s_waitcnt lgkmcnt(7)
  v_mfma_f32_32x32x16_bf16 v[48:63], v[212:215], v[232:235], v[48:63]
  ds_read_b128 v[212:215], v182 offset:40960
  v_exp_f32 v167, v18
  v_exp_f32 v168, v19
  v_add_f32 v163, v163, v167
  s_waitcnt lgkmcnt(7)
  v_mfma_f32_32x32x16_bf16 v[32:47], v[216:219], v[236:239], v[32:47]
  ds_read_b128 v[216:219], v183 offset:32768
  v_add_f32 v163, v163, v168
  v_cvt_pk_bf16_f32 v153, v167, v168
  v_exp_f32 v165, v20
  s_waitcnt lgkmcnt(7)
  v_mfma_f32_32x32x16_bf16 v[48:63], v[220:223], v[236:239], v[48:63]
  ds_read_b128 v[220:223], v183 offset:40960
  v_exp_f32 v166, v21
  v_add_f32 v163, v163, v165
  v_add_f32 v163, v163, v166
  v_cvt_pk_bf16_f32 v154, v165, v166
  s_waitcnt lgkmcnt(7)
  v_mfma_f32_32x32x16_bf16 v[32:47], v[192:195], v[240:243], v[32:47]
  ds_read_b64_tr_b16 v[192:193], v184 offset:16384
  ds_read_b64_tr_b16 v[194:195], v184 offset:18432
  v_exp_f32 v167, v22
  v_exp_f32 v168, v23
  s_waitcnt lgkmcnt(8)
  v_mfma_f32_32x32x16_bf16 v[48:63], v[196:199], v[240:243], v[48:63]
  ds_read_b64_tr_b16 v[196:197], v185 offset:16384
  ds_read_b64_tr_b16 v[198:199], v185 offset:18432
  v_add_f32 v163, v163, v167
  v_add_f32 v163, v163, v168
  v_cvt_pk_bf16_f32 v155, v167, v168
  v_exp_f32 v165, v24
  s_waitcnt lgkmcnt(9)
  v_mfma_f32_32x32x16_bf16 v[32:47], v[200:203], v[244:247], v[32:47]
  ds_read_b64_tr_b16 v[200:201], v186 offset:16384
  ds_read_b64_tr_b16 v[202:203], v186 offset:18432
  v_exp_f32 v166, v25
  v_add_f32 v163, v163, v165
  v_add_f32 v163, v163, v166
  s_waitcnt lgkmcnt(10)
  v_mfma_f32_32x32x16_bf16 v[48:63], v[204:207], v[244:247], v[48:63]
  ds_read_b64_tr_b16 v[204:205], v187 offset:16384
  ds_read_b64_tr_b16 v[206:207], v187 offset:18432
  v_cvt_pk_bf16_f32 v156, v165, v166
  v_exp_f32 v167, v26
  v_exp_f32 v168, v27
  s_waitcnt lgkmcnt(11)
  v_mfma_f32_32x32x16_bf16 v[32:47], v[208:211], v[248:251], v[32:47]
  ds_read_b64_tr_b16 v[208:209], v184 offset:20480
  ds_read_b64_tr_b16 v[210:211], v184 offset:22528
  v_add_f32 v163, v163, v167
  v_add_f32 v163, v163, v168
  v_cvt_pk_bf16_f32 v157, v167, v168
  s_waitcnt lgkmcnt(12)
  v_mfma_f32_32x32x16_bf16 v[48:63], v[212:215], v[248:251], v[48:63]
  ds_read_b64_tr_b16 v[212:213], v185 offset:20480
  ds_read_b64_tr_b16 v[214:215], v185 offset:22528
  v_exp_f32 v165, v28
  v_exp_f32 v166, v29
  v_add_f32 v163, v163, v165
  s_waitcnt lgkmcnt(13)
  v_mfma_f32_32x32x16_bf16 v[32:47], v[216:219], v[252:255], v[32:47]
  ds_read_b64_tr_b16 v[216:217], v186 offset:20480
  ds_read_b64_tr_b16 v[218:219], v186 offset:22528
  v_add_f32 v163, v163, v166
  v_cvt_pk_bf16_f32 v158, v165, v166
  v_exp_f32 v167, v30
  s_waitcnt lgkmcnt(14)
  v_mfma_f32_32x32x16_bf16 v[48:63], v[220:223], v[252:255], v[48:63]
  ds_read_b64_tr_b16 v[220:221], v187 offset:20480
  ds_read_b64_tr_b16 v[222:223], v187 offset:22528
  v_exp_f32 v168, v31
  v_add_f32 v163, v163, v167
  v_add_f32 v163, v163, v168
  v_cvt_pk_bf16_f32 v159, v167, v168
  v_cmp_nle_f32 vcc, v163, s4
  s_nop 4
  s_cbranch_vccnz L_fb_0_2
L_ret_0_2:
  v_add_f32 v162, v162, v163
  s_setprio 0
  s_waitcnt lgkmcnt(14)
  v_mfma_f32_32x32x16_bf16 v[64:79], v[192:195], v[144:147], v[64:79]
  ds_read_b64_tr_b16 v[192:193], v184 offset:24576
  ds_read_b64_tr_b16 v[194:195], v184 offset:26624
  v_mov_b32 v166, -1
  v_mov_b32 v167, -1
  v_mov_b32 v168, -1
  v_mov_b32 v169, -1
  s_waitcnt lgkmcnt(14)
  v_mfma_f32_32x32x16_bf16 v[80:95], v[196:199], v[144:147], v[80:95]
  ds_read_b64_tr_b16 v[196:197], v185 offset:24576
  ds_read_b64_tr_b16 v[198:199], v185 offset:26624
  buffer_store_dwordx4 v[166:169], v161, s[88:91], 0 offen offset:256 sc1
  s_waitcnt lgkmcnt(14)
  v_mfma_f32_32x32x16_bf16 v[96:111], v[200:203], v[144:147], v[96:111]
  ds_read_b64_tr_b16 v[200:201], v186 offset:24576
  ds_read_b64_tr_b16 v[202:203], v186 offset:26624
  buffer_store_dwordx4 v[166:169], v161, s[88:91], s3 offen offset:256 sc1
  s_waitcnt lgkmcnt(14)
  v_mfma_f32_32x32x16_bf16 v[112:127], v[204:207], v[144:147], v[112:127]
  ds_read_b64_tr_b16 v[204:205], v187 offset:24576
  ds_read_b64_tr_b16 v[206:207], v187 offset:26624
  s_waitcnt lgkmcnt(14)
  v_mfma_f32_32x32x16_bf16 v[64:79], v[208:211], v[148:151], v[64:79]
  ds_read_b64_tr_b16 v[208:209], v184 offset:28672
  ds_read_b64_tr_b16 v[210:211], v184 offset:30720
  v_exp_f32 v165, v32
  v_exp_f32 v166, v33
  s_waitcnt lgkmcnt(14)
  v_mfma_f32_32x32x16_bf16 v[80:95], v[212:215], v[148:151], v[80:95]
  ds_read_b64_tr_b16 v[212:213], v185 offset:28672
  ds_read_b64_tr_b16 v[214:215], v185 offset:30720
  v_add_f32 v163, v165, v166
  v_cvt_pk_bf16_f32 v144, v165, v166
  s_waitcnt lgkmcnt(14)
  v_mfma_f32_32x32x16_bf16 v[96:111], v[216:219], v[148:151], v[96:111]
  ds_read_b64_tr_b16 v[216:217], v186 offset:28672
  ds_read_b64_tr_b16 v[218:219], v186 offset:30720
  v_exp_f32 v167, v34
  v_exp_f32 v168, v35
  s_waitcnt lgkmcnt(14)
  v_mfma_f32_32x32x16_bf16 v[112:127], v[220:223], v[148:151], v[112:127]
  ds_read_b64_tr_b16 v[220:221], v187 offset:28672
  ds_read_b64_tr_b16 v[222:223], v187 offset:30720
  v_add_f32 v163, v163, v167
  v_add_f32 v163, v163, v168
  v_cvt_pk_bf16_f32 v145, v167, v168
  s_waitcnt lgkmcnt(14)
  v_mfma_f32_32x32x16_bf16 v[64:79], v[192:195], v[152:155], v[64:79]
  s_waitcnt vmcnt(15)
  s_waitcnt vmcnt(13)
  s_barrier
  ds_read_b128 v[192:195], v176 offset:49152
  v_exp_f32 v165, v36
  v_exp_f32 v166, v37
  s_waitcnt lgkmcnt(13)
  v_mfma_f32_32x32x16_bf16 v[80:95], v[196:199], v[152:155], v[80:95]
  ds_read_b128 v[196:199], v176 offset:57344
  s_add_u32 m0, s49, 32768
  s_nop 0
  buffer_load_dwordx4 v171, s[16:19], s50 offen lds
  buffer_load_dwordx4 v172, s[16:19], s50 offen offset:1024 lds
  s_add_u32 s50, s50, 16384
  s_add_u32 m0, s49, 65536
  s_nop 0
  buffer_load_dwordx4 v173, s[20:23], s51 offen lds
  buffer_load_dwordx4 v173, s[20:23], s51 offen offset:1024 lds
  s_add_u32 s51, s51, 16384
  v_add_f32 v163, v163, v165
  v_add_f32 v163, v163, v166
  v_cvt_pk_bf16_f32 v146, v165, v166
  s_waitcnt lgkmcnt(12)
  v_mfma_f32_32x32x16_bf16 v[96:111], v[200:203], v[152:155], v[96:111]
  ds_read_b128 v[200:203], v177 offset:49152
  s_mul_i32 s64, s5, 14
  s_min_u32 s64, s64, 40
  v_exp_f32 v167, v38
  v_exp_f32 v168, v39
  s_waitcnt lgkmcnt(11)
  v_mfma_f32_32x32x16_bf16 v[112:127], v[204:207], v[152:155], v[112:127]
  ds_read_b128 v[204:207], v177 offset:57344
  s_mul_i32 s43, s64, 40960
  s_add_u32 s64, s64, 128
  v_add_f32 v163, v163, v167
  v_add_f32 v163, v163, v168
  v_cvt_pk_bf16_f32 v147, v167, v168
  v_lshl_add_u32 v170, v175, 4, s96
  s_waitcnt lgkmcnt(10)
  v_mfma_f32_32x32x16_bf16 v[64:79], v[208:211], v[156:159], v[64:79]
  ds_read_b128 v[208:211], v178 offset:49152
  s_lshl_b32 s44, s64, 13
  v_exp_f32 v165, v40
  v_exp_f32 v166, v41
  s_mov_b32 m0, 131072
  s_waitcnt lgkmcnt(9)
  v_mfma_f32_32x32x16_bf16 v[80:95], v[212:215], v[156:159], v[80:95]
  ds_read_b128 v[212:215], v178 offset:57344
  v_lshlrev_b32 v172, 4, v175
  v_add_u32 v172, s49, v172
  v_add_f32 v163, v163, v165
  v_add_f32 v163, v163, v166
  v_cvt_pk_bf16_f32 v148, v165, v166
  buffer_load_dwordx4 v170, s[36:39], 0 offen offset:0 lds
  s_waitcnt lgkmcnt(8)
  v_mfma_f32_32x32x16_bf16 v[96:111], v[216:219], v[156:159], v[96:111]
  ds_read_b128 v[216:219], v179 offset:49152
  s_and_b32 s64, s40, 3
  s_mul_i32 s45, s64, 5120
  v_exp_f32 v167, v42
  v_exp_f32 v168, v43
  buffer_load_dwordx4 v170, s[36:39], 0 offen offset:1024 lds
  s_waitcnt lgkmcnt(7)
  v_mfma_f32_32x32x16_bf16 v[112:127], v[220:223], v[156:159], v[112:127]
  ds_read_b128 v[220:223], v179 offset:57344
  v_and_b32 v164, 31, v175
  v_lshlrev_b32 v164, 2, v164
  v_add_f32 v163, v163, v167
  v_add_f32 v163, v163, v168
  v_cvt_pk_bf16_f32 v149, v167, v168
  s_add_u32 s96, s96, 2048
  s_setprio 1
  s_waitcnt lgkmcnt(7)
  v_mfma_f32_32x32x16_bf16 v[0:15], v[192:195], v[224:227], v[128:143]
  ds_read_b128 v[192:195], v180 offset:49152
  v_exp_f32 v165, v44
  v_exp_f32 v166, v45
  s_waitcnt lgkmcnt(7)
  v_mfma_f32_32x32x16_bf16 v[16:31], v[196:199], v[224:227], v[128:143]
  ds_read_b128 v[196:199], v180 offset:57344
  v_add_f32 v163, v163, v165
  v_add_f32 v163, v163, v166
  v_cvt_pk_bf16_f32 v150, v165, v166
  v_exp_f32 v167, v46
  s_waitcnt lgkmcnt(7)
  v_mfma_f32_32x32x16_bf16 v[0:15], v[200:203], v[228:231], v[0:15]
  ds_read_b128 v[200:203], v181 offset:49152
  v_exp_f32 v168, v47
  v_add_f32 v163, v163, v167
  v_add_f32 v163, v163, v168
  s_waitcnt lgkmcnt(7)
  v_mfma_f32_32x32x16_bf16 v[16:31], v[204:207], v[228:231], v[16:31]
  ds_read_b128 v[204:207], v181 offset:57344
  v_cvt_pk_bf16_f32 v151, v167, v168
  v_exp_f32 v165, v48
  v_exp_f32 v166, v49
  s_waitcnt lgkmcnt(7)
  v_mfma_f32_32x32x16_bf16 v[0:15], v[208:211], v[232:235], v[0:15]
  ds_read_b128 v[208:211], v182 offset:49152
  v_add_f32 v163, v163, v165
  v_add_f32 v163, v163, v166
  v_cvt_pk_bf16_f32 v152, v165, v166
  s_waitcnt lgkmcnt(7)
  v_mfma_f32_32x32x16_bf16 v[16:31], v[212:215], v[232:235], v[16:31]
  ds_read_b128 v[212:215], v182 offset:57344
  v_exp_f32 v167, v50
  v_exp_f32 v168, v51
  v_add_f32 v163, v163, v167
  s_waitcnt lgkmcnt(7)
  v_mfma_f32_32x32x16_bf16 v[0:15], v[216:219], v[236:239], v[0:15]
  ds_read_b128 v[216:219], v183 offset:49152
  v_add_f32 v163, v163, v168
  v_cvt_pk_bf16_f32 v153, v167, v168
  v_exp_f32 v165, v52
  s_waitcnt lgkmcnt(7)
  v_mfma_f32_32x32x16_bf16 v[16:31], v[220:223], v[236:239], v[16:31]
  ds_read_b128 v[220:223], v183 offset:57344
  v_exp_f32 v166, v53
  v_add_f32 v163, v163, v165
  v_add_f32 v163, v163, v166
  v_cvt_pk_bf16_f32 v154, v165, v166
  s_waitcnt lgkmcnt(7)
  v_mfma_f32_32x32x16_bf16 v[0:15], v[192:195], v[240:243], v[0:15]
  ds_read_b64_tr_b16 v[192:193], v184 offset:32768
  ds_read_b64_tr_b16 v[194:195], v184 offset:34816
  v_exp_f32 v167, v54
  v_exp_f32 v168, v55
  s_waitcnt lgkmcnt(8)
  v_mfma_f32_32x32x16_bf16 v[16:31], v[196:199], v[240:243], v[16:31]
  ds_read_b64_tr_b16 v[196:197], v185 offset:32768
  ds_read_b64_tr_b16 v[198:199], v185 offset:34816
  v_add_f32 v163, v163, v167
  v_add_f32 v163, v163, v168
  v_cvt_pk_bf16_f32 v155, v167, v168
  v_exp_f32 v165, v56
  s_waitcnt lgkmcnt(9)
  v_mfma_f32_32x32x16_bf16 v[0:15], v[200:203], v[244:247], v[0:15]
  ds_read_b64_tr_b16 v[200:201], v186 offset:32768
  ds_read_b64_tr_b16 v[202:203], v186 offset:34816
  v_exp_f32 v166, v57
  v_add_f32 v163, v163, v165
  v_add_f32 v163, v163, v166
  s_waitcnt lgkmcnt(10)
  v_mfma_f32_32x32x16_bf16 v[16:31], v[204:207], v[244:247], v[16:31]
  ds_read_b64_tr_b16 v[204:205], v187 offset:32768
  ds_read_b64_tr_b16 v[206:207], v187 offset:34816
  v_cvt_pk_bf16_f32 v156, v165, v166
  v_exp_f32 v167, v58
  v_exp_f32 v168, v59
  s_waitcnt lgkmcnt(11)
  v_mfma_f32_32x32x16_bf16 v[0:15], v[208:211], v[248:251], v[0:15]
  ds_read_b64_tr_b16 v[208:209], v184 offset:36864
  ds_read_b64_tr_b16 v[210:211], v184 offset:38912
  v_add_f32 v163, v163, v167
  v_add_f32 v163, v163, v168
  v_cvt_pk_bf16_f32 v157, v167, v168
  s_waitcnt lgkmcnt(12)
  v_mfma_f32_32x32x16_bf16 v[16:31], v[212:215], v[248:251], v[16:31]
  ds_read_b64_tr_b16 v[212:213], v185 offset:36864
  ds_read_b64_tr_b16 v[214:215], v185 offset:38912
  v_exp_f32 v165, v60
  v_exp_f32 v166, v61
  v_add_f32 v163, v163, v165
  s_waitcnt lgkmcnt(13)
  v_mfma_f32_32x32x16_bf16 v[0:15], v[216:219], v[252:255], v[0:15]
  ds_read_b64_tr_b16 v[216:217], v186 offset:36864
  ds_read_b64_tr_b16 v[218:219], v186 offset:38912
  v_add_f32 v163, v163, v166
  v_cvt_pk_bf16_f32 v158, v165, v166
  v_exp_f32 v167, v62
  s_waitcnt lgkmcnt(14)
  v_mfma_f32_32x32x16_bf16 v[16:31], v[220:223], v[252:255], v[16:31]
  ds_read_b64_tr_b16 v[220:221], v187 offset:36864
  ds_read_b64_tr_b16 v[222:223], v187 offset:38912
  v_exp_f32 v168, v63
  v_add_f32 v163, v163, v167
  v_add_f32 v163, v163, v168
  v_cvt_pk_bf16_f32 v159, v167, v168
  v_cmp_nle_f32 vcc, v163, s4
  s_nop 4
  s_cbranch_vccnz L_fb_0_3
L_ret_0_3:
  v_add_f32 v162, v162, v163
  s_setprio 0
  s_waitcnt lgkmcnt(14)
  v_mfma_f32_32x32x16_bf16 v[64:79], v[192:195], v[144:147], v[64:79]
  ds_read_b64_tr_b16 v[192:193], v184 offset:40960
  ds_read_b64_tr_b16 v[194:195], v184 offset:43008
  v_mov_b32 v166, -1
  v_mov_b32 v167, -1
  v_mov_b32 v168, -1
  v_mov_b32 v169, -1
  s_waitcnt lgkmcnt(14)
  v_mfma_f32_32x32x16_bf16 v[80:95], v[196:199], v[144:147], v[80:95]
  ds_read_b64_tr_b16 v[196:197], v185 offset:40960
  ds_read_b64_tr_b16 v[198:199], v185 offset:43008
  buffer_store_dwordx4 v[166:169], v161, s[88:91], 0 offen offset:512 sc1
  s_waitcnt lgkmcnt(14)
  v_mfma_f32_32x32x16_bf16 v[96:111], v[200:203], v[144:147], v[96:111]
  ds_read_b64_tr_b16 v[200:201], v186 offset:40960
  ds_read_b64_tr_b16 v[202:203], v186 offset:43008
  buffer_store_dwordx4 v[166:169], v161, s[88:91], s3 offen offset:512 sc1
  s_waitcnt lgkmcnt(14)
  v_mfma_f32_32x32x16_bf16 v[112:127], v[204:207], v[144:147], v[112:127]
  ds_read_b64_tr_b16 v[204:205], v187 offset:40960
  ds_read_b64_tr_b16 v[206:207], v187 offset:43008
  s_waitcnt lgkmcnt(14)
  v_mfma_f32_32x32x16_bf16 v[64:79], v[208:211], v[148:151], v[64:79]
  ds_read_b64_tr_b16 v[208:209], v184 offset:45056
  ds_read_b64_tr_b16 v[210:211], v184 offset:47104
  v_exp_f32 v165, v0
  v_exp_f32 v166, v1
  s_waitcnt lgkmcnt(14)
  v_mfma_f32_32x32x16_bf16 v[80:95], v[212:215], v[148:151], v[80:95]
  ds_read_b64_tr_b16 v[212:213], v185 offset:45056
  ds_read_b64_tr_b16 v[214:215], v185 offset:47104
  v_add_f32 v163, v165, v166
  v_cvt_pk_bf16_f32 v144, v165, v166
  s_waitcnt lgkmcnt(14)
  v_mfma_f32_32x32x16_bf16 v[96:111], v[216:219], v[148:151], v[96:111]
  ds_read_b64_tr_b16 v[216:217], v186 offset:45056
  ds_read_b64_tr_b16 v[218:219], v186 offset:47104
  v_exp_f32 v167, v2
  v_exp_f32 v168, v3
  s_waitcnt lgkmcnt(14)
  v_mfma_f32_32x32x16_bf16 v[112:127], v[220:223], v[148:151], v[112:127]
  ds_read_b64_tr_b16 v[220:221], v187 offset:45056
  ds_read_b64_tr_b16 v[222:223], v187 offset:47104
  v_add_f32 v163, v163, v167
  v_add_f32 v163, v163, v168
  v_cvt_pk_bf16_f32 v145, v167, v168
  s_waitcnt lgkmcnt(14)
  v_mfma_f32_32x32x16_bf16 v[64:79], v[192:195], v[152:155], v[64:79]
  s_waitcnt vmcnt(17)
  s_waitcnt vmcnt(15)
  s_barrier
  ds_read_b128 v[192:195], v176 offset:0
  v_exp_f32 v165, v4
  v_exp_f32 v166, v5
  s_waitcnt lgkmcnt(13)
  v_mfma_f32_32x32x16_bf16 v[80:95], v[196:199], v[152:155], v[80:95]
  ds_read_b128 v[196:199], v176 offset:8192
  buffer_load_dword v171, v164, s[68:71], 0 offen sc1
  s_add_u32 m0, s49, 81920
  s_nop 0
  buffer_load_dwordx4 v173, s[20:23], s51 offen lds
  buffer_load_dwordx4 v173, s[20:23], s51 offen offset:1024 lds
  s_add_u32 s51, s51, 16384
  v_add_f32 v163, v163, v165
  v_add_f32 v163, v163, v166
  v_cvt_pk_bf16_f32 v146, v165, v166
  s_waitcnt lgkmcnt(12)
  v_mfma_f32_32x32x16_bf16 v[96:111], v[200:203], v[152:155], v[96:111]
  ds_read_b128 v[200:203], v177 offset:0
  v_exp_f32 v167, v6
  v_exp_f32 v168, v7
  s_waitcnt lgkmcnt(11)
  v_mfma_f32_32x32x16_bf16 v[112:127], v[204:207], v[152:155], v[112:127]
  ds_read_b128 v[204:207], v177 offset:8192
  v_add_f32 v163, v163, v167
  v_add_f32 v163, v163, v168
  v_cvt_pk_bf16_f32 v147, v167, v168
  v_lshl_add_u32 v170, v175, 4, s96
  s_waitcnt lgkmcnt(10)
  v_mfma_f32_32x32x16_bf16 v[64:79], v[208:211], v[156:159], v[64:79]
  ds_read_b128 v[208:211], v178 offset:0
  v_exp_f32 v165, v8
  v_exp_f32 v166, v9
  s_mov_b32 m0, 49152
  s_waitcnt lgkmcnt(9)
  v_mfma_f32_32x32x16_bf16 v[80:95], v[212:215], v[156:159], v[80:95]
  ds_read_b128 v[212:215], v178 offset:8192
  v_add_f32 v163, v163, v165
  v_add_f32 v163, v163, v166
  v_cvt_pk_bf16_f32 v148, v165, v166
  buffer_load_dwordx4 v170, s[36:39], 0 offen offset:0 lds
  s_waitcnt lgkmcnt(8)
  v_mfma_f32_32x32x16_bf16 v[96:111], v[216:219], v[156:159], v[96:111]
  ds_read_b128 v[216:219], v179 offset:0
  v_exp_f32 v167, v10
  v_exp_f32 v168, v11
  buffer_load_dwordx4 v170, s[36:39], 0 offen offset:1024 lds
  s_waitcnt lgkmcnt(7)
  v_mfma_f32_32x32x16_bf16 v[112:127], v[220:223], v[156:159], v[112:127]
  ds_read_b128 v[220:223], v179 offset:8192
  v_add_f32 v163, v163, v167
  v_add_f32 v163, v163, v168
  v_cvt_pk_bf16_f32 v149, v167, v168
  s_add_u32 s96, s96, 2048
  s_setprio 1
  s_waitcnt lgkmcnt(7)
  v_mfma_f32_32x32x16_bf16 v[32:47], v[192:195], v[224:227], v[128:143]
  ds_read_b128 v[192:195], v180 offset:0
  v_exp_f32 v165, v12
  v_exp_f32 v166, v13
  s_waitcnt lgkmcnt(7)
  v_mfma_f32_32x32x16_bf16 v[48:63], v[196:199], v[224:227], v[128:143]
  ds_read_b128 v[196:199], v180 offset:8192
  v_add_f32 v163, v163, v165
  v_add_f32 v163, v163, v166
  v_cvt_pk_bf16_f32 v150, v165, v166
  v_exp_f32 v167, v14
  s_waitcnt lgkmcnt(7)
  v_mfma_f32_32x32x16_bf16 v[32:47], v[200:203], v[228:231], v[32:47]
  ds_read_b128 v[200:203], v181 offset:0
  v_exp_f32 v168, v15
  v_add_f32 v163, v163, v167
  v_add_f32 v163, v163, v168
  s_waitcnt lgkmcnt(7)
  v_mfma_f32_32x32x16_bf16 v[48:63], v[204:207], v[228:231], v[48:63]
  ds_read_b128 v[204:207], v181 offset:8192
  v_cvt_pk_bf16_f32 v151, v167, v168
  v_exp_f32 v165, v16
  v_exp_f32 v166, v17
  s_waitcnt lgkmcnt(7)
  v_mfma_f32_32x32x16_bf16 v[32:47], v[208:211], v[232:235], v[32:47]
  ds_read_b128 v[208:211], v182 offset:0
  v_add_f32 v163, v163, v165
  v_add_f32 v163, v163, v166
  v_cvt_pk_bf16_f32 v152, v165, v166
  s_waitcnt lgkmcnt(7)
  v_mfma_f32_32x32x16_bf16 v[48:63], v[212:215], v[232:235], v[48:63]
  ds_read_b128 v[212:215], v182 offset:8192
  v_exp_f32 v167, v18
  v_exp_f32 v168, v19
  v_add_f32 v163, v163, v167
  s_waitcnt lgkmcnt(7)
  v_mfma_f32_32x32x16_bf16 v[32:47], v[216:219], v[236:239], v[32:47]
  ds_read_b128 v[216:219], v183 offset:0
  v_add_f32 v163, v163, v168
  v_cvt_pk_bf16_f32 v153, v167, v168
  v_exp_f32 v165, v20
  s_waitcnt lgkmcnt(7)
  v_mfma_f32_32x32x16_bf16 v[48:63], v[220:223], v[236:239], v[48:63]
  ds_read_b128 v[220:223], v183 offset:8192
  v_exp_f32 v166, v21
  v_add_f32 v163, v163, v165
  v_add_f32 v163, v163, v166
  v_cvt_pk_bf16_f32 v154, v165, v166
  s_waitcnt lgkmcnt(7)
  v_mfma_f32_32x32x16_bf16 v[32:47], v[192:195], v[240:243], v[32:47]
  ds_read_b64_tr_b16 v[192:193], v184 offset:49152
  ds_read_b64_tr_b16 v[194:195], v184 offset:51200
  v_exp_f32 v167, v22
  v_exp_f32 v168, v23
  s_waitcnt lgkmcnt(8)
  v_mfma_f32_32x32x16_bf16 v[48:63], v[196:199], v[240:243], v[48:63]
  ds_read_b64_tr_b16 v[196:197], v185 offset:49152
  ds_read_b64_tr_b16 v[198:199], v185 offset:51200
  v_add_f32 v163, v163, v167
  v_add_f32 v163, v163, v168
  v_cvt_pk_bf16_f32 v155, v167, v168
  v_exp_f32 v165, v24
  s_waitcnt lgkmcnt(9)
  v_mfma_f32_32x32x16_bf16 v[32:47], v[200:203], v[244:247], v[32:47]
  ds_read_b64_tr_b16 v[200:201], v186 offset:49152
  ds_read_b64_tr_b16 v[202:203], v186 offset:51200
  v_exp_f32 v166, v25
  v_add_f32 v163, v163, v165
  v_add_f32 v163, v163, v166
  s_waitcnt lgkmcnt(10)
  v_mfma_f32_32x32x16_bf16 v[48:63], v[204:207], v[244:247], v[48:63]
  ds_read_b64_tr_b16 v[204:205], v187 offset:49152
  ds_read_b64_tr_b16 v[206:207], v187 offset:51200
  v_cvt_pk_bf16_f32 v156, v165, v166
  v_exp_f32 v167, v26
  v_exp_f32 v168, v27
  s_waitcnt lgkmcnt(11)
  v_mfma_f32_32x32x16_bf16 v[32:47], v[208:211], v[248:251], v[32:47]
  ds_read_b64_tr_b16 v[208:209], v184 offset:53248
  ds_read_b64_tr_b16 v[210:211], v184 offset:55296
  v_add_f32 v163, v163, v167
  v_add_f32 v163, v163, v168
  v_cvt_pk_bf16_f32 v157, v167, v168
  s_waitcnt lgkmcnt(12)
  v_mfma_f32_32x32x16_bf16 v[48:63], v[212:215], v[248:251], v[48:63]
  ds_read_b64_tr_b16 v[212:213], v185 offset:53248
  ds_read_b64_tr_b16 v[214:215], v185 offset:55296
  v_exp_f32 v165, v28
  v_exp_f32 v166, v29
  v_add_f32 v163, v163, v165
  s_waitcnt lgkmcnt(13)
  v_mfma_f32_32x32x16_bf16 v[32:47], v[216:219], v[252:255], v[32:47]
  ds_read_b64_tr_b16 v[216:217], v186 offset:53248
  ds_read_b64_tr_b16 v[218:219], v186 offset:55296
  v_add_f32 v163, v163, v166
  v_cvt_pk_bf16_f32 v158, v165, v166
  v_exp_f32 v167, v30
  s_waitcnt lgkmcnt(14)
  v_mfma_f32_32x32x16_bf16 v[48:63], v[220:223], v[252:255], v[48:63]
  ds_read_b64_tr_b16 v[220:221], v187 offset:53248
  ds_read_b64_tr_b16 v[222:223], v187 offset:55296
  v_exp_f32 v168, v31
  v_add_f32 v163, v163, v167
  v_add_f32 v163, v163, v168
  v_cvt_pk_bf16_f32 v159, v167, v168
  v_cmp_nle_f32 vcc, v163, s4
  s_nop 4
  s_cbranch_vccnz L_fb_0_4
L_ret_0_4:
  v_add_f32 v162, v162, v163
  s_setprio 0
  s_waitcnt lgkmcnt(14)
  v_mfma_f32_32x32x16_bf16 v[64:79], v[192:195], v[144:147], v[64:79]
  ds_read_b64_tr_b16 v[192:193], v184 offset:57344
  ds_read_b64_tr_b16 v[194:195], v184 offset:59392
  v_mov_b32 v166, -1
  v_mov_b32 v167, -1
  v_mov_b32 v168, -1
  v_mov_b32 v169, -1
  s_waitcnt lgkmcnt(14)
  v_mfma_f32_32x32x16_bf16 v[80:95], v[196:199], v[144:147], v[80:95]
  ds_read_b64_tr_b16 v[196:197], v185 offset:57344
  ds_read_b64_tr_b16 v[198:199], v185 offset:59392
  buffer_store_dwordx4 v[166:169], v161, s[88:91], 0 offen offset:768 sc1
  s_waitcnt lgkmcnt(14)
  v_mfma_f32_32x32x16_bf16 v[96:111], v[200:203], v[144:147], v[96:111]
  ds_read_b64_tr_b16 v[200:201], v186 offset:57344
  ds_read_b64_tr_b16 v[202:203], v186 offset:59392
  buffer_store_dwordx4 v[166:169], v161, s[88:91], s3 offen offset:768 sc1
  s_waitcnt lgkmcnt(14)
  v_mfma_f32_32x32x16_bf16 v[112:127], v[204:207], v[144:147], v[112:127]
  ds_read_b64_tr_b16 v[204:205], v187 offset:57344
  ds_read_b64_tr_b16 v[206:207], v187 offset:59392
  s_waitcnt lgkmcnt(14)
  v_mfma_f32_32x32x16_bf16 v[64:79], v[208:211], v[148:151], v[64:79]
  ds_read_b64_tr_b16 v[208:209], v184 offset:61440
  ds_read_b64_tr_b16 v[210:211], v184 offset:63488
  v_exp_f32 v165, v32
  v_exp_f32 v166, v33
  s_waitcnt lgkmcnt(14)
  v_mfma_f32_32x32x16_bf16 v[80:95], v[212:215], v[148:151], v[80:95]
  ds_read_b64_tr_b16 v[212:213], v185 offset:61440
  ds_read_b64_tr_b16 v[214:215], v185 offset:63488
  v_add_f32 v163, v165, v166
  v_cvt_pk_bf16_f32 v144, v165, v166
  s_waitcnt lgkmcnt(14)
  v_mfma_f32_32x32x16_bf16 v[96:111], v[216:219], v[148:151], v[96:111]
  ds_read_b64_tr_b16 v[216:217], v186 offset:61440
  ds_read_b64_tr_b16 v[218:219], v186 offset:63488
  v_exp_f32 v167, v34
  v_exp_f32 v168, v35
  s_waitcnt lgkmcnt(14)
  v_mfma_f32_32x32x16_bf16 v[112:127], v[220:223], v[148:151], v[112:127]
  ds_read_b64_tr_b16 v[220:221], v187 offset:61440
  ds_read_b64_tr_b16 v[222:223], v187 offset:63488
  v_add_f32 v163, v163, v167
  v_add_f32 v163, v163, v168
  v_cvt_pk_bf16_f32 v145, v167, v168
  s_waitcnt lgkmcnt(14)
  v_mfma_f32_32x32x16_bf16 v[64:79], v[192:195], v[152:155], v[64:79]
  s_waitcnt vmcnt(20)
  s_waitcnt vmcnt(11)
  s_barrier
  ds_read_b128 v[192:195], v176 offset:16384
  v_exp_f32 v165, v36
  v_exp_f32 v166, v37
  s_waitcnt lgkmcnt(13)
  v_mfma_f32_32x32x16_bf16 v[80:95], v[196:199], v[152:155], v[80:95]
  ds_read_b128 v[196:199], v176 offset:24576
  s_add_u32 m0, s49, 98304
  s_nop 0
  buffer_load_dwordx4 v173, s[20:23], s51 offen lds
  buffer_load_dwordx4 v173, s[20:23], s51 offen offset:1024 lds
  s_add_u32 s51, s51, 16384
  s_waitcnt vmcnt(8)
  v_cmp_ne_u32 vcc, 1, v171
  s_nop 1
  s_and_b32 s64, vcc_lo, 0xff
  s_cbranch_scc1 L_spin_h0
L_ok_h0:
  s_and_b32 s64, s65, 12
  s_lshl_b32 s64, s64, 12
  s_add_u32 s64, s64, 49152
  s_add_u32 s64, s64, s44
  s_add_u32 m0, s49, 49152
  s_nop 0
  buffer_load_dwordx4 v172, s[84:87], s64 offen offset:0 sc1 lds
  buffer_load_dwordx4 v172, s[84:87], s64 offen offset:1024 sc1 lds
  v_add_f32 v163, v163, v165
  v_add_f32 v163, v163, v166
  v_cvt_pk_bf16_f32 v146, v165, v166
  s_waitcnt lgkmcnt(12)
  v_mfma_f32_32x32x16_bf16 v[96:111], v[200:203], v[152:155], v[96:111]
  ds_read_b128 v[200:203], v177 offset:16384
  v_exp_f32 v167, v38
  v_exp_f32 v168, v39
  s_waitcnt lgkmcnt(11)
  v_mfma_f32_32x32x16_bf16 v[112:127], v[204:207], v[152:155], v[112:127]
  ds_read_b128 v[204:207], v177 offset:24576
  v_add_f32 v163, v163, v167
  v_add_f32 v163, v163, v168
  v_cvt_pk_bf16_f32 v147, v167, v168
  v_lshl_add_u32 v170, v175, 4, s96
  s_waitcnt lgkmcnt(10)
  v_mfma_f32_32x32x16_bf16 v[64:79], v[208:211], v[156:159], v[64:79]
  ds_read_b128 v[208:211], v178 offset:16384
  v_exp_f32 v165, v40
  v_exp_f32 v166, v41
  s_mov_b32 m0, 49152
  s_waitcnt lgkmcnt(9)
  v_mfma_f32_32x32x16_bf16 v[80:95], v[212:215], v[156:159], v[80:95]
  ds_read_b128 v[212:215], v178 offset:24576
  v_add_f32 v163, v163, v165
  v_add_f32 v163, v163, v166
  v_cvt_pk_bf16_f32 v148, v165, v166
  s_waitcnt lgkmcnt(8)
  v_mfma_f32_32x32x16_bf16 v[96:111], v[216:219], v[156:159], v[96:111]
  ds_read_b128 v[216:219], v179 offset:16384
  v_exp_f32 v167, v42
  v_exp_f32 v168, v43
  buffer_load_dwordx4 v170, s[36:39], 0 offen offset:0 lds
  s_waitcnt lgkmcnt(7)
  v_mfma_f32_32x32x16_bf16 v[112:127], v[220:223], v[156:159], v[112:127]
  ds_read_b128 v[220:223], v179 offset:24576
  v_add_f32 v163, v163, v167
  v_add_f32 v163, v163, v168
  v_cvt_pk_bf16_f32 v149, v167, v168
  s_add_u32 s96, s96, 1024
  s_setprio 1
  s_waitcnt lgkmcnt(7)
  v_mfma_f32_32x32x16_bf16 v[0:15], v[192:195], v[224:227], v[128:143]
  ds_read_b128 v[192:195], v180 offset:16384
  v_exp_f32 v165, v44
  v_exp_f32 v166, v45
  s_waitcnt lgkmcnt(7)
  v_mfma_f32_32x32x16_bf16 v[16:31], v[196:199], v[224:227], v[128:143]
  ds_read_b128 v[196:199], v180 offset:24576
  v_add_f32 v163, v163, v165
  v_add_f32 v163, v163, v166
  v_cvt_pk_bf16_f32 v150, v165, v166
  v_exp_f32 v167, v46
  s_waitcnt lgkmcnt(7)
  v_mfma_f32_32x32x16_bf16 v[0:15], v[200:203], v[228:231], v[0:15]
  ds_read_b128 v[200:203], v181 offset:16384
  v_exp_f32 v168, v47
  v_add_f32 v163, v163, v167
  v_add_f32 v163, v163, v168
  s_waitcnt lgkmcnt(7)
  v_mfma_f32_32x32x16_bf16 v[16:31], v[204:207], v[228:231], v[16:31]
  ds_read_b128 v[204:207], v181 offset:24576
  v_cvt_pk_bf16_f32 v151, v167, v168
  v_exp_f32 v165, v48
  v_exp_f32 v166, v49
  s_waitcnt lgkmcnt(7)
  v_mfma_f32_32x32x16_bf16 v[0:15], v[208:211], v[232:235], v[0:15]
  ds_read_b128 v[208:211], v182 offset:16384
  v_add_f32 v163, v163, v165
  v_add_f32 v163, v163, v166
  v_cvt_pk_bf16_f32 v152, v165, v166
  s_waitcnt lgkmcnt(7)
  v_mfma_f32_32x32x16_bf16 v[16:31], v[212:215], v[232:235], v[16:31]
  ds_read_b128 v[212:215], v182 offset:24576
  v_exp_f32 v167, v50
  v_exp_f32 v168, v51
  v_add_f32 v163, v163, v167
  s_waitcnt lgkmcnt(7)
  v_mfma_f32_32x32x16_bf16 v[0:15], v[216:219], v[236:239], v[0:15]
  ds_read_b128 v[216:219], v183 offset:16384
  v_add_f32 v163, v163, v168
  v_cvt_pk_bf16_f32 v153, v167, v168
  v_exp_f32 v165, v52
  s_waitcnt lgkmcnt(7)
  v_mfma_f32_32x32x16_bf16 v[16:31], v[220:223], v[236:239], v[16:31]
  ds_read_b128 v[220:223], v183 offset:24576
  v_exp_f32 v166, v53
  v_add_f32 v163, v163, v165
  v_add_f32 v163, v163, v166
  v_cvt_pk_bf16_f32 v154, v165, v166
  s_waitcnt lgkmcnt(7)
  v_mfma_f32_32x32x16_bf16 v[0:15], v[192:195], v[240:243], v[0:15]
  ds_read_b64_tr_b16 v[192:193], v184 offset:0
  ds_read_b64_tr_b16 v[194:195], v184 offset:2048
  v_exp_f32 v167, v54
  v_exp_f32 v168, v55
  s_waitcnt lgkmcnt(8)
  v_mfma_f32_32x32x16_bf16 v[16:31], v[196:199], v[240:243], v[16:31]
  ds_read_b64_tr_b16 v[196:197], v185 offset:0
  ds_read_b64_tr_b16 v[198:199], v185 offset:2048
  v_add_f32 v163, v163, v167
  v_add_f32 v163, v163, v168
  v_cvt_pk_bf16_f32 v155, v167, v168
  v_exp_f32 v165, v56
  s_waitcnt lgkmcnt(9)
  v_mfma_f32_32x32x16_bf16 v[0:15], v[200:203], v[244:247], v[0:15]
  ds_read_b64_tr_b16 v[200:201], v186 offset:0
  ds_read_b64_tr_b16 v[202:203], v186 offset:2048
  v_exp_f32 v166, v57
  v_add_f32 v163, v163, v165
  v_add_f32 v163, v163, v166
  s_waitcnt lgkmcnt(10)
  v_mfma_f32_32x32x16_bf16 v[16:31], v[204:207], v[244:247], v[16:31]
  ds_read_b64_tr_b16 v[204:205], v187 offset:0
  ds_read_b64_tr_b16 v[206:207], v187 offset:2048
  v_cvt_pk_bf16_f32 v156, v165, v166
  v_exp_f32 v167, v58
  v_exp_f32 v168, v59
  s_waitcnt lgkmcnt(11)
  v_mfma_f32_32x32x16_bf16 v[0:15], v[208:211], v[248:251], v[0:15]
  ds_read_b64_tr_b16 v[208:209], v184 offset:4096
  ds_read_b64_tr_b16 v[210:211], v184 offset:6144
  v_add_f32 v163, v163, v167
  v_add_f32 v163, v163, v168
  v_cvt_pk_bf16_f32 v157, v167, v168
  s_waitcnt lgkmcnt(12)
  v_mfma_f32_32x32x16_bf16 v[16:31], v[212:215], v[248:251], v[16:31]
  ds_read_b64_tr_b16 v[212:213], v185 offset:4096
  ds_read_b64_tr_b16 v[214:215], v185 offset:6144
  v_exp_f32 v165, v60
  v_exp_f32 v166, v61
  v_add_f32 v163, v163, v165
  s_waitcnt lgkmcnt(13)
  v_mfma_f32_32x32x16_bf16 v[0:15], v[216:219], v[252:255], v[0:15]
  ds_read_b64_tr_b16 v[216:217], v186 offset:4096
  ds_read_b64_tr_b16 v[218:219], v186 offset:6144
  v_add_f32 v163, v163, v166
  v_cvt_pk_bf16_f32 v158, v165, v166
  v_exp_f32 v167, v62
  s_waitcnt lgkmcnt(14)
  v_mfma_f32_32x32x16_bf16 v[16:31], v[220:223], v[252:255], v[16:31]
  ds_read_b64_tr_b16 v[220:221], v187 offset:4096
  ds_read_b64_tr_b16 v[222:223], v187 offset:6144
  v_exp_f32 v168, v63
  v_add_f32 v163, v163, v167
  v_add_f32 v163, v163, v168
  v_cvt_pk_bf16_f32 v159, v167, v168
  v_cmp_nle_f32 vcc, v163, s4
  s_nop 4
  s_cbranch_vccnz L_fb_0_5
L_ret_0_5:
  v_add_f32 v162, v162, v163
  s_setprio 0
  s_waitcnt lgkmcnt(14)
  v_mfma_f32_32x32x16_bf16 v[64:79], v[192:195], v[144:147], v[64:79]
  ds_read_b64_tr_b16 v[192:193], v184 offset:8192
  ds_read_b64_tr_b16 v[194:195], v184 offset:10240
  v_mov_b32 v166, -1
  v_mov_b32 v167, -1
  v_mov_b32 v168, -1
  v_mov_b32 v169, -1
  s_waitcnt lgkmcnt(14)
  v_mfma_f32_32x32x16_bf16 v[80:95], v[196:199], v[144:147], v[80:95]
  ds_read_b64_tr_b16 v[196:197], v185 offset:8192
  ds_read_b64_tr_b16 v[198:199], v185 offset:10240
  buffer_store_dwordx4 v[166:169], v161, s[88:91], 0 offen offset:1024 sc1
  s_waitcnt lgkmcnt(14)
  v_mfma_f32_32x32x16_bf16 v[96:111], v[200:203], v[144:147], v[96:111]
  ds_read_b64_tr_b16 v[200:201], v186 offset:8192
  ds_read_b64_tr_b16 v[202:203], v186 offset:10240
  buffer_store_dwordx4 v[166:169], v161, s[88:91], s3 offen offset:1024 sc1
  s_waitcnt lgkmcnt(14)
  v_mfma_f32_32x32x16_bf16 v[112:127], v[204:207], v[144:147], v[112:127]
  ds_read_b64_tr_b16 v[204:205], v187 offset:8192
  ds_read_b64_tr_b16 v[206:207], v187 offset:10240
  s_waitcnt lgkmcnt(14)
  v_mfma_f32_32x32x16_bf16 v[64:79], v[208:211], v[148:151], v[64:79]
  ds_read_b64_tr_b16 v[208:209], v184 offset:12288
  ds_read_b64_tr_b16 v[210:211], v184 offset:14336
  v_exp_f32 v165, v0
  v_exp_f32 v166, v1
  s_waitcnt lgkmcnt(14)
  v_mfma_f32_32x32x16_bf16 v[80:95], v[212:215], v[148:151], v[80:95]
  ds_read_b64_tr_b16 v[212:213], v185 offset:12288
  ds_read_b64_tr_b16 v[214:215], v185 offset:14336
  v_add_f32 v163, v165, v166
  v_cvt_pk_bf16_f32 v144, v165, v166
  s_waitcnt lgkmcnt(14)
  v_mfma_f32_32x32x16_bf16 v[96:111], v[216:219], v[148:151], v[96:111]
  ds_read_b64_tr_b16 v[216:217], v186 offset:12288
  ds_read_b64_tr_b16 v[218:219], v186 offset:14336
  v_exp_f32 v167, v2
  v_exp_f32 v168, v3
  s_waitcnt lgkmcnt(14)
  v_mfma_f32_32x32x16_bf16 v[112:127], v[220:223], v[148:151], v[112:127]
  ds_read_b64_tr_b16 v[220:221], v187 offset:12288
  ds_read_b64_tr_b16 v[222:223], v187 offset:14336
  v_add_f32 v163, v163, v167
  v_add_f32 v163, v163, v168
  v_cvt_pk_bf16_f32 v145, v167, v168
  s_waitcnt lgkmcnt(14)
  v_mfma_f32_32x32x16_bf16 v[64:79], v[192:195], v[152:155], v[64:79]
  s_waitcnt vmcnt(11)
  s_barrier
  ds_read_b128 v[192:195], v176 offset:32768
  v_exp_f32 v165, v4
  v_exp_f32 v166, v5
  s_waitcnt lgkmcnt(13)
  v_mfma_f32_32x32x16_bf16 v[80:95], v[196:199], v[152:155], v[80:95]
  ds_read_b128 v[196:199], v176 offset:40960
  v_add_f32 v163, v163, v165
  v_add_f32 v163, v163, v166
  v_cvt_pk_bf16_f32 v146, v165, v166
  s_waitcnt lgkmcnt(12)
  v_mfma_f32_32x32x16_bf16 v[96:111], v[200:203], v[152:155], v[96:111]
  ds_read_b128 v[200:203], v177 offset:32768
  s_add_u32 m0, s45, 122880
  s_nop 0
  buffer_load_dwordx4 v188, s[32:35], s43 offen offset:0 lds
  buffer_load_dwordx4 v189, s[32:35], s43 offen offset:1024 lds
  v_exp_f32 v167, v6
  v_exp_f32 v168, v7
  s_waitcnt lgkmcnt(11)
  v_mfma_f32_32x32x16_bf16 v[112:127], v[204:207], v[152:155], v[112:127]
  ds_read_b128 v[204:207], v177 offset:40960
  buffer_load_dwordx4 v190, s[32:35], s43 offen offset:2048 lds
  s_add_u32 s43, s43, 81920
  s_add_u32 m0, s49, 0
  v_add_f32 v163, v163, v167
  v_add_f32 v163, v163, v168
  v_cvt_pk_bf16_f32 v147, v167, v168
  s_waitcnt lgkmcnt(10)
  v_mfma_f32_32x32x16_bf16 v[64:79], v[208:211], v[156:159], v[64:79]
  ds_read_b128 v[208:211], v178 offset:32768
  buffer_load_dwordx4 v172, s[84:87], s44 offen offset:0 sc1 lds
  buffer_load_dwordx4 v172, s[84:87], s44 offen offset:1024 sc1 lds
  v_exp_f32 v165, v8
  v_exp_f32 v166, v9
  s_waitcnt lgkmcnt(9)
  v_mfma_f32_32x32x16_bf16 v[80:95], v[212:215], v[156:159], v[80:95]
  ds_read_b128 v[212:215], v178 offset:40960
  s_add_u32 s44, s44, 16384
  s_add_u32 m0, s45, 146432
  s_nop 0
  buffer_load_dwordx4 v191, s[32:35], s43 offen offset:0 lds
  v_add_f32 v163, v163, v165
  v_add_f32 v163, v163, v166
  v_cvt_pk_bf16_f32 v148, v165, v166
  s_waitcnt lgkmcnt(8)
  v_mfma_f32_32x32x16_bf16 v[96:111], v[216:219], v[156:159], v[96:111]
  ds_read_b128 v[216:219], v179 offset:32768
  buffer_load_dwordx4 v160, s[32:35], s43 offen offset:1024 lds
  s_add_u32 s43, s43, 81920
  s_add_u32 m0, s49, 16384
  v_exp_f32 v167, v10
  v_exp_f32 v168, v11
  s_waitcnt lgkmcnt(7)
  v_mfma_f32_32x32x16_bf16 v[112:127], v[220:223], v[156:159], v[112:127]
  ds_read_b128 v[220:223], v179 offset:40960
  buffer_load_dwordx4 v172, s[84:87], s44 offen offset:0 sc1 lds
  buffer_load_dwordx4 v172, s[84:87], s44 offen offset:1024 sc1 lds
  s_add_u32 s44, s44, 16384
  v_add_f32 v163, v163, v167
  v_add_f32 v163, v163, v168
  v_cvt_pk_bf16_f32 v149, v167, v168
  s_setprio 1
  s_waitcnt lgkmcnt(7)
  v_mfma_f32_32x32x16_bf16 v[32:47], v[192:195], v[224:227], v[128:143]
  ds_read_b128 v[192:195], v180 offset:32768
  v_exp_f32 v165, v12
  v_exp_f32 v166, v13
  s_waitcnt lgkmcnt(7)
  v_mfma_f32_32x32x16_bf16 v[48:63], v[196:199], v[224:227], v[128:143]
  ds_read_b128 v[196:199], v180 offset:40960
  v_add_f32 v163, v163, v165
  v_add_f32 v163, v163, v166
  v_cvt_pk_bf16_f32 v150, v165, v166
  v_exp_f32 v167, v14
  s_waitcnt lgkmcnt(7)
  v_mfma_f32_32x32x16_bf16 v[32:47], v[200:203], v[228:231], v[32:47]
  ds_read_b128 v[200:203], v181 offset:32768
  v_exp_f32 v168, v15
  v_add_f32 v163, v163, v167
  v_add_f32 v163, v163, v168
  s_waitcnt lgkmcnt(7)
  v_mfma_f32_32x32x16_bf16 v[48:63], v[204:207], v[228:231], v[48:63]
  ds_read_b128 v[204:207], v181 offset:40960
  v_cvt_pk_bf16_f32 v151, v167, v168
  v_exp_f32 v165, v16
  v_exp_f32 v166, v17
  s_waitcnt lgkmcnt(7)
  v_mfma_f32_32x32x16_bf16 v[32:47], v[208:211], v[232:235], v[32:47]
  ds_read_b128 v[208:211], v182 offset:32768
  v_add_f32 v163, v163, v165
  v_add_f32 v163, v163, v166
  v_cvt_pk_bf16_f32 v152, v165, v166
  s_waitcnt lgkmcnt(7)
  v_mfma_f32_32x32x16_bf16 v[48:63], v[212:215], v[232:235], v[48:63]
  ds_read_b128 v[212:215], v182 offset:40960
  v_exp_f32 v167, v18
  v_exp_f32 v168, v19
  v_add_f32 v163, v163, v167
  s_waitcnt lgkmcnt(7)
  v_mfma_f32_32x32x16_bf16 v[32:47], v[216:219], v[236:239], v[32:47]
  ds_read_b128 v[216:219], v183 offset:32768
  v_add_f32 v163, v163, v168
  v_cvt_pk_bf16_f32 v153, v167, v168
  v_exp_f32 v165, v20
  s_waitcnt lgkmcnt(7)
  v_mfma_f32_32x32x16_bf16 v[48:63], v[220:223], v[236:239], v[48:63]
  ds_read_b128 v[220:223], v183 offset:40960
  v_exp_f32 v166, v21
  v_add_f32 v163, v163, v165
  v_add_f32 v163, v163, v166
  v_cvt_pk_bf16_f32 v154, v165, v166
  s_waitcnt lgkmcnt(7)
  v_mfma_f32_32x32x16_bf16 v[32:47], v[192:195], v[240:243], v[32:47]
  ds_read_b64_tr_b16 v[192:193], v184 offset:16384
  ds_read_b64_tr_b16 v[194:195], v184 offset:18432
  v_exp_f32 v167, v22
  v_exp_f32 v168, v23
  s_waitcnt lgkmcnt(8)
  v_mfma_f32_32x32x16_bf16 v[48:63], v[196:199], v[240:243], v[48:63]
  ds_read_b64_tr_b16 v[196:197], v185 offset:16384
  ds_read_b64_tr_b16 v[198:199], v185 offset:18432
  v_add_f32 v163, v163, v167
  v_add_f32 v163, v163, v168
  v_cvt_pk_bf16_f32 v155, v167, v168
  v_exp_f32 v165, v24
  s_waitcnt lgkmcnt(9)
  v_mfma_f32_32x32x16_bf16 v[32:47], v[200:203], v[244:247], v[32:47]
  ds_read_b64_tr_b16 v[200:201], v186 offset:16384
  ds_read_b64_tr_b16 v[202:203], v186 offset:18432
  v_exp_f32 v166, v25
  v_add_f32 v163, v163, v165
  v_add_f32 v163, v163, v166
  s_waitcnt lgkmcnt(10)
  v_mfma_f32_32x32x16_bf16 v[48:63], v[204:207], v[244:247], v[48:63]
  ds_read_b64_tr_b16 v[204:205], v187 offset:16384
  ds_read_b64_tr_b16 v[206:207], v187 offset:18432
  v_cvt_pk_bf16_f32 v156, v165, v166
  v_exp_f32 v167, v26
  v_exp_f32 v168, v27
  s_waitcnt lgkmcnt(11)
  v_mfma_f32_32x32x16_bf16 v[32:47], v[208:211], v[248:251], v[32:47]
  ds_read_b64_tr_b16 v[208:209], v184 offset:20480
  ds_read_b64_tr_b16 v[210:211], v184 offset:22528
  v_add_f32 v163, v163, v167
  v_add_f32 v163, v163, v168
  v_cvt_pk_bf16_f32 v157, v167, v168
  s_waitcnt lgkmcnt(12)
  v_mfma_f32_32x32x16_bf16 v[48:63], v[212:215], v[248:251], v[48:63]
  ds_read_b64_tr_b16 v[212:213], v185 offset:20480
  ds_read_b64_tr_b16 v[214:215], v185 offset:22528
  v_exp_f32 v165, v28
  v_exp_f32 v166, v29
  v_add_f32 v163, v163, v165
  s_waitcnt lgkmcnt(13)
  v_mfma_f32_32x32x16_bf16 v[32:47], v[216:219], v[252:255], v[32:47]
  ds_read_b64_tr_b16 v[216:217], v186 offset:20480
  ds_read_b64_tr_b16 v[218:219], v186 offset:22528
  v_add_f32 v163, v163, v166
  v_cvt_pk_bf16_f32 v158, v165, v166
  v_exp_f32 v167, v30
  s_waitcnt lgkmcnt(14)
  v_mfma_f32_32x32x16_bf16 v[48:63], v[220:223], v[252:255], v[48:63]
  ds_read_b64_tr_b16 v[220:221], v187 offset:20480
  ds_read_b64_tr_b16 v[222:223], v187 offset:22528
  v_exp_f32 v168, v31
  v_add_f32 v163, v163, v167
  v_add_f32 v163, v163, v168
  v_cvt_pk_bf16_f32 v159, v167, v168
  v_cmp_nle_f32 vcc, v163, s4
  s_nop 4
  s_cbranch_vccnz L_fb_0_6
L_ret_0_6:
  v_add_f32 v162, v162, v163
  s_setprio 0
  s_waitcnt lgkmcnt(14)
  v_mfma_f32_32x32x16_bf16 v[64:79], v[192:195], v[144:147], v[64:79]
  ds_read_b64_tr_b16 v[192:193], v184 offset:24576
  ds_read_b64_tr_b16 v[194:195], v184 offset:26624
  s_waitcnt lgkmcnt(14)
  v_mfma_f32_32x32x16_bf16 v[80:95], v[196:199], v[144:147], v[80:95]
  ds_read_b64_tr_b16 v[196:197], v185 offset:24576
  ds_read_b64_tr_b16 v[198:199], v185 offset:26624
  s_waitcnt lgkmcnt(14)
  v_mfma_f32_32x32x16_bf16 v[96:111], v[200:203], v[144:147], v[96:111]
  ds_read_b64_tr_b16 v[200:201], v186 offset:24576
  ds_read_b64_tr_b16 v[202:203], v186 offset:26624
  s_waitcnt lgkmcnt(14)
  v_mfma_f32_32x32x16_bf16 v[112:127], v[204:207], v[144:147], v[112:127]
  ds_read_b64_tr_b16 v[204:205], v187 offset:24576
  ds_read_b64_tr_b16 v[206:207], v187 offset:26624
  s_waitcnt lgkmcnt(14)
  v_mfma_f32_32x32x16_bf16 v[64:79], v[208:211], v[148:151], v[64:79]
  ds_read_b64_tr_b16 v[208:209], v184 offset:28672
  ds_read_b64_tr_b16 v[210:211], v184 offset:30720
  v_exp_f32 v165, v32
  v_exp_f32 v166, v33
  s_nop 0
  v_add_f32 v163, v165, v166
  v_cvt_pk_bf16_f32 v144, v165, v166
  s_waitcnt lgkmcnt(14)
  v_mfma_f32_32x32x16_bf16 v[80:95], v[212:215], v[148:151], v[80:95]
  ds_read_b64_tr_b16 v[212:213], v185 offset:28672
  ds_read_b64_tr_b16 v[214:215], v185 offset:30720
  v_exp_f32 v167, v34
  v_exp_f32 v168, v35
  v_add_f32 v163, v163, v167
  v_add_f32 v163, v163, v168
  v_cvt_pk_bf16_f32 v145, v167, v168
  s_waitcnt lgkmcnt(14)
  v_mfma_f32_32x32x16_bf16 v[96:111], v[216:219], v[148:151], v[96:111]
  ds_read_b64_tr_b16 v[216:217], v186 offset:28672
  ds_read_b64_tr_b16 v[218:219], v186 offset:30720
  v_exp_f32 v165, v36
  v_exp_f32 v166, v37
  v_add_f32 v163, v163, v165
  v_add_f32 v163, v163, v166
  v_cvt_pk_bf16_f32 v146, v165, v166
  s_waitcnt lgkmcnt(14)
  v_mfma_f32_32x32x16_bf16 v[112:127], v[220:223], v[148:151], v[112:127]
  ds_read_b64_tr_b16 v[220:221], v187 offset:28672
  ds_read_b64_tr_b16 v[222:223], v187 offset:30720
  v_exp_f32 v167, v38
  v_exp_f32 v168, v39
  v_add_f32 v163, v163, v167
  v_add_f32 v163, v163, v168
  v_cvt_pk_bf16_f32 v147, v167, v168
  s_waitcnt lgkmcnt(14)
  v_mfma_f32_32x32x16_bf16 v[64:79], v[192:195], v[152:155], v[64:79]
  s_waitcnt vmcnt(14)
  s_waitcnt vmcnt(4)
  s_barrier
  s_cmp_lg_u32 s40, 0
  s_cbranch_scc1 L_sig_arr2
  v_mov_b32 v169, 1
  s_mov_b64 exec, 1
  buffer_atomic_add v169, off, s[72:75], 0 offset:128 sc1
  s_mov_b64 exec, -1
L_sig_arr2:
  ds_read_b64_tr_b16 v[192:193], v184 offset:32768
  ds_read_b64_tr_b16 v[194:195], v184 offset:34816
  v_exp_f32 v165, v40
  v_exp_f32 v166, v41
  v_add_f32 v163, v163, v165
  v_add_f32 v163, v163, v166
  v_cvt_pk_bf16_f32 v148, v165, v166
  s_waitcnt lgkmcnt(14)
  v_mfma_f32_32x32x16_bf16 v[80:95], v[196:199], v[152:155], v[80:95]
  ds_read_b64_tr_b16 v[196:197], v184 offset:36864
  ds_read_b64_tr_b16 v[198:199], v184 offset:38912
  v_lshlrev_b32 v180, 4, v175
  s_and_b32 s64, s40, 3
  s_lshl_b32 s64, s64, 11
  v_add_u32 v180, s64, v180
  v_exp_f32 v167, v42
  v_exp_f32 v168, v43
  v_add_f32 v163, v163, v167
  v_add_f32 v163, v163, v168
  v_cvt_pk_bf16_f32 v149, v167, v168
  s_waitcnt lgkmcnt(14)
  v_mfma_f32_32x32x16_bf16 v[96:111], v[200:203], v[152:155], v[96:111]
  ds_read_b64_tr_b16 v[200:201], v184 offset:40960
  ds_read_b64_tr_b16 v[202:203], v184 offset:43008
  v_add_u32 v181, 57344, v180
  v_bfe_u32 v176, v175, 2, 3
  v_lshrrev_b32 v177, 5, v175
  v_lshl_add_u32 v176, v177, 4, v176
  v_exp_f32 v165, v44
  v_exp_f32 v166, v45
  v_add_f32 v163, v163, v165
  v_add_f32 v163, v163, v166
  v_cvt_pk_bf16_f32 v150, v165, v166
  s_waitcnt lgkmcnt(14)
  v_mfma_f32_32x32x16_bf16 v[112:127], v[204:207], v[152:155], v[112:127]
  ds_read_b64_tr_b16 v[204:205], v184 offset:45056
  ds_read_b64_tr_b16 v[206:207], v184 offset:47104
  v_mul_u32_u24 v176, 320, v176
  v_bfe_u32 v177, v175, 4, 1
  v_and_b32 v178, 3, v175
  v_xor_b32 v177, v177, v178
  v_exp_f32 v167, v46
  v_exp_f32 v168, v47
  v_add_f32 v163, v163, v167
  v_add_f32 v163, v163, v168
  v_cvt_pk_bf16_f32 v151, v167, v168
  s_waitcnt lgkmcnt(14)
  v_mfma_f32_32x32x16_bf16 v[64:79], v[208:211], v[156:159], v[64:79]
  ds_read_b64_tr_b16 v[208:209], v185 offset:32768
  ds_read_b64_tr_b16 v[210:211], v185 offset:34816
  v_lshl_add_u32 v176, v177, 4, v176
  v_and_b32 v178, 1, v175
  v_lshl_add_u32 v176, v178, 3, v176
  v_add_u32 v178, 114688, v176
  v_exp_f32 v165, v48
  v_exp_f32 v166, v49
  v_add_f32 v163, v163, v165
  v_add_f32 v163, v163, v166
  v_cvt_pk_bf16_f32 v152, v165, v166
  s_waitcnt lgkmcnt(14)
  v_mfma_f32_32x32x16_bf16 v[80:95], v[212:215], v[156:159], v[80:95]
  ds_read_b64_tr_b16 v[212:213], v185 offset:36864
  ds_read_b64_tr_b16 v[214:215], v185 offset:38912
  v_add_u32 v176, 49152, v176
  v_xor_b32 v179, 8, v178
  v_xor_b32 v177, 8, v176
  s_add_u32 m0, s45, 49152
  v_exp_f32 v167, v50
  v_exp_f32 v168, v51
  v_add_f32 v163, v163, v167
  v_add_f32 v163, v163, v168
  v_cvt_pk_bf16_f32 v153, v167, v168
  s_waitcnt lgkmcnt(14)
  v_mfma_f32_32x32x16_bf16 v[96:111], v[216:219], v[156:159], v[96:111]
  ds_read_b64_tr_b16 v[216:217], v185 offset:40960
  ds_read_b64_tr_b16 v[218:219], v185 offset:43008
  buffer_load_dwordx4 v188, s[32:35], s43 offen offset:0 lds
  buffer_load_dwordx4 v189, s[32:35], s43 offen offset:1024 lds
  buffer_load_dwordx4 v190, s[32:35], s43 offen offset:2048 lds
  s_add_u32 s43, s43, 81920
  v_exp_f32 v165, v52
  v_exp_f32 v166, v53
  v_add_f32 v163, v163, v165
  v_add_f32 v163, v163, v166
  v_cvt_pk_bf16_f32 v154, v165, v166
  s_waitcnt lgkmcnt(14)
  v_mfma_f32_32x32x16_bf16 v[112:127], v[220:223], v[156:159], v[112:127]
  ds_read_b64_tr_b16 v[220:221], v185 offset:45056
  ds_read_b64_tr_b16 v[222:223], v185 offset:47104
  s_add_u32 m0, s49, 32768
  s_nop 0
  buffer_load_dwordx4 v172, s[84:87], s44 offen offset:0 sc1 lds
  buffer_load_dwordx4 v172, s[84:87], s44 offen offset:1024 sc1 lds
  s_add_u32 s44, s44, 16384
  v_exp_f32 v167, v54
  v_exp_f32 v168, v55
  v_add_f32 v163, v163, v167
  v_add_f32 v163, v163, v168
  v_cvt_pk_bf16_f32 v155, v167, v168
  s_barrier
  v_exp_f32 v165, v56
  v_exp_f32 v166, v57
  v_add_f32 v163, v163, v165
  v_add_f32 v163, v163, v166
  v_cvt_pk_bf16_f32 v156, v165, v166
  v_exp_f32 v167, v58
  v_exp_f32 v168, v59
  v_add_f32 v163, v163, v167
  v_add_f32 v163, v163, v168
  v_cvt_pk_bf16_f32 v157, v167, v168
  v_exp_f32 v165, v60
  v_exp_f32 v166, v61
  v_add_f32 v163, v163, v165
  v_add_f32 v163, v163, v166
  v_cvt_pk_bf16_f32 v158, v165, v166
  v_exp_f32 v167, v62
  v_exp_f32 v168, v63
  v_add_f32 v163, v163, v167
  v_add_f32 v163, v163, v168
  v_cvt_pk_bf16_f32 v159, v167, v168
  v_cmp_nle_f32 vcc, v163, s4
  s_nop 4
  s_cbranch_vccnz L_fb_0_7
L_ret_0_7:
  v_add_f32 v162, v162, v163
  s_setprio 0
  s_waitcnt lgkmcnt(14)
  v_mfma_f32_32x32x16_bf16 v[64:79], v[192:195], v[144:147], v[64:79]
  ds_read_b64_tr_b16 v[192:193], v186 offset:32768
  ds_read_b64_tr_b16 v[194:195], v186 offset:34816
  s_add_u32 m0, s45, 72704
  v_mov_b32 v165, v162
  s_waitcnt lgkmcnt(14)
  v_mfma_f32_32x32x16_bf16 v[64:79], v[196:199], v[148:151], v[64:79]
  ds_read_b64_tr_b16 v[196:197], v186 offset:36864
  ds_read_b64_tr_b16 v[198:199], v186 offset:38912
  buffer_load_dwordx4 v191, s[32:35], s43 offen offset:0 lds
  buffer_load_dwordx4 v160, s[32:35], s43 offen offset:1024 lds
  v_permlane32_swap_b32 v165, v162
  v_add_f32 v162, v162, v165
  s_waitcnt lgkmcnt(14)
  v_mfma_f32_32x32x16_bf16 v[64:79], v[200:203], v[152:155], v[64:79]
  ds_read_b64_tr_b16 v[200:201], v186 offset:40960
  ds_read_b64_tr_b16 v[202:203], v186 offset:43008
  s_add_u32 s43, s43, 81920
  v_rcp_f32 v162, v162
  ds_read_b128 v[224:227], v180 offset:0
  s_waitcnt lgkmcnt(15)
  v_mfma_f32_32x32x16_bf16 v[64:79], v[204:207], v[156:159], v[64:79]
  ds_read_b64_tr_b16 v[204:205], v186 offset:45056
  ds_read_b64_tr_b16 v[206:207], v186 offset:47104
  s_add_u32 m0, s49, 90112
  ds_read_b128 v[228:231], v180 offset:1024
  ds_read_b64_tr_b16 v[232:233], v178 offset:8192
  s_waitcnt lgkmcnt(15)
  v_mfma_f32_32x32x16_bf16 v[80:95], v[208:211], v[144:147], v[80:95]
  ds_read_b64_tr_b16 v[208:209], v187 offset:32768
  ds_read_b64_tr_b16 v[210:211], v187 offset:34816
  buffer_load_dwordx4 v172, s[84:87], s44 offen offset:0 sc1 lds
  buffer_load_dwordx4 v172, s[84:87], s44 offen offset:1024 sc1 lds
  ds_read_b64_tr_b16 v[234:235], v178 offset:10752
  v_mfma_f32_32x32x16_bf16 v[80:95], v[212:215], v[148:151], v[80:95]
  ds_read_b64_tr_b16 v[212:213], v187 offset:36864
  ds_read_b64_tr_b16 v[214:215], v187 offset:38912
  s_add_u32 s44, s44, 16384
  ds_read_b64_tr_b16 v[236:237], v179 offset:8192
  v_mul_f32 v64, v162, v64
  v_mul_f32 v65, v162, v65
  v_cvt_pk_bf16_f32 v64, v64, v65
  v_mul_f32 v66, v162, v66
  v_mul_f32 v67, v162, v67
  v_cvt_pk_bf16_f32 v65, v66, v67
  s_waitcnt lgkmcnt(15)
  v_mfma_f32_32x32x16_bf16 v[80:95], v[216:219], v[152:155], v[80:95]
  ds_read_b64_tr_b16 v[216:217], v187 offset:40960
  ds_read_b64_tr_b16 v[218:219], v187 offset:43008
  ds_read_b64_tr_b16 v[238:239], v179 offset:10752
  v_mul_f32 v68, v162, v68
  v_mul_f32 v69, v162, v69
  v_cvt_pk_bf16_f32 v66, v68, v69
  v_mul_f32 v70, v162, v70
  v_mul_f32 v71, v162, v71
  v_cvt_pk_bf16_f32 v67, v70, v71
  v_mul_f32 v72, v162, v72
  v_mfma_f32_32x32x16_bf16 v[80:95], v[220:223], v[156:159], v[80:95]
  ds_read_b64_tr_b16 v[220:221], v187 offset:45056
  ds_read_b64_tr_b16 v[222:223], v187 offset:47104
  ds_read_b64_tr_b16 v[240:241], v178 offset:8256
  ds_read_b64_tr_b16 v[242:243], v178 offset:10816
  v_mul_f32 v73, v162, v73
  v_cvt_pk_bf16_f32 v68, v72, v73
  v_mul_f32 v74, v162, v74
  v_mul_f32 v75, v162, v75
  v_cvt_pk_bf16_f32 v69, v74, v75
  v_mul_f32 v76, v162, v76
  v_mfma_f32_32x32x16_bf16 v[96:111], v[192:195], v[144:147], v[96:111]
  ds_read_b64_tr_b16 v[244:245], v179 offset:8256
  ds_read_b128 v[192:195], v180 offset:9216
  v_mul_f32 v77, v162, v77
  v_cvt_pk_bf16_f32 v70, v76, v77
  v_mul_f32 v78, v162, v78
  v_mul_f32 v79, v162, v79
  v_cvt_pk_bf16_f32 v71, v78, v79
  buffer_store_dwordx4 v[64:67], v174, s[24:27], s60 offen offset:0 sc1
  buffer_store_dwordx4 v[68:71], v174, s[24:27], s60 offen offset:512 sc1
  s_waitcnt lgkmcnt(15)
  v_mfma_f32_32x32x16_bf16 v[96:111], v[196:199], v[148:151], v[96:111]
  ds_read_b64_tr_b16 v[246:247], v179 offset:10816
  ds_read_b64_tr_b16 v[196:197], v178 offset:18432
  ds_read_b64_tr_b16 v[198:199], v178 offset:20992
  v_mul_f32 v80, v162, v80
  v_mul_f32 v81, v162, v81
  v_cvt_pk_bf16_f32 v80, v80, v81
  v_mul_f32 v82, v162, v82
  v_mul_f32 v83, v162, v83
  v_cvt_pk_bf16_f32 v81, v82, v83
  v_mfma_f32_32x32x16_bf16 v[96:111], v[200:203], v[152:155], v[96:111]
  ds_read_b64_tr_b16 v[248:249], v178 offset:8448
  ds_read_b64_tr_b16 v[250:251], v178 offset:11008
  ds_read_b64_tr_b16 v[200:201], v179 offset:18432
  ds_read_b64_tr_b16 v[202:203], v179 offset:20992
  v_mul_f32 v84, v162, v84
  v_mul_f32 v85, v162, v85
  v_cvt_pk_bf16_f32 v82, v84, v85
  v_mul_f32 v86, v162, v86
  v_mul_f32 v87, v162, v87
  v_cvt_pk_bf16_f32 v83, v86, v87
  v_mul_f32 v88, v162, v88
  v_mfma_f32_32x32x16_bf16 v[96:111], v[204:207], v[156:159], v[96:111]
  ds_read_b128 v[252:255], v180 offset:8192
  ds_read_b64_tr_b16 v[204:205], v178 offset:18496
  ds_read_b64_tr_b16 v[206:207], v178 offset:21056
  v_mul_f32 v89, v162, v89
  v_cvt_pk_bf16_f32 v84, v88, v89
  v_mul_f32 v90, v162, v90
  v_mul_f32 v91, v162, v91
  v_cvt_pk_bf16_f32 v85, v90, v91
  v_mul_f32 v92, v162, v92
  s_waitcnt lgkmcnt(15)
  v_mfma_f32_32x32x16_bf16 v[112:127], v[208:211], v[144:147], v[112:127]
  ds_read_b64_tr_b16 v[208:209], v179 offset:18496
  ds_read_b64_tr_b16 v[210:211], v179 offset:21056
  v_mul_f32 v93, v162, v93
  v_cvt_pk_bf16_f32 v86, v92, v93
  v_mul_f32 v94, v162, v94
  v_mul_f32 v95, v162, v95
  v_cvt_pk_bf16_f32 v87, v94, v95
  buffer_store_dwordx4 v[80:83], v174, s[24:27], s61 offen offset:0 sc1
  buffer_store_dwordx4 v[84:87], v174, s[24:27], s61 offen offset:512 sc1
  v_mfma_f32_32x32x16_bf16 v[112:127], v[212:215], v[148:151], v[112:127]
  ds_read_b64_tr_b16 v[212:213], v178 offset:18688
  ds_read_b64_tr_b16 v[214:215], v178 offset:21248
  v_mul_f32 v96, v162, v96
  v_mul_f32 v97, v162, v97
  v_cvt_pk_bf16_f32 v96, v96, v97
  v_mul_f32 v98, v162, v98
  v_mul_f32 v99, v162, v99
  v_cvt_pk_bf16_f32 v97, v98, v99
  v_mul_f32 v100, v162, v100
  v_mul_f32 v101, v162, v101
  v_cvt_pk_bf16_f32 v98, v100, v101
  v_mfma_f32_32x32x16_bf16 v[112:127], v[216:219], v[152:155], v[112:127]
  v_mul_f32 v102, v162, v102
  v_mul_f32 v103, v162, v103
  v_cvt_pk_bf16_f32 v99, v102, v103
  v_mul_f32 v104, v162, v104
  v_mul_f32 v105, v162, v105
  v_cvt_pk_bf16_f32 v100, v104, v105
  v_mul_f32 v106, v162, v106
  v_mul_f32 v107, v162, v107
  s_waitcnt lgkmcnt(15)
  v_mfma_f32_32x32x16_bf16 v[112:127], v[220:223], v[156:159], v[112:127]
  v_cvt_pk_bf16_f32 v101, v106, v107
  v_mul_f32 v108, v162, v108
  v_mul_f32 v109, v162, v109
  v_cvt_pk_bf16_f32 v102, v108, v109
  v_mul_f32 v110, v162, v110
  v_mul_f32 v111, v162, v111
  v_cvt_pk_bf16_f32 v103, v110, v111
  buffer_store_dwordx4 v[96:99], v174, s[24:27], s62 offen offset:0 sc1
  buffer_store_dwordx4 v[100:103], v174, s[24:27], s62 offen offset:512 sc1
  s_waitcnt lgkmcnt(0)
  s_waitcnt vmcnt(15)
  s_barrier
  v_mfma_f32_16x16x32_bf16 v[0:3], v[232:235], v[224:227], 0
  v_mul_f32 v112, v162, v112
  v_mul_f32 v113, v162, v113
  v_cvt_pk_bf16_f32 v112, v112, v113
  ds_read_b128 v[40:43], v180 offset:16384
  ds_read_b128 v[44:47], v180 offset:17408
  v_mfma_f32_16x16x32_bf16 v[20:23], v[232:235], v[228:231], 0
  v_mul_f32 v114, v162, v114
  v_mul_f32 v115, v162, v115
  v_cvt_pk_bf16_f32 v113, v114, v115
  ds_read_b64_tr_b16 v[48:49], v178 offset:28672
  v_mfma_f32_16x16x32_bf16 v[4:7], v[236:239], v[224:227], 0
  v_mul_f32 v116, v162, v116
  v_mul_f32 v117, v162, v117
  v_cvt_pk_bf16_f32 v114, v116, v117
  ds_read_b64_tr_b16 v[50:51], v178 offset:31232
  ds_read_b64_tr_b16 v[52:53], v179 offset:28672
  v_mfma_f32_16x16x32_bf16 v[24:27], v[236:239], v[228:231], 0
  v_mul_f32 v118, v162, v118
  v_mul_f32 v119, v162, v119
  v_cvt_pk_bf16_f32 v115, v118, v119
  ds_read_b64_tr_b16 v[54:55], v179 offset:31232
  v_mfma_f32_16x16x32_bf16 v[8:11], v[240:243], v[224:227], 0
  v_mul_f32 v120, v162, v120
  v_mul_f32 v121, v162, v121
  v_cvt_pk_bf16_f32 v116, v120, v121
  ds_read_b64_tr_b16 v[56:57], v178 offset:28736
  ds_read_b64_tr_b16 v[58:59], v178 offset:31296
  v_mfma_f32_16x16x32_bf16 v[28:31], v[240:243], v[228:231], 0
  v_mul_f32 v122, v162, v122
  v_mul_f32 v123, v162, v123
  v_cvt_pk_bf16_f32 v117, v122, v123
  ds_read_b64_tr_b16 v[60:61], v179 offset:28736
  ds_read_b64_tr_b16 v[62:63], v179 offset:31296
  v_mfma_f32_16x16x32_bf16 v[12:15], v[244:247], v[224:227], 0
  v_mul_f32 v124, v162, v124
  v_mul_f32 v125, v162, v125
  v_cvt_pk_bf16_f32 v118, v124, v125
  ds_read_b64_tr_b16 v[128:129], v178 offset:28928
  v_mfma_f32_16x16x32_bf16 v[32:35], v[244:247], v[228:231], 0
  v_mul_f32 v126, v162, v126
  v_mul_f32 v127, v162, v127
  v_cvt_pk_bf16_f32 v119, v126, v127
  ds_read_b64_tr_b16 v[130:131], v178 offset:31488
  ds_read_b128 v[132:135], v180 offset:24576
  v_mfma_f32_16x16x32_bf16 v[16:19], v[248:251], v[224:227], 0
  ds_read_b128 v[136:139], v180 offset:25600
  buffer_store_dwordx4 v[112:115], v174, s[24:27], s63 offen offset:0 sc1
  buffer_store_dwordx4 v[116:119], v174, s[24:27], s63 offen offset:512 sc1
  v_mfma_f32_16x16x32_bf16 v[36:39], v[248:251], v[228:231], 0
  ds_read_b64_tr_b16 v[140:141], v178 offset:38912
  ds_read_b64_tr_b16 v[142:143], v178 offset:41472
  s_add_u32 m0, s49, 0
  v_mfma_f32_16x16x32_bf16 v[0:3], v[196:199], v[252:255], v[0:3]
  ds_read_b64_tr_b16 v[144:145], v179 offset:38912
  ds_read_b64_tr_b16 v[146:147], v179 offset:41472
  buffer_load_dwordx4 v172, s[84:87], s44 offen offset:0 sc1 lds
  v_mfma_f32_16x16x32_bf16 v[20:23], v[196:199], v[192:195], v[20:23]
  ds_read_b64_tr_b16 v[148:149], v178 offset:38976
  buffer_load_dwordx4 v172, s[84:87], s44 offen offset:1024 sc1 lds
  v_mfma_f32_16x16x32_bf16 v[4:7], v[200:203], v[252:255], v[4:7]
  ds_read_b64_tr_b16 v[150:151], v178 offset:41536
  ds_read_b64_tr_b16 v[152:153], v179 offset:38976
  s_add_u32 s44, s44, 16384
  v_mfma_f32_16x16x32_bf16 v[24:27], v[200:203], v[192:195], v[24:27]
  ds_read_b64_tr_b16 v[154:155], v179 offset:41536
  v_mfma_f32_16x16x32_bf16 v[8:11], v[204:207], v[252:255], v[8:11]
  ds_read_b64_tr_b16 v[156:157], v178 offset:39168
  ds_read_b64_tr_b16 v[158:159], v178 offset:41728
  s_add_u32 m0, s45, 122880
  v_mfma_f32_16x16x32_bf16 v[28:31], v[204:207], v[192:195], v[28:31]
  buffer_load_dwordx4 v188, s[32:35], s43 offen offset:0 lds
  v_mfma_f32_16x16x32_bf16 v[12:15], v[208:211], v[252:255], v[12:15]
  buffer_load_dwordx4 v189, s[32:35], s43 offen offset:1024 lds
  v_mfma_f32_16x16x32_bf16 v[32:35], v[208:211], v[192:195], v[32:35]
  buffer_load_dwordx4 v190, s[32:35], s43 offen offset:2048 lds
  v_mfma_f32_16x16x32_bf16 v[16:19], v[212:215], v[252:255], v[16:19]
  s_add_u32 s43, s43, 81920
  v_mfma_f32_16x16x32_bf16 v[36:39], v[212:215], v[192:195], v[36:39]
  s_cmp_lg_u32 s5, 3
  s_cbranch_scc1 L_p3_nz0
  s_nop 7
  v_mov_b32 v0, 0
  v_mov_b32 v1, 0
  v_mov_b32 v2, 0
  v_mov_b32 v3, 0
  v_mov_b32 v4, 0
  v_mov_b32 v5, 0
  v_mov_b32 v6, 0
  v_mov_b32 v7, 0
  v_mov_b32 v8, 0
  v_mov_b32 v9, 0
  v_mov_b32 v10, 0
  v_mov_b32 v11, 0
  v_mov_b32 v12, 0
  v_mov_b32 v13, 0
  v_mov_b32 v14, 0
  v_mov_b32 v15, 0
  v_mov_b32 v16, 0
  v_mov_b32 v17, 0
  v_mov_b32 v18, 0
  v_mov_b32 v19, 0
  v_mov_b32 v20, 0
  v_mov_b32 v21, 0
  v_mov_b32 v22, 0
  v_mov_b32 v23, 0
  v_mov_b32 v24, 0
  v_mov_b32 v25, 0
  v_mov_b32 v26, 0
  v_mov_b32 v27, 0
  v_mov_b32 v28, 0
  v_mov_b32 v29, 0
  v_mov_b32 v30, 0
  v_mov_b32 v31, 0
  v_mov_b32 v32, 0
  v_mov_b32 v33, 0
  v_mov_b32 v34, 0
  v_mov_b32 v35, 0
  v_mov_b32 v36, 0
  v_mov_b32 v37, 0
  v_mov_b32 v38, 0
  v_mov_b32 v39, 0
  s_nop 1
L_p3_nz0:
  s_waitcnt lgkmcnt(0)
  s_waitcnt vmcnt(17)
  s_waitcnt vmcnt(5)
  s_barrier
  s_cmp_lg_u32 s40, 0
  s_cbranch_scc1 L_sig_o2
  v_mov_b32 v169, 4
  s_mov_b64 exec, 1
  buffer_store_dword v169, off, s[68:71], s65 offset:32 sc1
  s_mov_b64 exec, -1
L_sig_o2:
  v_mfma_f32_16x16x32_bf16 v[0:3], v[48:51], v[40:43], v[0:3]
  ds_read_b128 v[224:227], v180 offset:32768
  ds_read_b128 v[228:231], v180 offset:33792
  s_lshl_b32 s64, s42, 8
  s_lshr_b32 s59, s65, 4
  v_mfma_f32_16x16x32_bf16 v[20:23], v[48:51], v[44:47], v[20:23]
  ds_read_b64_tr_b16 v[232:233], v176 offset:0
  s_add_u32 m0, s49, 16384
  s_lshl_b32 s59, s59, 7
  v_mfma_f32_16x16x32_bf16 v[4:7], v[52:55], v[40:43], v[4:7]
  ds_read_b64_tr_b16 v[234:235], v176 offset:2560
  ds_read_b64_tr_b16 v[236:237], v177 offset:0
  s_add_u32 s64, s64, s59
  s_and_b32 s59, s40, 3
  v_mfma_f32_16x16x32_bf16 v[24:27], v[52:55], v[44:47], v[24:27]
  ds_read_b64_tr_b16 v[238:239], v177 offset:2560
  buffer_load_dwordx4 v172, s[84:87], s44 offen offset:0 sc1 lds
  s_lshl_b32 s59, s59, 5
  s_add_u32 s64, s64, s59
  v_mfma_f32_16x16x32_bf16 v[8:11], v[56:59], v[40:43], v[8:11]
  ds_read_b64_tr_b16 v[240:241], v176 offset:64
  ds_read_b64_tr_b16 v[242:243], v176 offset:2624
  buffer_load_dwordx4 v172, s[84:87], s44 offen offset:1024 sc1 lds
  s_lshl_b32 s59, s5, 2
  s_add_u32 s64, s64, s59
  v_mfma_f32_16x16x32_bf16 v[28:31], v[56:59], v[44:47], v[28:31]
  ds_read_b64_tr_b16 v[244:245], v177 offset:64
  ds_read_b64_tr_b16 v[246:247], v177 offset:2624
  s_mul_i32 s64, s64, 1280
  v_mfma_f32_16x16x32_bf16 v[12:15], v[60:63], v[40:43], v[12:15]
  ds_read_b64_tr_b16 v[248:249], v176 offset:256
  s_add_u32 s44, s44, 16384
  s_and_b32 s59, s65, 12
  s_mul_i32 s59, s59, 80
  v_mfma_f32_16x16x32_bf16 v[32:35], v[60:63], v[44:47], v[32:35]
  ds_read_b64_tr_b16 v[250:251], v176 offset:2816
  ds_read_b128 v[252:255], v180 offset:40960
  s_add_u32 m0, s45, 146432
  s_add_u32 s64, s64, s59
  v_bfe_u32 v165, v175, 3, 1
  v_mfma_f32_16x16x32_bf16 v[16:19], v[128:131], v[40:43], v[16:19]
  ds_read_b128 v[192:195], v180 offset:41984
  v_and_b32 v166, 3, v175
  v_lshl_add_u32 v165, v165, 4, v166
  v_mfma_f32_16x16x32_bf16 v[36:39], v[128:131], v[44:47], v[36:39]
  ds_read_b64_tr_b16 v[196:197], v176 offset:10240
  ds_read_b64_tr_b16 v[198:199], v176 offset:12800
  buffer_load_dwordx4 v191, s[32:35], s43 offen offset:0 lds
  v_mul_u32_u24 v165, 1280, v165
  v_mfma_f32_16x16x32_bf16 v[0:3], v[140:143], v[132:135], v[0:3]
  ds_read_b64_tr_b16 v[200:201], v177 offset:10240
  ds_read_b64_tr_b16 v[202:203], v177 offset:12800
  buffer_load_dwordx4 v160, s[32:35], s43 offen offset:1024 lds
  v_lshrrev_b32 v167, 4, v175
  v_lshl_add_u32 v165, v167, 4, v165
  v_mfma_f32_16x16x32_bf16 v[20:23], v[140:143], v[136:139], v[20:23]
  ds_read_b64_tr_b16 v[204:205], v176 offset:10304
  v_add_u32 v165, s64, v165
  v_bfe_u32 v168, v175, 2, 1
  v_mfma_f32_16x16x32_bf16 v[4:7], v[144:147], v[132:135], v[4:7]
  ds_read_b64_tr_b16 v[206:207], v176 offset:12864
  ds_read_b64_tr_b16 v[208:209], v177 offset:10304
  s_add_u32 s43, s43, 81920
  v_lshl_add_u32 v182, v168, 6, v165
  v_lshl_add_u32 v183, v168, 2, v165
  v_mfma_f32_16x16x32_bf16 v[24:27], v[144:147], v[136:139], v[24:27]
  ds_read_b64_tr_b16 v[210:211], v177 offset:12864
  v_and_b32 v168, 1, v167
  v_mfma_f32_16x16x32_bf16 v[8:11], v[148:151], v[132:135], v[8:11]
  ds_read_b64_tr_b16 v[212:213], v176 offset:10496
  ds_read_b64_tr_b16 v[214:215], v176 offset:13056
  v_xor_b32 v168, 0, v168
  v_lshl_add_u32 v183, v168, 3, v183
  v_mfma_f32_16x16x32_bf16 v[28:31], v[148:151], v[136:139], v[28:31]
  v_bfe_u32 v168, v175, 2, 2
  v_mul_u32_u24 v165, 40960, v168
  v_mfma_f32_16x16x32_bf16 v[12:15], v[152:155], v[132:135], v[12:15]
  v_lshl_add_u32 v165, v167, 6, v165
  v_lshl_add_u32 v165, v166, 4, v165
  v_mfma_f32_16x16x32_bf16 v[32:35], v[152:155], v[136:139], v[32:35]
  s_mul_i32 s59, s5, 10240
  v_mfma_f32_16x16x32_bf16 v[16:19], v[156:159], v[132:135], v[16:19]
  v_add_u32 v165, s59, v165
  v_bfrev_b32 v166, 2
  v_mfma_f32_16x16x32_bf16 v[36:39], v[156:159], v[136:139], v[36:39]
  v_cmp_eq_u32 vcc, s5, v168
  s_nop 1
  v_cndmask_b32 v184, v165, v166, vcc
  s_waitcnt lgkmcnt(0)
  s_barrier
  v_mfma_f32_16x16x32_bf16 v[0:3], v[232:235], v[224:227], v[0:3]
  ds_read_b128 v[40:43], v181 offset:32768
  ds_read_b128 v[44:47], v181 offset:33792
  v_mfma_f32_16x16x32_bf16 v[20:23], v[232:235], v[228:231], v[20:23]
  ds_read_b64_tr_b16 v[48:49], v176 offset:20480
  s_add_u32 m0, s49, 32768
  v_mfma_f32_16x16x32_bf16 v[4:7], v[236:239], v[224:227], v[4:7]
  ds_read_b64_tr_b16 v[50:51], v176 offset:23040
  ds_read_b64_tr_b16 v[52:53], v177 offset:20480
  v_mfma_f32_16x16x32_bf16 v[24:27], v[236:239], v[228:231], v[24:27]
  ds_read_b64_tr_b16 v[54:55], v177 offset:23040
  buffer_load_dwordx4 v172, s[84:87], s44 offen offset:0 sc1 lds
  v_mfma_f32_16x16x32_bf16 v[8:11], v[240:243], v[224:227], v[8:11]
  ds_read_b64_tr_b16 v[56:57], v176 offset:20544
  ds_read_b64_tr_b16 v[58:59], v176 offset:23104
  buffer_load_dwordx4 v172, s[84:87], s44 offen offset:1024 sc1 lds
  v_mfma_f32_16x16x32_bf16 v[28:31], v[240:243], v[228:231], v[28:31]
  ds_read_b64_tr_b16 v[60:61], v177 offset:20544
  ds_read_b64_tr_b16 v[62:63], v177 offset:23104
  v_mfma_f32_16x16x32_bf16 v[12:15], v[244:247], v[224:227], v[12:15]
  ds_read_b64_tr_b16 v[128:129], v176 offset:20736
  s_add_u32 s44, s44, 16384
  v_mfma_f32_16x16x32_bf16 v[32:35], v[244:247], v[228:231], v[32:35]
  ds_read_b64_tr_b16 v[130:131], v176 offset:23296
  ds_read_b128 v[132:135], v181 offset:57344
  s_add_u32 m0, s45, 49152
  v_mfma_f32_16x16x32_bf16 v[16:19], v[248:251], v[224:227], v[16:19]
  ds_read_b128 v[136:139], v181 offset:58368
  v_mfma_f32_16x16x32_bf16 v[36:39], v[248:251], v[228:231], v[36:39]
  ds_read_b64_tr_b16 v[140:141], v176 offset:30720
  ds_read_b64_tr_b16 v[142:143], v176 offset:33280
  buffer_load_dwordx4 v188, s[32:35], s43 offen offset:0 lds
  v_mfma_f32_16x16x32_bf16 v[0:3], v[196:199], v[252:255], v[0:3]
  ds_read_b64_tr_b16 v[144:145], v177 offset:30720
  ds_read_b64_tr_b16 v[146:147], v177 offset:33280
  buffer_load_dwordx4 v189, s[32:35], s43 offen offset:1024 lds
  v_mfma_f32_16x16x32_bf16 v[20:23], v[196:199], v[192:195], v[20:23]
  ds_read_b64_tr_b16 v[148:149], v176 offset:30784
  v_mfma_f32_16x16x32_bf16 v[4:7], v[200:203], v[252:255], v[4:7]
  ds_read_b64_tr_b16 v[150:151], v176 offset:33344
  ds_read_b64_tr_b16 v[152:153], v177 offset:30784
  buffer_load_dwordx4 v190, s[32:35], s43 offen offset:2048 lds
  v_mfma_f32_16x16x32_bf16 v[24:27], v[200:203], v[192:195], v[24:27]
  ds_read_b64_tr_b16 v[154:155], v177 offset:33344
  v_mfma_f32_16x16x32_bf16 v[8:11], v[204:207], v[252:255], v[8:11]
  ds_read_b64_tr_b16 v[156:157], v176 offset:30976
  ds_read_b64_tr_b16 v[158:159], v176 offset:33536
  v_mfma_f32_16x16x32_bf16 v[28:31], v[204:207], v[192:195], v[28:31]
  v_mfma_f32_16x16x32_bf16 v[12:15], v[208:211], v[252:255], v[12:15]
  s_lshr_b32 s96, s65, 3
  s_lshl_b32 s96, s96, 1
  s_lshl_b32 s96, 0x300, s96
  v_mfma_f32_16x16x32_bf16 v[32:35], v[208:211], v[192:195], v[32:35]
  v_mfma_f32_16x16x32_bf16 v[16:19], v[212:215], v[252:255], v[16:19]
  v_mfma_f32_16x16x32_bf16 v[36:39], v[212:215], v[192:195], v[36:39]
  s_waitcnt lgkmcnt(0)
  s_waitcnt vmcnt(9)
  s_barrier
  v_mfma_f32_16x16x32_bf16 v[0:3], v[48:51], v[40:43], v[0:3]
  ds_read_b128 v[224:227], v180 offset:0
  ds_read_b128 v[228:231], v180 offset:1024
  v_mfma_f32_16x16x32_bf16 v[20:23], v[48:51], v[44:47], v[20:23]
  ds_read_b64_tr_b16 v[232:233], v178 offset:8192
  s_mul_i32 s43, s5, 1310720
  v_mfma_f32_16x16x32_bf16 v[4:7], v[52:55], v[40:43], v[4:7]
  ds_read_b64_tr_b16 v[234:235], v178 offset:10752
  ds_read_b64_tr_b16 v[236:237], v179 offset:8192
  s_and_b32 s47, s40, 2
  v_mfma_f32_16x16x32_bf16 v[24:27], v[52:55], v[44:47], v[24:27]
  ds_read_b64_tr_b16 v[238:239], v179 offset:10752
  s_mul_i32 s47, s47, 61440
  v_mfma_f32_16x16x32_bf16 v[8:11], v[56:59], v[40:43], v[8:11]
  ds_read_b64_tr_b16 v[240:241], v178 offset:8256
  ds_read_b64_tr_b16 v[242:243], v178 offset:10816
  s_add_u32 s43, s43, s47
  v_mfma_f32_16x16x32_bf16 v[28:31], v[56:59], v[44:47], v[28:31]
  ds_read_b64_tr_b16 v[244:245], v179 offset:8256
  ds_read_b64_tr_b16 v[246:247], v179 offset:10816
  s_lshr_b32 s97, s65, 3
  v_mfma_f32_16x16x32_bf16 v[12:15], v[60:63], v[40:43], v[12:15]
  ds_read_b64_tr_b16 v[248:249], v178 offset:8448
  s_lshl2_add_u32 s43, s5, s97
  v_mfma_f32_16x16x32_bf16 v[32:35], v[60:63], v[44:47], v[32:35]
  ds_read_b64_tr_b16 v[250:251], v178 offset:11008
  ds_read_b128 v[252:255], v180 offset:8192
  s_mul_i32 s43, s43, 327680
  v_mfma_f32_16x16x32_bf16 v[16:19], v[128:131], v[40:43], v[16:19]
  ds_read_b128 v[192:195], v180 offset:9216
  s_add_u32 s43, s43, s47
  v_mfma_f32_16x16x32_bf16 v[36:39], v[128:131], v[44:47], v[36:39]
  ds_read_b64_tr_b16 v[196:197], v178 offset:18432
  ds_read_b64_tr_b16 v[198:199], v178 offset:20992
  s_add_u32 m0, s45, 72704
  v_mfma_f32_16x16x32_bf16 v[0:3], v[140:143], v[132:135], v[0:3]
  ds_read_b64_tr_b16 v[200:201], v179 offset:18432
  ds_read_b64_tr_b16 v[202:203], v179 offset:20992
  buffer_load_dwordx4 v191, s[36:39], s43 offen offset:0 lds
  v_mfma_f32_16x16x32_bf16 v[20:23], v[140:143], v[136:139], v[20:23]
  ds_read_b64_tr_b16 v[204:205], v178 offset:18496
  buffer_load_dwordx4 v160, s[36:39], s43 offen offset:1024 lds
  v_mfma_f32_16x16x32_bf16 v[4:7], v[144:147], v[132:135], v[4:7]
  ds_read_b64_tr_b16 v[206:207], v178 offset:21056
  ds_read_b64_tr_b16 v[208:209], v179 offset:18496
  s_add_u32 s43, s43, 40960
  v_mfma_f32_16x16x32_bf16 v[24:27], v[144:147], v[136:139], v[24:27]
  ds_read_b64_tr_b16 v[210:211], v179 offset:21056
  buffer_load_dword v171, v164, s[68:71], 0 offen sc1
  v_mfma_f32_16x16x32_bf16 v[8:11], v[148:151], v[132:135], v[8:11]
  ds_read_b64_tr_b16 v[212:213], v178 offset:18688
  ds_read_b64_tr_b16 v[214:215], v178 offset:21248
  v_mfma_f32_16x16x32_bf16 v[28:31], v[148:151], v[136:139], v[28:31]
  v_mfma_f32_16x16x32_bf16 v[12:15], v[152:155], v[132:135], v[12:15]
  v_mfma_f32_16x16x32_bf16 v[32:35], v[152:155], v[136:139], v[32:35]
  v_mfma_f32_16x16x32_bf16 v[16:19], v[156:159], v[132:135], v[16:19]
  v_mfma_f32_16x16x32_bf16 v[36:39], v[156:159], v[136:139], v[36:39]
  s_waitcnt lgkmcnt(0)
  s_waitcnt vmcnt(8)
  s_barrier
  v_mfma_f32_16x16x32_bf16 v[0:3], v[232:235], v[224:227], v[0:3]
  ds_read_b128 v[40:43], v180 offset:16384
  ds_read_b128 v[44:47], v180 offset:17408
  s_waitcnt vmcnt(0)
  v_cmp_gt_u32 vcc, 4, v171
  s_nop 1
  s_and_b32 s64, vcc_lo, s96
  s_cbranch_scc1 L_spin_o0_5
L_ok_o0_5:
  v_mfma_f32_16x16x32_bf16 v[20:23], v[232:235], v[228:231], v[20:23]
  ds_read_b64_tr_b16 v[48:49], v178 offset:28672
  s_lshl_b32 s44, s65, 11
  v_mfma_f32_16x16x32_bf16 v[4:7], v[236:239], v[224:227], v[4:7]
  ds_read_b64_tr_b16 v[50:51], v178 offset:31232
  ds_read_b64_tr_b16 v[52:53], v179 offset:28672
  s_bfe_u32 s44, s44, 0x2000e
  s_lshl4_add_u32 s44, s5, s44
  v_mfma_f32_16x16x32_bf16 v[24:27], v[236:239], v[228:231], v[24:27]
  ds_read_b64_tr_b16 v[54:55], v179 offset:31232
  s_lshl_b32 s44, s44, 14
  v_mfma_f32_16x16x32_bf16 v[8:11], v[240:243], v[224:227], v[8:11]
  ds_read_b64_tr_b16 v[56:57], v178 offset:28736
  ds_read_b64_tr_b16 v[58:59], v178 offset:31296
  s_add_u32 m0, s49, 90112
  s_nop 0
  buffer_load_dwordx4 v172, s[84:87], s44 offen offset:0 sc1 lds
  v_mfma_f32_16x16x32_bf16 v[28:31], v[240:243], v[228:231], v[28:31]
  ds_read_b64_tr_b16 v[60:61], v179 offset:28736
  ds_read_b64_tr_b16 v[62:63], v179 offset:31296
  buffer_load_dwordx4 v172, s[84:87], s44 offen offset:1024 sc1 lds
  v_mfma_f32_16x16x32_bf16 v[12:15], v[244:247], v[224:227], v[12:15]
  ds_read_b64_tr_b16 v[128:129], v178 offset:28928
  s_add_u32 s44, s44, 65536
  v_mfma_f32_16x16x32_bf16 v[32:35], v[244:247], v[228:231], v[32:35]
  ds_read_b64_tr_b16 v[130:131], v178 offset:31488
  ds_read_b128 v[132:135], v180 offset:24576
  s_add_u32 m0, s49, 0
  s_nop 0
  buffer_load_dwordx4 v172, s[84:87], s44 offen offset:0 sc1 lds
  v_mfma_f32_16x16x32_bf16 v[16:19], v[248:251], v[224:227], v[16:19]
  ds_read_b128 v[136:139], v180 offset:25600
  buffer_load_dwordx4 v172, s[84:87], s44 offen offset:1024 sc1 lds
  v_mfma_f32_16x16x32_bf16 v[36:39], v[248:251], v[228:231], v[36:39]
  ds_read_b64_tr_b16 v[140:141], v178 offset:38912
  ds_read_b64_tr_b16 v[142:143], v178 offset:41472
  s_add_u32 s44, s44, 65536
  s_add_u32 m0, s45, 122880
  v_mfma_f32_16x16x32_bf16 v[0:3], v[196:199], v[252:255], v[0:3]
  ds_read_b64_tr_b16 v[144:145], v179 offset:38912
  ds_read_b64_tr_b16 v[146:147], v179 offset:41472
  buffer_load_dwordx4 v188, s[36:39], s43 offen offset:0 lds
  v_mfma_f32_16x16x32_bf16 v[20:23], v[196:199], v[192:195], v[20:23]
  ds_read_b64_tr_b16 v[148:149], v178 offset:38976
  buffer_load_dwordx4 v189, s[36:39], s43 offen offset:1024 lds
  buffer_load_dwordx4 v190, s[36:39], s43 offen offset:2048 lds
  v_mfma_f32_16x16x32_bf16 v[4:7], v[200:203], v[252:255], v[4:7]
  ds_read_b64_tr_b16 v[150:151], v178 offset:41536
  ds_read_b64_tr_b16 v[152:153], v179 offset:38976
  s_add_u32 s43, s43, 40960
  v_mfma_f32_16x16x32_bf16 v[24:27], v[200:203], v[192:195], v[24:27]
  ds_read_b64_tr_b16 v[154:155], v179 offset:41536
  buffer_load_dword v170, off, s[72:75], 0 offset:128 sc1
  v_mfma_f32_16x16x32_bf16 v[8:11], v[204:207], v[252:255], v[8:11]
  ds_read_b64_tr_b16 v[156:157], v178 offset:39168
  ds_read_b64_tr_b16 v[158:159], v178 offset:41728
  v_mfma_f32_16x16x32_bf16 v[28:31], v[204:207], v[192:195], v[28:31]
  v_mfma_f32_16x16x32_bf16 v[12:15], v[208:211], v[252:255], v[12:15]
  v_mfma_f32_16x16x32_bf16 v[32:35], v[208:211], v[192:195], v[32:35]
  v_mfma_f32_16x16x32_bf16 v[16:19], v[212:215], v[252:255], v[16:19]
  v_mfma_f32_16x16x32_bf16 v[36:39], v[212:215], v[192:195], v[36:39]
  s_waitcnt lgkmcnt(0)
  s_barrier
  v_mfma_f32_16x16x32_bf16 v[0:3], v[48:51], v[40:43], v[0:3]
  ds_read_b128 v[224:227], v180 offset:32768
  ds_read_b128 v[228:231], v180 offset:33792
  v_mfma_f32_16x16x32_bf16 v[20:23], v[48:51], v[44:47], v[20:23]
  ds_read_b64_tr_b16 v[232:233], v176 offset:0
  s_add_u32 m0, s49, 16384
  v_mfma_f32_16x16x32_bf16 v[4:7], v[52:55], v[40:43], v[4:7]
  ds_read_b64_tr_b16 v[234:235], v176 offset:2560
  ds_read_b64_tr_b16 v[236:237], v177 offset:0
  v_mfma_f32_16x16x32_bf16 v[24:27], v[52:55], v[44:47], v[24:27]
  ds_read_b64_tr_b16 v[238:239], v177 offset:2560
  buffer_load_dwordx4 v172, s[84:87], s44 offen offset:0 sc1 lds
  v_mfma_f32_16x16x32_bf16 v[8:11], v[56:59], v[40:43], v[8:11]
  ds_read_b64_tr_b16 v[240:241], v176 offset:64
  ds_read_b64_tr_b16 v[242:243], v176 offset:2624
  buffer_load_dwordx4 v172, s[84:87], s44 offen offset:1024 sc1 lds
  v_mfma_f32_16x16x32_bf16 v[28:31], v[56:59], v[44:47], v[28:31]
  ds_read_b64_tr_b16 v[244:245], v177 offset:64
  ds_read_b64_tr_b16 v[246:247], v177 offset:2624
  v_mfma_f32_16x16x32_bf16 v[12:15], v[60:63], v[40:43], v[12:15]
  ds_read_b64_tr_b16 v[248:249], v176 offset:256
  s_add_u32 s44, s44, 65536
  v_mfma_f32_16x16x32_bf16 v[32:35], v[60:63], v[44:47], v[32:35]
  ds_read_b64_tr_b16 v[250:251], v176 offset:2816
  ds_read_b128 v[252:255], v180 offset:40960
  s_add_u32 m0, s45, 146432
  v_mfma_f32_16x16x32_bf16 v[16:19], v[128:131], v[40:43], v[16:19]
  ds_read_b128 v[192:195], v180 offset:41984
  v_mfma_f32_16x16x32_bf16 v[36:39], v[128:131], v[44:47], v[36:39]
  ds_read_b64_tr_b16 v[196:197], v176 offset:10240
  ds_read_b64_tr_b16 v[198:199], v176 offset:12800
  buffer_load_dwordx4 v191, s[36:39], s43 offen offset:0 lds
  v_mfma_f32_16x16x32_bf16 v[0:3], v[140:143], v[132:135], v[0:3]
  ds_read_b64_tr_b16 v[200:201], v177 offset:10240
  ds_read_b64_tr_b16 v[202:203], v177 offset:12800
  buffer_load_dwordx4 v160, s[36:39], s43 offen offset:1024 lds
  v_mfma_f32_16x16x32_bf16 v[20:23], v[140:143], v[136:139], v[20:23]
  ds_read_b64_tr_b16 v[204:205], v176 offset:10304
  v_mfma_f32_16x16x32_bf16 v[4:7], v[144:147], v[132:135], v[4:7]
  ds_read_b64_tr_b16 v[206:207], v176 offset:12864
  ds_read_b64_tr_b16 v[208:209], v177 offset:10304
  s_add_u32 s43, s43, 40960
  v_mfma_f32_16x16x32_bf16 v[24:27], v[144:147], v[136:139], v[24:27]
  ds_read_b64_tr_b16 v[210:211], v177 offset:12864
  v_mfma_f32_16x16x32_bf16 v[8:11], v[148:151], v[132:135], v[8:11]
  ds_read_b64_tr_b16 v[212:213], v176 offset:10496
  ds_read_b64_tr_b16 v[214:215], v176 offset:13056
  v_mfma_f32_16x16x32_bf16 v[28:31], v[148:151], v[136:139], v[28:31]
  v_mfma_f32_16x16x32_bf16 v[12:15], v[152:155], v[132:135], v[12:15]
  v_mfma_f32_16x16x32_bf16 v[32:35], v[152:155], v[136:139], v[32:35]
  v_mfma_f32_16x16x32_bf16 v[16:19], v[156:159], v[132:135], v[16:19]
  v_mfma_f32_16x16x32_bf16 v[36:39], v[156:159], v[136:139], v[36:39]
  s_waitcnt lgkmcnt(0)
  s_waitcnt vmcnt(10)
  s_barrier
  v_mfma_f32_16x16x32_bf16 v[0:3], v[232:235], v[224:227], v[0:3]
  ds_read_b128 v[40:43], v181 offset:32768
  ds_read_b128 v[44:47], v181 offset:33792
  v_mfma_f32_16x16x32_bf16 v[20:23], v[232:235], v[228:231], v[20:23]
  ds_read_b64_tr_b16 v[48:49], v176 offset:20480
  s_add_u32 m0, s49, 32768
  v_mfma_f32_16x16x32_bf16 v[4:7], v[236:239], v[224:227], v[4:7]
  ds_read_b64_tr_b16 v[50:51], v176 offset:23040
  ds_read_b64_tr_b16 v[52:53], v177 offset:20480
  v_mfma_f32_16x16x32_bf16 v[24:27], v[236:239], v[228:231], v[24:27]
  ds_read_b64_tr_b16 v[54:55], v177 offset:23040
  buffer_load_dwordx4 v172, s[84:87], s44 offen offset:0 sc1 lds
  v_mfma_f32_16x16x32_bf16 v[8:11], v[240:243], v[224:227], v[8:11]
  ds_read_b64_tr_b16 v[56:57], v176 offset:20544
  ds_read_b64_tr_b16 v[58:59], v176 offset:23104
  buffer_load_dwordx4 v172, s[84:87], s44 offen offset:1024 sc1 lds
  v_mfma_f32_16x16x32_bf16 v[28:31], v[240:243], v[228:231], v[28:31]
  ds_read_b64_tr_b16 v[60:61], v177 offset:20544
  ds_read_b64_tr_b16 v[62:63], v177 offset:23104
  s_add_u32 s44, s44, 65536
  v_mfma_f32_16x16x32_bf16 v[12:15], v[244:247], v[224:227], v[12:15]
  ds_read_b64_tr_b16 v[128:129], v176 offset:20736
  v_mfma_f32_16x16x32_bf16 v[32:35], v[244:247], v[228:231], v[32:35]
  ds_read_b64_tr_b16 v[130:131], v176 offset:23296
  ds_read_b128 v[132:135], v181 offset:57344
  s_add_u32 m0, s45, 49152
  v_mfma_f32_16x16x32_bf16 v[16:19], v[248:251], v[224:227], v[16:19]
  ds_read_b128 v[136:139], v181 offset:58368
  buffer_load_dwordx4 v188, s[36:39], s43 offen offset:0 lds
  v_mfma_f32_16x16x32_bf16 v[36:39], v[248:251], v[228:231], v[36:39]
  ds_read_b64_tr_b16 v[140:141], v176 offset:30720
  ds_read_b64_tr_b16 v[142:143], v176 offset:33280
  buffer_load_dwordx4 v189, s[36:39], s43 offen offset:1024 lds
  v_mfma_f32_16x16x32_bf16 v[0:3], v[196:199], v[252:255], v[0:3]
  ds_read_b64_tr_b16 v[144:145], v177 offset:30720
  ds_read_b64_tr_b16 v[146:147], v177 offset:33280
  v_mfma_f32_16x16x32_bf16 v[20:23], v[196:199], v[192:195], v[20:23]
  ds_read_b64_tr_b16 v[148:149], v176 offset:30784
  buffer_load_dwordx4 v190, s[36:39], s43 offen offset:2048 lds
  v_mfma_f32_16x16x32_bf16 v[4:7], v[200:203], v[252:255], v[4:7]
  ds_read_b64_tr_b16 v[150:151], v176 offset:33344
  ds_read_b64_tr_b16 v[152:153], v177 offset:30784
  s_add_u32 s43, s43, 40960
  v_mfma_f32_16x16x32_bf16 v[24:27], v[200:203], v[192:195], v[24:27]
  ds_read_b64_tr_b16 v[154:155], v177 offset:33344
  v_mfma_f32_16x16x32_bf16 v[8:11], v[204:207], v[252:255], v[8:11]
  ds_read_b64_tr_b16 v[156:157], v176 offset:30976
  ds_read_b64_tr_b16 v[158:159], v176 offset:33536
  v_mfma_f32_16x16x32_bf16 v[28:31], v[204:207], v[192:195], v[28:31]
  v_mfma_f32_16x16x32_bf16 v[12:15], v[208:211], v[252:255], v[12:15]
  v_mfma_f32_16x16x32_bf16 v[32:35], v[208:211], v[192:195], v[32:35]
  v_mfma_f32_16x16x32_bf16 v[16:19], v[212:215], v[252:255], v[16:19]
  v_mfma_f32_16x16x32_bf16 v[36:39], v[212:215], v[192:195], v[36:39]
  s_waitcnt lgkmcnt(0)
  s_waitcnt vmcnt(10)
  s_barrier
  v_mfma_f32_16x16x32_bf16 v[64:67], v[48:51], v[40:43], 0
  ds_read_b128 v[224:227], v180 offset:0
  ds_read_b128 v[228:231], v180 offset:1024
  v_mfma_f32_16x16x32_bf16 v[84:87], v[48:51], v[44:47], 0
  ds_read_b64_tr_b16 v[232:233], v178 offset:8192
  s_add_u32 s97, s97, 1
  s_waitcnt vmcnt(9)
  v_cmp_ne_u32 vcc, 256, v170
  s_nop 1
  s_and_b32 s64, vcc_lo, 0x1
  s_cbranch_scc1 L_spin_d0
L_ok_d0:
  v_mfma_f32_16x16x32_bf16 v[68:71], v[52:55], v[40:43], 0
  ds_read_b64_tr_b16 v[234:235], v178 offset:10752
  ds_read_b64_tr_b16 v[236:237], v179 offset:8192
  v_cvt_pk_bf16_f32 v0, v0, v1
  v_cvt_pk_bf16_f32 v1, v2, v3
  v_mfma_f32_16x16x32_bf16 v[88:91], v[52:55], v[44:47], 0
  ds_read_b64_tr_b16 v[238:239], v179 offset:10752
  s_and_b32 s97, s97, 3
  v_cvt_pk_bf16_f32 v2, v4, v5
  v_cvt_pk_bf16_f32 v3, v6, v7
  v_mfma_f32_16x16x32_bf16 v[72:75], v[56:59], v[40:43], 0
  ds_read_b64_tr_b16 v[240:241], v178 offset:8256
  ds_read_b64_tr_b16 v[242:243], v178 offset:10816
  s_lshl2_add_u32 s43, s5, s97
  v_cvt_pk_bf16_f32 v4, v8, v9
  v_mfma_f32_16x16x32_bf16 v[92:95], v[56:59], v[44:47], 0
  ds_read_b64_tr_b16 v[244:245], v179 offset:8256
  ds_read_b64_tr_b16 v[246:247], v179 offset:10816
  s_mul_i32 s43, s43, 327680
  v_cvt_pk_bf16_f32 v5, v10, v11
  v_cvt_pk_bf16_f32 v6, v12, v13
  v_mfma_f32_16x16x32_bf16 v[76:79], v[60:63], v[40:43], 0
  ds_read_b64_tr_b16 v[248:249], v178 offset:8448
  v_cvt_pk_bf16_f32 v7, v14, v15
  v_cvt_pk_bf16_f32 v8, v16, v17
  v_mfma_f32_16x16x32_bf16 v[96:99], v[60:63], v[44:47], 0
  ds_read_b64_tr_b16 v[250:251], v178 offset:11008
  ds_read_b128 v[252:255], v180 offset:8192
  s_add_u32 s43, s43, s47
  v_cvt_pk_bf16_f32 v9, v18, v19
  v_cvt_pk_bf16_f32 v10, v20, v21
  v_mfma_f32_16x16x32_bf16 v[80:83], v[128:131], v[40:43], 0
  ds_read_b128 v[192:195], v180 offset:9216
  s_add_u32 m0, s45, 72704
  v_cvt_pk_bf16_f32 v11, v22, v23
  v_cvt_pk_bf16_f32 v12, v24, v25
  v_mfma_f32_16x16x32_bf16 v[100:103], v[128:131], v[44:47], 0
  ds_read_b64_tr_b16 v[196:197], v178 offset:18432
  ds_read_b64_tr_b16 v[198:199], v178 offset:20992
  buffer_load_dwordx4 v191, s[36:39], s43 offen offset:0 lds
  v_cvt_pk_bf16_f32 v13, v26, v27
  v_cvt_pk_bf16_f32 v14, v28, v29
  v_mfma_f32_16x16x32_bf16 v[64:67], v[140:143], v[132:135], v[64:67]
  ds_read_b64_tr_b16 v[200:201], v179 offset:18432
  ds_read_b64_tr_b16 v[202:203], v179 offset:20992
  v_cvt_pk_bf16_f32 v15, v30, v31
  v_mfma_f32_16x16x32_bf16 v[84:87], v[140:143], v[136:139], v[84:87]
  ds_read_b64_tr_b16 v[204:205], v178 offset:18496
  buffer_load_dwordx4 v160, s[36:39], s43 offen offset:1024 lds
  v_cvt_pk_bf16_f32 v16, v32, v33
  v_cvt_pk_bf16_f32 v17, v34, v35
  v_mfma_f32_16x16x32_bf16 v[68:71], v[144:147], v[132:135], v[68:71]
  ds_read_b64_tr_b16 v[206:207], v178 offset:21056
  ds_read_b64_tr_b16 v[208:209], v179 offset:18496
  s_add_u32 s43, s43, 40960
  v_cvt_pk_bf16_f32 v18, v36, v37
  v_cvt_pk_bf16_f32 v19, v38, v39
  v_mfma_f32_16x16x32_bf16 v[88:91], v[144:147], v[136:139], v[88:91]
  ds_read_b64_tr_b16 v[210:211], v179 offset:21056
  buffer_load_dword v171, v164, s[68:71], 0 offen sc1
  buffer_store_dwordx4 v[0:3], v184, s[88:91], 0 offen offset:0 sc1
  v_mfma_f32_16x16x32_bf16 v[72:75], v[148:151], v[132:135], v[72:75]
  ds_read_b64_tr_b16 v[212:213], v178 offset:18688
  ds_read_b64_tr_b16 v[214:215], v178 offset:21248
  v_mfma_f32_16x16x32_bf16 v[92:95], v[148:151], v[136:139], v[92:95]
  v_mfma_f32_16x16x32_bf16 v[76:79], v[152:155], v[132:135], v[76:79]
  v_mfma_f32_16x16x32_bf16 v[96:99], v[152:155], v[136:139], v[96:99]
  v_mfma_f32_16x16x32_bf16 v[80:83], v[156:159], v[132:135], v[80:83]
  v_mfma_f32_16x16x32_bf16 v[100:103], v[156:159], v[136:139], v[100:103]
  s_waitcnt lgkmcnt(0)
  s_waitcnt vmcnt(9)
  s_barrier
  v_mfma_f32_16x16x32_bf16 v[64:67], v[232:235], v[224:227], v[64:67]
  ds_read_b128 v[40:43], v180 offset:16384
  ds_read_b128 v[44:47], v180 offset:17408
  s_waitcnt vmcnt(1)
  v_cmp_gt_u32 vcc, 4, v171
  s_nop 1
  s_and_b32 s64, vcc_lo, 0xff00
  s_cbranch_scc1 L_spin_o0_9
L_ok_o0_9:
  v_mfma_f32_16x16x32_bf16 v[84:87], v[232:235], v[228:231], v[84:87]
  ds_read_b64_tr_b16 v[48:49], v178 offset:28672
  s_add_u32 s44, s44, 16384
  v_mfma_f32_16x16x32_bf16 v[68:71], v[236:239], v[224:227], v[68:71]
  ds_read_b64_tr_b16 v[50:51], v178 offset:31232
  ds_read_b64_tr_b16 v[52:53], v179 offset:28672
  s_bfe_u32 s44, s44, 0x2000e
  s_lshl4_add_u32 s44, s5, s44
  v_mfma_f32_16x16x32_bf16 v[88:91], v[236:239], v[228:231], v[88:91]
  ds_read_b64_tr_b16 v[54:55], v179 offset:31232
  s_lshl_b32 s44, s44, 14
  v_mfma_f32_16x16x32_bf16 v[72:75], v[240:243], v[224:227], v[72:75]
  ds_read_b64_tr_b16 v[56:57], v178 offset:28736
  ds_read_b64_tr_b16 v[58:59], v178 offset:31296
  s_add_u32 m0, s49, 90112
  s_nop 0
  buffer_load_dwordx4 v172, s[84:87], s44 offen offset:0 sc1 lds
  v_mfma_f32_16x16x32_bf16 v[92:95], v[240:243], v[228:231], v[92:95]
  ds_read_b64_tr_b16 v[60:61], v179 offset:28736
  ds_read_b64_tr_b16 v[62:63], v179 offset:31296
  buffer_load_dwordx4 v172, s[84:87], s44 offen offset:1024 sc1 lds
  v_mfma_f32_16x16x32_bf16 v[76:79], v[244:247], v[224:227], v[76:79]
  ds_read_b64_tr_b16 v[128:129], v178 offset:28928
  s_add_u32 s44, s44, 65536
  v_mfma_f32_16x16x32_bf16 v[96:99], v[244:247], v[228:231], v[96:99]
  ds_read_b64_tr_b16 v[130:131], v178 offset:31488
  ds_read_b128 v[132:135], v180 offset:24576
  s_add_u32 m0, s49, 0
  s_nop 0
  buffer_load_dwordx4 v172, s[84:87], s44 offen offset:0 sc1 lds
  v_mfma_f32_16x16x32_bf16 v[80:83], v[248:251], v[224:227], v[80:83]
  ds_read_b128 v[136:139], v180 offset:25600
  buffer_load_dwordx4 v172, s[84:87], s44 offen offset:1024 sc1 lds
  v_mfma_f32_16x16x32_bf16 v[100:103], v[248:251], v[228:231], v[100:103]
  ds_read_b64_tr_b16 v[140:141], v178 offset:38912
  ds_read_b64_tr_b16 v[142:143], v178 offset:41472
  s_add_u32 s44, s44, 65536
  s_add_u32 m0, s45, 122880
  v_mfma_f32_16x16x32_bf16 v[64:67], v[196:199], v[252:255], v[64:67]
  ds_read_b64_tr_b16 v[144:145], v179 offset:38912
  ds_read_b64_tr_b16 v[146:147], v179 offset:41472
  buffer_load_dwordx4 v188, s[36:39], s43 offen offset:0 lds
  v_mfma_f32_16x16x32_bf16 v[84:87], v[196:199], v[192:195], v[84:87]
  ds_read_b64_tr_b16 v[148:149], v178 offset:38976
  buffer_load_dwordx4 v189, s[36:39], s43 offen offset:1024 lds
  buffer_load_dwordx4 v190, s[36:39], s43 offen offset:2048 lds
  v_mfma_f32_16x16x32_bf16 v[68:71], v[200:203], v[252:255], v[68:71]
  ds_read_b64_tr_b16 v[150:151], v178 offset:41536
  ds_read_b64_tr_b16 v[152:153], v179 offset:38976
  s_add_u32 s43, s43, 40960
  v_mfma_f32_16x16x32_bf16 v[88:91], v[200:203], v[192:195], v[88:91]
  ds_read_b64_tr_b16 v[154:155], v179 offset:41536
  v_mfma_f32_16x16x32_bf16 v[72:75], v[204:207], v[252:255], v[72:75]
  ds_read_b64_tr_b16 v[156:157], v178 offset:39168
  ds_read_b64_tr_b16 v[158:159], v178 offset:41728
  v_mfma_f32_16x16x32_bf16 v[92:95], v[204:207], v[192:195], v[92:95]
  v_mfma_f32_16x16x32_bf16 v[76:79], v[208:211], v[252:255], v[76:79]
  v_mfma_f32_16x16x32_bf16 v[96:99], v[208:211], v[192:195], v[96:99]
  v_mfma_f32_16x16x32_bf16 v[80:83], v[212:215], v[252:255], v[80:83]
  v_mfma_f32_16x16x32_bf16 v[100:103], v[212:215], v[192:195], v[100:103]
  s_waitcnt lgkmcnt(0)
  s_barrier
  v_mfma_f32_16x16x32_bf16 v[64:67], v[48:51], v[40:43], v[64:67]
  ds_read_b128 v[224:227], v180 offset:32768
  ds_read_b128 v[228:231], v180 offset:33792
  v_mfma_f32_16x16x32_bf16 v[84:87], v[48:51], v[44:47], v[84:87]
  ds_read_b64_tr_b16 v[232:233], v176 offset:0
  s_add_u32 m0, s49, 16384
  v_mfma_f32_16x16x32_bf16 v[68:71], v[52:55], v[40:43], v[68:71]
  ds_read_b64_tr_b16 v[234:235], v176 offset:2560
  ds_read_b64_tr_b16 v[236:237], v177 offset:0
  v_mfma_f32_16x16x32_bf16 v[88:91], v[52:55], v[44:47], v[88:91]
  ds_read_b64_tr_b16 v[238:239], v177 offset:2560
  buffer_load_dwordx4 v172, s[84:87], s44 offen offset:0 sc1 lds
  v_mfma_f32_16x16x32_bf16 v[72:75], v[56:59], v[40:43], v[72:75]
  ds_read_b64_tr_b16 v[240:241], v176 offset:64
  ds_read_b64_tr_b16 v[242:243], v176 offset:2624
  buffer_load_dwordx4 v172, s[84:87], s44 offen offset:1024 sc1 lds
  v_mfma_f32_16x16x32_bf16 v[92:95], v[56:59], v[44:47], v[92:95]
  ds_read_b64_tr_b16 v[244:245], v177 offset:64
  ds_read_b64_tr_b16 v[246:247], v177 offset:2624
  v_mfma_f32_16x16x32_bf16 v[76:79], v[60:63], v[40:43], v[76:79]
  ds_read_b64_tr_b16 v[248:249], v176 offset:256
  s_add_u32 s44, s44, 65536
  v_mfma_f32_16x16x32_bf16 v[96:99], v[60:63], v[44:47], v[96:99]
  ds_read_b64_tr_b16 v[250:251], v176 offset:2816
  ds_read_b128 v[252:255], v180 offset:40960
  s_add_u32 m0, s45, 146432
  v_mfma_f32_16x16x32_bf16 v[80:83], v[128:131], v[40:43], v[80:83]
  ds_read_b128 v[192:195], v180 offset:41984
  v_mfma_f32_16x16x32_bf16 v[100:103], v[128:131], v[44:47], v[100:103]
  ds_read_b64_tr_b16 v[196:197], v176 offset:10240
  ds_read_b64_tr_b16 v[198:199], v176 offset:12800
  buffer_load_dwordx4 v191, s[36:39], s43 offen offset:0 lds
  v_mfma_f32_16x16x32_bf16 v[64:67], v[140:143], v[132:135], v[64:67]
  ds_read_b64_tr_b16 v[200:201], v177 offset:10240
  ds_read_b64_tr_b16 v[202:203], v177 offset:12800
  buffer_load_dwordx4 v160, s[36:39], s43 offen offset:1024 lds
  v_mfma_f32_16x16x32_bf16 v[84:87], v[140:143], v[136:139], v[84:87]
  ds_read_b64_tr_b16 v[204:205], v176 offset:10304
  v_mfma_f32_16x16x32_bf16 v[68:71], v[144:147], v[132:135], v[68:71]
  ds_read_b64_tr_b16 v[206:207], v176 offset:12864
  ds_read_b64_tr_b16 v[208:209], v177 offset:10304
  s_add_u32 s43, s43, 40960
  v_mfma_f32_16x16x32_bf16 v[88:91], v[144:147], v[136:139], v[88:91]
  ds_read_b64_tr_b16 v[210:211], v177 offset:12864
  buffer_store_dwordx4 v[4:7], v184, s[88:91], 0 offen offset:256 sc1
  v_mfma_f32_16x16x32_bf16 v[72:75], v[148:151], v[132:135], v[72:75]
  ds_read_b64_tr_b16 v[212:213], v176 offset:10496
  ds_read_b64_tr_b16 v[214:215], v176 offset:13056
  v_mfma_f32_16x16x32_bf16 v[92:95], v[148:151], v[136:139], v[92:95]
  v_mfma_f32_16x16x32_bf16 v[76:79], v[152:155], v[132:135], v[76:79]
  v_mfma_f32_16x16x32_bf16 v[96:99], v[152:155], v[136:139], v[96:99]
  v_mfma_f32_16x16x32_bf16 v[80:83], v[156:159], v[132:135], v[80:83]
  v_mfma_f32_16x16x32_bf16 v[100:103], v[156:159], v[136:139], v[100:103]
  s_waitcnt lgkmcnt(0)
  s_waitcnt vmcnt(10)
  s_barrier
  v_mfma_f32_16x16x32_bf16 v[64:67], v[232:235], v[224:227], v[64:67]
  ds_read_b128 v[40:43], v181 offset:32768
  ds_read_b128 v[44:47], v181 offset:33792
  v_mfma_f32_16x16x32_bf16 v[84:87], v[232:235], v[228:231], v[84:87]
  ds_read_b64_tr_b16 v[48:49], v176 offset:20480
  s_add_u32 m0, s49, 32768
  v_mfma_f32_16x16x32_bf16 v[68:71], v[236:239], v[224:227], v[68:71]
  ds_read_b64_tr_b16 v[50:51], v176 offset:23040
  ds_read_b64_tr_b16 v[52:53], v177 offset:20480
  v_mfma_f32_16x16x32_bf16 v[88:91], v[236:239], v[228:231], v[88:91]
  ds_read_b64_tr_b16 v[54:55], v177 offset:23040
  buffer_load_dwordx4 v172, s[84:87], s44 offen offset:0 sc1 lds
  v_mfma_f32_16x16x32_bf16 v[72:75], v[240:243], v[224:227], v[72:75]
  ds_read_b64_tr_b16 v[56:57], v176 offset:20544
  ds_read_b64_tr_b16 v[58:59], v176 offset:23104
  buffer_load_dwordx4 v172, s[84:87], s44 offen offset:1024 sc1 lds
  v_mfma_f32_16x16x32_bf16 v[92:95], v[240:243], v[228:231], v[92:95]
  ds_read_b64_tr_b16 v[60:61], v177 offset:20544
  ds_read_b64_tr_b16 v[62:63], v177 offset:23104
  s_add_u32 s44, s44, 65536
  v_mfma_f32_16x16x32_bf16 v[76:79], v[244:247], v[224:227], v[76:79]
  ds_read_b64_tr_b16 v[128:129], v176 offset:20736
  v_mfma_f32_16x16x32_bf16 v[96:99], v[244:247], v[228:231], v[96:99]
  ds_read_b64_tr_b16 v[130:131], v176 offset:23296
  ds_read_b128 v[132:135], v181 offset:57344
  s_add_u32 m0, s45, 49152
  v_mfma_f32_16x16x32_bf16 v[80:83], v[248:251], v[224:227], v[80:83]
  ds_read_b128 v[136:139], v181 offset:58368
  buffer_load_dwordx4 v188, s[36:39], s43 offen offset:0 lds
  v_mfma_f32_16x16x32_bf16 v[100:103], v[248:251], v[228:231], v[100:103]
  ds_read_b64_tr_b16 v[140:141], v176 offset:30720
  ds_read_b64_tr_b16 v[142:143], v176 offset:33280
  buffer_load_dwordx4 v189, s[36:39], s43 offen offset:1024 lds
  v_mfma_f32_16x16x32_bf16 v[64:67], v[196:199], v[252:255], v[64:67]
  ds_read_b64_tr_b16 v[144:145], v177 offset:30720
  ds_read_b64_tr_b16 v[146:147], v177 offset:33280
  v_mfma_f32_16x16x32_bf16 v[84:87], v[196:199], v[192:195], v[84:87]
  ds_read_b64_tr_b16 v[148:149], v176 offset:30784
  buffer_load_dwordx4 v190, s[36:39], s43 offen offset:2048 lds
  v_mfma_f32_16x16x32_bf16 v[68:71], v[200:203], v[252:255], v[68:71]
  ds_read_b64_tr_b16 v[150:151], v176 offset:33344
  ds_read_b64_tr_b16 v[152:153], v177 offset:30784
  s_add_u32 s43, s43, 40960
  v_mfma_f32_16x16x32_bf16 v[88:91], v[200:203], v[192:195], v[88:91]
  ds_read_b64_tr_b16 v[154:155], v177 offset:33344
  v_mfma_f32_16x16x32_bf16 v[72:75], v[204:207], v[252:255], v[72:75]
  ds_read_b64_tr_b16 v[156:157], v176 offset:30976
  ds_read_b64_tr_b16 v[158:159], v176 offset:33536
  v_mfma_f32_16x16x32_bf16 v[92:95], v[204:207], v[192:195], v[92:95]
  v_mfma_f32_16x16x32_bf16 v[76:79], v[208:211], v[252:255], v[76:79]
  v_mfma_f32_16x16x32_bf16 v[96:99], v[208:211], v[192:195], v[96:99]
  v_mfma_f32_16x16x32_bf16 v[80:83], v[212:215], v[252:255], v[80:83]
  v_mfma_f32_16x16x32_bf16 v[100:103], v[212:215], v[192:195], v[100:103]
  s_waitcnt lgkmcnt(0)
  s_waitcnt vmcnt(10)
  s_barrier
  v_mfma_f32_16x16x32_bf16 v[64:67], v[48:51], v[40:43], v[64:67]
  ds_read_b128 v[224:227], v180 offset:0
  ds_read_b128 v[228:231], v180 offset:1024
  v_mfma_f32_16x16x32_bf16 v[84:87], v[48:51], v[44:47], v[84:87]
  ds_read_b64_tr_b16 v[232:233], v178 offset:8192
  s_add_u32 s44, s44, 16384
  v_mfma_f32_16x16x32_bf16 v[68:71], v[52:55], v[40:43], v[68:71]
  ds_read_b64_tr_b16 v[234:235], v178 offset:10752
  ds_read_b64_tr_b16 v[236:237], v179 offset:8192
  s_bfe_u32 s44, s44, 0x2000e
  s_lshl4_add_u32 s44, s5, s44
  v_mfma_f32_16x16x32_bf16 v[88:91], v[52:55], v[44:47], v[88:91]
  ds_read_b64_tr_b16 v[238:239], v179 offset:10752
  s_lshl_b32 s44, s44, 14
  v_mfma_f32_16x16x32_bf16 v[72:75], v[56:59], v[40:43], v[72:75]
  ds_read_b64_tr_b16 v[240:241], v178 offset:8256
  ds_read_b64_tr_b16 v[242:243], v178 offset:10816
  s_add_u32 m0, s49, 90112
  s_nop 0
  buffer_load_dwordx4 v172, s[84:87], s44 offen offset:0 sc1 lds
  v_mfma_f32_16x16x32_bf16 v[92:95], v[56:59], v[44:47], v[92:95]
  ds_read_b64_tr_b16 v[244:245], v179 offset:8256
  ds_read_b64_tr_b16 v[246:247], v179 offset:10816
  buffer_load_dwordx4 v172, s[84:87], s44 offen offset:1024 sc1 lds
  v_mfma_f32_16x16x32_bf16 v[76:79], v[60:63], v[40:43], v[76:79]
  ds_read_b64_tr_b16 v[248:249], v178 offset:8448
  s_add_u32 s44, s44, 65536
  v_mfma_f32_16x16x32_bf16 v[96:99], v[60:63], v[44:47], v[96:99]
  ds_read_b64_tr_b16 v[250:251], v178 offset:11008
  ds_read_b128 v[252:255], v180 offset:8192
  s_add_u32 s97, s97, 1
  s_and_b32 s97, s97, 3
  v_mfma_f32_16x16x32_bf16 v[80:83], v[128:131], v[40:43], v[80:83]
  ds_read_b128 v[192:195], v180 offset:9216
  s_lshl2_add_u32 s43, s5, s97
  v_mfma_f32_16x16x32_bf16 v[100:103], v[128:131], v[44:47], v[100:103]
  ds_read_b64_tr_b16 v[196:197], v178 offset:18432
  ds_read_b64_tr_b16 v[198:199], v178 offset:20992
  s_mul_i32 s43, s43, 327680
  s_add_u32 s43, s43, s47
  v_mfma_f32_16x16x32_bf16 v[64:67], v[140:143], v[132:135], v[64:67]
  ds_read_b64_tr_b16 v[200:201], v179 offset:18432
  ds_read_b64_tr_b16 v[202:203], v179 offset:20992
  s_add_u32 m0, s45, 72704
  v_mfma_f32_16x16x32_bf16 v[84:87], v[140:143], v[136:139], v[84:87]
  ds_read_b64_tr_b16 v[204:205], v178 offset:18496
  buffer_load_dwordx4 v191, s[36:39], s43 offen offset:0 lds
  buffer_load_dwordx4 v160, s[36:39], s43 offen offset:1024 lds
  v_mfma_f32_16x16x32_bf16 v[68:71], v[144:147], v[132:135], v[68:71]
  ds_read_b64_tr_b16 v[206:207], v178 offset:21056
  ds_read_b64_tr_b16 v[208:209], v179 offset:18496
  s_add_u32 s43, s43, 40960
  v_mfma_f32_16x16x32_bf16 v[88:91], v[144:147], v[136:139], v[88:91]
  ds_read_b64_tr_b16 v[210:211], v179 offset:21056
  buffer_store_dwordx4 v[8:11], v184, s[88:91], 0 offen offset:512 sc1
  v_mfma_f32_16x16x32_bf16 v[72:75], v[148:151], v[132:135], v[72:75]
  ds_read_b64_tr_b16 v[212:213], v178 offset:18688
  ds_read_b64_tr_b16 v[214:215], v178 offset:21248
  v_mfma_f32_16x16x32_bf16 v[92:95], v[148:151], v[136:139], v[92:95]
  v_mfma_f32_16x16x32_bf16 v[76:79], v[152:155], v[132:135], v[76:79]
  v_mfma_f32_16x16x32_bf16 v[96:99], v[152:155], v[136:139], v[96:99]
  v_mfma_f32_16x16x32_bf16 v[80:83], v[156:159], v[132:135], v[80:83]
  v_mfma_f32_16x16x32_bf16 v[100:103], v[156:159], v[136:139], v[100:103]
  s_waitcnt lgkmcnt(0)
  s_waitcnt vmcnt(11)
  s_barrier
  v_mfma_f32_16x16x32_bf16 v[64:67], v[232:235], v[224:227], v[64:67]
  ds_read_b128 v[40:43], v180 offset:16384
  ds_read_b128 v[44:47], v180 offset:17408
  v_mfma_f32_16x16x32_bf16 v[84:87], v[232:235], v[228:231], v[84:87]
  ds_read_b64_tr_b16 v[48:49], v178 offset:28672
  s_add_u32 m0, s49, 0
  v_mfma_f32_16x16x32_bf16 v[68:71], v[236:239], v[224:227], v[68:71]
  ds_read_b64_tr_b16 v[50:51], v178 offset:31232
  ds_read_b64_tr_b16 v[52:53], v179 offset:28672
  v_mfma_f32_16x16x32_bf16 v[88:91], v[236:239], v[228:231], v[88:91]
  ds_read_b64_tr_b16 v[54:55], v179 offset:31232
  buffer_load_dwordx4 v172, s[84:87], s44 offen offset:0 sc1 lds
  v_mfma_f32_16x16x32_bf16 v[72:75], v[240:243], v[224:227], v[72:75]
  ds_read_b64_tr_b16 v[56:57], v178 offset:28736
  ds_read_b64_tr_b16 v[58:59], v178 offset:31296
  buffer_load_dwordx4 v172, s[84:87], s44 offen offset:1024 sc1 lds
  v_mfma_f32_16x16x32_bf16 v[92:95], v[240:243], v[228:231], v[92:95]
  ds_read_b64_tr_b16 v[60:61], v179 offset:28736
  ds_read_b64_tr_b16 v[62:63], v179 offset:31296
  s_add_u32 s44, s44, 65536
  v_mfma_f32_16x16x32_bf16 v[76:79], v[244:247], v[224:227], v[76:79]
  ds_read_b64_tr_b16 v[128:129], v178 offset:28928
  v_mfma_f32_16x16x32_bf16 v[96:99], v[244:247], v[228:231], v[96:99]
  ds_read_b64_tr_b16 v[130:131], v178 offset:31488
  ds_read_b128 v[132:135], v180 offset:24576
  s_add_u32 m0, s45, 122880
  v_mfma_f32_16x16x32_bf16 v[80:83], v[248:251], v[224:227], v[80:83]
  ds_read_b128 v[136:139], v180 offset:25600
  buffer_load_dwordx4 v188, s[36:39], s43 offen offset:0 lds
  v_mfma_f32_16x16x32_bf16 v[100:103], v[248:251], v[228:231], v[100:103]
  ds_read_b64_tr_b16 v[140:141], v178 offset:38912
  ds_read_b64_tr_b16 v[142:143], v178 offset:41472
  buffer_load_dwordx4 v189, s[36:39], s43 offen offset:1024 lds
  v_mfma_f32_16x16x32_bf16 v[64:67], v[196:199], v[252:255], v[64:67]
  ds_read_b64_tr_b16 v[144:145], v179 offset:38912
  ds_read_b64_tr_b16 v[146:147], v179 offset:41472
  v_mfma_f32_16x16x32_bf16 v[84:87], v[196:199], v[192:195], v[84:87]
  ds_read_b64_tr_b16 v[148:149], v178 offset:38976
  buffer_load_dwordx4 v190, s[36:39], s43 offen offset:2048 lds
  v_mfma_f32_16x16x32_bf16 v[68:71], v[200:203], v[252:255], v[68:71]
  ds_read_b64_tr_b16 v[150:151], v178 offset:41536
  ds_read_b64_tr_b16 v[152:153], v179 offset:38976
  s_add_u32 s43, s43, 40960
  v_mfma_f32_16x16x32_bf16 v[88:91], v[200:203], v[192:195], v[88:91]
  ds_read_b64_tr_b16 v[154:155], v179 offset:41536
  v_mfma_f32_16x16x32_bf16 v[72:75], v[204:207], v[252:255], v[72:75]
  ds_read_b64_tr_b16 v[156:157], v178 offset:39168
  ds_read_b64_tr_b16 v[158:159], v178 offset:41728
  v_mfma_f32_16x16x32_bf16 v[92:95], v[204:207], v[192:195], v[92:95]
  v_mfma_f32_16x16x32_bf16 v[76:79], v[208:211], v[252:255], v[76:79]
  v_mfma_f32_16x16x32_bf16 v[96:99], v[208:211], v[192:195], v[96:99]
  v_mfma_f32_16x16x32_bf16 v[80:83], v[212:215], v[252:255], v[80:83]
  v_mfma_f32_16x16x32_bf16 v[100:103], v[212:215], v[192:195], v[100:103]
  s_waitcnt lgkmcnt(0)
  s_waitcnt vmcnt(10)
  s_barrier
  v_mfma_f32_16x16x32_bf16 v[64:67], v[48:51], v[40:43], v[64:67]
  ds_read_b128 v[224:227], v180 offset:32768
  ds_read_b128 v[228:231], v180 offset:33792
  v_mfma_f32_16x16x32_bf16 v[84:87], v[48:51], v[44:47], v[84:87]
  ds_read_b64_tr_b16 v[232:233], v176 offset:0
  s_add_u32 m0, s49, 16384
  v_mfma_f32_16x16x32_bf16 v[68:71], v[52:55], v[40:43], v[68:71]
  ds_read_b64_tr_b16 v[234:235], v176 offset:2560
  ds_read_b64_tr_b16 v[236:237], v177 offset:0
  v_mfma_f32_16x16x32_bf16 v[88:91], v[52:55], v[44:47], v[88:91]
  ds_read_b64_tr_b16 v[238:239], v177 offset:2560
  buffer_load_dwordx4 v172, s[84:87], s44 offen offset:0 sc1 lds
  v_mfma_f32_16x16x32_bf16 v[72:75], v[56:59], v[40:43], v[72:75]
  ds_read_b64_tr_b16 v[240:241], v176 offset:64
  ds_read_b64_tr_b16 v[242:243], v176 offset:2624
  buffer_load_dwordx4 v172, s[84:87], s44 offen offset:1024 sc1 lds
  v_mfma_f32_16x16x32_bf16 v[92:95], v[56:59], v[44:47], v[92:95]
  ds_read_b64_tr_b16 v[244:245], v177 offset:64
  ds_read_b64_tr_b16 v[246:247], v177 offset:2624
  v_mfma_f32_16x16x32_bf16 v[76:79], v[60:63], v[40:43], v[76:79]
  ds_read_b64_tr_b16 v[248:249], v176 offset:256
  s_add_u32 s44, s44, 65536
  v_mfma_f32_16x16x32_bf16 v[96:99], v[60:63], v[44:47], v[96:99]
  ds_read_b64_tr_b16 v[250:251], v176 offset:2816
  ds_read_b128 v[252:255], v180 offset:40960
  s_add_u32 m0, s45, 146432
  v_mfma_f32_16x16x32_bf16 v[80:83], v[128:131], v[40:43], v[80:83]
  ds_read_b128 v[192:195], v180 offset:41984
  v_mfma_f32_16x16x32_bf16 v[100:103], v[128:131], v[44:47], v[100:103]
  ds_read_b64_tr_b16 v[196:197], v176 offset:10240
  ds_read_b64_tr_b16 v[198:199], v176 offset:12800
  buffer_load_dwordx4 v191, s[36:39], s43 offen offset:0 lds
  v_mfma_f32_16x16x32_bf16 v[64:67], v[140:143], v[132:135], v[64:67]
  ds_read_b64_tr_b16 v[200:201], v177 offset:10240
  ds_read_b64_tr_b16 v[202:203], v177 offset:12800
  buffer_load_dwordx4 v160, s[36:39], s43 offen offset:1024 lds
  v_mfma_f32_16x16x32_bf16 v[84:87], v[140:143], v[136:139], v[84:87]
  ds_read_b64_tr_b16 v[204:205], v176 offset:10304
  v_mfma_f32_16x16x32_bf16 v[68:71], v[144:147], v[132:135], v[68:71]
  ds_read_b64_tr_b16 v[206:207], v176 offset:12864
  ds_read_b64_tr_b16 v[208:209], v177 offset:10304
  s_add_u32 s43, s43, 40960
  v_mfma_f32_16x16x32_bf16 v[88:91], v[144:147], v[136:139], v[88:91]
  ds_read_b64_tr_b16 v[210:211], v177 offset:12864
  buffer_store_dwordx4 v[12:15], v184, s[88:91], 0 offen offset:768 sc1
  v_mfma_f32_16x16x32_bf16 v[72:75], v[148:151], v[132:135], v[72:75]
  ds_read_b64_tr_b16 v[212:213], v176 offset:10496
  ds_read_b64_tr_b16 v[214:215], v176 offset:13056
  v_mfma_f32_16x16x32_bf16 v[92:95], v[148:151], v[136:139], v[92:95]
  v_mfma_f32_16x16x32_bf16 v[76:79], v[152:155], v[132:135], v[76:79]
  v_mfma_f32_16x16x32_bf16 v[96:99], v[152:155], v[136:139], v[96:99]
  v_mfma_f32_16x16x32_bf16 v[80:83], v[156:159], v[132:135], v[80:83]
  v_mfma_f32_16x16x32_bf16 v[100:103], v[156:159], v[136:139], v[100:103]
  s_waitcnt lgkmcnt(0)
  s_waitcnt vmcnt(11)
  s_barrier
  v_mfma_f32_16x16x32_bf16 v[64:67], v[232:235], v[224:227], v[64:67]
  ds_read_b128 v[40:43], v181 offset:32768
  ds_read_b128 v[44:47], v181 offset:33792
  v_mfma_f32_16x16x32_bf16 v[84:87], v[232:235], v[228:231], v[84:87]
  ds_read_b64_tr_b16 v[48:49], v176 offset:20480
  s_add_u32 m0, s49, 32768
  v_mfma_f32_16x16x32_bf16 v[68:71], v[236:239], v[224:227], v[68:71]
  ds_read_b64_tr_b16 v[50:51], v176 offset:23040
  ds_read_b64_tr_b16 v[52:53], v177 offset:20480
  v_mfma_f32_16x16x32_bf16 v[88:91], v[236:239], v[228:231], v[88:91]
  ds_read_b64_tr_b16 v[54:55], v177 offset:23040
  buffer_load_dwordx4 v172, s[84:87], s44 offen offset:0 sc1 lds
  v_mfma_f32_16x16x32_bf16 v[72:75], v[240:243], v[224:227], v[72:75]
  ds_read_b64_tr_b16 v[56:57], v176 offset:20544
  ds_read_b64_tr_b16 v[58:59], v176 offset:23104
  buffer_load_dwordx4 v172, s[84:87], s44 offen offset:1024 sc1 lds
  v_mfma_f32_16x16x32_bf16 v[92:95], v[240:243], v[228:231], v[92:95]
  ds_read_b64_tr_b16 v[60:61], v177 offset:20544
  ds_read_b64_tr_b16 v[62:63], v177 offset:23104
  s_add_u32 s44, s44, 65536
  v_mfma_f32_16x16x32_bf16 v[76:79], v[244:247], v[224:227], v[76:79]
  ds_read_b64_tr_b16 v[128:129], v176 offset:20736
  v_mfma_f32_16x16x32_bf16 v[96:99], v[244:247], v[228:231], v[96:99]
  ds_read_b64_tr_b16 v[130:131], v176 offset:23296
  ds_read_b128 v[132:135], v181 offset:57344
  s_add_u32 m0, s45, 49152
  v_mfma_f32_16x16x32_bf16 v[80:83], v[248:251], v[224:227], v[80:83]
  ds_read_b128 v[136:139], v181 offset:58368
  buffer_load_dwordx4 v188, s[36:39], s43 offen offset:0 lds
  v_mfma_f32_16x16x32_bf16 v[100:103], v[248:251], v[228:231], v[100:103]
  ds_read_b64_tr_b16 v[140:141], v176 offset:30720
  ds_read_b64_tr_b16 v[142:143], v176 offset:33280
  buffer_load_dwordx4 v189, s[36:39], s43 offen offset:1024 lds
  v_mfma_f32_16x16x32_bf16 v[64:67], v[196:199], v[252:255], v[64:67]
  ds_read_b64_tr_b16 v[144:145], v177 offset:30720
  ds_read_b64_tr_b16 v[146:147], v177 offset:33280
  v_mfma_f32_16x16x32_bf16 v[84:87], v[196:199], v[192:195], v[84:87]
  ds_read_b64_tr_b16 v[148:149], v176 offset:30784
  buffer_load_dwordx4 v190, s[36:39], s43 offen offset:2048 lds
  v_mfma_f32_16x16x32_bf16 v[68:71], v[200:203], v[252:255], v[68:71]
  ds_read_b64_tr_b16 v[150:151], v176 offset:33344
  ds_read_b64_tr_b16 v[152:153], v177 offset:30784
  s_add_u32 s43, s43, 40960
  v_mfma_f32_16x16x32_bf16 v[88:91], v[200:203], v[192:195], v[88:91]
  ds_read_b64_tr_b16 v[154:155], v177 offset:33344
  v_mfma_f32_16x16x32_bf16 v[72:75], v[204:207], v[252:255], v[72:75]
  ds_read_b64_tr_b16 v[156:157], v176 offset:30976
  ds_read_b64_tr_b16 v[158:159], v176 offset:33536
  v_mfma_f32_16x16x32_bf16 v[92:95], v[204:207], v[192:195], v[92:95]
  v_mfma_f32_16x16x32_bf16 v[76:79], v[208:211], v[252:255], v[76:79]
  v_mfma_f32_16x16x32_bf16 v[96:99], v[208:211], v[192:195], v[96:99]
  v_mfma_f32_16x16x32_bf16 v[80:83], v[212:215], v[252:255], v[80:83]
  v_mfma_f32_16x16x32_bf16 v[100:103], v[212:215], v[192:195], v[100:103]
  s_waitcnt lgkmcnt(0)
  s_waitcnt vmcnt(10)
  s_barrier
  v_mfma_f32_16x16x32_bf16 v[64:67], v[48:51], v[40:43], v[64:67]
  ds_read_b128 v[224:227], v180 offset:0
  ds_read_b128 v[228:231], v180 offset:1024
  v_mfma_f32_16x16x32_bf16 v[84:87], v[48:51], v[44:47], v[84:87]
  ds_read_b64_tr_b16 v[232:233], v178 offset:8192
  s_add_u32 s44, s44, 16384
  v_mfma_f32_16x16x32_bf16 v[68:71], v[52:55], v[40:43], v[68:71]
  ds_read_b64_tr_b16 v[234:235], v178 offset:10752
  ds_read_b64_tr_b16 v[236:237], v179 offset:8192
  s_bfe_u32 s44, s44, 0x2000e
  s_lshl4_add_u32 s44, s5, s44
  v_mfma_f32_16x16x32_bf16 v[88:91], v[52:55], v[44:47], v[88:91]
  ds_read_b64_tr_b16 v[238:239], v179 offset:10752
  s_lshl_b32 s44, s44, 14
  v_mfma_f32_16x16x32_bf16 v[72:75], v[56:59], v[40:43], v[72:75]
  ds_read_b64_tr_b16 v[240:241], v178 offset:8256
  ds_read_b64_tr_b16 v[242:243], v178 offset:10816
  s_add_u32 m0, s49, 90112
  s_nop 0
  buffer_load_dwordx4 v172, s[84:87], s44 offen offset:0 sc1 lds
  v_mfma_f32_16x16x32_bf16 v[92:95], v[56:59], v[44:47], v[92:95]
  ds_read_b64_tr_b16 v[244:245], v179 offset:8256
  ds_read_b64_tr_b16 v[246:247], v179 offset:10816
  buffer_load_dwordx4 v172, s[84:87], s44 offen offset:1024 sc1 lds
  v_mfma_f32_16x16x32_bf16 v[76:79], v[60:63], v[40:43], v[76:79]
  ds_read_b64_tr_b16 v[248:249], v178 offset:8448
  s_add_u32 s44, s44, 65536
  v_mfma_f32_16x16x32_bf16 v[96:99], v[60:63], v[44:47], v[96:99]
  ds_read_b64_tr_b16 v[250:251], v178 offset:11008
  ds_read_b128 v[252:255], v180 offset:8192
  s_add_u32 s97, s97, 1
  s_and_b32 s97, s97, 3
  v_mfma_f32_16x16x32_bf16 v[80:83], v[128:131], v[40:43], v[80:83]
  ds_read_b128 v[192:195], v180 offset:9216
  s_lshl2_add_u32 s43, s5, s97
  v_mfma_f32_16x16x32_bf16 v[100:103], v[128:131], v[44:47], v[100:103]
  ds_read_b64_tr_b16 v[196:197], v178 offset:18432
  ds_read_b64_tr_b16 v[198:199], v178 offset:20992
  s_mul_i32 s43, s43, 327680
  s_add_u32 s43, s43, s47
  v_mfma_f32_16x16x32_bf16 v[64:67], v[140:143], v[132:135], v[64:67]
  ds_read_b64_tr_b16 v[200:201], v179 offset:18432
  ds_read_b64_tr_b16 v[202:203], v179 offset:20992
  s_add_u32 m0, s45, 72704
  v_mfma_f32_16x16x32_bf16 v[84:87], v[140:143], v[136:139], v[84:87]
  ds_read_b64_tr_b16 v[204:205], v178 offset:18496
  buffer_load_dwordx4 v191, s[36:39], s43 offen offset:0 lds
  buffer_load_dwordx4 v160, s[36:39], s43 offen offset:1024 lds
  v_mfma_f32_16x16x32_bf16 v[68:71], v[144:147], v[132:135], v[68:71]
  ds_read_b64_tr_b16 v[206:207], v178 offset:21056
  ds_read_b64_tr_b16 v[208:209], v179 offset:18496
  s_add_u32 s43, s43, 40960
  v_mfma_f32_16x16x32_bf16 v[88:91], v[144:147], v[136:139], v[88:91]
  ds_read_b64_tr_b16 v[210:211], v179 offset:21056
  buffer_store_dwordx4 v[16:19], v184, s[88:91], 0 offen offset:1024 sc1
  v_mfma_f32_16x16x32_bf16 v[72:75], v[148:151], v[132:135], v[72:75]
  ds_read_b64_tr_b16 v[212:213], v178 offset:18688
  ds_read_b64_tr_b16 v[214:215], v178 offset:21248
  v_mfma_f32_16x16x32_bf16 v[92:95], v[148:151], v[136:139], v[92:95]
  v_mfma_f32_16x16x32_bf16 v[76:79], v[152:155], v[132:135], v[76:79]
  v_mfma_f32_16x16x32_bf16 v[96:99], v[152:155], v[136:139], v[96:99]
  v_mfma_f32_16x16x32_bf16 v[80:83], v[156:159], v[132:135], v[80:83]
  v_mfma_f32_16x16x32_bf16 v[100:103], v[156:159], v[136:139], v[100:103]
  s_waitcnt lgkmcnt(0)
  s_waitcnt vmcnt(11)
  s_barrier
  v_mfma_f32_16x16x32_bf16 v[64:67], v[232:235], v[224:227], v[64:67]
  ds_read_b128 v[40:43], v180 offset:16384
  ds_read_b128 v[44:47], v180 offset:17408
  v_mfma_f32_16x16x32_bf16 v[84:87], v[232:235], v[228:231], v[84:87]
  ds_read_b64_tr_b16 v[48:49], v178 offset:28672
  s_add_u32 m0, s49, 0
  v_mfma_f32_16x16x32_bf16 v[68:71], v[236:239], v[224:227], v[68:71]
  ds_read_b64_tr_b16 v[50:51], v178 offset:31232
  ds_read_b64_tr_b16 v[52:53], v179 offset:28672
  v_mfma_f32_16x16x32_bf16 v[88:91], v[236:239], v[228:231], v[88:91]
  ds_read_b64_tr_b16 v[54:55], v179 offset:31232
  buffer_load_dwordx4 v172, s[84:87], s44 offen offset:0 sc1 lds
  v_mfma_f32_16x16x32_bf16 v[72:75], v[240:243], v[224:227], v[72:75]
  ds_read_b64_tr_b16 v[56:57], v178 offset:28736
  ds_read_b64_tr_b16 v[58:59], v178 offset:31296
  buffer_load_dwordx4 v172, s[84:87], s44 offen offset:1024 sc1 lds
  v_mfma_f32_16x16x32_bf16 v[92:95], v[240:243], v[228:231], v[92:95]
  ds_read_b64_tr_b16 v[60:61], v179 offset:28736
  ds_read_b64_tr_b16 v[62:63], v179 offset:31296
  s_add_u32 s44, s44, 65536
  v_mfma_f32_16x16x32_bf16 v[76:79], v[244:247], v[224:227], v[76:79]
  ds_read_b64_tr_b16 v[128:129], v178 offset:28928
  v_mfma_f32_16x16x32_bf16 v[96:99], v[244:247], v[228:231], v[96:99]
  ds_read_b64_tr_b16 v[130:131], v178 offset:31488
  ds_read_b128 v[132:135], v180 offset:24576
  s_add_u32 m0, s45, 122880
  v_mfma_f32_16x16x32_bf16 v[80:83], v[248:251], v[224:227], v[80:83]
  ds_read_b128 v[136:139], v180 offset:25600
  buffer_load_dwordx4 v188, s[36:39], s43 offen offset:0 lds
  v_mfma_f32_16x16x32_bf16 v[100:103], v[248:251], v[228:231], v[100:103]
  ds_read_b64_tr_b16 v[140:141], v178 offset:38912
  ds_read_b64_tr_b16 v[142:143], v178 offset:41472
  buffer_load_dwordx4 v189, s[36:39], s43 offen offset:1024 lds
  v_mfma_f32_16x16x32_bf16 v[64:67], v[196:199], v[252:255], v[64:67]
  ds_read_b64_tr_b16 v[144:145], v179 offset:38912
  ds_read_b64_tr_b16 v[146:147], v179 offset:41472
  v_mfma_f32_16x16x32_bf16 v[84:87], v[196:199], v[192:195], v[84:87]
  ds_read_b64_tr_b16 v[148:149], v178 offset:38976
  buffer_load_dwordx4 v190, s[36:39], s43 offen offset:2048 lds
  v_mfma_f32_16x16x32_bf16 v[68:71], v[200:203], v[252:255], v[68:71]
  ds_read_b64_tr_b16 v[150:151], v178 offset:41536
  ds_read_b64_tr_b16 v[152:153], v179 offset:38976
  s_add_u32 s43, s43, 40960
  v_mfma_f32_16x16x32_bf16 v[88:91], v[200:203], v[192:195], v[88:91]
  ds_read_b64_tr_b16 v[154:155], v179 offset:41536
  v_mfma_f32_16x16x32_bf16 v[72:75], v[204:207], v[252:255], v[72:75]
  ds_read_b64_tr_b16 v[156:157], v178 offset:39168
  ds_read_b64_tr_b16 v[158:159], v178 offset:41728
  v_mfma_f32_16x16x32_bf16 v[92:95], v[204:207], v[192:195], v[92:95]
  v_mfma_f32_16x16x32_bf16 v[76:79], v[208:211], v[252:255], v[76:79]
  v_mfma_f32_16x16x32_bf16 v[96:99], v[208:211], v[192:195], v[96:99]
  v_mfma_f32_16x16x32_bf16 v[80:83], v[212:215], v[252:255], v[80:83]
  v_mfma_f32_16x16x32_bf16 v[100:103], v[212:215], v[192:195], v[100:103]
  s_waitcnt lgkmcnt(0)
  s_waitcnt vmcnt(10)
  s_barrier
  v_mfma_f32_16x16x32_bf16 v[64:67], v[48:51], v[40:43], v[64:67]
  ds_read_b128 v[224:227], v180 offset:32768
  ds_read_b128 v[228:231], v180 offset:33792
  v_mfma_f32_16x16x32_bf16 v[84:87], v[48:51], v[44:47], v[84:87]
  ds_read_b64_tr_b16 v[232:233], v176 offset:0
  s_add_u32 m0, s49, 16384
  v_mfma_f32_16x16x32_bf16 v[68:71], v[52:55], v[40:43], v[68:71]
  ds_read_b64_tr_b16 v[234:235], v176 offset:2560
  ds_read_b64_tr_b16 v[236:237], v177 offset:0
  v_mfma_f32_16x16x32_bf16 v[88:91], v[52:55], v[44:47], v[88:91]
  ds_read_b64_tr_b16 v[238:239], v177 offset:2560
  buffer_load_dwordx4 v172, s[84:87], s44 offen offset:0 sc1 lds
  v_mfma_f32_16x16x32_bf16 v[72:75], v[56:59], v[40:43], v[72:75]
  ds_read_b64_tr_b16 v[240:241], v176 offset:64
  ds_read_b64_tr_b16 v[242:243], v176 offset:2624
  buffer_load_dwordx4 v172, s[84:87], s44 offen offset:1024 sc1 lds
  v_mfma_f32_16x16x32_bf16 v[92:95], v[56:59], v[44:47], v[92:95]
  ds_read_b64_tr_b16 v[244:245], v177 offset:64
  ds_read_b64_tr_b16 v[246:247], v177 offset:2624
  v_mfma_f32_16x16x32_bf16 v[76:79], v[60:63], v[40:43], v[76:79]
  ds_read_b64_tr_b16 v[248:249], v176 offset:256
  s_add_u32 s44, s44, 65536
  v_mfma_f32_16x16x32_bf16 v[96:99], v[60:63], v[44:47], v[96:99]
  ds_read_b64_tr_b16 v[250:251], v176 offset:2816
  ds_read_b128 v[252:255], v180 offset:40960
  s_add_u32 m0, s45, 146432
  v_mfma_f32_16x16x32_bf16 v[80:83], v[128:131], v[40:43], v[80:83]
  ds_read_b128 v[192:195], v180 offset:41984
  v_mfma_f32_16x16x32_bf16 v[100:103], v[128:131], v[44:47], v[100:103]
  ds_read_b64_tr_b16 v[196:197], v176 offset:10240
  ds_read_b64_tr_b16 v[198:199], v176 offset:12800
  buffer_load_dwordx4 v191, s[36:39], s43 offen offset:0 lds
  v_mfma_f32_16x16x32_bf16 v[64:67], v[140:143], v[132:135], v[64:67]
  ds_read_b64_tr_b16 v[200:201], v177 offset:10240
  ds_read_b64_tr_b16 v[202:203], v177 offset:12800
  buffer_load_dwordx4 v160, s[36:39], s43 offen offset:1024 lds
  v_mfma_f32_16x16x32_bf16 v[84:87], v[140:143], v[136:139], v[84:87]
  ds_read_b64_tr_b16 v[204:205], v176 offset:10304
  v_mfma_f32_16x16x32_bf16 v[68:71], v[144:147], v[132:135], v[68:71]
  ds_read_b64_tr_b16 v[206:207], v176 offset:12864
  ds_read_b64_tr_b16 v[208:209], v177 offset:10304
  s_add_u32 s43, s43, 40960
  v_mfma_f32_16x16x32_bf16 v[88:91], v[144:147], v[136:139], v[88:91]
  ds_read_b64_tr_b16 v[210:211], v177 offset:12864
  s_mov_b64 exec, s[56:57]
  buffer_load_dwordx4 v[0:3], v161, s[88:91], 0 offen offset:0 sc1
  s_mov_b64 exec, -1
  v_mfma_f32_16x16x32_bf16 v[72:75], v[148:151], v[132:135], v[72:75]
  ds_read_b64_tr_b16 v[212:213], v176 offset:10496
  ds_read_b64_tr_b16 v[214:215], v176 offset:13056
  v_mfma_f32_16x16x32_bf16 v[92:95], v[148:151], v[136:139], v[92:95]
  v_mfma_f32_16x16x32_bf16 v[76:79], v[152:155], v[132:135], v[76:79]
  v_mfma_f32_16x16x32_bf16 v[96:99], v[152:155], v[136:139], v[96:99]
  v_mfma_f32_16x16x32_bf16 v[80:83], v[156:159], v[132:135], v[80:83]
  v_mfma_f32_16x16x32_bf16 v[100:103], v[156:159], v[136:139], v[100:103]
  s_waitcnt lgkmcnt(0)
  s_waitcnt vmcnt(11)
  s_barrier
  v_mfma_f32_16x16x32_bf16 v[64:67], v[232:235], v[224:227], v[64:67]
  ds_read_b128 v[40:43], v181 offset:32768
  ds_read_b128 v[44:47], v181 offset:33792
  v_mfma_f32_16x16x32_bf16 v[84:87], v[232:235], v[228:231], v[84:87]
  ds_read_b64_tr_b16 v[48:49], v176 offset:20480
  s_add_u32 m0, s49, 32768
  v_mfma_f32_16x16x32_bf16 v[68:71], v[236:239], v[224:227], v[68:71]
  ds_read_b64_tr_b16 v[50:51], v176 offset:23040
  ds_read_b64_tr_b16 v[52:53], v177 offset:20480
  v_mfma_f32_16x16x32_bf16 v[88:91], v[236:239], v[228:231], v[88:91]
  ds_read_b64_tr_b16 v[54:55], v177 offset:23040
  buffer_load_dwordx4 v172, s[84:87], s44 offen offset:0 sc1 lds
  v_mfma_f32_16x16x32_bf16 v[72:75], v[240:243], v[224:227], v[72:75]
  ds_read_b64_tr_b16 v[56:57], v176 offset:20544
  ds_read_b64_tr_b16 v[58:59], v176 offset:23104
  buffer_load_dwordx4 v172, s[84:87], s44 offen offset:1024 sc1 lds
  v_mfma_f32_16x16x32_bf16 v[92:95], v[240:243], v[228:231], v[92:95]
  ds_read_b64_tr_b16 v[60:61], v177 offset:20544
  ds_read_b64_tr_b16 v[62:63], v177 offset:23104
  s_add_u32 s44, s44, 65536
  v_mfma_f32_16x16x32_bf16 v[76:79], v[244:247], v[224:227], v[76:79]
  ds_read_b64_tr_b16 v[128:129], v176 offset:20736
  v_mfma_f32_16x16x32_bf16 v[96:99], v[244:247], v[228:231], v[96:99]
  ds_read_b64_tr_b16 v[130:131], v176 offset:23296
  ds_read_b128 v[132:135], v181 offset:57344
  s_add_u32 m0, s45, 49152
  v_mfma_f32_16x16x32_bf16 v[80:83], v[248:251], v[224:227], v[80:83]
  ds_read_b128 v[136:139], v181 offset:58368
  buffer_load_dwordx4 v188, s[36:39], s43 offen offset:0 lds
  v_mfma_f32_16x16x32_bf16 v[100:103], v[248:251], v[228:231], v[100:103]
  ds_read_b64_tr_b16 v[140:141], v176 offset:30720
  ds_read_b64_tr_b16 v[142:143], v176 offset:33280
  buffer_load_dwordx4 v189, s[36:39], s43 offen offset:1024 lds
  v_mfma_f32_16x16x32_bf16 v[64:67], v[196:199], v[252:255], v[64:67]
  ds_read_b64_tr_b16 v[144:145], v177 offset:30720
  ds_read_b64_tr_b16 v[146:147], v177 offset:33280
  v_mfma_f32_16x16x32_bf16 v[84:87], v[196:199], v[192:195], v[84:87]
  ds_read_b64_tr_b16 v[148:149], v176 offset:30784
  buffer_load_dwordx4 v190, s[36:39], s43 offen offset:2048 lds
  v_mfma_f32_16x16x32_bf16 v[68:71], v[200:203], v[252:255], v[68:71]
  ds_read_b64_tr_b16 v[150:151], v176 offset:33344
  ds_read_b64_tr_b16 v[152:153], v177 offset:30784
  s_add_u32 s43, s43, 40960
  v_mfma_f32_16x16x32_bf16 v[88:91], v[200:203], v[192:195], v[88:91]
  ds_read_b64_tr_b16 v[154:155], v177 offset:33344
  s_mov_b64 exec, s[56:57]
  buffer_load_dwordx4 v[4:7], v161, s[88:91], 0 offen offset:256 sc1
  s_mov_b64 exec, -1
  buffer_load_dwordx4 v[104:107], v182, s[76:79], 0 offen offset:0
  buffer_load_dword v108, v183, s[76:79], 0 offen offset:256
  v_mfma_f32_16x16x32_bf16 v[72:75], v[204:207], v[252:255], v[72:75]
  ds_read_b64_tr_b16 v[156:157], v176 offset:30976
  ds_read_b64_tr_b16 v[158:159], v176 offset:33536
  v_mfma_f32_16x16x32_bf16 v[92:95], v[204:207], v[192:195], v[92:95]
  v_mfma_f32_16x16x32_bf16 v[76:79], v[208:211], v[252:255], v[76:79]
  v_mfma_f32_16x16x32_bf16 v[96:99], v[208:211], v[192:195], v[96:99]
  v_mfma_f32_16x16x32_bf16 v[80:83], v[212:215], v[252:255], v[80:83]
  v_mfma_f32_16x16x32_bf16 v[100:103], v[212:215], v[192:195], v[100:103]
  s_waitcnt lgkmcnt(0)
  s_waitcnt vmcnt(13)
  s_barrier
  v_mfma_f32_16x16x32_bf16 v[64:67], v[48:51], v[40:43], v[64:67]
  ds_read_b128 v[224:227], v180 offset:0
  ds_read_b128 v[228:231], v180 offset:1024
  v_mfma_f32_16x16x32_bf16 v[84:87], v[48:51], v[44:47], v[84:87]
  ds_read_b64_tr_b16 v[232:233], v178 offset:8192
  v_mfma_f32_16x16x32_bf16 v[68:71], v[52:55], v[40:43], v[68:71]
  ds_read_b64_tr_b16 v[234:235], v178 offset:10752
  ds_read_b64_tr_b16 v[236:237], v179 offset:8192
  v_mfma_f32_16x16x32_bf16 v[88:91], v[52:55], v[44:47], v[88:91]
  ds_read_b64_tr_b16 v[238:239], v179 offset:10752
  v_mfma_f32_16x16x32_bf16 v[72:75], v[56:59], v[40:43], v[72:75]
  ds_read_b64_tr_b16 v[240:241], v178 offset:8256
  ds_read_b64_tr_b16 v[242:243], v178 offset:10816
  v_mfma_f32_16x16x32_bf16 v[92:95], v[56:59], v[44:47], v[92:95]
  ds_read_b64_tr_b16 v[244:245], v179 offset:8256
  ds_read_b64_tr_b16 v[246:247], v179 offset:10816
  v_mfma_f32_16x16x32_bf16 v[76:79], v[60:63], v[40:43], v[76:79]
  ds_read_b64_tr_b16 v[248:249], v178 offset:8448
  v_mfma_f32_16x16x32_bf16 v[96:99], v[60:63], v[44:47], v[96:99]
  ds_read_b64_tr_b16 v[250:251], v178 offset:11008
  ds_read_b128 v[252:255], v180 offset:8192
  v_mfma_f32_16x16x32_bf16 v[80:83], v[128:131], v[40:43], v[80:83]
  ds_read_b128 v[192:195], v180 offset:9216
  v_mfma_f32_16x16x32_bf16 v[100:103], v[128:131], v[44:47], v[100:103]
  ds_read_b64_tr_b16 v[196:197], v178 offset:18432
  ds_read_b64_tr_b16 v[198:199], v178 offset:20992
  v_mfma_f32_16x16x32_bf16 v[64:67], v[140:143], v[132:135], v[64:67]
  ds_read_b64_tr_b16 v[200:201], v179 offset:18432
  ds_read_b64_tr_b16 v[202:203], v179 offset:20992
  v_mfma_f32_16x16x32_bf16 v[84:87], v[140:143], v[136:139], v[84:87]
  ds_read_b64_tr_b16 v[204:205], v178 offset:18496
  v_mfma_f32_16x16x32_bf16 v[68:71], v[144:147], v[132:135], v[68:71]
  ds_read_b64_tr_b16 v[206:207], v178 offset:21056
  ds_read_b64_tr_b16 v[208:209], v179 offset:18496
  v_mfma_f32_16x16x32_bf16 v[88:91], v[144:147], v[136:139], v[88:91]
  ds_read_b64_tr_b16 v[210:211], v179 offset:21056
  s_mov_b64 exec, s[56:57]
  buffer_load_dwordx4 v[8:11], v161, s[88:91], 0 offen offset:512 sc1
  s_mov_b64 exec, -1
  v_mfma_f32_16x16x32_bf16 v[72:75], v[148:151], v[132:135], v[72:75]
  ds_read_b64_tr_b16 v[212:213], v178 offset:18688
  ds_read_b64_tr_b16 v[214:215], v178 offset:21248
  v_mfma_f32_16x16x32_bf16 v[92:95], v[148:151], v[136:139], v[92:95]
  v_mfma_f32_16x16x32_bf16 v[76:79], v[152:155], v[132:135], v[76:79]
  v_mfma_f32_16x16x32_bf16 v[96:99], v[152:155], v[136:139], v[96:99]
  v_mfma_f32_16x16x32_bf16 v[80:83], v[156:159], v[132:135], v[80:83]
  v_mfma_f32_16x16x32_bf16 v[100:103], v[156:159], v[136:139], v[100:103]
  s_waitcnt lgkmcnt(0)
  s_waitcnt vmcnt(10)
  s_barrier
  v_mfma_f32_16x16x32_bf16 v[64:67], v[232:235], v[224:227], v[64:67]
  ds_read_b128 v[40:43], v180 offset:16384
  ds_read_b128 v[44:47], v180 offset:17408
  v_mfma_f32_16x16x32_bf16 v[84:87], v[232:235], v[228:231], v[84:87]
  ds_read_b64_tr_b16 v[48:49], v178 offset:28672
  v_mfma_f32_16x16x32_bf16 v[68:71], v[236:239], v[224:227], v[68:71]
  ds_read_b64_tr_b16 v[50:51], v178 offset:31232
  ds_read_b64_tr_b16 v[52:53], v179 offset:28672
  v_mfma_f32_16x16x32_bf16 v[88:91], v[236:239], v[228:231], v[88:91]
  ds_read_b64_tr_b16 v[54:55], v179 offset:31232
  v_mfma_f32_16x16x32_bf16 v[72:75], v[240:243], v[224:227], v[72:75]
  ds_read_b64_tr_b16 v[56:57], v178 offset:28736
  ds_read_b64_tr_b16 v[58:59], v178 offset:31296
  v_mfma_f32_16x16x32_bf16 v[92:95], v[240:243], v[228:231], v[92:95]
  ds_read_b64_tr_b16 v[60:61], v179 offset:28736
  ds_read_b64_tr_b16 v[62:63], v179 offset:31296
  v_mfma_f32_16x16x32_bf16 v[76:79], v[244:247], v[224:227], v[76:79]
  ds_read_b64_tr_b16 v[128:129], v178 offset:28928
  v_mfma_f32_16x16x32_bf16 v[96:99], v[244:247], v[228:231], v[96:99]
  ds_read_b64_tr_b16 v[130:131], v178 offset:31488
  ds_read_b128 v[132:135], v180 offset:24576
  v_mfma_f32_16x16x32_bf16 v[80:83], v[248:251], v[224:227], v[80:83]
  ds_read_b128 v[136:139], v180 offset:25600
  v_mfma_f32_16x16x32_bf16 v[100:103], v[248:251], v[228:231], v[100:103]
  ds_read_b64_tr_b16 v[140:141], v178 offset:38912
  ds_read_b64_tr_b16 v[142:143], v178 offset:41472
  v_mfma_f32_16x16x32_bf16 v[64:67], v[196:199], v[252:255], v[64:67]
  ds_read_b64_tr_b16 v[144:145], v179 offset:38912
  ds_read_b64_tr_b16 v[146:147], v179 offset:41472
  v_mfma_f32_16x16x32_bf16 v[84:87], v[196:199], v[192:195], v[84:87]
  ds_read_b64_tr_b16 v[148:149], v178 offset:38976
  v_mfma_f32_16x16x32_bf16 v[68:71], v[200:203], v[252:255], v[68:71]
  ds_read_b64_tr_b16 v[150:151], v178 offset:41536
  ds_read_b64_tr_b16 v[152:153], v179 offset:38976
  v_mfma_f32_16x16x32_bf16 v[88:91], v[200:203], v[192:195], v[88:91]
  ds_read_b64_tr_b16 v[154:155], v179 offset:41536
  s_mov_b64 exec, s[56:57]
  buffer_load_dwordx4 v[12:15], v161, s[88:91], 0 offen offset:768 sc1
  s_mov_b64 exec, -1
  v_mfma_f32_16x16x32_bf16 v[72:75], v[204:207], v[252:255], v[72:75]
  ds_read_b64_tr_b16 v[156:157], v178 offset:39168
  ds_read_b64_tr_b16 v[158:159], v178 offset:41728
  v_mfma_f32_16x16x32_bf16 v[92:95], v[204:207], v[192:195], v[92:95]
  v_mfma_f32_16x16x32_bf16 v[76:79], v[208:211], v[252:255], v[76:79]
  v_mfma_f32_16x16x32_bf16 v[96:99], v[208:211], v[192:195], v[96:99]
  v_mfma_f32_16x16x32_bf16 v[80:83], v[212:215], v[252:255], v[80:83]
  v_mfma_f32_16x16x32_bf16 v[100:103], v[212:215], v[192:195], v[100:103]
  s_waitcnt lgkmcnt(0)
  s_waitcnt vmcnt(5)
  s_barrier
  v_mfma_f32_16x16x32_bf16 v[64:67], v[48:51], v[40:43], v[64:67]
  ds_read_b128 v[224:227], v180 offset:32768
  ds_read_b128 v[228:231], v180 offset:33792
  v_mfma_f32_16x16x32_bf16 v[84:87], v[48:51], v[44:47], v[84:87]
  ds_read_b64_tr_b16 v[232:233], v176 offset:0
  v_mfma_f32_16x16x32_bf16 v[68:71], v[52:55], v[40:43], v[68:71]
  ds_read_b64_tr_b16 v[234:235], v176 offset:2560
  ds_read_b64_tr_b16 v[236:237], v177 offset:0
  v_mfma_f32_16x16x32_bf16 v[88:91], v[52:55], v[44:47], v[88:91]
  ds_read_b64_tr_b16 v[238:239], v177 offset:2560
  v_mfma_f32_16x16x32_bf16 v[72:75], v[56:59], v[40:43], v[72:75]
  ds_read_b64_tr_b16 v[240:241], v176 offset:64
  ds_read_b64_tr_b16 v[242:243], v176 offset:2624
  v_mfma_f32_16x16x32_bf16 v[92:95], v[56:59], v[44:47], v[92:95]
  ds_read_b64_tr_b16 v[244:245], v177 offset:64
  ds_read_b64_tr_b16 v[246:247], v177 offset:2624
  v_mfma_f32_16x16x32_bf16 v[76:79], v[60:63], v[40:43], v[76:79]
  ds_read_b64_tr_b16 v[248:249], v176 offset:256
  v_mfma_f32_16x16x32_bf16 v[96:99], v[60:63], v[44:47], v[96:99]
  ds_read_b64_tr_b16 v[250:251], v176 offset:2816
  ds_read_b128 v[252:255], v180 offset:40960
  v_mfma_f32_16x16x32_bf16 v[80:83], v[128:131], v[40:43], v[80:83]
  ds_read_b128 v[192:195], v180 offset:41984
  v_mfma_f32_16x16x32_bf16 v[100:103], v[128:131], v[44:47], v[100:103]
  ds_read_b64_tr_b16 v[196:197], v176 offset:10240
  ds_read_b64_tr_b16 v[198:199], v176 offset:12800
  v_mfma_f32_16x16x32_bf16 v[64:67], v[140:143], v[132:135], v[64:67]
  ds_read_b64_tr_b16 v[200:201], v177 offset:10240
  ds_read_b64_tr_b16 v[202:203], v177 offset:12800
  v_mfma_f32_16x16x32_bf16 v[84:87], v[140:143], v[136:139], v[84:87]
  ds_read_b64_tr_b16 v[204:205], v176 offset:10304
  v_mfma_f32_16x16x32_bf16 v[68:71], v[144:147], v[132:135], v[68:71]
  ds_read_b64_tr_b16 v[206:207], v176 offset:12864
  ds_read_b64_tr_b16 v[208:209], v177 offset:10304
  v_mfma_f32_16x16x32_bf16 v[88:91], v[144:147], v[136:139], v[88:91]
  ds_read_b64_tr_b16 v[210:211], v177 offset:12864
  s_mov_b64 exec, s[56:57]
  buffer_load_dwordx4 v[16:19], v161, s[88:91], 0 offen offset:1024 sc1
  s_mov_b64 exec, -1
  v_mfma_f32_16x16x32_bf16 v[72:75], v[148:151], v[132:135], v[72:75]
  ds_read_b64_tr_b16 v[212:213], v176 offset:10496
  ds_read_b64_tr_b16 v[214:215], v176 offset:13056
  v_mfma_f32_16x16x32_bf16 v[92:95], v[148:151], v[136:139], v[92:95]
  v_mfma_f32_16x16x32_bf16 v[76:79], v[152:155], v[132:135], v[76:79]
  v_mfma_f32_16x16x32_bf16 v[96:99], v[152:155], v[136:139], v[96:99]
  v_mfma_f32_16x16x32_bf16 v[80:83], v[156:159], v[132:135], v[80:83]
  v_mfma_f32_16x16x32_bf16 v[100:103], v[156:159], v[136:139], v[100:103]
  s_waitcnt lgkmcnt(15)
  v_mfma_f32_16x16x32_bf16 v[64:67], v[232:235], v[224:227], v[64:67]
  v_mfma_f32_16x16x32_bf16 v[84:87], v[232:235], v[228:231], v[84:87]
  v_mfma_f32_16x16x32_bf16 v[68:71], v[236:239], v[224:227], v[68:71]
  v_mfma_f32_16x16x32_bf16 v[88:91], v[236:239], v[228:231], v[88:91]
  v_mfma_f32_16x16x32_bf16 v[72:75], v[240:243], v[224:227], v[72:75]
  v_mfma_f32_16x16x32_bf16 v[92:95], v[240:243], v[228:231], v[92:95]
  s_waitcnt lgkmcnt(14)
  v_mfma_f32_16x16x32_bf16 v[76:79], v[244:247], v[224:227], v[76:79]
  v_mfma_f32_16x16x32_bf16 v[96:99], v[244:247], v[228:231], v[96:99]
  s_waitcnt lgkmcnt(12)
  v_mfma_f32_16x16x32_bf16 v[80:83], v[248:251], v[224:227], v[80:83]
  v_mfma_f32_16x16x32_bf16 v[100:103], v[248:251], v[228:231], v[100:103]
  s_waitcnt lgkmcnt(8)
  v_mfma_f32_16x16x32_bf16 v[64:67], v[196:199], v[252:255], v[64:67]
  s_waitcnt vmcnt(4)
  v_mov_b32 v170, v104
  s_mov_b32 exec_lo, s46
  s_mov_b32 exec_hi, s46
  v_swap_b32 v104, v106
  v_swap_b32 v105, v107
  s_mov_b64 exec, -1
  v_mfma_f32_16x16x32_bf16 v[84:87], v[196:199], v[192:195], v[84:87]
  s_waitcnt lgkmcnt(6)
  v_mfma_f32_16x16x32_bf16 v[68:71], v[200:203], v[252:255], v[68:71]
  v_mfma_f32_16x16x32_bf16 v[88:91], v[200:203], v[192:195], v[88:91]
  s_waitcnt lgkmcnt(4)
  v_mfma_f32_16x16x32_bf16 v[72:75], v[204:207], v[252:255], v[72:75]
  v_mfma_f32_16x16x32_bf16 v[92:95], v[204:207], v[192:195], v[92:95]
  s_waitcnt lgkmcnt(2)
  v_mfma_f32_16x16x32_bf16 v[76:79], v[208:211], v[252:255], v[76:79]
  v_mfma_f32_16x16x32_bf16 v[96:99], v[208:211], v[192:195], v[96:99]
  s_waitcnt lgkmcnt(0)
  v_mfma_f32_16x16x32_bf16 v[80:83], v[212:215], v[252:255], v[80:83]
  v_mfma_f32_16x16x32_bf16 v[100:103], v[212:215], v[192:195], v[100:103]
  v_cvt_pk_bf16_f32 v64, v64, v65
  v_cvt_pk_bf16_f32 v65, v66, v67
  v_cvt_pk_bf16_f32 v66, v68, v69
  v_cvt_pk_bf16_f32 v67, v70, v71
  buffer_store_dwordx4 v[64:67], v184, s[88:91], s3 offen offset:0 sc1
  v_cvt_pk_bf16_f32 v68, v72, v73
  v_cvt_pk_bf16_f32 v69, v74, v75
  v_cvt_pk_bf16_f32 v70, v76, v77
  v_cvt_pk_bf16_f32 v71, v78, v79
  buffer_store_dwordx4 v[68:71], v184, s[88:91], s3 offen offset:256 sc1
  v_cvt_pk_bf16_f32 v72, v80, v81
  v_cvt_pk_bf16_f32 v73, v82, v83
  v_cvt_pk_bf16_f32 v74, v84, v85
  v_cvt_pk_bf16_f32 v75, v86, v87
  buffer_store_dwordx4 v[72:75], v184, s[88:91], s3 offen offset:512 sc1
  v_cvt_pk_bf16_f32 v76, v88, v89
  v_cvt_pk_bf16_f32 v77, v90, v91
  v_cvt_pk_bf16_f32 v78, v92, v93
  v_cvt_pk_bf16_f32 v79, v94, v95
  buffer_store_dwordx4 v[76:79], v184, s[88:91], s3 offen offset:768 sc1
  v_cvt_pk_bf16_f32 v80, v96, v97
  v_cvt_pk_bf16_f32 v81, v98, v99
  v_cvt_pk_bf16_f32 v82, v100, v101
  v_cvt_pk_bf16_f32 v83, v102, v103
  buffer_store_dwordx4 v[80:83], v184, s[88:91], s3 offen offset:1024 sc1
  s_mov_b64 exec, s[56:57]
  buffer_load_dwordx4 v[64:67], v161, s[88:91], s3 offen offset:0 sc1
  buffer_load_dwordx4 v[68:71], v161, s[88:91], s3 offen offset:256 sc1
  buffer_load_dwordx4 v[72:75], v161, s[88:91], s3 offen offset:512 sc1
  buffer_load_dwordx4 v[76:79], v161, s[88:91], s3 offen offset:768 sc1
  buffer_load_dwordx4 v[80:83], v161, s[88:91], s3 offen offset:1024 sc1
  s_mov_b64 exec, -1
  v_max3_u32 v165, v0, v1, v2
  v_max3_u32 v165, v165, v3, v4
  v_max3_u32 v165, v165, v5, v6
  s_waitcnt vmcnt(12)
  v_max3_u32 v165, v165, v7, v8
  v_max3_u32 v165, v165, v9, v10
  s_waitcnt vmcnt(11)
  v_max3_u32 v165, v165, v11, v12
  v_max3_u32 v165, v165, v13, v14
  s_waitcnt vmcnt(10)
  v_max3_u32 v165, v165, v15, v16
  v_max3_u32 v165, v165, v17, v18
  v_max_u32 v165, v165, v19
  v_cmp_eq_u32 vcc, -1, v165
  s_nop 4
  s_cbranch_vccnz L_p3_spin_0_0
L_p3_ok_0_0:
  v_and_b32 v39, s46, v19
  v_lshlrev_b32 v38, 16, v19
  v_and_b32 v37, s46, v18
  v_lshlrev_b32 v36, 16, v18
  v_and_b32 v35, s46, v17
  v_lshlrev_b32 v34, 16, v17
  v_and_b32 v33, s46, v16
  v_lshlrev_b32 v32, 16, v16
  v_and_b32 v31, s46, v15
  v_lshlrev_b32 v30, 16, v15
  v_and_b32 v29, s46, v14
  v_lshlrev_b32 v28, 16, v14
  v_and_b32 v27, s46, v13
  v_lshlrev_b32 v26, 16, v13
  v_and_b32 v25, s46, v12
  v_lshlrev_b32 v24, 16, v12
  v_and_b32 v23, s46, v11
  v_lshlrev_b32 v22, 16, v11
  v_and_b32 v21, s46, v10
  v_lshlrev_b32 v20, 16, v10
  v_and_b32 v19, s46, v9
  v_lshlrev_b32 v18, 16, v9
  v_and_b32 v17, s46, v8
  v_lshlrev_b32 v16, 16, v8
  v_and_b32 v15, s46, v7
  v_lshlrev_b32 v14, 16, v7
  v_and_b32 v13, s46, v6
  v_lshlrev_b32 v12, 16, v6
  v_and_b32 v11, s46, v5
  v_lshlrev_b32 v10, 16, v5
  v_and_b32 v9, s46, v4
  v_lshlrev_b32 v8, 16, v4
  v_and_b32 v7, s46, v3
  v_lshlrev_b32 v6, 16, v3
  v_and_b32 v5, s46, v2
  v_lshlrev_b32 v4, 16, v2
  v_and_b32 v3, s46, v1
  v_lshlrev_b32 v2, 16, v1
  v_and_b32 v1, s46, v0
  v_lshlrev_b32 v0, 16, v0
  v_add_f32_dpp v19, v19, v19 row_ror:8 row_mask:0xf bank_mask:0x3
  v_add_f32_dpp v18, v18, v18 row_ror:8 row_mask:0xf bank_mask:0x3
  v_add_f32_dpp v17, v17, v17 row_ror:8 row_mask:0xf bank_mask:0x3
  v_add_f32_dpp v16, v16, v16 row_ror:8 row_mask:0xf bank_mask:0x3
  v_add_f32_dpp v15, v15, v15 row_ror:8 row_mask:0xf bank_mask:0x3
  v_add_f32_dpp v14, v14, v14 row_ror:8 row_mask:0xf bank_mask:0x3
  v_add_f32_dpp v13, v13, v13 row_ror:8 row_mask:0xf bank_mask:0x3
  v_add_f32_dpp v12, v12, v12 row_ror:8 row_mask:0xf bank_mask:0x3
  v_add_f32_dpp v11, v11, v11 row_ror:8 row_mask:0xf bank_mask:0x3
  v_add_f32_dpp v10, v10, v10 row_ror:8 row_mask:0xf bank_mask:0x3
  v_add_f32_dpp v9, v9, v9 row_ror:8 row_mask:0xf bank_mask:0x3
  v_add_f32_dpp v8, v8, v8 row_ror:8 row_mask:0xf bank_mask:0x3
  v_add_f32_dpp v7, v7, v7 row_ror:8 row_mask:0xf bank_mask:0x3
  v_add_f32_dpp v6, v6, v6 row_ror:8 row_mask:0xf bank_mask:0x3
  v_add_f32_dpp v5, v5, v5 row_ror:8 row_mask:0xf bank_mask:0x3
  v_add_f32_dpp v4, v4, v4 row_ror:8 row_mask:0xf bank_mask:0x3
  v_add_f32_dpp v3, v3, v3 row_ror:8 row_mask:0xf bank_mask:0x3
  v_add_f32_dpp v2, v2, v2 row_ror:8 row_mask:0xf bank_mask:0x3
  v_add_f32_dpp v1, v1, v1 row_ror:8 row_mask:0xf bank_mask:0x3
  v_add_f32_dpp v0, v0, v0 row_ror:8 row_mask:0xf bank_mask:0x3
  v_add_f32_dpp v19, v39, v39 row_ror:8 row_mask:0xf bank_mask:0xc
  v_add_f32_dpp v18, v38, v38 row_ror:8 row_mask:0xf bank_mask:0xc
  v_add_f32_dpp v17, v37, v37 row_ror:8 row_mask:0xf bank_mask:0xc
  v_add_f32_dpp v16, v36, v36 row_ror:8 row_mask:0xf bank_mask:0xc
  v_add_f32_dpp v15, v35, v35 row_ror:8 row_mask:0xf bank_mask:0xc
  v_add_f32_dpp v14, v34, v34 row_ror:8 row_mask:0xf bank_mask:0xc
  v_add_f32_dpp v13, v33, v33 row_ror:8 row_mask:0xf bank_mask:0xc
  v_add_f32_dpp v12, v32, v32 row_ror:8 row_mask:0xf bank_mask:0xc
  v_add_f32_dpp v11, v31, v31 row_ror:8 row_mask:0xf bank_mask:0xc
  v_add_f32_dpp v10, v30, v30 row_ror:8 row_mask:0xf bank_mask:0xc
  v_add_f32_dpp v9, v29, v29 row_ror:8 row_mask:0xf bank_mask:0xc
  v_add_f32_dpp v8, v28, v28 row_ror:8 row_mask:0xf bank_mask:0xc
  v_add_f32_dpp v7, v27, v27 row_ror:8 row_mask:0xf bank_mask:0xc
  v_add_f32_dpp v6, v26, v26 row_ror:8 row_mask:0xf bank_mask:0xc
  v_add_f32_dpp v5, v25, v25 row_ror:8 row_mask:0xf bank_mask:0xc
  v_add_f32_dpp v4, v24, v24 row_ror:8 row_mask:0xf bank_mask:0xc
  v_add_f32_dpp v3, v23, v23 row_ror:8 row_mask:0xf bank_mask:0xc
  v_add_f32_dpp v2, v22, v22 row_ror:8 row_mask:0xf bank_mask:0xc
  v_add_f32_dpp v1, v21, v21 row_ror:8 row_mask:0xf bank_mask:0xc
  v_add_f32_dpp v0, v20, v20 row_ror:8 row_mask:0xf bank_mask:0xc
  v_add_f32_dpp v17, v17, v17 row_shl:4 row_mask:0xf bank_mask:0x5
  v_add_f32_dpp v16, v16, v16 row_shl:4 row_mask:0xf bank_mask:0x5
  v_add_f32_dpp v7, v7, v7 row_shl:4 row_mask:0xf bank_mask:0x5
  v_add_f32_dpp v6, v6, v6 row_shl:4 row_mask:0xf bank_mask:0x5
  v_add_f32_dpp v5, v5, v5 row_shl:4 row_mask:0xf bank_mask:0x5
  v_add_f32_dpp v4, v4, v4 row_shl:4 row_mask:0xf bank_mask:0x5
  v_add_f32_dpp v3, v3, v3 row_shl:4 row_mask:0xf bank_mask:0x5
  v_add_f32_dpp v2, v2, v2 row_shl:4 row_mask:0xf bank_mask:0x5
  v_add_f32_dpp v1, v1, v1 row_shl:4 row_mask:0xf bank_mask:0x5
  v_add_f32_dpp v0, v0, v0 row_shl:4 row_mask:0xf bank_mask:0x5
  v_add_f32_dpp v17, v19, v19 row_shr:4 row_mask:0xf bank_mask:0xa
  v_add_f32_dpp v16, v18, v18 row_shr:4 row_mask:0xf bank_mask:0xa
  v_add_f32_dpp v7, v15, v15 row_shr:4 row_mask:0xf bank_mask:0xa
  v_add_f32_dpp v6, v14, v14 row_shr:4 row_mask:0xf bank_mask:0xa
  v_add_f32_dpp v5, v13, v13 row_shr:4 row_mask:0xf bank_mask:0xa
  v_add_f32_dpp v4, v12, v12 row_shr:4 row_mask:0xf bank_mask:0xa
  v_add_f32_dpp v3, v11, v11 row_shr:4 row_mask:0xf bank_mask:0xa
  v_add_f32_dpp v2, v10, v10 row_shr:4 row_mask:0xf bank_mask:0xa
  v_add_f32_dpp v1, v9, v9 row_shr:4 row_mask:0xf bank_mask:0xa
  v_add_f32_dpp v0, v8, v8 row_shr:4 row_mask:0xf bank_mask:0xa
  v_mul_f32 v165, 0xbfb8aa3b, v0
  v_mul_f32 v166, 0xbfb8aa3b, v1
  v_exp_f32 v165, v165
  v_exp_f32 v166, v166
  v_add_f32 v165, 1.0, v165
  v_add_f32 v166, 1.0, v166
  v_rcp_f32 v165, v165
  v_rcp_f32 v166, v166
  v_mul_f32 v0, v165, v0
  v_mul_f32 v1, v166, v1
  v_mul_f32 v165, 0xbfb8aa3b, v2
  v_mul_f32 v166, 0xbfb8aa3b, v3
  v_exp_f32 v165, v165
  v_exp_f32 v166, v166
  v_add_f32 v165, 1.0, v165
  v_add_f32 v166, 1.0, v166
  v_rcp_f32 v165, v165
  v_rcp_f32 v166, v166
  v_mul_f32 v2, v165, v2
  v_mul_f32 v3, v166, v3
  v_mul_f32 v165, 0xbfb8aa3b, v4
  v_mul_f32 v166, 0xbfb8aa3b, v5
  v_exp_f32 v165, v165
  v_exp_f32 v166, v166
  v_add_f32 v165, 1.0, v165
  v_add_f32 v166, 1.0, v166
  v_rcp_f32 v165, v165
  v_rcp_f32 v166, v166
  v_mul_f32 v4, v165, v4
  v_mul_f32 v5, v166, v5
  v_mul_f32 v165, 0xbfb8aa3b, v6
  v_mul_f32 v166, 0xbfb8aa3b, v7
  v_exp_f32 v165, v165
  v_exp_f32 v166, v166
  v_add_f32 v165, 1.0, v165
  v_add_f32 v166, 1.0, v166
  v_rcp_f32 v165, v165
  v_rcp_f32 v166, v166
  v_mul_f32 v6, v165, v6
  v_mul_f32 v7, v166, v7
  v_mul_f32 v165, 0xbfb8aa3b, v16
  v_mul_f32 v166, 0xbfb8aa3b, v17
  v_exp_f32 v165, v165
  v_exp_f32 v166, v166
  v_add_f32 v165, 1.0, v165
  v_add_f32 v166, 1.0, v166
  v_rcp_f32 v165, v165
  v_rcp_f32 v166, v166
  v_mul_f32 v16, v165, v16
  v_mul_f32 v17, v166, v17
  s_waitcnt vmcnt(4)
  v_max3_u32 v165, v64, v65, v66
  s_waitcnt vmcnt(3)
  v_max3_u32 v165, v165, v67, v68
  v_max3_u32 v165, v165, v69, v70
  s_waitcnt vmcnt(2)
  v_max3_u32 v165, v165, v71, v72
  v_max3_u32 v165, v165, v73, v74
  s_waitcnt vmcnt(1)
  v_max3_u32 v165, v165, v75, v76
  v_max3_u32 v165, v165, v77, v78
  s_waitcnt vmcnt(0)
  v_max3_u32 v165, v165, v79, v80
  v_max3_u32 v165, v165, v81, v82
  v_max_u32 v165, v165, v83
  v_cmp_eq_u32 vcc, -1, v165
  s_nop 4
  s_cbranch_vccnz L_p3_spin_0_1
L_p3_ok_0_1:
  v_and_b32 v103, s46, v83
  v_lshlrev_b32 v102, 16, v83
  v_and_b32 v101, s46, v82
  v_lshlrev_b32 v100, 16, v82
  v_and_b32 v99, s46, v81
  v_lshlrev_b32 v98, 16, v81
  v_and_b32 v97, s46, v80
  v_lshlrev_b32 v96, 16, v80
  v_and_b32 v95, s46, v79
  v_lshlrev_b32 v94, 16, v79
  v_and_b32 v93, s46, v78
  v_lshlrev_b32 v92, 16, v78
  v_and_b32 v91, s46, v77
  v_lshlrev_b32 v90, 16, v77
  v_and_b32 v89, s46, v76
  v_lshlrev_b32 v88, 16, v76
  v_and_b32 v87, s46, v75
  v_lshlrev_b32 v86, 16, v75
  v_and_b32 v85, s46, v74
  v_lshlrev_b32 v84, 16, v74
  v_and_b32 v83, s46, v73
  v_lshlrev_b32 v82, 16, v73
  v_and_b32 v81, s46, v72
  v_lshlrev_b32 v80, 16, v72
  v_and_b32 v79, s46, v71
  v_lshlrev_b32 v78, 16, v71
  v_and_b32 v77, s46, v70
  v_lshlrev_b32 v76, 16, v70
  v_and_b32 v75, s46, v69
  v_lshlrev_b32 v74, 16, v69
  v_and_b32 v73, s46, v68
  v_lshlrev_b32 v72, 16, v68
  v_and_b32 v71, s46, v67
  v_lshlrev_b32 v70, 16, v67
  v_and_b32 v69, s46, v66
  v_lshlrev_b32 v68, 16, v66
  v_and_b32 v67, s46, v65
  v_lshlrev_b32 v66, 16, v65
  v_and_b32 v65, s46, v64
  v_lshlrev_b32 v64, 16, v64
  v_add_f32_dpp v83, v83, v83 row_ror:8 row_mask:0xf bank_mask:0x3
  v_add_f32_dpp v82, v82, v82 row_ror:8 row_mask:0xf bank_mask:0x3
  v_add_f32_dpp v81, v81, v81 row_ror:8 row_mask:0xf bank_mask:0x3
  v_add_f32_dpp v80, v80, v80 row_ror:8 row_mask:0xf bank_mask:0x3
  v_add_f32_dpp v79, v79, v79 row_ror:8 row_mask:0xf bank_mask:0x3
  v_add_f32_dpp v78, v78, v78 row_ror:8 row_mask:0xf bank_mask:0x3
  v_add_f32_dpp v77, v77, v77 row_ror:8 row_mask:0xf bank_mask:0x3
  v_add_f32_dpp v76, v76, v76 row_ror:8 row_mask:0xf bank_mask:0x3
  v_add_f32_dpp v75, v75, v75 row_ror:8 row_mask:0xf bank_mask:0x3
  v_add_f32_dpp v74, v74, v74 row_ror:8 row_mask:0xf bank_mask:0x3
  v_add_f32_dpp v73, v73, v73 row_ror:8 row_mask:0xf bank_mask:0x3
  v_add_f32_dpp v72, v72, v72 row_ror:8 row_mask:0xf bank_mask:0x3
  v_add_f32_dpp v71, v71, v71 row_ror:8 row_mask:0xf bank_mask:0x3
  v_add_f32_dpp v70, v70, v70 row_ror:8 row_mask:0xf bank_mask:0x3
  v_add_f32_dpp v69, v69, v69 row_ror:8 row_mask:0xf bank_mask:0x3
  v_add_f32_dpp v68, v68, v68 row_ror:8 row_mask:0xf bank_mask:0x3
  v_add_f32_dpp v67, v67, v67 row_ror:8 row_mask:0xf bank_mask:0x3
  v_add_f32_dpp v66, v66, v66 row_ror:8 row_mask:0xf bank_mask:0x3
  v_add_f32_dpp v65, v65, v65 row_ror:8 row_mask:0xf bank_mask:0x3
  v_add_f32_dpp v64, v64, v64 row_ror:8 row_mask:0xf bank_mask:0x3
  v_add_f32_dpp v83, v103, v103 row_ror:8 row_mask:0xf bank_mask:0xc
  v_add_f32_dpp v82, v102, v102 row_ror:8 row_mask:0xf bank_mask:0xc
  v_add_f32_dpp v81, v101, v101 row_ror:8 row_mask:0xf bank_mask:0xc
  v_add_f32_dpp v80, v100, v100 row_ror:8 row_mask:0xf bank_mask:0xc
  v_add_f32_dpp v79, v99, v99 row_ror:8 row_mask:0xf bank_mask:0xc
  v_add_f32_dpp v78, v98, v98 row_ror:8 row_mask:0xf bank_mask:0xc
  v_add_f32_dpp v77, v97, v97 row_ror:8 row_mask:0xf bank_mask:0xc
  v_add_f32_dpp v76, v96, v96 row_ror:8 row_mask:0xf bank_mask:0xc
  v_add_f32_dpp v75, v95, v95 row_ror:8 row_mask:0xf bank_mask:0xc
  v_add_f32_dpp v74, v94, v94 row_ror:8 row_mask:0xf bank_mask:0xc
  v_add_f32_dpp v73, v93, v93 row_ror:8 row_mask:0xf bank_mask:0xc
  v_add_f32_dpp v72, v92, v92 row_ror:8 row_mask:0xf bank_mask:0xc
  v_add_f32_dpp v71, v91, v91 row_ror:8 row_mask:0xf bank_mask:0xc
  v_add_f32_dpp v70, v90, v90 row_ror:8 row_mask:0xf bank_mask:0xc
  v_add_f32_dpp v69, v89, v89 row_ror:8 row_mask:0xf bank_mask:0xc
  v_add_f32_dpp v68, v88, v88 row_ror:8 row_mask:0xf bank_mask:0xc
  v_add_f32_dpp v67, v87, v87 row_ror:8 row_mask:0xf bank_mask:0xc
  v_add_f32_dpp v66, v86, v86 row_ror:8 row_mask:0xf bank_mask:0xc
  v_add_f32_dpp v65, v85, v85 row_ror:8 row_mask:0xf bank_mask:0xc
  v_add_f32_dpp v64, v84, v84 row_ror:8 row_mask:0xf bank_mask:0xc
  v_add_f32_dpp v81, v81, v81 row_shl:4 row_mask:0xf bank_mask:0x5
  v_add_f32_dpp v80, v80, v80 row_shl:4 row_mask:0xf bank_mask:0x5
  v_add_f32_dpp v71, v71, v71 row_shl:4 row_mask:0xf bank_mask:0x5
  v_add_f32_dpp v70, v70, v70 row_shl:4 row_mask:0xf bank_mask:0x5
  v_add_f32_dpp v69, v69, v69 row_shl:4 row_mask:0xf bank_mask:0x5
  v_add_f32_dpp v68, v68, v68 row_shl:4 row_mask:0xf bank_mask:0x5
  v_add_f32_dpp v67, v67, v67 row_shl:4 row_mask:0xf bank_mask:0x5
  v_add_f32_dpp v66, v66, v66 row_shl:4 row_mask:0xf bank_mask:0x5
  v_add_f32_dpp v65, v65, v65 row_shl:4 row_mask:0xf bank_mask:0x5
  v_add_f32_dpp v64, v64, v64 row_shl:4 row_mask:0xf bank_mask:0x5
  v_add_f32_dpp v81, v83, v83 row_shr:4 row_mask:0xf bank_mask:0xa
  v_add_f32_dpp v80, v82, v82 row_shr:4 row_mask:0xf bank_mask:0xa
  v_add_f32_dpp v71, v79, v79 row_shr:4 row_mask:0xf bank_mask:0xa
  v_add_f32_dpp v70, v78, v78 row_shr:4 row_mask:0xf bank_mask:0xa
  v_add_f32_dpp v69, v77, v77 row_shr:4 row_mask:0xf bank_mask:0xa
  v_add_f32_dpp v68, v76, v76 row_shr:4 row_mask:0xf bank_mask:0xa
  v_add_f32_dpp v67, v75, v75 row_shr:4 row_mask:0xf bank_mask:0xa
  v_add_f32_dpp v66, v74, v74 row_shr:4 row_mask:0xf bank_mask:0xa
  v_add_f32_dpp v65, v73, v73 row_shr:4 row_mask:0xf bank_mask:0xa
  v_add_f32_dpp v64, v72, v72 row_shr:4 row_mask:0xf bank_mask:0xa
  v_lshlrev_b32 v165, 16, v104
  v_and_b32 v166, s46, v104
  v_fmac_f32 v165, v64, v0
  v_fmac_f32 v166, v65, v1
  v_cvt_pk_bf16_f32 v104, v165, v166
  v_lshlrev_b32 v165, 16, v105
  v_and_b32 v166, s46, v105
  v_fmac_f32 v165, v66, v2
  v_fmac_f32 v166, v67, v3
  v_cvt_pk_bf16_f32 v105, v165, v166
  v_lshlrev_b32 v165, 16, v106
  v_and_b32 v166, s46, v106
  v_fmac_f32 v165, v68, v4
  v_fmac_f32 v166, v69, v5
  v_cvt_pk_bf16_f32 v106, v165, v166
  v_lshlrev_b32 v165, 16, v107
  v_and_b32 v166, s46, v107
  v_fmac_f32 v165, v70, v6
  v_fmac_f32 v166, v71, v7
  v_cvt_pk_bf16_f32 v107, v165, v166
  v_lshlrev_b32 v165, 16, v108
  v_and_b32 v166, s46, v108
  v_fmac_f32 v165, v80, v16
  v_fmac_f32 v166, v81, v17
  v_cvt_pk_bf16_f32 v108, v165, v166
  buffer_store_dword v108, v183, s[92:95], 0 offen offset:256 sc1
  v_mov_b32 v170, v104
  s_mov_b32 exec_lo, s46
  s_mov_b32 exec_hi, s46
  v_swap_b32 v104, v106
  v_swap_b32 v105, v107
  s_mov_b64 exec, -1
  buffer_store_dwordx4 v[104:107], v182, s[92:95], 0 offen offset:0 sc1
  s_endpgm
L_grpB:
  s_waitcnt vmcnt(7)
  v_mfma_f32_32x32x16_bf16 v[64:79], v[240:243], v[128:131], v[64:79]
  s_waitcnt vmcnt(6)
  v_mfma_f32_32x32x16_bf16 v[80:95], v[244:247], v[128:131], v[80:95]
  s_waitcnt vmcnt(5)
  v_mfma_f32_32x32x16_bf16 v[96:111], v[248:251], v[128:131], v[96:111]
  s_waitcnt vmcnt(4)
  v_mfma_f32_32x32x16_bf16 v[112:127], v[252:255], v[128:131], v[112:127]
  v_mfma_f32_32x32x16_bf16 v[0:15], v[224:227], v[128:131], v[0:15]
  v_mfma_f32_32x32x16_bf16 v[16:31], v[228:231], v[128:131], v[16:31]
  v_mfma_f32_32x32x16_bf16 v[32:47], v[232:235], v[128:131], v[32:47]
  v_mfma_f32_32x32x16_bf16 v[48:63], v[236:239], v[128:131], v[48:63]
  s_nop 1
  v_pk_mul_f32 v[64:65], v[64:65], v[162:163] op_sel:[0,1] op_sel_hi:[1,1]
  v_pk_mul_f32 v[66:67], v[66:67], v[162:163] op_sel:[0,1] op_sel_hi:[1,1]
  v_cvt_pk_bf16_f32 v224, v64, v65
  v_cvt_pk_bf16_f32 v225, v66, v67
  v_pk_mul_f32 v[68:69], v[68:69], v[162:163] op_sel:[0,1] op_sel_hi:[1,1]
  v_pk_mul_f32 v[70:71], v[70:71], v[162:163] op_sel:[0,1] op_sel_hi:[1,1]
  v_cvt_pk_bf16_f32 v226, v68, v69
  v_cvt_pk_bf16_f32 v227, v70, v71
  v_pk_mul_f32 v[72:73], v[72:73], v[162:163] op_sel:[0,1] op_sel_hi:[1,1]
  v_pk_mul_f32 v[74:75], v[74:75], v[162:163] op_sel:[0,1] op_sel_hi:[1,1]
  v_cvt_pk_bf16_f32 v228, v72, v73
  v_cvt_pk_bf16_f32 v229, v74, v75
  v_pk_mul_f32 v[76:77], v[76:77], v[162:163] op_sel:[0,1] op_sel_hi:[1,1]
  v_pk_mul_f32 v[78:79], v[78:79], v[162:163] op_sel:[0,1] op_sel_hi:[1,1]
  v_cvt_pk_bf16_f32 v230, v76, v77
  v_cvt_pk_bf16_f32 v231, v78, v79
  v_pk_mul_f32 v[80:81], v[80:81], v[162:163] op_sel:[0,1] op_sel_hi:[1,1]
  v_pk_mul_f32 v[82:83], v[82:83], v[162:163] op_sel:[0,1] op_sel_hi:[1,1]
  v_cvt_pk_bf16_f32 v232, v80, v81
  v_cvt_pk_bf16_f32 v233, v82, v83
  v_pk_mul_f32 v[84:85], v[84:85], v[162:163] op_sel:[0,1] op_sel_hi:[1,1]
  v_pk_mul_f32 v[86:87], v[86:87], v[162:163] op_sel:[0,1] op_sel_hi:[1,1]
  v_cvt_pk_bf16_f32 v234, v84, v85
  v_cvt_pk_bf16_f32 v235, v86, v87
  v_pk_mul_f32 v[88:89], v[88:89], v[162:163] op_sel:[0,1] op_sel_hi:[1,1]
  v_pk_mul_f32 v[90:91], v[90:91], v[162:163] op_sel:[0,1] op_sel_hi:[1,1]
  v_cvt_pk_bf16_f32 v236, v88, v89
  v_cvt_pk_bf16_f32 v237, v90, v91
  v_pk_mul_f32 v[92:93], v[92:93], v[162:163] op_sel:[0,1] op_sel_hi:[1,1]
  v_pk_mul_f32 v[94:95], v[94:95], v[162:163] op_sel:[0,1] op_sel_hi:[1,1]
  v_cvt_pk_bf16_f32 v238, v92, v93
  v_cvt_pk_bf16_f32 v239, v94, v95
  v_pk_mul_f32 v[96:97], v[96:97], v[162:163] op_sel:[0,1] op_sel_hi:[1,1]
  v_pk_mul_f32 v[98:99], v[98:99], v[162:163] op_sel:[0,1] op_sel_hi:[1,1]
  v_cvt_pk_bf16_f32 v240, v96, v97
  v_cvt_pk_bf16_f32 v241, v98, v99
  v_pk_mul_f32 v[100:101], v[100:101], v[162:163] op_sel:[0,1] op_sel_hi:[1,1]
  v_pk_mul_f32 v[102:103], v[102:103], v[162:163] op_sel:[0,1] op_sel_hi:[1,1]
  v_cvt_pk_bf16_f32 v242, v100, v101
  v_cvt_pk_bf16_f32 v243, v102, v103
  v_pk_mul_f32 v[104:105], v[104:105], v[162:163] op_sel:[0,1] op_sel_hi:[1,1]
  v_pk_mul_f32 v[106:107], v[106:107], v[162:163] op_sel:[0,1] op_sel_hi:[1,1]
  v_cvt_pk_bf16_f32 v244, v104, v105
  v_cvt_pk_bf16_f32 v245, v106, v107
  v_pk_mul_f32 v[108:109], v[108:109], v[162:163] op_sel:[0,1] op_sel_hi:[1,1]
  v_pk_mul_f32 v[110:111], v[110:111], v[162:163] op_sel:[0,1] op_sel_hi:[1,1]
  v_cvt_pk_bf16_f32 v246, v108, v109
  v_cvt_pk_bf16_f32 v247, v110, v111
  v_pk_mul_f32 v[112:113], v[112:113], v[162:163] op_sel:[0,1] op_sel_hi:[1,1]
  v_pk_mul_f32 v[114:115], v[114:115], v[162:163] op_sel:[0,1] op_sel_hi:[1,1]
  v_cvt_pk_bf16_f32 v248, v112, v113
  v_cvt_pk_bf16_f32 v249, v114, v115
  v_pk_mul_f32 v[116:117], v[116:117], v[162:163] op_sel:[0,1] op_sel_hi:[1,1]
  v_pk_mul_f32 v[118:119], v[118:119], v[162:163] op_sel:[0,1] op_sel_hi:[1,1]
  v_cvt_pk_bf16_f32 v250, v116, v117
  v_cvt_pk_bf16_f32 v251, v118, v119
  v_pk_mul_f32 v[120:121], v[120:121], v[162:163] op_sel:[0,1] op_sel_hi:[1,1]
  v_pk_mul_f32 v[122:123], v[122:123], v[162:163] op_sel:[0,1] op_sel_hi:[1,1]
  v_cvt_pk_bf16_f32 v252, v120, v121
  v_cvt_pk_bf16_f32 v253, v122, v123
  v_pk_mul_f32 v[124:125], v[124:125], v[162:163] op_sel:[0,1] op_sel_hi:[1,1]
  v_pk_mul_f32 v[126:127], v[126:127], v[162:163] op_sel:[0,1] op_sel_hi:[1,1]
  v_cvt_pk_bf16_f32 v254, v124, v125
  v_cvt_pk_bf16_f32 v255, v126, v127
  ds_read_b128 v[192:195], v176 offset:0
  ds_read_b128 v[196:199], v176 offset:8192
  ds_read_b128 v[200:203], v177 offset:0
  ds_read_b128 v[204:207], v177 offset:8192
  ds_read_b128 v[208:211], v178 offset:0
  ds_read_b128 v[212:215], v178 offset:8192
  ds_read_b128 v[216:219], v179 offset:0
  ds_read_b128 v[220:223], v179 offset:8192
  v_pk_mul_f32 v[146:147], v[0:1], v[164:165] op_sel_hi:[1,0]
  v_pk_mul_f32 v[148:149], v[2:3], v[164:165] op_sel_hi:[1,0]
  v_exp_f32 v146, v146
  v_exp_f32 v147, v147
  v_exp_f32 v148, v148
  v_exp_f32 v149, v149
  v_pk_mul_f32 v[0:1], v[0:1], v[8:9]
  v_pk_mul_f32 v[2:3], v[2:3], v[10:11]
  v_pk_fma_f32 v[146:147], v[146:147], v[164:165], v[164:165] op_sel:[0,1,1] op_sel_hi:[1,1,1]
  v_pk_fma_f32 v[148:149], v[148:149], v[164:165], v[164:165] op_sel:[0,1,1] op_sel_hi:[1,1,1]
  v_rcp_f32 v146, v146
  v_rcp_f32 v147, v147
  v_rcp_f32 v148, v148
  v_rcp_f32 v149, v149
  v_pk_mul_f32 v[146:147], v[146:147], v[0:1]
  v_pk_mul_f32 v[148:149], v[148:149], v[2:3]
  v_cvt_pk_bf16_f32 v8, v146, v147
  v_cvt_pk_bf16_f32 v9, v148, v149
  v_pk_mul_f32 v[146:147], v[4:5], v[164:165] op_sel_hi:[1,0]
  v_pk_mul_f32 v[148:149], v[6:7], v[164:165] op_sel_hi:[1,0]
  v_exp_f32 v146, v146
  v_exp_f32 v147, v147
  v_exp_f32 v148, v148
  v_exp_f32 v149, v149
  v_pk_mul_f32 v[4:5], v[4:5], v[12:13]
  v_pk_mul_f32 v[6:7], v[6:7], v[14:15]
  v_pk_fma_f32 v[146:147], v[146:147], v[164:165], v[164:165] op_sel:[0,1,1] op_sel_hi:[1,1,1]
  v_pk_fma_f32 v[148:149], v[148:149], v[164:165], v[164:165] op_sel:[0,1,1] op_sel_hi:[1,1,1]
  v_rcp_f32 v146, v146
  v_rcp_f32 v147, v147
  v_rcp_f32 v148, v148
  v_rcp_f32 v149, v149
  v_pk_mul_f32 v[146:147], v[146:147], v[4:5]
  v_pk_mul_f32 v[148:149], v[148:149], v[6:7]
  v_cvt_pk_bf16_f32 v10, v146, v147
  v_cvt_pk_bf16_f32 v11, v148, v149
  buffer_store_dwordx4 v[8:11], v174, s[28:31], s52 offen sc1
  v_pk_mul_f32 v[146:147], v[16:17], v[164:165] op_sel_hi:[1,0]
  v_pk_mul_f32 v[148:149], v[18:19], v[164:165] op_sel_hi:[1,0]
  v_exp_f32 v146, v146
  v_exp_f32 v147, v147
  v_exp_f32 v148, v148
  v_exp_f32 v149, v149
  v_pk_mul_f32 v[16:17], v[16:17], v[24:25]
  v_pk_mul_f32 v[18:19], v[18:19], v[26:27]
  v_pk_fma_f32 v[146:147], v[146:147], v[164:165], v[164:165] op_sel:[0,1,1] op_sel_hi:[1,1,1]
  v_pk_fma_f32 v[148:149], v[148:149], v[164:165], v[164:165] op_sel:[0,1,1] op_sel_hi:[1,1,1]
  v_rcp_f32 v146, v146
  v_rcp_f32 v147, v147
  v_rcp_f32 v148, v148
  v_rcp_f32 v149, v149
  v_pk_mul_f32 v[146:147], v[146:147], v[16:17]
  v_pk_mul_f32 v[148:149], v[148:149], v[18:19]
  v_cvt_pk_bf16_f32 v24, v146, v147
  v_cvt_pk_bf16_f32 v25, v148, v149
  v_pk_mul_f32 v[146:147], v[20:21], v[164:165] op_sel_hi:[1,0]
  v_pk_mul_f32 v[148:149], v[22:23], v[164:165] op_sel_hi:[1,0]
  v_exp_f32 v146, v146
  v_exp_f32 v147, v147
  v_exp_f32 v148, v148
  v_exp_f32 v149, v149
  v_pk_mul_f32 v[20:21], v[20:21], v[28:29]
  v_pk_mul_f32 v[22:23], v[22:23], v[30:31]
  v_pk_fma_f32 v[146:147], v[146:147], v[164:165], v[164:165] op_sel:[0,1,1] op_sel_hi:[1,1,1]
  v_pk_fma_f32 v[148:149], v[148:149], v[164:165], v[164:165] op_sel:[0,1,1] op_sel_hi:[1,1,1]
  v_rcp_f32 v146, v146
  v_rcp_f32 v147, v147
  v_rcp_f32 v148, v148
  v_rcp_f32 v149, v149
  v_pk_mul_f32 v[146:147], v[146:147], v[20:21]
  v_pk_mul_f32 v[148:149], v[148:149], v[22:23]
  v_cvt_pk_bf16_f32 v26, v146, v147
  v_cvt_pk_bf16_f32 v27, v148, v149
  buffer_store_dwordx4 v[24:27], v174, s[28:31], s53 offen sc1
  v_pk_mul_f32 v[146:147], v[32:33], v[164:165] op_sel_hi:[1,0]
  v_pk_mul_f32 v[148:149], v[34:35], v[164:165] op_sel_hi:[1,0]
  v_exp_f32 v146, v146
  v_exp_f32 v147, v147
  v_exp_f32 v148, v148
  v_exp_f32 v149, v149
  v_pk_mul_f32 v[32:33], v[32:33], v[40:41]
  v_pk_mul_f32 v[34:35], v[34:35], v[42:43]
  v_pk_fma_f32 v[146:147], v[146:147], v[164:165], v[164:165] op_sel:[0,1,1] op_sel_hi:[1,1,1]
  v_pk_fma_f32 v[148:149], v[148:149], v[164:165], v[164:165] op_sel:[0,1,1] op_sel_hi:[1,1,1]
  v_rcp_f32 v146, v146
  v_rcp_f32 v147, v147
  v_rcp_f32 v148, v148
  v_rcp_f32 v149, v149
  v_pk_mul_f32 v[146:147], v[146:147], v[32:33]
  v_pk_mul_f32 v[148:149], v[148:149], v[34:35]
  v_cvt_pk_bf16_f32 v40, v146, v147
  v_cvt_pk_bf16_f32 v41, v148, v149
  v_pk_mul_f32 v[146:147], v[36:37], v[164:165] op_sel_hi:[1,0]
  v_pk_mul_f32 v[148:149], v[38:39], v[164:165] op_sel_hi:[1,0]
  v_exp_f32 v146, v146
  v_exp_f32 v147, v147
  v_exp_f32 v148, v148
  v_exp_f32 v149, v149
  v_pk_mul_f32 v[36:37], v[36:37], v[44:45]
  v_pk_mul_f32 v[38:39], v[38:39], v[46:47]
  v_pk_fma_f32 v[146:147], v[146:147], v[164:165], v[164:165] op_sel:[0,1,1] op_sel_hi:[1,1,1]
  v_pk_fma_f32 v[148:149], v[148:149], v[164:165], v[164:165] op_sel:[0,1,1] op_sel_hi:[1,1,1]
  v_rcp_f32 v146, v146
  v_rcp_f32 v147, v147
  v_rcp_f32 v148, v148
  v_rcp_f32 v149, v149
  v_pk_mul_f32 v[146:147], v[146:147], v[36:37]
  v_pk_mul_f32 v[148:149], v[148:149], v[38:39]
  v_cvt_pk_bf16_f32 v42, v146, v147
  v_cvt_pk_bf16_f32 v43, v148, v149
  buffer_store_dwordx4 v[40:43], v174, s[28:31], s54 offen sc1
  v_pk_mul_f32 v[146:147], v[48:49], v[164:165] op_sel_hi:[1,0]
  v_pk_mul_f32 v[148:149], v[50:51], v[164:165] op_sel_hi:[1,0]
  v_exp_f32 v146, v146
  v_exp_f32 v147, v147
  v_exp_f32 v148, v148
  v_exp_f32 v149, v149
  v_pk_mul_f32 v[48:49], v[48:49], v[56:57]
  v_pk_mul_f32 v[50:51], v[50:51], v[58:59]
  v_pk_fma_f32 v[146:147], v[146:147], v[164:165], v[164:165] op_sel:[0,1,1] op_sel_hi:[1,1,1]
  v_pk_fma_f32 v[148:149], v[148:149], v[164:165], v[164:165] op_sel:[0,1,1] op_sel_hi:[1,1,1]
  v_rcp_f32 v146, v146
  v_rcp_f32 v147, v147
  v_rcp_f32 v148, v148
  v_rcp_f32 v149, v149
  v_pk_mul_f32 v[146:147], v[146:147], v[48:49]
  v_pk_mul_f32 v[148:149], v[148:149], v[50:51]
  v_cvt_pk_bf16_f32 v56, v146, v147
  v_cvt_pk_bf16_f32 v57, v148, v149
  v_pk_mul_f32 v[146:147], v[52:53], v[164:165] op_sel_hi:[1,0]
  v_pk_mul_f32 v[148:149], v[54:55], v[164:165] op_sel_hi:[1,0]
  v_exp_f32 v146, v146
  v_exp_f32 v147, v147
  v_exp_f32 v148, v148
  v_exp_f32 v149, v149
  v_pk_mul_f32 v[52:53], v[52:53], v[60:61]
  v_pk_mul_f32 v[54:55], v[54:55], v[62:63]
  v_pk_fma_f32 v[146:147], v[146:147], v[164:165], v[164:165] op_sel:[0,1,1] op_sel_hi:[1,1,1]
  v_pk_fma_f32 v[148:149], v[148:149], v[164:165], v[164:165] op_sel:[0,1,1] op_sel_hi:[1,1,1]
  v_rcp_f32 v146, v146
  v_rcp_f32 v147, v147
  v_rcp_f32 v148, v148
  v_rcp_f32 v149, v149
  v_pk_mul_f32 v[146:147], v[146:147], v[52:53]
  v_pk_mul_f32 v[148:149], v[148:149], v[54:55]
  v_cvt_pk_bf16_f32 v58, v146, v147
  v_cvt_pk_bf16_f32 v59, v148, v149
  buffer_store_dwordx4 v[56:59], v174, s[28:31], s55 offen sc1
  s_setprio 0
  s_waitcnt lgkmcnt(7)
  v_mfma_f32_32x32x16_bf16 v[64:79], v[192:195], v[224:227], 0
  ds_read_b128 v[192:195], v180 offset:0
  s_waitcnt lgkmcnt(7)
  v_mfma_f32_32x32x16_bf16 v[80:95], v[196:199], v[224:227], 0
  ds_read_b128 v[196:199], v180 offset:8192
  s_waitcnt lgkmcnt(7)
  v_mfma_f32_32x32x16_bf16 v[64:79], v[200:203], v[228:231], v[64:79]
  ds_read_b128 v[200:203], v181 offset:0
  s_waitcnt lgkmcnt(7)
  v_mfma_f32_32x32x16_bf16 v[80:95], v[204:207], v[228:231], v[80:95]
  ds_read_b128 v[204:207], v181 offset:8192
  s_waitcnt lgkmcnt(7)
  v_mfma_f32_32x32x16_bf16 v[64:79], v[208:211], v[232:235], v[64:79]
  ds_read_b128 v[208:211], v182 offset:0
  s_waitcnt lgkmcnt(7)
  v_mfma_f32_32x32x16_bf16 v[80:95], v[212:215], v[232:235], v[80:95]
  ds_read_b128 v[212:215], v182 offset:8192
  s_waitcnt lgkmcnt(7)
  v_mfma_f32_32x32x16_bf16 v[64:79], v[216:219], v[236:239], v[64:79]
  ds_read_b128 v[216:219], v183 offset:0
  s_waitcnt lgkmcnt(7)
  v_mfma_f32_32x32x16_bf16 v[80:95], v[220:223], v[236:239], v[80:95]
  ds_read_b128 v[220:223], v183 offset:8192
  s_waitcnt lgkmcnt(7)
  v_mfma_f32_32x32x16_bf16 v[64:79], v[192:195], v[240:243], v[64:79]
  s_barrier
  v_subrev_u32 v176, 131072, v176
  v_subrev_u32 v177, 131072, v177
  v_subrev_u32 v178, 131072, v178
  v_subrev_u32 v179, 131072, v179
  v_subrev_u32 v180, 131072, v180
  v_subrev_u32 v181, 131072, v181
  v_subrev_u32 v182, 131072, v182
  v_subrev_u32 v183, 131072, v183
  ds_read_b128 v[192:195], v176 offset:0
  s_waitcnt lgkmcnt(7)
  v_mfma_f32_32x32x16_bf16 v[80:95], v[196:199], v[240:243], v[80:95]
  ds_read_b128 v[196:199], v176 offset:8192
  s_add_u32 m0, s49, 81920
  s_waitcnt lgkmcnt(7)
  v_mfma_f32_32x32x16_bf16 v[64:79], v[200:203], v[244:247], v[64:79]
  ds_read_b128 v[200:203], v177 offset:0
  buffer_load_dwordx4 v173, s[20:23], s51 offen lds
  s_waitcnt lgkmcnt(7)
  v_mfma_f32_32x32x16_bf16 v[80:95], v[204:207], v[244:247], v[80:95]
  ds_read_b128 v[204:207], v177 offset:8192
  buffer_load_dwordx4 v173, s[20:23], s51 offen offset:1024 lds
  s_waitcnt lgkmcnt(7)
  v_mfma_f32_32x32x16_bf16 v[64:79], v[208:211], v[248:251], v[64:79]
  ds_read_b128 v[208:211], v178 offset:0
  s_add_u32 s51, s51, 16384
  s_add_u32 m0, s49, 32768
  s_waitcnt lgkmcnt(7)
  v_mfma_f32_32x32x16_bf16 v[80:95], v[212:215], v[248:251], v[80:95]
  ds_read_b128 v[212:215], v178 offset:8192
  buffer_load_dwordx4 v171, s[16:19], s50 offen lds
  s_waitcnt lgkmcnt(7)
  v_mfma_f32_32x32x16_bf16 v[64:79], v[216:219], v[252:255], v[64:79]
  ds_read_b128 v[216:219], v179 offset:0
  buffer_load_dwordx4 v172, s[16:19], s50 offen offset:1024 lds
  s_waitcnt lgkmcnt(7)
  v_mfma_f32_32x32x16_bf16 v[80:95], v[220:223], v[252:255], v[80:95]
  ds_read_b128 v[220:223], v179 offset:8192
  s_add_u32 s50, s50, 16384
  s_nop 5
  v_max3_f32 v169, v64, v65, v66
  v_max3_f32 v169, v169, v67, v68
  v_max3_f32 v169, v169, v69, v70
  v_max3_f32 v169, v169, v71, v72
  v_max3_f32 v169, v169, v73, v74
  v_max3_f32 v169, v169, v75, v76
  v_max3_f32 v169, v169, v77, v78
  v_max3_f32 v169, v169, v79, v80
  v_max3_f32 v169, v169, v81, v82
  v_max3_f32 v169, v169, v83, v84
  v_max3_f32 v169, v169, v85, v86
  v_max3_f32 v169, v169, v87, v88
  v_max3_f32 v169, v169, v89, v90
  v_max3_f32 v169, v169, v91, v92
  v_max3_f32 v169, v169, v93, v94
  v_max_f32 v169, v169, v95
  v_mov_b32 v170, v169
  s_nop 1
  v_permlane32_swap_b32 v170, v169
  v_max_f32 v169, v169, v170
  v_sub_f32 v128, 0, v169
  v_sub_f32 v129, 0, v169
  v_pk_mov_b32 v[130:131], v[128:129], v[128:129]
  v_pk_mov_b32 v[132:133], v[128:129], v[128:129]
  v_pk_mov_b32 v[134:135], v[128:129], v[128:129]
  v_pk_mov_b32 v[136:137], v[128:129], v[128:129]
  v_pk_mov_b32 v[138:139], v[128:129], v[128:129]
  v_pk_mov_b32 v[140:141], v[128:129], v[128:129]
  v_pk_mov_b32 v[142:143], v[128:129], v[128:129]
  v_pk_add_f32 v[64:65], v[64:65], v[128:129]
  v_pk_add_f32 v[66:67], v[66:67], v[128:129]
  v_pk_add_f32 v[68:69], v[68:69], v[128:129]
  v_pk_add_f32 v[70:71], v[70:71], v[128:129]
  v_pk_add_f32 v[72:73], v[72:73], v[128:129]
  v_pk_add_f32 v[74:75], v[74:75], v[128:129]
  v_pk_add_f32 v[76:77], v[76:77], v[128:129]
  v_pk_add_f32 v[78:79], v[78:79], v[128:129]
  v_pk_add_f32 v[80:81], v[80:81], v[128:129]
  v_pk_add_f32 v[82:83], v[82:83], v[128:129]
  v_pk_add_f32 v[84:85], v[84:85], v[128:129]
  v_pk_add_f32 v[86:87], v[86:87], v[128:129]
  v_pk_add_f32 v[88:89], v[88:89], v[128:129]
  v_pk_add_f32 v[90:91], v[90:91], v[128:129]
  v_pk_add_f32 v[92:93], v[92:93], v[128:129]
  v_pk_add_f32 v[94:95], v[94:95], v[128:129]
  v_mov_b32 v162, 0
  s_setprio 2
  s_waitcnt lgkmcnt(7)
  v_mfma_f32_32x32x16_bf16 v[96:111], v[192:195], v[224:227], v[128:143]
  ds_read_b128 v[192:195], v180 offset:0
  v_exp_f32 v165, v64
  v_exp_f32 v166, v65
  s_nop 0
  v_add_f32 v163, v165, v166
  v_cvt_pk_bf16_f32 v144, v165, v166
  s_waitcnt lgkmcnt(7)
  v_mfma_f32_32x32x16_bf16 v[112:127], v[196:199], v[224:227], v[128:143]
  ds_read_b128 v[196:199], v180 offset:8192
  v_exp_f32 v167, v66
  v_exp_f32 v168, v67
  v_add_f32 v163, v163, v167
  v_add_f32 v163, v163, v168
  v_cvt_pk_bf16_f32 v145, v167, v168
  s_waitcnt lgkmcnt(7)
  v_mfma_f32_32x32x16_bf16 v[96:111], v[200:203], v[228:231], v[96:111]
  ds_read_b128 v[200:203], v181 offset:0
  v_exp_f32 v165, v68
  v_exp_f32 v166, v69
  v_add_f32 v163, v163, v165
  v_add_f32 v163, v163, v166
  v_cvt_pk_bf16_f32 v146, v165, v166
  s_waitcnt lgkmcnt(7)
  v_mfma_f32_32x32x16_bf16 v[112:127], v[204:207], v[228:231], v[112:127]
  ds_read_b128 v[204:207], v181 offset:8192
  v_exp_f32 v167, v70
  v_exp_f32 v168, v71
  v_add_f32 v163, v163, v167
  v_add_f32 v163, v163, v168
  v_cvt_pk_bf16_f32 v147, v167, v168
  s_waitcnt lgkmcnt(7)
  v_mfma_f32_32x32x16_bf16 v[96:111], v[208:211], v[232:235], v[96:111]
  ds_read_b128 v[208:211], v182 offset:0
  v_exp_f32 v165, v72
  v_exp_f32 v166, v73
  v_add_f32 v163, v163, v165
  v_add_f32 v163, v163, v166
  v_cvt_pk_bf16_f32 v148, v165, v166
  s_waitcnt lgkmcnt(7)
  v_mfma_f32_32x32x16_bf16 v[112:127], v[212:215], v[232:235], v[112:127]
  ds_read_b128 v[212:215], v182 offset:8192
  v_exp_f32 v167, v74
  v_exp_f32 v168, v75
  v_add_f32 v163, v163, v167
  v_add_f32 v163, v163, v168
  v_cvt_pk_bf16_f32 v149, v167, v168
  s_waitcnt lgkmcnt(7)
  v_mfma_f32_32x32x16_bf16 v[96:111], v[216:219], v[236:239], v[96:111]
  ds_read_b128 v[216:219], v183 offset:0
  v_exp_f32 v165, v76
  v_exp_f32 v166, v77
  v_add_f32 v163, v163, v165
  v_add_f32 v163, v163, v166
  v_cvt_pk_bf16_f32 v150, v165, v166
  s_waitcnt lgkmcnt(7)
  v_mfma_f32_32x32x16_bf16 v[112:127], v[220:223], v[236:239], v[112:127]
  ds_read_b128 v[220:223], v183 offset:8192
  v_exp_f32 v167, v78
  v_exp_f32 v168, v79
  v_add_f32 v163, v163, v167
  v_add_f32 v163, v163, v168
  v_cvt_pk_bf16_f32 v151, v167, v168
  s_waitcnt lgkmcnt(7)
  v_mfma_f32_32x32x16_bf16 v[96:111], v[192:195], v[240:243], v[96:111]
  ds_read_b64_tr_b16 v[192:193], v184 offset:0
  ds_read_b64_tr_b16 v[194:195], v184 offset:2048
  v_exp_f32 v165, v80
  v_exp_f32 v166, v81
  v_add_f32 v163, v163, v165
  v_add_f32 v163, v163, v166
  v_cvt_pk_bf16_f32 v152, v165, v166
  s_waitcnt lgkmcnt(8)
  v_mfma_f32_32x32x16_bf16 v[112:127], v[196:199], v[240:243], v[112:127]
  ds_read_b64_tr_b16 v[196:197], v185 offset:0
  ds_read_b64_tr_b16 v[198:199], v185 offset:2048
  v_exp_f32 v167, v82
  v_exp_f32 v168, v83
  v_add_f32 v163, v163, v167
  v_add_f32 v163, v163, v168
  v_cvt_pk_bf16_f32 v153, v167, v168
  s_waitcnt lgkmcnt(9)
  v_mfma_f32_32x32x16_bf16 v[96:111], v[200:203], v[244:247], v[96:111]
  ds_read_b64_tr_b16 v[200:201], v186 offset:0
  ds_read_b64_tr_b16 v[202:203], v186 offset:2048
  v_exp_f32 v165, v84
  v_exp_f32 v166, v85
  v_add_f32 v163, v163, v165
  v_add_f32 v163, v163, v166
  v_cvt_pk_bf16_f32 v154, v165, v166
  s_waitcnt lgkmcnt(10)
  v_mfma_f32_32x32x16_bf16 v[112:127], v[204:207], v[244:247], v[112:127]
  ds_read_b64_tr_b16 v[204:205], v187 offset:0
  ds_read_b64_tr_b16 v[206:207], v187 offset:2048
  v_exp_f32 v167, v86
  v_exp_f32 v168, v87
  v_add_f32 v163, v163, v167
  v_add_f32 v163, v163, v168
  v_cvt_pk_bf16_f32 v155, v167, v168
  s_waitcnt lgkmcnt(11)
  v_mfma_f32_32x32x16_bf16 v[96:111], v[208:211], v[248:251], v[96:111]
  ds_read_b64_tr_b16 v[208:209], v184 offset:4096
  ds_read_b64_tr_b16 v[210:211], v184 offset:6144
  v_exp_f32 v165, v88
  v_exp_f32 v166, v89
  v_add_f32 v163, v163, v165
  v_add_f32 v163, v163, v166
  v_cvt_pk_bf16_f32 v156, v165, v166
  s_waitcnt lgkmcnt(12)
  v_mfma_f32_32x32x16_bf16 v[112:127], v[212:215], v[248:251], v[112:127]
  ds_read_b64_tr_b16 v[212:213], v185 offset:4096
  ds_read_b64_tr_b16 v[214:215], v185 offset:6144
  v_exp_f32 v167, v90
  v_exp_f32 v168, v91
  v_add_f32 v163, v163, v167
  v_add_f32 v163, v163, v168
  v_cvt_pk_bf16_f32 v157, v167, v168
  s_waitcnt lgkmcnt(13)
  v_mfma_f32_32x32x16_bf16 v[96:111], v[216:219], v[252:255], v[96:111]
  ds_read_b64_tr_b16 v[216:217], v186 offset:4096
  ds_read_b64_tr_b16 v[218:219], v186 offset:6144
  v_exp_f32 v165, v92
  v_exp_f32 v166, v93
  v_add_f32 v163, v163, v165
  v_add_f32 v163, v163, v166
  v_cvt_pk_bf16_f32 v158, v165, v166
  s_waitcnt lgkmcnt(14)
  v_mfma_f32_32x32x16_bf16 v[112:127], v[220:223], v[252:255], v[112:127]
  ds_read_b64_tr_b16 v[220:221], v187 offset:4096
  ds_read_b64_tr_b16 v[222:223], v187 offset:6144
  v_exp_f32 v167, v94
  v_exp_f32 v168, v95
  v_add_f32 v163, v163, v167
  v_add_f32 v163, v163, v168
  v_cvt_pk_bf16_f32 v159, v167, v168
  v_add_f32 v162, v162, v163
  s_setprio 0
  s_waitcnt lgkmcnt(14)
  v_mfma_f32_32x32x16_bf16 v[0:15], v[192:195], v[144:147], 0
  ds_read_b64_tr_b16 v[192:193], v184 offset:8192
  ds_read_b64_tr_b16 v[194:195], v184 offset:10240
  s_waitcnt lgkmcnt(14)
  v_mfma_f32_32x32x16_bf16 v[16:31], v[196:199], v[144:147], 0
  ds_read_b64_tr_b16 v[196:197], v185 offset:8192
  ds_read_b64_tr_b16 v[198:199], v185 offset:10240
  s_waitcnt lgkmcnt(14)
  v_mfma_f32_32x32x16_bf16 v[32:47], v[200:203], v[144:147], 0
  ds_read_b64_tr_b16 v[200:201], v186 offset:8192
  ds_read_b64_tr_b16 v[202:203], v186 offset:10240
  s_waitcnt lgkmcnt(14)
  v_mfma_f32_32x32x16_bf16 v[48:63], v[204:207], v[144:147], 0
  ds_read_b64_tr_b16 v[204:205], v187 offset:8192
  ds_read_b64_tr_b16 v[206:207], v187 offset:10240
  s_waitcnt lgkmcnt(14)
  v_mfma_f32_32x32x16_bf16 v[0:15], v[208:211], v[148:151], v[0:15]
  ds_read_b64_tr_b16 v[208:209], v184 offset:12288
  ds_read_b64_tr_b16 v[210:211], v184 offset:14336
  v_exp_f32 v165, v96
  v_exp_f32 v166, v97
  s_waitcnt lgkmcnt(14)
  v_mfma_f32_32x32x16_bf16 v[16:31], v[212:215], v[148:151], v[16:31]
  ds_read_b64_tr_b16 v[212:213], v185 offset:12288
  ds_read_b64_tr_b16 v[214:215], v185 offset:14336
  v_add_f32 v163, v165, v166
  v_cvt_pk_bf16_f32 v144, v165, v166
  s_waitcnt lgkmcnt(14)
  v_mfma_f32_32x32x16_bf16 v[32:47], v[216:219], v[148:151], v[32:47]
  ds_read_b64_tr_b16 v[216:217], v186 offset:12288
  ds_read_b64_tr_b16 v[218:219], v186 offset:14336
  v_exp_f32 v167, v98
  v_exp_f32 v168, v99
  s_waitcnt lgkmcnt(14)
  v_mfma_f32_32x32x16_bf16 v[48:63], v[220:223], v[148:151], v[48:63]
  ds_read_b64_tr_b16 v[220:221], v187 offset:12288
  ds_read_b64_tr_b16 v[222:223], v187 offset:14336
  v_add_f32 v163, v163, v167
  v_add_f32 v163, v163, v168
  v_cvt_pk_bf16_f32 v145, v167, v168
  s_waitcnt lgkmcnt(14)
  v_mfma_f32_32x32x16_bf16 v[0:15], v[192:195], v[152:155], v[0:15]
  s_waitcnt vmcnt(10)
  s_waitcnt vmcnt(8)
  s_barrier
  ds_read_b128 v[192:195], v176 offset:16384
  v_exp_f32 v165, v100
  v_exp_f32 v166, v101
  s_waitcnt lgkmcnt(13)
  v_mfma_f32_32x32x16_bf16 v[16:31], v[196:199], v[152:155], v[16:31]
  ds_read_b128 v[196:199], v176 offset:24576
  s_add_u32 m0, s49, 49152
  s_nop 0
  buffer_load_dwordx4 v171, s[16:19], s50 offen lds
  buffer_load_dwordx4 v172, s[16:19], s50 offen offset:1024 lds
  s_add_u32 s50, s50, 16384
  v_add_f32 v163, v163, v165
  v_add_f32 v163, v163, v166
  v_cvt_pk_bf16_f32 v146, v165, v166
  s_waitcnt lgkmcnt(12)
  v_mfma_f32_32x32x16_bf16 v[32:47], v[200:203], v[152:155], v[32:47]
  ds_read_b128 v[200:203], v177 offset:16384
  s_add_u32 m0, s49, 98304
  s_nop 0
  buffer_load_dwordx4 v173, s[20:23], s51 offen lds
  buffer_load_dwordx4 v173, s[20:23], s51 offen offset:1024 lds
  s_add_u32 s51, s51, 16384
  v_exp_f32 v167, v102
  v_exp_f32 v168, v103
  s_waitcnt lgkmcnt(11)
  v_mfma_f32_32x32x16_bf16 v[48:63], v[204:207], v[152:155], v[48:63]
  ds_read_b128 v[204:207], v177 offset:24576
  v_add_f32 v163, v163, v167
  v_add_f32 v163, v163, v168
  v_cvt_pk_bf16_f32 v147, v167, v168
  s_waitcnt lgkmcnt(10)
  v_mfma_f32_32x32x16_bf16 v[0:15], v[208:211], v[156:159], v[0:15]
  ds_read_b128 v[208:211], v178 offset:16384
  v_exp_f32 v165, v104
  v_exp_f32 v166, v105
  s_waitcnt lgkmcnt(9)
  v_mfma_f32_32x32x16_bf16 v[16:31], v[212:215], v[156:159], v[16:31]
  ds_read_b128 v[212:215], v178 offset:24576
  v_add_f32 v163, v163, v165
  v_add_f32 v163, v163, v166
  v_cvt_pk_bf16_f32 v148, v165, v166
  s_waitcnt lgkmcnt(8)
  v_mfma_f32_32x32x16_bf16 v[32:47], v[216:219], v[156:159], v[32:47]
  ds_read_b128 v[216:219], v179 offset:16384
  v_exp_f32 v167, v106
  v_exp_f32 v168, v107
  s_waitcnt lgkmcnt(7)
  v_mfma_f32_32x32x16_bf16 v[48:63], v[220:223], v[156:159], v[48:63]
  ds_read_b128 v[220:223], v179 offset:24576
  v_add_f32 v163, v163, v167
  v_add_f32 v163, v163, v168
  v_cvt_pk_bf16_f32 v149, v167, v168
  s_setprio 2
  s_waitcnt lgkmcnt(7)
  v_mfma_f32_32x32x16_bf16 v[64:79], v[192:195], v[224:227], v[128:143]
  ds_read_b128 v[192:195], v180 offset:16384
  v_exp_f32 v165, v108
  v_exp_f32 v166, v109
  s_waitcnt lgkmcnt(7)
  v_mfma_f32_32x32x16_bf16 v[80:95], v[196:199], v[224:227], v[128:143]
  ds_read_b128 v[196:199], v180 offset:24576
  v_add_f32 v163, v163, v165
  v_add_f32 v163, v163, v166
  v_cvt_pk_bf16_f32 v150, v165, v166
  v_exp_f32 v167, v110
  s_waitcnt lgkmcnt(7)
  v_mfma_f32_32x32x16_bf16 v[64:79], v[200:203], v[228:231], v[64:79]
  ds_read_b128 v[200:203], v181 offset:16384
  v_exp_f32 v168, v111
  v_add_f32 v163, v163, v167
  v_add_f32 v163, v163, v168
  s_waitcnt lgkmcnt(7)
  v_mfma_f32_32x32x16_bf16 v[80:95], v[204:207], v[228:231], v[80:95]
  ds_read_b128 v[204:207], v181 offset:24576
  v_cvt_pk_bf16_f32 v151, v167, v168
  v_exp_f32 v165, v112
  v_exp_f32 v166, v113
  s_waitcnt lgkmcnt(7)
  v_mfma_f32_32x32x16_bf16 v[64:79], v[208:211], v[232:235], v[64:79]
  ds_read_b128 v[208:211], v182 offset:16384
  v_add_f32 v163, v163, v165
  v_add_f32 v163, v163, v166
  v_cvt_pk_bf16_f32 v152, v165, v166
  s_waitcnt lgkmcnt(7)
  v_mfma_f32_32x32x16_bf16 v[80:95], v[212:215], v[232:235], v[80:95]
  ds_read_b128 v[212:215], v182 offset:24576
  v_exp_f32 v167, v114
  v_exp_f32 v168, v115
  v_add_f32 v163, v163, v167
  s_waitcnt lgkmcnt(7)
  v_mfma_f32_32x32x16_bf16 v[64:79], v[216:219], v[236:239], v[64:79]
  ds_read_b128 v[216:219], v183 offset:16384
  v_add_f32 v163, v163, v168
  v_cvt_pk_bf16_f32 v153, v167, v168
  v_exp_f32 v165, v116
  s_waitcnt lgkmcnt(7)
  v_mfma_f32_32x32x16_bf16 v[80:95], v[220:223], v[236:239], v[80:95]
  ds_read_b128 v[220:223], v183 offset:24576
  v_exp_f32 v166, v117
  v_add_f32 v163, v163, v165
  v_add_f32 v163, v163, v166
  v_cvt_pk_bf16_f32 v154, v165, v166
  s_waitcnt lgkmcnt(7)
  v_mfma_f32_32x32x16_bf16 v[64:79], v[192:195], v[240:243], v[64:79]
  v_subrev_u32 v184, 81920, v184
  v_subrev_u32 v185, 81920, v185
  v_subrev_u32 v186, 81920, v186
  v_subrev_u32 v187, 81920, v187
  ds_read_b64_tr_b16 v[192:193], v184 offset:0
  ds_read_b64_tr_b16 v[194:195], v184 offset:2048
  v_exp_f32 v167, v118
  v_exp_f32 v168, v119
  s_waitcnt lgkmcnt(8)
  v_mfma_f32_32x32x16_bf16 v[80:95], v[196:199], v[240:243], v[80:95]
  ds_read_b64_tr_b16 v[196:197], v185 offset:0
  ds_read_b64_tr_b16 v[198:199], v185 offset:2048
  v_add_f32 v163, v163, v167
  v_add_f32 v163, v163, v168
  v_cvt_pk_bf16_f32 v155, v167, v168
  v_exp_f32 v165, v120
  s_waitcnt lgkmcnt(9)
  v_mfma_f32_32x32x16_bf16 v[64:79], v[200:203], v[244:247], v[64:79]
  ds_read_b64_tr_b16 v[200:201], v186 offset:0
  ds_read_b64_tr_b16 v[202:203], v186 offset:2048
  v_exp_f32 v166, v121
  v_add_f32 v163, v163, v165
  v_add_f32 v163, v163, v166
  s_waitcnt lgkmcnt(10)
  v_mfma_f32_32x32x16_bf16 v[80:95], v[204:207], v[244:247], v[80:95]
  ds_read_b64_tr_b16 v[204:205], v187 offset:0
  ds_read_b64_tr_b16 v[206:207], v187 offset:2048
  v_cvt_pk_bf16_f32 v156, v165, v166
  v_exp_f32 v167, v122
  v_exp_f32 v168, v123
  s_waitcnt lgkmcnt(11)
  v_mfma_f32_32x32x16_bf16 v[64:79], v[208:211], v[248:251], v[64:79]
  ds_read_b64_tr_b16 v[208:209], v184 offset:4096
  ds_read_b64_tr_b16 v[210:211], v184 offset:6144
  v_add_f32 v163, v163, v167
  v_add_f32 v163, v163, v168
  v_cvt_pk_bf16_f32 v157, v167, v168
  s_waitcnt lgkmcnt(12)
  v_mfma_f32_32x32x16_bf16 v[80:95], v[212:215], v[248:251], v[80:95]
  ds_read_b64_tr_b16 v[212:213], v185 offset:4096
  ds_read_b64_tr_b16 v[214:215], v185 offset:6144
  v_exp_f32 v165, v124
  v_exp_f32 v166, v125
  v_add_f32 v163, v163, v165
  s_waitcnt lgkmcnt(13)
  v_mfma_f32_32x32x16_bf16 v[64:79], v[216:219], v[252:255], v[64:79]
  ds_read_b64_tr_b16 v[216:217], v186 offset:4096
  ds_read_b64_tr_b16 v[218:219], v186 offset:6144
  v_add_f32 v163, v163, v166
  v_cvt_pk_bf16_f32 v158, v165, v166
  v_exp_f32 v167, v126
  s_waitcnt lgkmcnt(14)
  v_mfma_f32_32x32x16_bf16 v[80:95], v[220:223], v[252:255], v[80:95]
  ds_read_b64_tr_b16 v[220:221], v187 offset:4096
  ds_read_b64_tr_b16 v[222:223], v187 offset:6144
  v_exp_f32 v168, v127
  v_add_f32 v163, v163, v167
  v_add_f32 v163, v163, v168
  v_cvt_pk_bf16_f32 v159, v167, v168
  v_cmp_nle_f32 vcc, v163, s4
  s_nop 4
  s_cbranch_vccnz L_fb_1_1
L_ret_1_1:
  v_add_f32 v162, v162, v163
  s_setprio 0
  s_waitcnt lgkmcnt(14)
  v_mfma_f32_32x32x16_bf16 v[0:15], v[192:195], v[144:147], v[0:15]
  ds_read_b64_tr_b16 v[192:193], v184 offset:8192
  ds_read_b64_tr_b16 v[194:195], v184 offset:10240
  v_mov_b32 v166, -1
  v_mov_b32 v167, -1
  v_mov_b32 v168, -1
  v_mov_b32 v169, -1
  s_waitcnt lgkmcnt(14)
  v_mfma_f32_32x32x16_bf16 v[16:31], v[196:199], v[144:147], v[16:31]
  ds_read_b64_tr_b16 v[196:197], v185 offset:8192
  ds_read_b64_tr_b16 v[198:199], v185 offset:10240
  buffer_store_dwordx4 v[166:169], v161, s[88:91], 0 offen offset:0 sc1
  s_waitcnt lgkmcnt(14)
  v_mfma_f32_32x32x16_bf16 v[32:47], v[200:203], v[144:147], v[32:47]
  ds_read_b64_tr_b16 v[200:201], v186 offset:8192
  ds_read_b64_tr_b16 v[202:203], v186 offset:10240
  buffer_store_dwordx4 v[166:169], v161, s[88:91], s3 offen offset:0 sc1
  s_waitcnt lgkmcnt(14)
  v_mfma_f32_32x32x16_bf16 v[48:63], v[204:207], v[144:147], v[48:63]
  ds_read_b64_tr_b16 v[204:205], v187 offset:8192
  ds_read_b64_tr_b16 v[206:207], v187 offset:10240
  s_waitcnt lgkmcnt(14)
  v_mfma_f32_32x32x16_bf16 v[0:15], v[208:211], v[148:151], v[0:15]
  ds_read_b64_tr_b16 v[208:209], v184 offset:12288
  ds_read_b64_tr_b16 v[210:211], v184 offset:14336
  v_exp_f32 v165, v64
  v_exp_f32 v166, v65
  s_waitcnt lgkmcnt(14)
  v_mfma_f32_32x32x16_bf16 v[16:31], v[212:215], v[148:151], v[16:31]
  ds_read_b64_tr_b16 v[212:213], v185 offset:12288
  ds_read_b64_tr_b16 v[214:215], v185 offset:14336
  v_add_f32 v163, v165, v166
  v_cvt_pk_bf16_f32 v144, v165, v166
  s_waitcnt lgkmcnt(14)
  v_mfma_f32_32x32x16_bf16 v[32:47], v[216:219], v[148:151], v[32:47]
  ds_read_b64_tr_b16 v[216:217], v186 offset:12288
  ds_read_b64_tr_b16 v[218:219], v186 offset:14336
  v_exp_f32 v167, v66
  v_exp_f32 v168, v67
  s_waitcnt lgkmcnt(14)
  v_mfma_f32_32x32x16_bf16 v[48:63], v[220:223], v[148:151], v[48:63]
  ds_read_b64_tr_b16 v[220:221], v187 offset:12288
  ds_read_b64_tr_b16 v[222:223], v187 offset:14336
  v_add_f32 v163, v163, v167
  v_add_f32 v163, v163, v168
  v_cvt_pk_bf16_f32 v145, v167, v168
  s_waitcnt lgkmcnt(14)
  v_mfma_f32_32x32x16_bf16 v[0:15], v[192:195], v[152:155], v[0:15]
  s_waitcnt vmcnt(6)
  s_barrier
  ds_read_b128 v[192:195], v176 offset:32768
  v_exp_f32 v165, v68
  v_exp_f32 v166, v69
  s_waitcnt lgkmcnt(13)
  v_mfma_f32_32x32x16_bf16 v[16:31], v[196:199], v[152:155], v[16:31]
  ds_read_b128 v[196:199], v176 offset:40960
  s_add_u32 m0, s49, 0
  s_nop 0
  buffer_load_dwordx4 v171, s[16:19], s50 offen lds
  buffer_load_dwordx4 v172, s[16:19], s50 offen offset:1024 lds
  s_add_u32 s50, s50, 16384
  s_add_u32 m0, s49, 114688
  s_nop 0
  buffer_load_dwordx4 v173, s[20:23], s51 offen lds
  v_add_f32 v163, v163, v165
  v_add_f32 v163, v163, v166
  v_cvt_pk_bf16_f32 v146, v165, v166
  s_waitcnt lgkmcnt(12)
  v_mfma_f32_32x32x16_bf16 v[32:47], v[200:203], v[152:155], v[32:47]
  ds_read_b128 v[200:203], v177 offset:32768
  buffer_load_dwordx4 v173, s[20:23], s51 offen offset:1024 lds
  s_add_u32 s51, s51, 16384
  s_add_u32 m0, s49, 16384
  s_nop 0
  buffer_load_dwordx4 v171, s[16:19], s50 offen lds
  buffer_load_dwordx4 v172, s[16:19], s50 offen offset:1024 lds
  s_add_u32 s50, s50, 16384
  v_exp_f32 v167, v70
  v_exp_f32 v168, v71
  s_waitcnt lgkmcnt(11)
  v_mfma_f32_32x32x16_bf16 v[48:63], v[204:207], v[152:155], v[48:63]
  ds_read_b128 v[204:207], v177 offset:40960
  v_add_f32 v163, v163, v167
  v_add_f32 v163, v163, v168
  v_cvt_pk_bf16_f32 v147, v167, v168
  v_lshl_add_u32 v170, v175, 4, s97
  s_waitcnt lgkmcnt(10)
  v_mfma_f32_32x32x16_bf16 v[0:15], v[208:211], v[156:159], v[0:15]
  ds_read_b128 v[208:211], v178 offset:32768
  v_exp_f32 v165, v72
  v_exp_f32 v166, v73
  s_mov_b32 m0, 131072
  s_waitcnt lgkmcnt(9)
  v_mfma_f32_32x32x16_bf16 v[16:31], v[212:215], v[156:159], v[16:31]
  ds_read_b128 v[212:215], v178 offset:40960
  v_add_f32 v163, v163, v165
  v_add_f32 v163, v163, v166
  v_cvt_pk_bf16_f32 v148, v165, v166
  buffer_load_dwordx4 v170, s[32:35], 0 offen offset:0 lds
  buffer_load_dwordx4 v170, s[32:35], 0 offen offset:1024 lds
  s_waitcnt lgkmcnt(8)
  v_mfma_f32_32x32x16_bf16 v[32:47], v[216:219], v[156:159], v[32:47]
  ds_read_b128 v[216:219], v179 offset:32768
  v_exp_f32 v167, v74
  v_exp_f32 v168, v75
  buffer_load_dwordx4 v170, s[32:35], 0 offen offset:2048 lds
  s_waitcnt lgkmcnt(7)
  v_mfma_f32_32x32x16_bf16 v[48:63], v[220:223], v[156:159], v[48:63]
  ds_read_b128 v[220:223], v179 offset:40960
  v_add_f32 v163, v163, v167
  v_add_f32 v163, v163, v168
  v_cvt_pk_bf16_f32 v149, v167, v168
  s_add_u32 s97, s97, 3072
  s_setprio 2
  s_waitcnt lgkmcnt(7)
  v_mfma_f32_32x32x16_bf16 v[96:111], v[192:195], v[224:227], v[128:143]
  ds_read_b128 v[192:195], v180 offset:32768
  v_exp_f32 v165, v76
  v_exp_f32 v166, v77
  s_waitcnt lgkmcnt(7)
  v_mfma_f32_32x32x16_bf16 v[112:127], v[196:199], v[224:227], v[128:143]
  ds_read_b128 v[196:199], v180 offset:40960
  v_add_f32 v163, v163, v165
  v_add_f32 v163, v163, v166
  v_cvt_pk_bf16_f32 v150, v165, v166
  v_exp_f32 v167, v78
  s_waitcnt lgkmcnt(7)
  v_mfma_f32_32x32x16_bf16 v[96:111], v[200:203], v[228:231], v[96:111]
  ds_read_b128 v[200:203], v181 offset:32768
  v_exp_f32 v168, v79
  v_add_f32 v163, v163, v167
  v_add_f32 v163, v163, v168
  s_waitcnt lgkmcnt(7)
  v_mfma_f32_32x32x16_bf16 v[112:127], v[204:207], v[228:231], v[112:127]
  ds_read_b128 v[204:207], v181 offset:40960
  v_cvt_pk_bf16_f32 v151, v167, v168
  v_exp_f32 v165, v80
  v_exp_f32 v166, v81
  s_waitcnt lgkmcnt(7)
  v_mfma_f32_32x32x16_bf16 v[96:111], v[208:211], v[232:235], v[96:111]
  ds_read_b128 v[208:211], v182 offset:32768
  v_add_f32 v163, v163, v165
  v_add_f32 v163, v163, v166
  v_cvt_pk_bf16_f32 v152, v165, v166
  s_waitcnt lgkmcnt(7)
  v_mfma_f32_32x32x16_bf16 v[112:127], v[212:215], v[232:235], v[112:127]
  ds_read_b128 v[212:215], v182 offset:40960
  v_exp_f32 v167, v82
  v_exp_f32 v168, v83
  v_add_f32 v163, v163, v167
  s_waitcnt lgkmcnt(7)
  v_mfma_f32_32x32x16_bf16 v[96:111], v[216:219], v[236:239], v[96:111]
  ds_read_b128 v[216:219], v183 offset:32768
  v_add_f32 v163, v163, v168
  v_cvt_pk_bf16_f32 v153, v167, v168
  v_exp_f32 v165, v84
  s_waitcnt lgkmcnt(7)
  v_mfma_f32_32x32x16_bf16 v[112:127], v[220:223], v[236:239], v[112:127]
  ds_read_b128 v[220:223], v183 offset:40960
  v_exp_f32 v166, v85
  v_add_f32 v163, v163, v165
  v_add_f32 v163, v163, v166
  v_cvt_pk_bf16_f32 v154, v165, v166
  s_waitcnt lgkmcnt(7)
  v_mfma_f32_32x32x16_bf16 v[96:111], v[192:195], v[240:243], v[96:111]
  ds_read_b64_tr_b16 v[192:193], v184 offset:16384
  ds_read_b64_tr_b16 v[194:195], v184 offset:18432
  v_exp_f32 v167, v86
  v_exp_f32 v168, v87
  s_waitcnt lgkmcnt(8)
  v_mfma_f32_32x32x16_bf16 v[112:127], v[196:199], v[240:243], v[112:127]
  ds_read_b64_tr_b16 v[196:197], v185 offset:16384
  ds_read_b64_tr_b16 v[198:199], v185 offset:18432
  v_add_f32 v163, v163, v167
  v_add_f32 v163, v163, v168
  v_cvt_pk_bf16_f32 v155, v167, v168
  v_exp_f32 v165, v88
  s_waitcnt lgkmcnt(9)
  v_mfma_f32_32x32x16_bf16 v[96:111], v[200:203], v[244:247], v[96:111]
  ds_read_b64_tr_b16 v[200:201], v186 offset:16384
  ds_read_b64_tr_b16 v[202:203], v186 offset:18432
  v_exp_f32 v166, v89
  v_add_f32 v163, v163, v165
  v_add_f32 v163, v163, v166
  s_waitcnt lgkmcnt(10)
  v_mfma_f32_32x32x16_bf16 v[112:127], v[204:207], v[244:247], v[112:127]
  ds_read_b64_tr_b16 v[204:205], v187 offset:16384
  ds_read_b64_tr_b16 v[206:207], v187 offset:18432
  v_cvt_pk_bf16_f32 v156, v165, v166
  v_exp_f32 v167, v90
  v_exp_f32 v168, v91
  s_waitcnt lgkmcnt(11)
  v_mfma_f32_32x32x16_bf16 v[96:111], v[208:211], v[248:251], v[96:111]
  ds_read_b64_tr_b16 v[208:209], v184 offset:20480
  ds_read_b64_tr_b16 v[210:211], v184 offset:22528
  v_add_f32 v163, v163, v167
  v_add_f32 v163, v163, v168
  v_cvt_pk_bf16_f32 v157, v167, v168
  s_waitcnt lgkmcnt(12)
  v_mfma_f32_32x32x16_bf16 v[112:127], v[212:215], v[248:251], v[112:127]
  ds_read_b64_tr_b16 v[212:213], v185 offset:20480
  ds_read_b64_tr_b16 v[214:215], v185 offset:22528
  v_exp_f32 v165, v92
  v_exp_f32 v166, v93
  v_add_f32 v163, v163, v165
  s_waitcnt lgkmcnt(13)
  v_mfma_f32_32x32x16_bf16 v[96:111], v[216:219], v[252:255], v[96:111]
  ds_read_b64_tr_b16 v[216:217], v186 offset:20480
  ds_read_b64_tr_b16 v[218:219], v186 offset:22528
  v_add_f32 v163, v163, v166
  v_cvt_pk_bf16_f32 v158, v165, v166
  v_exp_f32 v167, v94
  s_waitcnt lgkmcnt(14)
  v_mfma_f32_32x32x16_bf16 v[112:127], v[220:223], v[252:255], v[112:127]
  ds_read_b64_tr_b16 v[220:221], v187 offset:20480
  ds_read_b64_tr_b16 v[222:223], v187 offset:22528
  v_exp_f32 v168, v95
  v_add_f32 v163, v163, v167
  v_add_f32 v163, v163, v168
  v_cvt_pk_bf16_f32 v159, v167, v168
  v_cmp_nle_f32 vcc, v163, s4
  s_nop 4
  s_cbranch_vccnz L_fb_1_2
L_ret_1_2:
  v_add_f32 v162, v162, v163
  s_setprio 0
  s_waitcnt lgkmcnt(14)
  v_mfma_f32_32x32x16_bf16 v[0:15], v[192:195], v[144:147], v[0:15]
  ds_read_b64_tr_b16 v[192:193], v184 offset:24576
  ds_read_b64_tr_b16 v[194:195], v184 offset:26624
  v_mov_b32 v166, -1
  v_mov_b32 v167, -1
  v_mov_b32 v168, -1
  v_mov_b32 v169, -1
  s_waitcnt lgkmcnt(14)
  v_mfma_f32_32x32x16_bf16 v[16:31], v[196:199], v[144:147], v[16:31]
  ds_read_b64_tr_b16 v[196:197], v185 offset:24576
  ds_read_b64_tr_b16 v[198:199], v185 offset:26624
  buffer_store_dwordx4 v[166:169], v161, s[88:91], 0 offen offset:256 sc1
  s_waitcnt lgkmcnt(14)
  v_mfma_f32_32x32x16_bf16 v[32:47], v[200:203], v[144:147], v[32:47]
  ds_read_b64_tr_b16 v[200:201], v186 offset:24576
  ds_read_b64_tr_b16 v[202:203], v186 offset:26624
  buffer_store_dwordx4 v[166:169], v161, s[88:91], s3 offen offset:256 sc1
  s_waitcnt lgkmcnt(14)
  v_mfma_f32_32x32x16_bf16 v[48:63], v[204:207], v[144:147], v[48:63]
  ds_read_b64_tr_b16 v[204:205], v187 offset:24576
  ds_read_b64_tr_b16 v[206:207], v187 offset:26624
  s_waitcnt lgkmcnt(14)
  v_mfma_f32_32x32x16_bf16 v[0:15], v[208:211], v[148:151], v[0:15]
  ds_read_b64_tr_b16 v[208:209], v184 offset:28672
  ds_read_b64_tr_b16 v[210:211], v184 offset:30720
  v_exp_f32 v165, v96
  v_exp_f32 v166, v97
  s_waitcnt lgkmcnt(14)
  v_mfma_f32_32x32x16_bf16 v[16:31], v[212:215], v[148:151], v[16:31]
  ds_read_b64_tr_b16 v[212:213], v185 offset:28672
  ds_read_b64_tr_b16 v[214:215], v185 offset:30720
  v_add_f32 v163, v165, v166
  v_cvt_pk_bf16_f32 v144, v165, v166
  s_waitcnt lgkmcnt(14)
  v_mfma_f32_32x32x16_bf16 v[32:47], v[216:219], v[148:151], v[32:47]
  ds_read_b64_tr_b16 v[216:217], v186 offset:28672
  ds_read_b64_tr_b16 v[218:219], v186 offset:30720
  v_exp_f32 v167, v98
  v_exp_f32 v168, v99
  s_waitcnt lgkmcnt(14)
  v_mfma_f32_32x32x16_bf16 v[48:63], v[220:223], v[148:151], v[48:63]
  ds_read_b64_tr_b16 v[220:221], v187 offset:28672
  ds_read_b64_tr_b16 v[222:223], v187 offset:30720
  v_add_f32 v163, v163, v167
  v_add_f32 v163, v163, v168
  v_cvt_pk_bf16_f32 v145, v167, v168
  s_waitcnt lgkmcnt(14)
  v_mfma_f32_32x32x16_bf16 v[0:15], v[192:195], v[152:155], v[0:15]
  s_waitcnt vmcnt(15)
  s_waitcnt vmcnt(13)
  s_barrier
  ds_read_b128 v[192:195], v176 offset:49152
  v_exp_f32 v165, v100
  v_exp_f32 v166, v101
  s_waitcnt lgkmcnt(13)
  v_mfma_f32_32x32x16_bf16 v[16:31], v[196:199], v[152:155], v[16:31]
  ds_read_b128 v[196:199], v176 offset:57344
  s_add_u32 m0, s49, 32768
  s_nop 0
  buffer_load_dwordx4 v171, s[16:19], s50 offen lds
  buffer_load_dwordx4 v172, s[16:19], s50 offen offset:1024 lds
  s_add_u32 s50, s50, 16384
  s_add_u32 m0, s49, 65536
  s_nop 0
  buffer_load_dwordx4 v173, s[20:23], s51 offen lds
  buffer_load_dwordx4 v173, s[20:23], s51 offen offset:1024 lds
  s_add_u32 s51, s51, 16384
  v_add_f32 v163, v163, v165
  v_add_f32 v163, v163, v166
  v_cvt_pk_bf16_f32 v146, v165, v166
  s_waitcnt lgkmcnt(12)
  v_mfma_f32_32x32x16_bf16 v[32:47], v[200:203], v[152:155], v[32:47]
  ds_read_b128 v[200:203], v177 offset:49152
  s_mul_i32 s64, s5, 14
  s_min_u32 s64, s64, 40
  v_exp_f32 v167, v102
  v_exp_f32 v168, v103
  s_waitcnt lgkmcnt(11)
  v_mfma_f32_32x32x16_bf16 v[48:63], v[204:207], v[152:155], v[48:63]
  ds_read_b128 v[204:207], v177 offset:57344
  s_mul_i32 s43, s64, 40960
  s_add_u32 s64, s64, 128
  v_add_f32 v163, v163, v167
  v_add_f32 v163, v163, v168
  v_cvt_pk_bf16_f32 v147, v167, v168
  v_lshl_add_u32 v170, v175, 4, s96
  s_waitcnt lgkmcnt(10)
  v_mfma_f32_32x32x16_bf16 v[0:15], v[208:211], v[156:159], v[0:15]
  ds_read_b128 v[208:211], v178 offset:49152
  s_lshl_b32 s44, s64, 13
  v_exp_f32 v165, v104
  v_exp_f32 v166, v105
  s_mov_b32 m0, 131072
  s_waitcnt lgkmcnt(9)
  v_mfma_f32_32x32x16_bf16 v[16:31], v[212:215], v[156:159], v[16:31]
  ds_read_b128 v[212:215], v178 offset:57344
  v_lshlrev_b32 v172, 4, v175
  v_add_u32 v172, s49, v172
  v_add_f32 v163, v163, v165
  v_add_f32 v163, v163, v166
  v_cvt_pk_bf16_f32 v148, v165, v166
  buffer_load_dwordx4 v170, s[36:39], 0 offen offset:0 lds
  s_waitcnt lgkmcnt(8)
  v_mfma_f32_32x32x16_bf16 v[32:47], v[216:219], v[156:159], v[32:47]
  ds_read_b128 v[216:219], v179 offset:49152
  s_and_b32 s64, s40, 3
  s_mul_i32 s45, s64, 5120
  v_exp_f32 v167, v106
  v_exp_f32 v168, v107
  buffer_load_dwordx4 v170, s[36:39], 0 offen offset:1024 lds
  s_waitcnt lgkmcnt(7)
  v_mfma_f32_32x32x16_bf16 v[48:63], v[220:223], v[156:159], v[48:63]
  ds_read_b128 v[220:223], v179 offset:57344
  v_and_b32 v164, 31, v175
  v_lshlrev_b32 v164, 2, v164
  v_add_f32 v163, v163, v167
  v_add_f32 v163, v163, v168
  v_cvt_pk_bf16_f32 v149, v167, v168
  s_add_u32 s96, s96, 2048
  s_setprio 2
  s_waitcnt lgkmcnt(7)
  v_mfma_f32_32x32x16_bf16 v[64:79], v[192:195], v[224:227], v[128:143]
  ds_read_b128 v[192:195], v180 offset:49152
  v_exp_f32 v165, v108
  v_exp_f32 v166, v109
  s_waitcnt lgkmcnt(7)
  v_mfma_f32_32x32x16_bf16 v[80:95], v[196:199], v[224:227], v[128:143]
  ds_read_b128 v[196:199], v180 offset:57344
  v_add_f32 v163, v163, v165
  v_add_f32 v163, v163, v166
  v_cvt_pk_bf16_f32 v150, v165, v166
  v_exp_f32 v167, v110
  s_waitcnt lgkmcnt(7)
  v_mfma_f32_32x32x16_bf16 v[64:79], v[200:203], v[228:231], v[64:79]
  ds_read_b128 v[200:203], v181 offset:49152
  v_exp_f32 v168, v111
  v_add_f32 v163, v163, v167
  v_add_f32 v163, v163, v168
  s_waitcnt lgkmcnt(7)
  v_mfma_f32_32x32x16_bf16 v[80:95], v[204:207], v[228:231], v[80:95]
  ds_read_b128 v[204:207], v181 offset:57344
  v_cvt_pk_bf16_f32 v151, v167, v168
  v_exp_f32 v165, v112
  v_exp_f32 v166, v113
  s_waitcnt lgkmcnt(7)
  v_mfma_f32_32x32x16_bf16 v[64:79], v[208:211], v[232:235], v[64:79]
  ds_read_b128 v[208:211], v182 offset:49152
  v_add_f32 v163, v163, v165
  v_add_f32 v163, v163, v166
  v_cvt_pk_bf16_f32 v152, v165, v166
  s_waitcnt lgkmcnt(7)
  v_mfma_f32_32x32x16_bf16 v[80:95], v[212:215], v[232:235], v[80:95]
  ds_read_b128 v[212:215], v182 offset:57344
  v_exp_f32 v167, v114
  v_exp_f32 v168, v115
  v_add_f32 v163, v163, v167
  s_waitcnt lgkmcnt(7)
  v_mfma_f32_32x32x16_bf16 v[64:79], v[216:219], v[236:239], v[64:79]
  ds_read_b128 v[216:219], v183 offset:49152
  v_add_f32 v163, v163, v168
  v_cvt_pk_bf16_f32 v153, v167, v168
  v_exp_f32 v165, v116
  s_waitcnt lgkmcnt(7)
  v_mfma_f32_32x32x16_bf16 v[80:95], v[220:223], v[236:239], v[80:95]
  ds_read_b128 v[220:223], v183 offset:57344
  v_exp_f32 v166, v117
  v_add_f32 v163, v163, v165
  v_add_f32 v163, v163, v166
  v_cvt_pk_bf16_f32 v154, v165, v166
  s_waitcnt lgkmcnt(7)
  v_mfma_f32_32x32x16_bf16 v[64:79], v[192:195], v[240:243], v[64:79]
  ds_read_b64_tr_b16 v[192:193], v184 offset:32768
  ds_read_b64_tr_b16 v[194:195], v184 offset:34816
  v_exp_f32 v167, v118
  v_exp_f32 v168, v119
  s_waitcnt lgkmcnt(8)
  v_mfma_f32_32x32x16_bf16 v[80:95], v[196:199], v[240:243], v[80:95]
  ds_read_b64_tr_b16 v[196:197], v185 offset:32768
  ds_read_b64_tr_b16 v[198:199], v185 offset:34816
  v_add_f32 v163, v163, v167
  v_add_f32 v163, v163, v168
  v_cvt_pk_bf16_f32 v155, v167, v168
  v_exp_f32 v165, v120
  s_waitcnt lgkmcnt(9)
  v_mfma_f32_32x32x16_bf16 v[64:79], v[200:203], v[244:247], v[64:79]
  ds_read_b64_tr_b16 v[200:201], v186 offset:32768
  ds_read_b64_tr_b16 v[202:203], v186 offset:34816
  v_exp_f32 v166, v121
  v_add_f32 v163, v163, v165
  v_add_f32 v163, v163, v166
  s_waitcnt lgkmcnt(10)
  v_mfma_f32_32x32x16_bf16 v[80:95], v[204:207], v[244:247], v[80:95]
  ds_read_b64_tr_b16 v[204:205], v187 offset:32768
  ds_read_b64_tr_b16 v[206:207], v187 offset:34816
  v_cvt_pk_bf16_f32 v156, v165, v166
  v_exp_f32 v167, v122
  v_exp_f32 v168, v123
  s_waitcnt lgkmcnt(11)
  v_mfma_f32_32x32x16_bf16 v[64:79], v[208:211], v[248:251], v[64:79]
  ds_read_b64_tr_b16 v[208:209], v184 offset:36864
  ds_read_b64_tr_b16 v[210:211], v184 offset:38912
  v_add_f32 v163, v163, v167
  v_add_f32 v163, v163, v168
  v_cvt_pk_bf16_f32 v157, v167, v168
  s_waitcnt lgkmcnt(12)
  v_mfma_f32_32x32x16_bf16 v[80:95], v[212:215], v[248:251], v[80:95]
  ds_read_b64_tr_b16 v[212:213], v185 offset:36864
  ds_read_b64_tr_b16 v[214:215], v185 offset:38912
  v_exp_f32 v165, v124
  v_exp_f32 v166, v125
  v_add_f32 v163, v163, v165
  s_waitcnt lgkmcnt(13)
  v_mfma_f32_32x32x16_bf16 v[64:79], v[216:219], v[252:255], v[64:79]
  ds_read_b64_tr_b16 v[216:217], v186 offset:36864
  ds_read_b64_tr_b16 v[218:219], v186 offset:38912
  v_add_f32 v163, v163, v166
  v_cvt_pk_bf16_f32 v158, v165, v166
  v_exp_f32 v167, v126
  s_waitcnt lgkmcnt(14)
  v_mfma_f32_32x32x16_bf16 v[80:95], v[220:223], v[252:255], v[80:95]
  ds_read_b64_tr_b16 v[220:221], v187 offset:36864
  ds_read_b64_tr_b16 v[222:223], v187 offset:38912
  v_exp_f32 v168, v127
  v_add_f32 v163, v163, v167
  v_add_f32 v163, v163, v168
  v_cvt_pk_bf16_f32 v159, v167, v168
  v_cmp_nle_f32 vcc, v163, s4
  s_nop 4
  s_cbranch_vccnz L_fb_1_3
L_ret_1_3:
  v_add_f32 v162, v162, v163
  s_setprio 0
  s_waitcnt lgkmcnt(14)
  v_mfma_f32_32x32x16_bf16 v[0:15], v[192:195], v[144:147], v[0:15]
  ds_read_b64_tr_b16 v[192:193], v184 offset:40960
  ds_read_b64_tr_b16 v[194:195], v184 offset:43008
  v_mov_b32 v166, -1
  v_mov_b32 v167, -1
  v_mov_b32 v168, -1
  v_mov_b32 v169, -1
  s_waitcnt lgkmcnt(14)
  v_mfma_f32_32x32x16_bf16 v[16:31], v[196:199], v[144:147], v[16:31]
  ds_read_b64_tr_b16 v[196:197], v185 offset:40960
  ds_read_b64_tr_b16 v[198:199], v185 offset:43008
  buffer_store_dwordx4 v[166:169], v161, s[88:91], 0 offen offset:512 sc1
  s_waitcnt lgkmcnt(14)
  v_mfma_f32_32x32x16_bf16 v[32:47], v[200:203], v[144:147], v[32:47]
  ds_read_b64_tr_b16 v[200:201], v186 offset:40960
  ds_read_b64_tr_b16 v[202:203], v186 offset:43008
  buffer_store_dwordx4 v[166:169], v161, s[88:91], s3 offen offset:512 sc1
  s_waitcnt lgkmcnt(14)
  v_mfma_f32_32x32x16_bf16 v[48:63], v[204:207], v[144:147], v[48:63]
  ds_read_b64_tr_b16 v[204:205], v187 offset:40960
  ds_read_b64_tr_b16 v[206:207], v187 offset:43008
  s_waitcnt lgkmcnt(14)
  v_mfma_f32_32x32x16_bf16 v[0:15], v[208:211], v[148:151], v[0:15]
  ds_read_b64_tr_b16 v[208:209], v184 offset:45056
  ds_read_b64_tr_b16 v[210:211], v184 offset:47104
  v_exp_f32 v165, v64
  v_exp_f32 v166, v65
  s_waitcnt lgkmcnt(14)
  v_mfma_f32_32x32x16_bf16 v[16:31], v[212:215], v[148:151], v[16:31]
  ds_read_b64_tr_b16 v[212:213], v185 offset:45056
  ds_read_b64_tr_b16 v[214:215], v185 offset:47104
  v_add_f32 v163, v165, v166
  v_cvt_pk_bf16_f32 v144, v165, v166
  s_waitcnt lgkmcnt(14)
  v_mfma_f32_32x32x16_bf16 v[32:47], v[216:219], v[148:151], v[32:47]
  ds_read_b64_tr_b16 v[216:217], v186 offset:45056
  ds_read_b64_tr_b16 v[218:219], v186 offset:47104
  v_exp_f32 v167, v66
  v_exp_f32 v168, v67
  s_waitcnt lgkmcnt(14)
  v_mfma_f32_32x32x16_bf16 v[48:63], v[220:223], v[148:151], v[48:63]
  ds_read_b64_tr_b16 v[220:221], v187 offset:45056
  ds_read_b64_tr_b16 v[222:223], v187 offset:47104
  v_add_f32 v163, v163, v167
  v_add_f32 v163, v163, v168
  v_cvt_pk_bf16_f32 v145, v167, v168
  s_waitcnt lgkmcnt(14)
  v_mfma_f32_32x32x16_bf16 v[0:15], v[192:195], v[152:155], v[0:15]
  s_waitcnt vmcnt(17)
  s_waitcnt vmcnt(15)
  s_barrier
  ds_read_b128 v[192:195], v176 offset:0
  v_exp_f32 v165, v68
  v_exp_f32 v166, v69
  s_waitcnt lgkmcnt(13)
  v_mfma_f32_32x32x16_bf16 v[16:31], v[196:199], v[152:155], v[16:31]
  ds_read_b128 v[196:199], v176 offset:8192
  buffer_load_dword v171, v164, s[68:71], 0 offen sc1
  s_add_u32 m0, s49, 81920
  s_nop 0
  buffer_load_dwordx4 v173, s[20:23], s51 offen lds
  buffer_load_dwordx4 v173, s[20:23], s51 offen offset:1024 lds
  s_add_u32 s51, s51, 16384
  v_add_f32 v163, v163, v165
  v_add_f32 v163, v163, v166
  v_cvt_pk_bf16_f32 v146, v165, v166
  s_waitcnt lgkmcnt(12)
  v_mfma_f32_32x32x16_bf16 v[32:47], v[200:203], v[152:155], v[32:47]
  ds_read_b128 v[200:203], v177 offset:0
  v_exp_f32 v167, v70
  v_exp_f32 v168, v71
  s_waitcnt lgkmcnt(11)
  v_mfma_f32_32x32x16_bf16 v[48:63], v[204:207], v[152:155], v[48:63]
  ds_read_b128 v[204:207], v177 offset:8192
  v_add_f32 v163, v163, v167
  v_add_f32 v163, v163, v168
  v_cvt_pk_bf16_f32 v147, v167, v168
  v_lshl_add_u32 v170, v175, 4, s96
  s_waitcnt lgkmcnt(10)
  v_mfma_f32_32x32x16_bf16 v[0:15], v[208:211], v[156:159], v[0:15]
  ds_read_b128 v[208:211], v178 offset:0
  v_exp_f32 v165, v72
  v_exp_f32 v166, v73
  s_mov_b32 m0, 49152
  s_waitcnt lgkmcnt(9)
  v_mfma_f32_32x32x16_bf16 v[16:31], v[212:215], v[156:159], v[16:31]
  ds_read_b128 v[212:215], v178 offset:8192
  v_add_f32 v163, v163, v165
  v_add_f32 v163, v163, v166
  v_cvt_pk_bf16_f32 v148, v165, v166
  buffer_load_dwordx4 v170, s[36:39], 0 offen offset:0 lds
  s_waitcnt lgkmcnt(8)
  v_mfma_f32_32x32x16_bf16 v[32:47], v[216:219], v[156:159], v[32:47]
  ds_read_b128 v[216:219], v179 offset:0
  v_exp_f32 v167, v74
  v_exp_f32 v168, v75
  buffer_load_dwordx4 v170, s[36:39], 0 offen offset:1024 lds
  s_waitcnt lgkmcnt(7)
  v_mfma_f32_32x32x16_bf16 v[48:63], v[220:223], v[156:159], v[48:63]
  ds_read_b128 v[220:223], v179 offset:8192
  v_add_f32 v163, v163, v167
  v_add_f32 v163, v163, v168
  v_cvt_pk_bf16_f32 v149, v167, v168
  s_add_u32 s96, s96, 2048
  s_setprio 2
  s_waitcnt lgkmcnt(7)
  v_mfma_f32_32x32x16_bf16 v[96:111], v[192:195], v[224:227], v[128:143]
  ds_read_b128 v[192:195], v180 offset:0
  v_exp_f32 v165, v76
  v_exp_f32 v166, v77
  s_waitcnt lgkmcnt(7)
  v_mfma_f32_32x32x16_bf16 v[112:127], v[196:199], v[224:227], v[128:143]
  ds_read_b128 v[196:199], v180 offset:8192
  v_add_f32 v163, v163, v165
  v_add_f32 v163, v163, v166
  v_cvt_pk_bf16_f32 v150, v165, v166
  v_exp_f32 v167, v78
  s_waitcnt lgkmcnt(7)
  v_mfma_f32_32x32x16_bf16 v[96:111], v[200:203], v[228:231], v[96:111]
  ds_read_b128 v[200:203], v181 offset:0
  v_exp_f32 v168, v79
  v_add_f32 v163, v163, v167
  v_add_f32 v163, v163, v168
  s_waitcnt lgkmcnt(7)
  v_mfma_f32_32x32x16_bf16 v[112:127], v[204:207], v[228:231], v[112:127]
  ds_read_b128 v[204:207], v181 offset:8192
  v_cvt_pk_bf16_f32 v151, v167, v168
  v_exp_f32 v165, v80
  v_exp_f32 v166, v81
  s_waitcnt lgkmcnt(7)
  v_mfma_f32_32x32x16_bf16 v[96:111], v[208:211], v[232:235], v[96:111]
  ds_read_b128 v[208:211], v182 offset:0
  v_add_f32 v163, v163, v165
  v_add_f32 v163, v163, v166
  v_cvt_pk_bf16_f32 v152, v165, v166
  s_waitcnt lgkmcnt(7)
  v_mfma_f32_32x32x16_bf16 v[112:127], v[212:215], v[232:235], v[112:127]
  ds_read_b128 v[212:215], v182 offset:8192
  v_exp_f32 v167, v82
  v_exp_f32 v168, v83
  v_add_f32 v163, v163, v167
  s_waitcnt lgkmcnt(7)
  v_mfma_f32_32x32x16_bf16 v[96:111], v[216:219], v[236:239], v[96:111]
  ds_read_b128 v[216:219], v183 offset:0
  v_add_f32 v163, v163, v168
  v_cvt_pk_bf16_f32 v153, v167, v168
  v_exp_f32 v165, v84
  s_waitcnt lgkmcnt(7)
  v_mfma_f32_32x32x16_bf16 v[112:127], v[220:223], v[236:239], v[112:127]
  ds_read_b128 v[220:223], v183 offset:8192
  v_exp_f32 v166, v85
  v_add_f32 v163, v163, v165
  v_add_f32 v163, v163, v166
  v_cvt_pk_bf16_f32 v154, v165, v166
  s_waitcnt lgkmcnt(7)
  v_mfma_f32_32x32x16_bf16 v[96:111], v[192:195], v[240:243], v[96:111]
  ds_read_b64_tr_b16 v[192:193], v184 offset:49152
  ds_read_b64_tr_b16 v[194:195], v184 offset:51200
  v_exp_f32 v167, v86
  v_exp_f32 v168, v87
  s_waitcnt lgkmcnt(8)
  v_mfma_f32_32x32x16_bf16 v[112:127], v[196:199], v[240:243], v[112:127]
  ds_read_b64_tr_b16 v[196:197], v185 offset:49152
  ds_read_b64_tr_b16 v[198:199], v185 offset:51200
  v_add_f32 v163, v163, v167
  v_add_f32 v163, v163, v168
  v_cvt_pk_bf16_f32 v155, v167, v168
  v_exp_f32 v165, v88
  s_waitcnt lgkmcnt(9)
  v_mfma_f32_32x32x16_bf16 v[96:111], v[200:203], v[244:247], v[96:111]
  ds_read_b64_tr_b16 v[200:201], v186 offset:49152
  ds_read_b64_tr_b16 v[202:203], v186 offset:51200
  v_exp_f32 v166, v89
  v_add_f32 v163, v163, v165
  v_add_f32 v163, v163, v166
  s_waitcnt lgkmcnt(10)
  v_mfma_f32_32x32x16_bf16 v[112:127], v[204:207], v[244:247], v[112:127]
  ds_read_b64_tr_b16 v[204:205], v187 offset:49152
  ds_read_b64_tr_b16 v[206:207], v187 offset:51200
  v_cvt_pk_bf16_f32 v156, v165, v166
  v_exp_f32 v167, v90
  v_exp_f32 v168, v91
  s_waitcnt lgkmcnt(11)
  v_mfma_f32_32x32x16_bf16 v[96:111], v[208:211], v[248:251], v[96:111]
  ds_read_b64_tr_b16 v[208:209], v184 offset:53248
  ds_read_b64_tr_b16 v[210:211], v184 offset:55296
  v_add_f32 v163, v163, v167
  v_add_f32 v163, v163, v168
  v_cvt_pk_bf16_f32 v157, v167, v168
  s_waitcnt lgkmcnt(12)
  v_mfma_f32_32x32x16_bf16 v[112:127], v[212:215], v[248:251], v[112:127]
  ds_read_b64_tr_b16 v[212:213], v185 offset:53248
  ds_read_b64_tr_b16 v[214:215], v185 offset:55296
  v_exp_f32 v165, v92
  v_exp_f32 v166, v93
  v_add_f32 v163, v163, v165
  s_waitcnt lgkmcnt(13)
  v_mfma_f32_32x32x16_bf16 v[96:111], v[216:219], v[252:255], v[96:111]
  ds_read_b64_tr_b16 v[216:217], v186 offset:53248
  ds_read_b64_tr_b16 v[218:219], v186 offset:55296
  v_add_f32 v163, v163, v166
  v_cvt_pk_bf16_f32 v158, v165, v166
  v_exp_f32 v167, v94
  s_waitcnt lgkmcnt(14)
  v_mfma_f32_32x32x16_bf16 v[112:127], v[220:223], v[252:255], v[112:127]
  ds_read_b64_tr_b16 v[220:221], v187 offset:53248
  ds_read_b64_tr_b16 v[222:223], v187 offset:55296
  v_exp_f32 v168, v95
  v_add_f32 v163, v163, v167
  v_add_f32 v163, v163, v168
  v_cvt_pk_bf16_f32 v159, v167, v168
  v_cmp_nle_f32 vcc, v163, s4
  s_nop 4
  s_cbranch_vccnz L_fb_1_4
L_ret_1_4:
  v_add_f32 v162, v162, v163
  s_setprio 0
  s_waitcnt lgkmcnt(14)
  v_mfma_f32_32x32x16_bf16 v[0:15], v[192:195], v[144:147], v[0:15]
  ds_read_b64_tr_b16 v[192:193], v184 offset:57344
  ds_read_b64_tr_b16 v[194:195], v184 offset:59392
  v_mov_b32 v166, -1
  v_mov_b32 v167, -1
  v_mov_b32 v168, -1
  v_mov_b32 v169, -1
  s_waitcnt lgkmcnt(14)
  v_mfma_f32_32x32x16_bf16 v[16:31], v[196:199], v[144:147], v[16:31]
  ds_read_b64_tr_b16 v[196:197], v185 offset:57344
  ds_read_b64_tr_b16 v[198:199], v185 offset:59392
  buffer_store_dwordx4 v[166:169], v161, s[88:91], 0 offen offset:768 sc1
  s_waitcnt lgkmcnt(14)
  v_mfma_f32_32x32x16_bf16 v[32:47], v[200:203], v[144:147], v[32:47]
  ds_read_b64_tr_b16 v[200:201], v186 offset:57344
  ds_read_b64_tr_b16 v[202:203], v186 offset:59392
  buffer_store_dwordx4 v[166:169], v161, s[88:91], s3 offen offset:768 sc1
  s_waitcnt lgkmcnt(14)
  v_mfma_f32_32x32x16_bf16 v[48:63], v[204:207], v[144:147], v[48:63]
  ds_read_b64_tr_b16 v[204:205], v187 offset:57344
  ds_read_b64_tr_b16 v[206:207], v187 offset:59392
  s_waitcnt lgkmcnt(14)
  v_mfma_f32_32x32x16_bf16 v[0:15], v[208:211], v[148:151], v[0:15]
  ds_read_b64_tr_b16 v[208:209], v184 offset:61440
  ds_read_b64_tr_b16 v[210:211], v184 offset:63488
  v_exp_f32 v165, v96
  v_exp_f32 v166, v97
  s_waitcnt lgkmcnt(14)
  v_mfma_f32_32x32x16_bf16 v[16:31], v[212:215], v[148:151], v[16:31]
  ds_read_b64_tr_b16 v[212:213], v185 offset:61440
  ds_read_b64_tr_b16 v[214:215], v185 offset:63488
  v_add_f32 v163, v165, v166
  v_cvt_pk_bf16_f32 v144, v165, v166
  s_waitcnt lgkmcnt(14)
  v_mfma_f32_32x32x16_bf16 v[32:47], v[216:219], v[148:151], v[32:47]
  ds_read_b64_tr_b16 v[216:217], v186 offset:61440
  ds_read_b64_tr_b16 v[218:219], v186 offset:63488
  v_exp_f32 v167, v98
  v_exp_f32 v168, v99
  s_waitcnt lgkmcnt(14)
  v_mfma_f32_32x32x16_bf16 v[48:63], v[220:223], v[148:151], v[48:63]
  ds_read_b64_tr_b16 v[220:221], v187 offset:61440
  ds_read_b64_tr_b16 v[222:223], v187 offset:63488
  v_add_f32 v163, v163, v167
  v_add_f32 v163, v163, v168
  v_cvt_pk_bf16_f32 v145, v167, v168
  s_waitcnt lgkmcnt(14)
  v_mfma_f32_32x32x16_bf16 v[0:15], v[192:195], v[152:155], v[0:15]
  s_waitcnt vmcnt(20)
  s_waitcnt vmcnt(11)
  s_barrier
  ds_read_b128 v[192:195], v176 offset:16384
  v_exp_f32 v165, v100
  v_exp_f32 v166, v101
  s_waitcnt lgkmcnt(13)
  v_mfma_f32_32x32x16_bf16 v[16:31], v[196:199], v[152:155], v[16:31]
  ds_read_b128 v[196:199], v176 offset:24576
  s_add_u32 m0, s49, 98304
  s_nop 0
  buffer_load_dwordx4 v173, s[20:23], s51 offen lds
  buffer_load_dwordx4 v173, s[20:23], s51 offen offset:1024 lds
  s_add_u32 s51, s51, 16384
  s_waitcnt vmcnt(8)
  v_cmp_ne_u32 vcc, 1, v171
  s_nop 1
  s_and_b32 s64, vcc_lo, 0xff
  s_cbranch_scc1 L_spin_h1
L_ok_h1:
  s_and_b32 s64, s65, 12
  s_lshl_b32 s64, s64, 12
  s_add_u32 s64, s64, 49152
  s_add_u32 s64, s64, s44
  s_add_u32 m0, s49, 49152
  s_nop 0
  buffer_load_dwordx4 v172, s[84:87], s64 offen offset:0 sc1 lds
  buffer_load_dwordx4 v172, s[84:87], s64 offen offset:1024 sc1 lds
  v_add_f32 v163, v163, v165
  v_add_f32 v163, v163, v166
  v_cvt_pk_bf16_f32 v146, v165, v166
  s_waitcnt lgkmcnt(12)
  v_mfma_f32_32x32x16_bf16 v[32:47], v[200:203], v[152:155], v[32:47]
  ds_read_b128 v[200:203], v177 offset:16384
  v_exp_f32 v167, v102
  v_exp_f32 v168, v103
  s_waitcnt lgkmcnt(11)
  v_mfma_f32_32x32x16_bf16 v[48:63], v[204:207], v[152:155], v[48:63]
  ds_read_b128 v[204:207], v177 offset:24576
  v_add_f32 v163, v163, v167
  v_add_f32 v163, v163, v168
  v_cvt_pk_bf16_f32 v147, v167, v168
  v_lshl_add_u32 v170, v175, 4, s96
  s_waitcnt lgkmcnt(10)
  v_mfma_f32_32x32x16_bf16 v[0:15], v[208:211], v[156:159], v[0:15]
  ds_read_b128 v[208:211], v178 offset:16384
  v_exp_f32 v165, v104
  v_exp_f32 v166, v105
  s_mov_b32 m0, 49152
  s_waitcnt lgkmcnt(9)
  v_mfma_f32_32x32x16_bf16 v[16:31], v[212:215], v[156:159], v[16:31]
  ds_read_b128 v[212:215], v178 offset:24576
  v_add_f32 v163, v163, v165
  v_add_f32 v163, v163, v166
  v_cvt_pk_bf16_f32 v148, v165, v166
  s_waitcnt lgkmcnt(8)
  v_mfma_f32_32x32x16_bf16 v[32:47], v[216:219], v[156:159], v[32:47]
  ds_read_b128 v[216:219], v179 offset:16384
  v_exp_f32 v167, v106
  v_exp_f32 v168, v107
  buffer_load_dwordx4 v170, s[36:39], 0 offen offset:0 lds
  s_waitcnt lgkmcnt(7)
  v_mfma_f32_32x32x16_bf16 v[48:63], v[220:223], v[156:159], v[48:63]
  ds_read_b128 v[220:223], v179 offset:24576
  v_add_f32 v163, v163, v167
  v_add_f32 v163, v163, v168
  v_cvt_pk_bf16_f32 v149, v167, v168
  s_add_u32 s96, s96, 1024
  s_setprio 2
  s_waitcnt lgkmcnt(7)
  v_mfma_f32_32x32x16_bf16 v[64:79], v[192:195], v[224:227], v[128:143]
  ds_read_b128 v[192:195], v180 offset:16384
  v_exp_f32 v165, v108
  v_exp_f32 v166, v109
  s_waitcnt lgkmcnt(7)
  v_mfma_f32_32x32x16_bf16 v[80:95], v[196:199], v[224:227], v[128:143]
  ds_read_b128 v[196:199], v180 offset:24576
  v_add_f32 v163, v163, v165
  v_add_f32 v163, v163, v166
  v_cvt_pk_bf16_f32 v150, v165, v166
  v_exp_f32 v167, v110
  s_waitcnt lgkmcnt(7)
  v_mfma_f32_32x32x16_bf16 v[64:79], v[200:203], v[228:231], v[64:79]
  ds_read_b128 v[200:203], v181 offset:16384
  v_exp_f32 v168, v111
  v_add_f32 v163, v163, v167
  v_add_f32 v163, v163, v168
  s_waitcnt lgkmcnt(7)
  v_mfma_f32_32x32x16_bf16 v[80:95], v[204:207], v[228:231], v[80:95]
  ds_read_b128 v[204:207], v181 offset:24576
  v_cvt_pk_bf16_f32 v151, v167, v168
  v_exp_f32 v165, v112
  v_exp_f32 v166, v113
  s_waitcnt lgkmcnt(7)
  v_mfma_f32_32x32x16_bf16 v[64:79], v[208:211], v[232:235], v[64:79]
  ds_read_b128 v[208:211], v182 offset:16384
  v_add_f32 v163, v163, v165
  v_add_f32 v163, v163, v166
  v_cvt_pk_bf16_f32 v152, v165, v166
  s_waitcnt lgkmcnt(7)
  v_mfma_f32_32x32x16_bf16 v[80:95], v[212:215], v[232:235], v[80:95]
  ds_read_b128 v[212:215], v182 offset:24576
  v_exp_f32 v167, v114
  v_exp_f32 v168, v115
  v_add_f32 v163, v163, v167
  s_waitcnt lgkmcnt(7)
  v_mfma_f32_32x32x16_bf16 v[64:79], v[216:219], v[236:239], v[64:79]
  ds_read_b128 v[216:219], v183 offset:16384
  v_add_f32 v163, v163, v168
  v_cvt_pk_bf16_f32 v153, v167, v168
  v_exp_f32 v165, v116
  s_waitcnt lgkmcnt(7)
  v_mfma_f32_32x32x16_bf16 v[80:95], v[220:223], v[236:239], v[80:95]
  ds_read_b128 v[220:223], v183 offset:24576
  v_exp_f32 v166, v117
  v_add_f32 v163, v163, v165
  v_add_f32 v163, v163, v166
  v_cvt_pk_bf16_f32 v154, v165, v166
  s_waitcnt lgkmcnt(7)
  v_mfma_f32_32x32x16_bf16 v[64:79], v[192:195], v[240:243], v[64:79]
  ds_read_b64_tr_b16 v[192:193], v184 offset:0
  ds_read_b64_tr_b16 v[194:195], v184 offset:2048
  v_exp_f32 v167, v118
  v_exp_f32 v168, v119
  s_waitcnt lgkmcnt(8)
  v_mfma_f32_32x32x16_bf16 v[80:95], v[196:199], v[240:243], v[80:95]
  ds_read_b64_tr_b16 v[196:197], v185 offset:0
  ds_read_b64_tr_b16 v[198:199], v185 offset:2048
  v_add_f32 v163, v163, v167
  v_add_f32 v163, v163, v168
  v_cvt_pk_bf16_f32 v155, v167, v168
  v_exp_f32 v165, v120
  s_waitcnt lgkmcnt(9)
  v_mfma_f32_32x32x16_bf16 v[64:79], v[200:203], v[244:247], v[64:79]
  ds_read_b64_tr_b16 v[200:201], v186 offset:0
  ds_read_b64_tr_b16 v[202:203], v186 offset:2048
  v_exp_f32 v166, v121
  v_add_f32 v163, v163, v165
  v_add_f32 v163, v163, v166
  s_waitcnt lgkmcnt(10)
  v_mfma_f32_32x32x16_bf16 v[80:95], v[204:207], v[244:247], v[80:95]
  ds_read_b64_tr_b16 v[204:205], v187 offset:0
  ds_read_b64_tr_b16 v[206:207], v187 offset:2048
  v_cvt_pk_bf16_f32 v156, v165, v166
  v_exp_f32 v167, v122
  v_exp_f32 v168, v123
  s_waitcnt lgkmcnt(11)
  v_mfma_f32_32x32x16_bf16 v[64:79], v[208:211], v[248:251], v[64:79]
  ds_read_b64_tr_b16 v[208:209], v184 offset:4096
  ds_read_b64_tr_b16 v[210:211], v184 offset:6144
  v_add_f32 v163, v163, v167
  v_add_f32 v163, v163, v168
  v_cvt_pk_bf16_f32 v157, v167, v168
  s_waitcnt lgkmcnt(12)
  v_mfma_f32_32x32x16_bf16 v[80:95], v[212:215], v[248:251], v[80:95]
  ds_read_b64_tr_b16 v[212:213], v185 offset:4096
  ds_read_b64_tr_b16 v[214:215], v185 offset:6144
  v_exp_f32 v165, v124
  v_exp_f32 v166, v125
  v_add_f32 v163, v163, v165
  s_waitcnt lgkmcnt(13)
  v_mfma_f32_32x32x16_bf16 v[64:79], v[216:219], v[252:255], v[64:79]
  ds_read_b64_tr_b16 v[216:217], v186 offset:4096
  ds_read_b64_tr_b16 v[218:219], v186 offset:6144
  v_add_f32 v163, v163, v166
  v_cvt_pk_bf16_f32 v158, v165, v166
  v_exp_f32 v167, v126
  s_waitcnt lgkmcnt(14)
  v_mfma_f32_32x32x16_bf16 v[80:95], v[220:223], v[252:255], v[80:95]
  ds_read_b64_tr_b16 v[220:221], v187 offset:4096
  ds_read_b64_tr_b16 v[222:223], v187 offset:6144
  v_exp_f32 v168, v127
  v_add_f32 v163, v163, v167
  v_add_f32 v163, v163, v168
  v_cvt_pk_bf16_f32 v159, v167, v168
  v_cmp_nle_f32 vcc, v163, s4
  s_nop 4
  s_cbranch_vccnz L_fb_1_5
L_ret_1_5:
  v_add_f32 v162, v162, v163
  s_setprio 0
  s_waitcnt lgkmcnt(14)
  v_mfma_f32_32x32x16_bf16 v[0:15], v[192:195], v[144:147], v[0:15]
  ds_read_b64_tr_b16 v[192:193], v184 offset:8192
  ds_read_b64_tr_b16 v[194:195], v184 offset:10240
  v_mov_b32 v166, -1
  v_mov_b32 v167, -1
  v_mov_b32 v168, -1
  v_mov_b32 v169, -1
  s_waitcnt lgkmcnt(14)
  v_mfma_f32_32x32x16_bf16 v[16:31], v[196:199], v[144:147], v[16:31]
  ds_read_b64_tr_b16 v[196:197], v185 offset:8192
  ds_read_b64_tr_b16 v[198:199], v185 offset:10240
  buffer_store_dwordx4 v[166:169], v161, s[88:91], 0 offen offset:1024 sc1
  s_waitcnt lgkmcnt(14)
  v_mfma_f32_32x32x16_bf16 v[32:47], v[200:203], v[144:147], v[32:47]
  ds_read_b64_tr_b16 v[200:201], v186 offset:8192
  ds_read_b64_tr_b16 v[202:203], v186 offset:10240
  buffer_store_dwordx4 v[166:169], v161, s[88:91], s3 offen offset:1024 sc1
  s_waitcnt lgkmcnt(14)
  v_mfma_f32_32x32x16_bf16 v[48:63], v[204:207], v[144:147], v[48:63]
  ds_read_b64_tr_b16 v[204:205], v187 offset:8192
  ds_read_b64_tr_b16 v[206:207], v187 offset:10240
  s_waitcnt lgkmcnt(14)
  v_mfma_f32_32x32x16_bf16 v[0:15], v[208:211], v[148:151], v[0:15]
  ds_read_b64_tr_b16 v[208:209], v184 offset:12288
  ds_read_b64_tr_b16 v[210:211], v184 offset:14336
  v_exp_f32 v165, v64
  v_exp_f32 v166, v65
  s_waitcnt lgkmcnt(14)
  v_mfma_f32_32x32x16_bf16 v[16:31], v[212:215], v[148:151], v[16:31]
  ds_read_b64_tr_b16 v[212:213], v185 offset:12288
  ds_read_b64_tr_b16 v[214:215], v185 offset:14336
  v_add_f32 v163, v165, v166
  v_cvt_pk_bf16_f32 v144, v165, v166
  s_waitcnt lgkmcnt(14)
  v_mfma_f32_32x32x16_bf16 v[32:47], v[216:219], v[148:151], v[32:47]
  ds_read_b64_tr_b16 v[216:217], v186 offset:12288
  ds_read_b64_tr_b16 v[218:219], v186 offset:14336
  v_exp_f32 v167, v66
  v_exp_f32 v168, v67
  s_waitcnt lgkmcnt(14)
  v_mfma_f32_32x32x16_bf16 v[48:63], v[220:223], v[148:151], v[48:63]
  ds_read_b64_tr_b16 v[220:221], v187 offset:12288
  ds_read_b64_tr_b16 v[222:223], v187 offset:14336
  v_add_f32 v163, v163, v167
  v_add_f32 v163, v163, v168
  v_cvt_pk_bf16_f32 v145, v167, v168
  s_waitcnt lgkmcnt(14)
  v_mfma_f32_32x32x16_bf16 v[0:15], v[192:195], v[152:155], v[0:15]
  s_waitcnt vmcnt(11)
  s_barrier
  ds_read_b128 v[192:195], v176 offset:32768
  v_exp_f32 v165, v68
  v_exp_f32 v166, v69
  s_waitcnt lgkmcnt(13)
  v_mfma_f32_32x32x16_bf16 v[16:31], v[196:199], v[152:155], v[16:31]
  ds_read_b128 v[196:199], v176 offset:40960
  v_add_f32 v163, v163, v165
  v_add_f32 v163, v163, v166
  v_cvt_pk_bf16_f32 v146, v165, v166
  s_waitcnt lgkmcnt(12)
  v_mfma_f32_32x32x16_bf16 v[32:47], v[200:203], v[152:155], v[32:47]
  ds_read_b128 v[200:203], v177 offset:32768
  s_add_u32 m0, s45, 125952
  s_nop 0
  buffer_load_dwordx4 v191, s[32:35], s43 offen offset:0 lds
  buffer_load_dwordx4 v160, s[32:35], s43 offen offset:1024 lds
  v_exp_f32 v167, v70
  v_exp_f32 v168, v71
  s_waitcnt lgkmcnt(11)
  v_mfma_f32_32x32x16_bf16 v[48:63], v[204:207], v[152:155], v[48:63]
  ds_read_b128 v[204:207], v177 offset:40960
  s_add_u32 s43, s43, 81920
  s_add_u32 m0, s49, 0
  s_nop 0
  buffer_load_dwordx4 v172, s[84:87], s44 offen offset:0 sc1 lds
  v_add_f32 v163, v163, v167
  v_add_f32 v163, v163, v168
  v_cvt_pk_bf16_f32 v147, v167, v168
  s_waitcnt lgkmcnt(10)
  v_mfma_f32_32x32x16_bf16 v[0:15], v[208:211], v[156:159], v[0:15]
  ds_read_b128 v[208:211], v178 offset:32768
  buffer_load_dwordx4 v172, s[84:87], s44 offen offset:1024 sc1 lds
  s_add_u32 s44, s44, 16384
  v_exp_f32 v165, v72
  v_exp_f32 v166, v73
  s_waitcnt lgkmcnt(9)
  v_mfma_f32_32x32x16_bf16 v[16:31], v[212:215], v[156:159], v[16:31]
  ds_read_b128 v[212:215], v178 offset:40960
  s_add_u32 m0, s45, 143360
  s_nop 0
  buffer_load_dwordx4 v188, s[32:35], s43 offen offset:0 lds
  buffer_load_dwordx4 v189, s[32:35], s43 offen offset:1024 lds
  v_add_f32 v163, v163, v165
  v_add_f32 v163, v163, v166
  v_cvt_pk_bf16_f32 v148, v165, v166
  s_waitcnt lgkmcnt(8)
  v_mfma_f32_32x32x16_bf16 v[32:47], v[216:219], v[156:159], v[32:47]
  ds_read_b128 v[216:219], v179 offset:32768
  buffer_load_dwordx4 v190, s[32:35], s43 offen offset:2048 lds
  s_add_u32 s43, s43, 81920
  s_add_u32 m0, s49, 16384
  v_exp_f32 v167, v74
  v_exp_f32 v168, v75
  s_waitcnt lgkmcnt(7)
  v_mfma_f32_32x32x16_bf16 v[48:63], v[220:223], v[156:159], v[48:63]
  ds_read_b128 v[220:223], v179 offset:40960
  buffer_load_dwordx4 v172, s[84:87], s44 offen offset:0 sc1 lds
  buffer_load_dwordx4 v172, s[84:87], s44 offen offset:1024 sc1 lds
  s_add_u32 s44, s44, 16384
  v_add_f32 v163, v163, v167
  v_add_f32 v163, v163, v168
  v_cvt_pk_bf16_f32 v149, v167, v168
  s_setprio 2
  s_waitcnt lgkmcnt(7)
  v_mfma_f32_32x32x16_bf16 v[96:111], v[192:195], v[224:227], v[128:143]
  ds_read_b128 v[192:195], v180 offset:32768
  v_exp_f32 v165, v76
  v_exp_f32 v166, v77
  s_waitcnt lgkmcnt(7)
  v_mfma_f32_32x32x16_bf16 v[112:127], v[196:199], v[224:227], v[128:143]
  ds_read_b128 v[196:199], v180 offset:40960
  v_add_f32 v163, v163, v165
  v_add_f32 v163, v163, v166
  v_cvt_pk_bf16_f32 v150, v165, v166
  v_exp_f32 v167, v78
  s_waitcnt lgkmcnt(7)
  v_mfma_f32_32x32x16_bf16 v[96:111], v[200:203], v[228:231], v[96:111]
  ds_read_b128 v[200:203], v181 offset:32768
  v_exp_f32 v168, v79
  v_add_f32 v163, v163, v167
  v_add_f32 v163, v163, v168
  s_waitcnt lgkmcnt(7)
  v_mfma_f32_32x32x16_bf16 v[112:127], v[204:207], v[228:231], v[112:127]
  ds_read_b128 v[204:207], v181 offset:40960
  v_cvt_pk_bf16_f32 v151, v167, v168
  v_exp_f32 v165, v80
  v_exp_f32 v166, v81
  s_waitcnt lgkmcnt(7)
  v_mfma_f32_32x32x16_bf16 v[96:111], v[208:211], v[232:235], v[96:111]
  ds_read_b128 v[208:211], v182 offset:32768
  v_add_f32 v163, v163, v165
  v_add_f32 v163, v163, v166
  v_cvt_pk_bf16_f32 v152, v165, v166
  s_waitcnt lgkmcnt(7)
  v_mfma_f32_32x32x16_bf16 v[112:127], v[212:215], v[232:235], v[112:127]
  ds_read_b128 v[212:215], v182 offset:40960
  v_exp_f32 v167, v82
  v_exp_f32 v168, v83
  v_add_f32 v163, v163, v167
  s_waitcnt lgkmcnt(7)
  v_mfma_f32_32x32x16_bf16 v[96:111], v[216:219], v[236:239], v[96:111]
  ds_read_b128 v[216:219], v183 offset:32768
  v_add_f32 v163, v163, v168
  v_cvt_pk_bf16_f32 v153, v167, v168
  v_exp_f32 v165, v84
  s_waitcnt lgkmcnt(7)
  v_mfma_f32_32x32x16_bf16 v[112:127], v[220:223], v[236:239], v[112:127]
  ds_read_b128 v[220:223], v183 offset:40960
  v_exp_f32 v166, v85
  v_add_f32 v163, v163, v165
  v_add_f32 v163, v163, v166
  v_cvt_pk_bf16_f32 v154, v165, v166
  s_waitcnt lgkmcnt(7)
  v_mfma_f32_32x32x16_bf16 v[96:111], v[192:195], v[240:243], v[96:111]
  ds_read_b64_tr_b16 v[192:193], v184 offset:16384
  ds_read_b64_tr_b16 v[194:195], v184 offset:18432
  v_exp_f32 v167, v86
  v_exp_f32 v168, v87
  s_waitcnt lgkmcnt(8)
  v_mfma_f32_32x32x16_bf16 v[112:127], v[196:199], v[240:243], v[112:127]
  ds_read_b64_tr_b16 v[196:197], v185 offset:16384
  ds_read_b64_tr_b16 v[198:199], v185 offset:18432
  v_add_f32 v163, v163, v167
  v_add_f32 v163, v163, v168
  v_cvt_pk_bf16_f32 v155, v167, v168
  v_exp_f32 v165, v88
  s_waitcnt lgkmcnt(9)
  v_mfma_f32_32x32x16_bf16 v[96:111], v[200:203], v[244:247], v[96:111]
  ds_read_b64_tr_b16 v[200:201], v186 offset:16384
  ds_read_b64_tr_b16 v[202:203], v186 offset:18432
  v_exp_f32 v166, v89
  v_add_f32 v163, v163, v165
  v_add_f32 v163, v163, v166
  s_waitcnt lgkmcnt(10)
  v_mfma_f32_32x32x16_bf16 v[112:127], v[204:207], v[244:247], v[112:127]
  ds_read_b64_tr_b16 v[204:205], v187 offset:16384
  ds_read_b64_tr_b16 v[206:207], v187 offset:18432
  v_cvt_pk_bf16_f32 v156, v165, v166
  v_exp_f32 v167, v90
  v_exp_f32 v168, v91
  s_waitcnt lgkmcnt(11)
  v_mfma_f32_32x32x16_bf16 v[96:111], v[208:211], v[248:251], v[96:111]
  ds_read_b64_tr_b16 v[208:209], v184 offset:20480
  ds_read_b64_tr_b16 v[210:211], v184 offset:22528
  v_add_f32 v163, v163, v167
  v_add_f32 v163, v163, v168
  v_cvt_pk_bf16_f32 v157, v167, v168
  s_waitcnt lgkmcnt(12)
  v_mfma_f32_32x32x16_bf16 v[112:127], v[212:215], v[248:251], v[112:127]
  ds_read_b64_tr_b16 v[212:213], v185 offset:20480
  ds_read_b64_tr_b16 v[214:215], v185 offset:22528
  v_exp_f32 v165, v92
  v_exp_f32 v166, v93
  v_add_f32 v163, v163, v165
  s_waitcnt lgkmcnt(13)
  v_mfma_f32_32x32x16_bf16 v[96:111], v[216:219], v[252:255], v[96:111]
  ds_read_b64_tr_b16 v[216:217], v186 offset:20480
  ds_read_b64_tr_b16 v[218:219], v186 offset:22528
  v_add_f32 v163, v163, v166
  v_cvt_pk_bf16_f32 v158, v165, v166
  v_exp_f32 v167, v94
  s_waitcnt lgkmcnt(14)
  v_mfma_f32_32x32x16_bf16 v[112:127], v[220:223], v[252:255], v[112:127]
  ds_read_b64_tr_b16 v[220:221], v187 offset:20480
  ds_read_b64_tr_b16 v[222:223], v187 offset:22528
  v_exp_f32 v168, v95
  v_add_f32 v163, v163, v167
  v_add_f32 v163, v163, v168
  v_cvt_pk_bf16_f32 v159, v167, v168
  v_cmp_nle_f32 vcc, v163, s4
  s_nop 4
  s_cbranch_vccnz L_fb_1_6
L_ret_1_6:
  v_add_f32 v162, v162, v163
  s_setprio 0
  s_waitcnt lgkmcnt(14)
  v_mfma_f32_32x32x16_bf16 v[0:15], v[192:195], v[144:147], v[0:15]
  ds_read_b64_tr_b16 v[192:193], v184 offset:24576
  ds_read_b64_tr_b16 v[194:195], v184 offset:26624
  s_waitcnt lgkmcnt(14)
  v_mfma_f32_32x32x16_bf16 v[16:31], v[196:199], v[144:147], v[16:31]
  ds_read_b64_tr_b16 v[196:197], v185 offset:24576
  ds_read_b64_tr_b16 v[198:199], v185 offset:26624
  s_waitcnt lgkmcnt(14)
  v_mfma_f32_32x32x16_bf16 v[32:47], v[200:203], v[144:147], v[32:47]
  ds_read_b64_tr_b16 v[200:201], v186 offset:24576
  ds_read_b64_tr_b16 v[202:203], v186 offset:26624
  s_waitcnt lgkmcnt(14)
  v_mfma_f32_32x32x16_bf16 v[48:63], v[204:207], v[144:147], v[48:63]
  ds_read_b64_tr_b16 v[204:205], v187 offset:24576
  ds_read_b64_tr_b16 v[206:207], v187 offset:26624
  s_waitcnt lgkmcnt(14)
  v_mfma_f32_32x32x16_bf16 v[0:15], v[208:211], v[148:151], v[0:15]
  ds_read_b64_tr_b16 v[208:209], v184 offset:28672
  ds_read_b64_tr_b16 v[210:211], v184 offset:30720
  v_exp_f32 v165, v96
  v_exp_f32 v166, v97
  s_nop 0
  v_add_f32 v163, v165, v166
  v_cvt_pk_bf16_f32 v144, v165, v166
  s_waitcnt lgkmcnt(14)
  v_mfma_f32_32x32x16_bf16 v[16:31], v[212:215], v[148:151], v[16:31]
  ds_read_b64_tr_b16 v[212:213], v185 offset:28672
  ds_read_b64_tr_b16 v[214:215], v185 offset:30720
  v_exp_f32 v167, v98
  v_exp_f32 v168, v99
  v_add_f32 v163, v163, v167
  v_add_f32 v163, v163, v168
  v_cvt_pk_bf16_f32 v145, v167, v168
  s_waitcnt lgkmcnt(14)
  v_mfma_f32_32x32x16_bf16 v[32:47], v[216:219], v[148:151], v[32:47]
  ds_read_b64_tr_b16 v[216:217], v186 offset:28672
  ds_read_b64_tr_b16 v[218:219], v186 offset:30720
  v_exp_f32 v165, v100
  v_exp_f32 v166, v101
  v_add_f32 v163, v163, v165
  v_add_f32 v163, v163, v166
  v_cvt_pk_bf16_f32 v146, v165, v166
  s_waitcnt lgkmcnt(14)
  v_mfma_f32_32x32x16_bf16 v[48:63], v[220:223], v[148:151], v[48:63]
  ds_read_b64_tr_b16 v[220:221], v187 offset:28672
  ds_read_b64_tr_b16 v[222:223], v187 offset:30720
  v_exp_f32 v167, v102
  v_exp_f32 v168, v103
  v_add_f32 v163, v163, v167
  v_add_f32 v163, v163, v168
  v_cvt_pk_bf16_f32 v147, v167, v168
  s_waitcnt lgkmcnt(14)
  v_mfma_f32_32x32x16_bf16 v[0:15], v[192:195], v[152:155], v[0:15]
  s_waitcnt vmcnt(14)
  s_waitcnt vmcnt(5)
  s_barrier
  ds_read_b64_tr_b16 v[192:193], v184 offset:32768
  ds_read_b64_tr_b16 v[194:195], v184 offset:34816
  v_exp_f32 v165, v104
  v_exp_f32 v166, v105
  v_add_f32 v163, v163, v165
  v_add_f32 v163, v163, v166
  v_cvt_pk_bf16_f32 v148, v165, v166
  s_waitcnt lgkmcnt(14)
  v_mfma_f32_32x32x16_bf16 v[16:31], v[196:199], v[152:155], v[16:31]
  ds_read_b64_tr_b16 v[196:197], v184 offset:36864
  ds_read_b64_tr_b16 v[198:199], v184 offset:38912
  v_lshlrev_b32 v180, 4, v175
  s_and_b32 s64, s40, 3
  s_lshl_b32 s64, s64, 11
  v_add_u32 v180, s64, v180
  v_exp_f32 v167, v106
  v_exp_f32 v168, v107
  v_add_f32 v163, v163, v167
  v_add_f32 v163, v163, v168
  v_cvt_pk_bf16_f32 v149, v167, v168
  s_waitcnt lgkmcnt(14)
  v_mfma_f32_32x32x16_bf16 v[32:47], v[200:203], v[152:155], v[32:47]
  ds_read_b64_tr_b16 v[200:201], v184 offset:40960
  ds_read_b64_tr_b16 v[202:203], v184 offset:43008
  v_add_u32 v181, 57344, v180
  v_bfe_u32 v176, v175, 2, 3
  v_lshrrev_b32 v177, 5, v175
  v_lshl_add_u32 v176, v177, 4, v176
  v_exp_f32 v165, v108
  v_exp_f32 v166, v109
  v_add_f32 v163, v163, v165
  v_add_f32 v163, v163, v166
  v_cvt_pk_bf16_f32 v150, v165, v166
  s_waitcnt lgkmcnt(14)
  v_mfma_f32_32x32x16_bf16 v[48:63], v[204:207], v[152:155], v[48:63]
  ds_read_b64_tr_b16 v[204:205], v184 offset:45056
  ds_read_b64_tr_b16 v[206:207], v184 offset:47104
  v_mul_u32_u24 v176, 320, v176
  v_bfe_u32 v177, v175, 4, 1
  v_and_b32 v178, 3, v175
  v_xor_b32 v177, v177, v178
  v_exp_f32 v167, v110
  v_exp_f32 v168, v111
  v_add_f32 v163, v163, v167
  v_add_f32 v163, v163, v168
  v_cvt_pk_bf16_f32 v151, v167, v168
  s_waitcnt lgkmcnt(14)
  v_mfma_f32_32x32x16_bf16 v[0:15], v[208:211], v[156:159], v[0:15]
  ds_read_b64_tr_b16 v[208:209], v185 offset:32768
  ds_read_b64_tr_b16 v[210:211], v185 offset:34816
  v_lshl_add_u32 v176, v177, 4, v176
  v_and_b32 v178, 1, v175
  v_lshl_add_u32 v176, v178, 3, v176
  v_exp_f32 v165, v112
  v_exp_f32 v166, v113
  v_add_f32 v163, v163, v165
  v_add_f32 v163, v163, v166
  v_cvt_pk_bf16_f32 v152, v165, v166
  s_waitcnt lgkmcnt(14)
  v_mfma_f32_32x32x16_bf16 v[16:31], v[212:215], v[156:159], v[16:31]
  ds_read_b64_tr_b16 v[212:213], v185 offset:36864
  ds_read_b64_tr_b16 v[214:215], v185 offset:38912
  v_add_u32 v178, 114688, v176
  v_add_u32 v176, 49152, v176
  v_xor_b32 v179, 8, v178
  v_xor_b32 v177, 8, v176
  v_exp_f32 v167, v114
  v_exp_f32 v168, v115
  v_add_f32 v163, v163, v167
  v_add_f32 v163, v163, v168
  v_cvt_pk_bf16_f32 v153, v167, v168
  s_waitcnt lgkmcnt(14)
  v_mfma_f32_32x32x16_bf16 v[32:47], v[216:219], v[156:159], v[32:47]
  ds_read_b64_tr_b16 v[216:217], v185 offset:40960
  ds_read_b64_tr_b16 v[218:219], v185 offset:43008
  s_add_u32 m0, s45, 52224
  s_nop 0
  buffer_load_dwordx4 v191, s[32:35], s43 offen offset:0 lds
  buffer_load_dwordx4 v160, s[32:35], s43 offen offset:1024 lds
  s_add_u32 s43, s43, 81920
  v_exp_f32 v165, v116
  v_exp_f32 v166, v117
  v_add_f32 v163, v163, v165
  v_add_f32 v163, v163, v166
  v_cvt_pk_bf16_f32 v154, v165, v166
  s_waitcnt lgkmcnt(14)
  v_mfma_f32_32x32x16_bf16 v[48:63], v[220:223], v[156:159], v[48:63]
  ds_read_b64_tr_b16 v[220:221], v185 offset:45056
  ds_read_b64_tr_b16 v[222:223], v185 offset:47104
  s_add_u32 m0, s49, 32768
  s_nop 0
  buffer_load_dwordx4 v172, s[84:87], s44 offen offset:0 sc1 lds
  buffer_load_dwordx4 v172, s[84:87], s44 offen offset:1024 sc1 lds
  s_add_u32 s44, s44, 16384
  v_exp_f32 v167, v118
  v_exp_f32 v168, v119
  v_add_f32 v163, v163, v167
  v_add_f32 v163, v163, v168
  v_cvt_pk_bf16_f32 v155, v167, v168
  s_barrier
  v_exp_f32 v165, v120
  v_exp_f32 v166, v121
  v_add_f32 v163, v163, v165
  v_add_f32 v163, v163, v166
  v_cvt_pk_bf16_f32 v156, v165, v166
  v_exp_f32 v167, v122
  v_exp_f32 v168, v123
  v_add_f32 v163, v163, v167
  v_add_f32 v163, v163, v168
  v_cvt_pk_bf16_f32 v157, v167, v168
  v_exp_f32 v165, v124
  v_exp_f32 v166, v125
  v_add_f32 v163, v163, v165
  v_add_f32 v163, v163, v166
  v_cvt_pk_bf16_f32 v158, v165, v166
  v_exp_f32 v167, v126
  v_exp_f32 v168, v127
  v_add_f32 v163, v163, v167
  v_add_f32 v163, v163, v168
  v_cvt_pk_bf16_f32 v159, v167, v168
  v_cmp_nle_f32 vcc, v163, s4
  s_nop 4
  s_cbranch_vccnz L_fb_1_7
L_ret_1_7:
  v_add_f32 v162, v162, v163
  s_setprio 0
  s_waitcnt lgkmcnt(14)
  v_mfma_f32_32x32x16_bf16 v[0:15], v[192:195], v[144:147], v[0:15]
  ds_read_b64_tr_b16 v[192:193], v186 offset:32768
  ds_read_b64_tr_b16 v[194:195], v186 offset:34816
  s_add_u32 m0, s45, 69632
  v_mov_b32 v165, v162
  s_waitcnt lgkmcnt(14)
  v_mfma_f32_32x32x16_bf16 v[0:15], v[196:199], v[148:151], v[0:15]
  ds_read_b64_tr_b16 v[196:197], v186 offset:36864
  ds_read_b64_tr_b16 v[198:199], v186 offset:38912
  buffer_load_dwordx4 v188, s[32:35], s43 offen offset:0 lds
  buffer_load_dwordx4 v189, s[32:35], s43 offen offset:1024 lds
  v_permlane32_swap_b32 v165, v162
  v_add_f32 v162, v162, v165
  s_waitcnt lgkmcnt(14)
  v_mfma_f32_32x32x16_bf16 v[0:15], v[200:203], v[152:155], v[0:15]
  ds_read_b64_tr_b16 v[200:201], v186 offset:40960
  ds_read_b64_tr_b16 v[202:203], v186 offset:43008
  buffer_load_dwordx4 v190, s[32:35], s43 offen offset:2048 lds
  v_rcp_f32 v162, v162
  ds_read_b128 v[224:227], v180 offset:0
  s_waitcnt lgkmcnt(15)
  v_mfma_f32_32x32x16_bf16 v[0:15], v[204:207], v[156:159], v[0:15]
  ds_read_b64_tr_b16 v[204:205], v186 offset:45056
  ds_read_b64_tr_b16 v[206:207], v186 offset:47104
  s_add_u32 s43, s43, 81920
  s_add_u32 m0, s49, 106496
  ds_read_b128 v[228:231], v180 offset:1024
  ds_read_b64_tr_b16 v[232:233], v178 offset:8320
  s_waitcnt lgkmcnt(15)
  v_mfma_f32_32x32x16_bf16 v[16:31], v[208:211], v[144:147], v[16:31]
  ds_read_b64_tr_b16 v[208:209], v187 offset:32768
  ds_read_b64_tr_b16 v[210:211], v187 offset:34816
  buffer_load_dwordx4 v172, s[84:87], s44 offen offset:0 sc1 lds
  ds_read_b64_tr_b16 v[234:235], v178 offset:10880
  v_mfma_f32_32x32x16_bf16 v[16:31], v[212:215], v[148:151], v[16:31]
  ds_read_b64_tr_b16 v[212:213], v187 offset:36864
  ds_read_b64_tr_b16 v[214:215], v187 offset:38912
  buffer_load_dwordx4 v172, s[84:87], s44 offen offset:1024 sc1 lds
  s_add_u32 s44, s44, 16384
  ds_read_b64_tr_b16 v[236:237], v179 offset:8320
  v_mul_f32 v0, v162, v0
  v_mul_f32 v1, v162, v1
  v_cvt_pk_bf16_f32 v0, v0, v1
  v_mul_f32 v2, v162, v2
  v_mul_f32 v3, v162, v3
  v_cvt_pk_bf16_f32 v1, v2, v3
  s_waitcnt lgkmcnt(15)
  v_mfma_f32_32x32x16_bf16 v[16:31], v[216:219], v[152:155], v[16:31]
  ds_read_b64_tr_b16 v[216:217], v187 offset:40960
  ds_read_b64_tr_b16 v[218:219], v187 offset:43008
  ds_read_b64_tr_b16 v[238:239], v179 offset:10880
  v_mul_f32 v4, v162, v4
  v_mul_f32 v5, v162, v5
  v_cvt_pk_bf16_f32 v2, v4, v5
  v_mul_f32 v6, v162, v6
  v_mul_f32 v7, v162, v7
  v_cvt_pk_bf16_f32 v3, v6, v7
  v_mul_f32 v8, v162, v8
  v_mfma_f32_32x32x16_bf16 v[16:31], v[220:223], v[156:159], v[16:31]
  ds_read_b64_tr_b16 v[220:221], v187 offset:45056
  ds_read_b64_tr_b16 v[222:223], v187 offset:47104
  ds_read_b64_tr_b16 v[240:241], v178 offset:8384
  ds_read_b64_tr_b16 v[242:243], v178 offset:10944
  v_mul_f32 v9, v162, v9
  v_cvt_pk_bf16_f32 v4, v8, v9
  v_mul_f32 v10, v162, v10
  v_mul_f32 v11, v162, v11
  v_cvt_pk_bf16_f32 v5, v10, v11
  v_mul_f32 v12, v162, v12
  v_mfma_f32_32x32x16_bf16 v[32:47], v[192:195], v[144:147], v[32:47]
  ds_read_b64_tr_b16 v[244:245], v179 offset:8384
  ds_read_b128 v[192:195], v180 offset:9216
  v_mul_f32 v13, v162, v13
  v_cvt_pk_bf16_f32 v6, v12, v13
  v_mul_f32 v14, v162, v14
  v_mul_f32 v15, v162, v15
  v_cvt_pk_bf16_f32 v7, v14, v15
  buffer_store_dwordx4 v[0:3], v174, s[24:27], s60 offen offset:0 sc1
  buffer_store_dwordx4 v[4:7], v174, s[24:27], s60 offen offset:512 sc1
  s_waitcnt lgkmcnt(15)
  v_mfma_f32_32x32x16_bf16 v[32:47], v[196:199], v[148:151], v[32:47]
  ds_read_b64_tr_b16 v[246:247], v179 offset:10944
  ds_read_b64_tr_b16 v[196:197], v178 offset:18560
  ds_read_b64_tr_b16 v[198:199], v178 offset:21120
  v_mul_f32 v16, v162, v16
  v_mul_f32 v17, v162, v17
  v_cvt_pk_bf16_f32 v16, v16, v17
  v_mul_f32 v18, v162, v18
  v_mul_f32 v19, v162, v19
  v_cvt_pk_bf16_f32 v17, v18, v19
  v_mfma_f32_32x32x16_bf16 v[32:47], v[200:203], v[152:155], v[32:47]
  ds_read_b64_tr_b16 v[248:249], v179 offset:8448
  ds_read_b64_tr_b16 v[250:251], v179 offset:11008
  ds_read_b64_tr_b16 v[200:201], v179 offset:18560
  ds_read_b64_tr_b16 v[202:203], v179 offset:21120
  v_mul_f32 v20, v162, v20
  v_mul_f32 v21, v162, v21
  v_cvt_pk_bf16_f32 v18, v20, v21
  v_mul_f32 v22, v162, v22
  v_mul_f32 v23, v162, v23
  v_cvt_pk_bf16_f32 v19, v22, v23
  v_mul_f32 v24, v162, v24
  v_mfma_f32_32x32x16_bf16 v[32:47], v[204:207], v[156:159], v[32:47]
  ds_read_b128 v[252:255], v180 offset:8192
  ds_read_b64_tr_b16 v[204:205], v178 offset:18624
  ds_read_b64_tr_b16 v[206:207], v178 offset:21184
  v_mul_f32 v25, v162, v25
  v_cvt_pk_bf16_f32 v20, v24, v25
  v_mul_f32 v26, v162, v26
  v_mul_f32 v27, v162, v27
  v_cvt_pk_bf16_f32 v21, v26, v27
  v_mul_f32 v28, v162, v28
  s_waitcnt lgkmcnt(15)
  v_mfma_f32_32x32x16_bf16 v[48:63], v[208:211], v[144:147], v[48:63]
  ds_read_b64_tr_b16 v[208:209], v179 offset:18624
  ds_read_b64_tr_b16 v[210:211], v179 offset:21184
  v_mul_f32 v29, v162, v29
  v_cvt_pk_bf16_f32 v22, v28, v29
  v_mul_f32 v30, v162, v30
  v_mul_f32 v31, v162, v31
  v_cvt_pk_bf16_f32 v23, v30, v31
  buffer_store_dwordx4 v[16:19], v174, s[24:27], s61 offen offset:0 sc1
  buffer_store_dwordx4 v[20:23], v174, s[24:27], s61 offen offset:512 sc1
  v_mfma_f32_32x32x16_bf16 v[48:63], v[212:215], v[148:151], v[48:63]
  ds_read_b64_tr_b16 v[212:213], v179 offset:18688
  ds_read_b64_tr_b16 v[214:215], v179 offset:21248
  v_mul_f32 v32, v162, v32
  v_mul_f32 v33, v162, v33
  v_cvt_pk_bf16_f32 v32, v32, v33
  v_mul_f32 v34, v162, v34
  v_mul_f32 v35, v162, v35
  v_cvt_pk_bf16_f32 v33, v34, v35
  v_mul_f32 v36, v162, v36
  v_mul_f32 v37, v162, v37
  v_cvt_pk_bf16_f32 v34, v36, v37
  v_mfma_f32_32x32x16_bf16 v[48:63], v[216:219], v[152:155], v[48:63]
  v_mul_f32 v38, v162, v38
  v_mul_f32 v39, v162, v39
  v_cvt_pk_bf16_f32 v35, v38, v39
  v_mul_f32 v40, v162, v40
  v_mul_f32 v41, v162, v41
  v_cvt_pk_bf16_f32 v36, v40, v41
  v_mul_f32 v42, v162, v42
  v_mul_f32 v43, v162, v43
  s_waitcnt lgkmcnt(15)
  v_mfma_f32_32x32x16_bf16 v[48:63], v[220:223], v[156:159], v[48:63]
  v_cvt_pk_bf16_f32 v37, v42, v43
  v_mul_f32 v44, v162, v44
  v_mul_f32 v45, v162, v45
  v_cvt_pk_bf16_f32 v38, v44, v45
  v_mul_f32 v46, v162, v46
  v_mul_f32 v47, v162, v47
  v_cvt_pk_bf16_f32 v39, v46, v47
  buffer_store_dwordx4 v[32:35], v174, s[24:27], s62 offen offset:0 sc1
  buffer_store_dwordx4 v[36:39], v174, s[24:27], s62 offen offset:512 sc1
  s_waitcnt lgkmcnt(0)
  s_waitcnt vmcnt(15)
  s_barrier
  v_mfma_f32_16x16x32_bf16 v[64:67], v[232:235], v[224:227], 0
  v_mul_f32 v48, v162, v48
  v_mul_f32 v49, v162, v49
  v_cvt_pk_bf16_f32 v48, v48, v49
  ds_read_b128 v[104:107], v180 offset:16384
  ds_read_b128 v[108:111], v180 offset:17408
  v_mfma_f32_16x16x32_bf16 v[84:87], v[232:235], v[228:231], 0
  v_mul_f32 v50, v162, v50
  v_mul_f32 v51, v162, v51
  v_cvt_pk_bf16_f32 v49, v50, v51
  ds_read_b64_tr_b16 v[112:113], v178 offset:28800
  v_mfma_f32_16x16x32_bf16 v[68:71], v[236:239], v[224:227], 0
  v_mul_f32 v52, v162, v52
  v_mul_f32 v53, v162, v53
  v_cvt_pk_bf16_f32 v50, v52, v53
  ds_read_b64_tr_b16 v[114:115], v178 offset:31360
  ds_read_b64_tr_b16 v[116:117], v179 offset:28800
  v_mfma_f32_16x16x32_bf16 v[88:91], v[236:239], v[228:231], 0
  v_mul_f32 v54, v162, v54
  v_mul_f32 v55, v162, v55
  v_cvt_pk_bf16_f32 v51, v54, v55
  ds_read_b64_tr_b16 v[118:119], v179 offset:31360
  v_mfma_f32_16x16x32_bf16 v[72:75], v[240:243], v[224:227], 0
  v_mul_f32 v56, v162, v56
  v_mul_f32 v57, v162, v57
  v_cvt_pk_bf16_f32 v52, v56, v57
  ds_read_b64_tr_b16 v[120:121], v178 offset:28864
  ds_read_b64_tr_b16 v[122:123], v178 offset:31424
  v_mfma_f32_16x16x32_bf16 v[92:95], v[240:243], v[228:231], 0
  v_mul_f32 v58, v162, v58
  v_mul_f32 v59, v162, v59
  v_cvt_pk_bf16_f32 v53, v58, v59
  ds_read_b64_tr_b16 v[124:125], v179 offset:28864
  ds_read_b64_tr_b16 v[126:127], v179 offset:31424
  v_mfma_f32_16x16x32_bf16 v[76:79], v[244:247], v[224:227], 0
  v_mul_f32 v60, v162, v60
  v_mul_f32 v61, v162, v61
  v_cvt_pk_bf16_f32 v54, v60, v61
  ds_read_b64_tr_b16 v[128:129], v179 offset:28928
  v_mfma_f32_16x16x32_bf16 v[96:99], v[244:247], v[228:231], 0
  v_mul_f32 v62, v162, v62
  v_mul_f32 v63, v162, v63
  v_cvt_pk_bf16_f32 v55, v62, v63
  ds_read_b64_tr_b16 v[130:131], v179 offset:31488
  ds_read_b128 v[132:135], v180 offset:24576
  v_mfma_f32_16x16x32_bf16 v[80:83], v[248:251], v[224:227], 0
  ds_read_b128 v[136:139], v180 offset:25600
  buffer_store_dwordx4 v[48:51], v174, s[24:27], s63 offen offset:0 sc1
  buffer_store_dwordx4 v[52:55], v174, s[24:27], s63 offen offset:512 sc1
  v_mfma_f32_16x16x32_bf16 v[100:103], v[248:251], v[228:231], 0
  ds_read_b64_tr_b16 v[140:141], v178 offset:39040
  ds_read_b64_tr_b16 v[142:143], v178 offset:41600
  s_add_u32 m0, s49, 0
  v_mfma_f32_16x16x32_bf16 v[64:67], v[196:199], v[252:255], v[64:67]
  ds_read_b64_tr_b16 v[144:145], v179 offset:39040
  ds_read_b64_tr_b16 v[146:147], v179 offset:41600
  buffer_load_dwordx4 v172, s[84:87], s44 offen offset:0 sc1 lds
  v_mfma_f32_16x16x32_bf16 v[84:87], v[196:199], v[192:195], v[84:87]
  ds_read_b64_tr_b16 v[148:149], v178 offset:39104
  v_mfma_f32_16x16x32_bf16 v[68:71], v[200:203], v[252:255], v[68:71]
  ds_read_b64_tr_b16 v[150:151], v178 offset:41664
  ds_read_b64_tr_b16 v[152:153], v179 offset:39104
  buffer_load_dwordx4 v172, s[84:87], s44 offen offset:1024 sc1 lds
  v_mfma_f32_16x16x32_bf16 v[88:91], v[200:203], v[192:195], v[88:91]
  ds_read_b64_tr_b16 v[154:155], v179 offset:41664
  s_add_u32 s44, s44, 16384
  v_mfma_f32_16x16x32_bf16 v[72:75], v[204:207], v[252:255], v[72:75]
  ds_read_b64_tr_b16 v[156:157], v179 offset:39168
  ds_read_b64_tr_b16 v[158:159], v179 offset:41728
  s_add_u32 m0, s45, 125952
  v_mfma_f32_16x16x32_bf16 v[92:95], v[204:207], v[192:195], v[92:95]
  buffer_load_dwordx4 v191, s[32:35], s43 offen offset:0 lds
  v_mfma_f32_16x16x32_bf16 v[76:79], v[208:211], v[252:255], v[76:79]
  v_mfma_f32_16x16x32_bf16 v[96:99], v[208:211], v[192:195], v[96:99]
  buffer_load_dwordx4 v160, s[32:35], s43 offen offset:1024 lds
  v_mfma_f32_16x16x32_bf16 v[80:83], v[212:215], v[252:255], v[80:83]
  s_add_u32 s43, s43, 81920
  v_mfma_f32_16x16x32_bf16 v[100:103], v[212:215], v[192:195], v[100:103]
  s_cmp_lg_u32 s5, 3
  s_cbranch_scc1 L_p3_nz1
  s_nop 7
  v_mov_b32 v64, 0
  v_mov_b32 v65, 0
  v_mov_b32 v66, 0
  v_mov_b32 v67, 0
  v_mov_b32 v68, 0
  v_mov_b32 v69, 0
  v_mov_b32 v70, 0
  v_mov_b32 v71, 0
  v_mov_b32 v72, 0
  v_mov_b32 v73, 0
  v_mov_b32 v74, 0
  v_mov_b32 v75, 0
  v_mov_b32 v76, 0
  v_mov_b32 v77, 0
  v_mov_b32 v78, 0
  v_mov_b32 v79, 0
  v_mov_b32 v80, 0
  v_mov_b32 v81, 0
  v_mov_b32 v82, 0
  v_mov_b32 v83, 0
  v_mov_b32 v84, 0
  v_mov_b32 v85, 0
  v_mov_b32 v86, 0
  v_mov_b32 v87, 0
  v_mov_b32 v88, 0
  v_mov_b32 v89, 0
  v_mov_b32 v90, 0
  v_mov_b32 v91, 0
  v_mov_b32 v92, 0
  v_mov_b32 v93, 0
  v_mov_b32 v94, 0
  v_mov_b32 v95, 0
  v_mov_b32 v96, 0
  v_mov_b32 v97, 0
  v_mov_b32 v98, 0
  v_mov_b32 v99, 0
  v_mov_b32 v100, 0
  v_mov_b32 v101, 0
  v_mov_b32 v102, 0
  v_mov_b32 v103, 0
  s_nop 1
L_p3_nz1:
  s_waitcnt lgkmcnt(0)
  s_waitcnt vmcnt(17)
  s_waitcnt vmcnt(4)
  s_barrier
  v_mfma_f32_16x16x32_bf16 v[64:67], v[112:115], v[104:107], v[64:67]
  ds_read_b128 v[224:227], v180 offset:32768
  ds_read_b128 v[228:231], v180 offset:33792
  s_lshl_b32 s64, s42, 8
  s_lshr_b32 s59, s65, 4
  v_mfma_f32_16x16x32_bf16 v[84:87], v[112:115], v[108:111], v[84:87]
  ds_read_b64_tr_b16 v[232:233], v176 offset:128
  s_add_u32 m0, s49, 16384
  s_lshl_b32 s59, s59, 7
  v_mfma_f32_16x16x32_bf16 v[68:71], v[116:119], v[104:107], v[68:71]
  ds_read_b64_tr_b16 v[234:235], v176 offset:2688
  ds_read_b64_tr_b16 v[236:237], v177 offset:128
  s_add_u32 s64, s64, s59
  s_and_b32 s59, s40, 3
  v_mfma_f32_16x16x32_bf16 v[88:91], v[116:119], v[108:111], v[88:91]
  ds_read_b64_tr_b16 v[238:239], v177 offset:2688
  buffer_load_dwordx4 v172, s[84:87], s44 offen offset:0 sc1 lds
  s_lshl_b32 s59, s59, 5
  s_add_u32 s64, s64, s59
  v_mfma_f32_16x16x32_bf16 v[72:75], v[120:123], v[104:107], v[72:75]
  ds_read_b64_tr_b16 v[240:241], v176 offset:192
  ds_read_b64_tr_b16 v[242:243], v176 offset:2752
  buffer_load_dwordx4 v172, s[84:87], s44 offen offset:1024 sc1 lds
  s_lshl_b32 s59, s5, 2
  s_add_u32 s64, s64, s59
  v_mfma_f32_16x16x32_bf16 v[92:95], v[120:123], v[108:111], v[92:95]
  ds_read_b64_tr_b16 v[244:245], v177 offset:192
  ds_read_b64_tr_b16 v[246:247], v177 offset:2752
  s_add_u32 s44, s44, 16384
  s_mul_i32 s64, s64, 1280
  v_mfma_f32_16x16x32_bf16 v[76:79], v[124:127], v[104:107], v[76:79]
  ds_read_b64_tr_b16 v[248:249], v177 offset:256
  s_and_b32 s59, s65, 12
  s_mul_i32 s59, s59, 80
  v_mfma_f32_16x16x32_bf16 v[96:99], v[124:127], v[108:111], v[96:99]
  ds_read_b64_tr_b16 v[250:251], v177 offset:2816
  ds_read_b128 v[252:255], v180 offset:40960
  s_add_u32 m0, s45, 143360
  s_add_u32 s64, s64, s59
  v_bfe_u32 v165, v175, 3, 1
  v_mfma_f32_16x16x32_bf16 v[80:83], v[128:131], v[104:107], v[80:83]
  ds_read_b128 v[192:195], v180 offset:41984
  buffer_load_dwordx4 v188, s[32:35], s43 offen offset:0 lds
  v_and_b32 v166, 3, v175
  v_lshl_add_u32 v165, v165, 4, v166
  v_mfma_f32_16x16x32_bf16 v[100:103], v[128:131], v[108:111], v[100:103]
  ds_read_b64_tr_b16 v[196:197], v176 offset:10368
  ds_read_b64_tr_b16 v[198:199], v176 offset:12928
  buffer_load_dwordx4 v189, s[32:35], s43 offen offset:1024 lds
  v_mul_u32_u24 v165, 1280, v165
  v_mfma_f32_16x16x32_bf16 v[64:67], v[140:143], v[132:135], v[64:67]
  ds_read_b64_tr_b16 v[200:201], v177 offset:10368
  ds_read_b64_tr_b16 v[202:203], v177 offset:12928
  v_lshrrev_b32 v167, 4, v175
  v_lshl_add_u32 v165, v167, 4, v165
  v_mfma_f32_16x16x32_bf16 v[84:87], v[140:143], v[136:139], v[84:87]
  ds_read_b64_tr_b16 v[204:205], v176 offset:10432
  buffer_load_dwordx4 v190, s[32:35], s43 offen offset:2048 lds
  v_add_u32 v165, s64, v165
  v_bfe_u32 v168, v175, 2, 1
  v_mfma_f32_16x16x32_bf16 v[68:71], v[144:147], v[132:135], v[68:71]
  ds_read_b64_tr_b16 v[206:207], v176 offset:12992
  ds_read_b64_tr_b16 v[208:209], v177 offset:10432
  s_add_u32 s43, s43, 81920
  v_lshl_add_u32 v182, v168, 6, v165
  v_lshl_add_u32 v183, v168, 2, v165
  v_mfma_f32_16x16x32_bf16 v[88:91], v[144:147], v[136:139], v[88:91]
  ds_read_b64_tr_b16 v[210:211], v177 offset:12992
  v_and_b32 v168, 1, v167
  v_mfma_f32_16x16x32_bf16 v[72:75], v[148:151], v[132:135], v[72:75]
  ds_read_b64_tr_b16 v[212:213], v177 offset:10496
  ds_read_b64_tr_b16 v[214:215], v177 offset:13056
  v_xor_b32 v168, 1, v168
  v_lshl_add_u32 v183, v168, 3, v183
  v_mfma_f32_16x16x32_bf16 v[92:95], v[148:151], v[136:139], v[92:95]
  v_bfe_u32 v168, v175, 2, 2
  v_mul_u32_u24 v165, 40960, v168
  v_mfma_f32_16x16x32_bf16 v[76:79], v[152:155], v[132:135], v[76:79]
  v_lshl_add_u32 v165, v167, 6, v165
  v_lshl_add_u32 v165, v166, 4, v165
  v_mfma_f32_16x16x32_bf16 v[96:99], v[152:155], v[136:139], v[96:99]
  s_mul_i32 s59, s5, 10240
  v_mfma_f32_16x16x32_bf16 v[80:83], v[156:159], v[132:135], v[80:83]
  v_add_u32 v165, s59, v165
  v_bfrev_b32 v166, 2
  v_mfma_f32_16x16x32_bf16 v[100:103], v[156:159], v[136:139], v[100:103]
  v_cmp_eq_u32 vcc, s5, v168
  s_nop 1
  v_cndmask_b32 v184, v165, v166, vcc
  s_waitcnt lgkmcnt(0)
  s_barrier
  v_mfma_f32_16x16x32_bf16 v[64:67], v[232:235], v[224:227], v[64:67]
  ds_read_b128 v[104:107], v181 offset:32768
  ds_read_b128 v[108:111], v181 offset:33792
  v_mfma_f32_16x16x32_bf16 v[84:87], v[232:235], v[228:231], v[84:87]
  ds_read_b64_tr_b16 v[112:113], v176 offset:20608
  s_add_u32 m0, s49, 32768
  v_mfma_f32_16x16x32_bf16 v[68:71], v[236:239], v[224:227], v[68:71]
  ds_read_b64_tr_b16 v[114:115], v176 offset:23168
  ds_read_b64_tr_b16 v[116:117], v177 offset:20608
  v_mfma_f32_16x16x32_bf16 v[88:91], v[236:239], v[228:231], v[88:91]
  ds_read_b64_tr_b16 v[118:119], v177 offset:23168
  buffer_load_dwordx4 v172, s[84:87], s44 offen offset:0 sc1 lds
  v_mfma_f32_16x16x32_bf16 v[72:75], v[240:243], v[224:227], v[72:75]
  ds_read_b64_tr_b16 v[120:121], v176 offset:20672
  ds_read_b64_tr_b16 v[122:123], v176 offset:23232
  v_mfma_f32_16x16x32_bf16 v[92:95], v[240:243], v[228:231], v[92:95]
  ds_read_b64_tr_b16 v[124:125], v177 offset:20672
  ds_read_b64_tr_b16 v[126:127], v177 offset:23232
  buffer_load_dwordx4 v172, s[84:87], s44 offen offset:1024 sc1 lds
  v_mfma_f32_16x16x32_bf16 v[76:79], v[244:247], v[224:227], v[76:79]
  ds_read_b64_tr_b16 v[128:129], v177 offset:20736
  v_mfma_f32_16x16x32_bf16 v[96:99], v[244:247], v[228:231], v[96:99]
  ds_read_b64_tr_b16 v[130:131], v177 offset:23296
  ds_read_b128 v[132:135], v181 offset:57344
  s_add_u32 s44, s44, 16384
  v_mfma_f32_16x16x32_bf16 v[80:83], v[248:251], v[224:227], v[80:83]
  ds_read_b128 v[136:139], v181 offset:58368
  s_add_u32 m0, s45, 52224
  v_mfma_f32_16x16x32_bf16 v[100:103], v[248:251], v[228:231], v[100:103]
  ds_read_b64_tr_b16 v[140:141], v176 offset:30848
  ds_read_b64_tr_b16 v[142:143], v176 offset:33408
  v_mfma_f32_16x16x32_bf16 v[64:67], v[196:199], v[252:255], v[64:67]
  ds_read_b64_tr_b16 v[144:145], v177 offset:30848
  ds_read_b64_tr_b16 v[146:147], v177 offset:33408
  buffer_load_dwordx4 v191, s[32:35], s43 offen offset:0 lds
  v_mfma_f32_16x16x32_bf16 v[84:87], v[196:199], v[192:195], v[84:87]
  ds_read_b64_tr_b16 v[148:149], v176 offset:30912
  v_mfma_f32_16x16x32_bf16 v[68:71], v[200:203], v[252:255], v[68:71]
  ds_read_b64_tr_b16 v[150:151], v176 offset:33472
  ds_read_b64_tr_b16 v[152:153], v177 offset:30912
  buffer_load_dwordx4 v160, s[32:35], s43 offen offset:1024 lds
  v_mfma_f32_16x16x32_bf16 v[88:91], v[200:203], v[192:195], v[88:91]
  ds_read_b64_tr_b16 v[154:155], v177 offset:33472
  v_mfma_f32_16x16x32_bf16 v[72:75], v[204:207], v[252:255], v[72:75]
  ds_read_b64_tr_b16 v[156:157], v177 offset:30976
  ds_read_b64_tr_b16 v[158:159], v177 offset:33536
  v_mfma_f32_16x16x32_bf16 v[92:95], v[204:207], v[192:195], v[92:95]
  v_mfma_f32_16x16x32_bf16 v[76:79], v[208:211], v[252:255], v[76:79]
  s_lshr_b32 s96, s65, 3
  s_lshl_b32 s96, s96, 1
  s_lshl_b32 s96, 0x300, s96
  v_mfma_f32_16x16x32_bf16 v[96:99], v[208:211], v[192:195], v[96:99]
  v_mfma_f32_16x16x32_bf16 v[80:83], v[212:215], v[252:255], v[80:83]
  v_mfma_f32_16x16x32_bf16 v[100:103], v[212:215], v[192:195], v[100:103]
  s_waitcnt lgkmcnt(0)
  s_waitcnt vmcnt(9)
  s_barrier
  v_mfma_f32_16x16x32_bf16 v[64:67], v[112:115], v[104:107], v[64:67]
  ds_read_b128 v[224:227], v180 offset:0
  ds_read_b128 v[228:231], v180 offset:1024
  v_mfma_f32_16x16x32_bf16 v[84:87], v[112:115], v[108:111], v[84:87]
  ds_read_b64_tr_b16 v[232:233], v178 offset:8320
  s_mul_i32 s43, s5, 1310720
  v_mfma_f32_16x16x32_bf16 v[68:71], v[116:119], v[104:107], v[68:71]
  ds_read_b64_tr_b16 v[234:235], v178 offset:10880
  ds_read_b64_tr_b16 v[236:237], v179 offset:8320
  s_and_b32 s47, s40, 2
  v_mfma_f32_16x16x32_bf16 v[88:91], v[116:119], v[108:111], v[88:91]
  ds_read_b64_tr_b16 v[238:239], v179 offset:10880
  s_mul_i32 s47, s47, 61440
  v_mfma_f32_16x16x32_bf16 v[72:75], v[120:123], v[104:107], v[72:75]
  ds_read_b64_tr_b16 v[240:241], v178 offset:8384
  ds_read_b64_tr_b16 v[242:243], v178 offset:10944
  s_add_u32 s43, s43, s47
  v_mfma_f32_16x16x32_bf16 v[92:95], v[120:123], v[108:111], v[92:95]
  ds_read_b64_tr_b16 v[244:245], v179 offset:8384
  ds_read_b64_tr_b16 v[246:247], v179 offset:10944
  s_lshr_b32 s97, s65, 3
  v_mfma_f32_16x16x32_bf16 v[76:79], v[124:127], v[104:107], v[76:79]
  ds_read_b64_tr_b16 v[248:249], v179 offset:8448
  s_lshl2_add_u32 s43, s5, s97
  v_mfma_f32_16x16x32_bf16 v[96:99], v[124:127], v[108:111], v[96:99]
  ds_read_b64_tr_b16 v[250:251], v179 offset:11008
  ds_read_b128 v[252:255], v180 offset:8192
  s_mul_i32 s43, s43, 327680
  s_add_u32 s43, s43, s47
  v_mfma_f32_16x16x32_bf16 v[80:83], v[128:131], v[104:107], v[80:83]
  ds_read_b128 v[192:195], v180 offset:9216
  s_add_u32 m0, s45, 69632
  v_mfma_f32_16x16x32_bf16 v[100:103], v[128:131], v[108:111], v[100:103]
  ds_read_b64_tr_b16 v[196:197], v178 offset:18560
  ds_read_b64_tr_b16 v[198:199], v178 offset:21120
  buffer_load_dwordx4 v188, s[36:39], s43 offen offset:0 lds
  v_mfma_f32_16x16x32_bf16 v[64:67], v[140:143], v[132:135], v[64:67]
  ds_read_b64_tr_b16 v[200:201], v179 offset:18560
  ds_read_b64_tr_b16 v[202:203], v179 offset:21120
  buffer_load_dwordx4 v189, s[36:39], s43 offen offset:1024 lds
  v_mfma_f32_16x16x32_bf16 v[84:87], v[140:143], v[136:139], v[84:87]
  ds_read_b64_tr_b16 v[204:205], v178 offset:18624
  buffer_load_dwordx4 v190, s[36:39], s43 offen offset:2048 lds
  v_mfma_f32_16x16x32_bf16 v[68:71], v[144:147], v[132:135], v[68:71]
  ds_read_b64_tr_b16 v[206:207], v178 offset:21184
  ds_read_b64_tr_b16 v[208:209], v179 offset:18624
  s_add_u32 s43, s43, 40960
  v_mfma_f32_16x16x32_bf16 v[88:91], v[144:147], v[136:139], v[88:91]
  ds_read_b64_tr_b16 v[210:211], v179 offset:21184
  buffer_load_dword v171, v164, s[68:71], 0 offen sc1
  v_mfma_f32_16x16x32_bf16 v[72:75], v[148:151], v[132:135], v[72:75]
  ds_read_b64_tr_b16 v[212:213], v179 offset:18688
  ds_read_b64_tr_b16 v[214:215], v179 offset:21248
  v_mfma_f32_16x16x32_bf16 v[92:95], v[148:151], v[136:139], v[92:95]
  v_mfma_f32_16x16x32_bf16 v[76:79], v[152:155], v[132:135], v[76:79]
  v_mfma_f32_16x16x32_bf16 v[96:99], v[152:155], v[136:139], v[96:99]
  v_mfma_f32_16x16x32_bf16 v[80:83], v[156:159], v[132:135], v[80:83]
  v_mfma_f32_16x16x32_bf16 v[100:103], v[156:159], v[136:139], v[100:103]
  s_waitcnt lgkmcnt(0)
  s_waitcnt vmcnt(8)
  s_barrier
  v_mfma_f32_16x16x32_bf16 v[64:67], v[232:235], v[224:227], v[64:67]
  ds_read_b128 v[104:107], v180 offset:16384
  ds_read_b128 v[108:111], v180 offset:17408
  s_waitcnt vmcnt(0)
  v_cmp_gt_u32 vcc, 4, v171
  s_nop 1
  s_and_b32 s64, vcc_lo, s96
  s_cbranch_scc1 L_spin_o1_5
L_ok_o1_5:
  v_mfma_f32_16x16x32_bf16 v[84:87], v[232:235], v[228:231], v[84:87]
  ds_read_b64_tr_b16 v[112:113], v178 offset:28800
  s_lshl_b32 s44, s65, 11
  v_mfma_f32_16x16x32_bf16 v[68:71], v[236:239], v[224:227], v[68:71]
  ds_read_b64_tr_b16 v[114:115], v178 offset:31360
  ds_read_b64_tr_b16 v[116:117], v179 offset:28800
  s_bfe_u32 s44, s44, 0x2000e
  s_lshl4_add_u32 s44, s5, s44
  v_mfma_f32_16x16x32_bf16 v[88:91], v[236:239], v[228:231], v[88:91]
  ds_read_b64_tr_b16 v[118:119], v179 offset:31360
  s_lshl_b32 s44, s44, 14
  v_mfma_f32_16x16x32_bf16 v[72:75], v[240:243], v[224:227], v[72:75]
  ds_read_b64_tr_b16 v[120:121], v178 offset:28864
  ds_read_b64_tr_b16 v[122:123], v178 offset:31424
  s_add_u32 m0, s49, 106496
  v_mfma_f32_16x16x32_bf16 v[92:95], v[240:243], v[228:231], v[92:95]
  ds_read_b64_tr_b16 v[124:125], v179 offset:28864
  ds_read_b64_tr_b16 v[126:127], v179 offset:31424
  buffer_load_dwordx4 v172, s[84:87], s44 offen offset:0 sc1 lds
  buffer_load_dwordx4 v172, s[84:87], s44 offen offset:1024 sc1 lds
  v_mfma_f32_16x16x32_bf16 v[76:79], v[244:247], v[224:227], v[76:79]
  ds_read_b64_tr_b16 v[128:129], v179 offset:28928
  s_add_u32 s44, s44, 65536
  v_mfma_f32_16x16x32_bf16 v[96:99], v[244:247], v[228:231], v[96:99]
  ds_read_b64_tr_b16 v[130:131], v179 offset:31488
  ds_read_b128 v[132:135], v180 offset:24576
  s_add_u32 m0, s49, 0
  v_mfma_f32_16x16x32_bf16 v[80:83], v[248:251], v[224:227], v[80:83]
  ds_read_b128 v[136:139], v180 offset:25600
  buffer_load_dwordx4 v172, s[84:87], s44 offen offset:0 sc1 lds
  buffer_load_dwordx4 v172, s[84:87], s44 offen offset:1024 sc1 lds
  v_mfma_f32_16x16x32_bf16 v[100:103], v[248:251], v[228:231], v[100:103]
  ds_read_b64_tr_b16 v[140:141], v178 offset:39040
  ds_read_b64_tr_b16 v[142:143], v178 offset:41600
  s_add_u32 s44, s44, 65536
  v_mfma_f32_16x16x32_bf16 v[64:67], v[196:199], v[252:255], v[64:67]
  ds_read_b64_tr_b16 v[144:145], v179 offset:39040
  ds_read_b64_tr_b16 v[146:147], v179 offset:41600
  s_add_u32 m0, s45, 125952
  v_mfma_f32_16x16x32_bf16 v[84:87], v[196:199], v[192:195], v[84:87]
  ds_read_b64_tr_b16 v[148:149], v178 offset:39104
  buffer_load_dwordx4 v191, s[36:39], s43 offen offset:0 lds
  buffer_load_dwordx4 v160, s[36:39], s43 offen offset:1024 lds
  v_mfma_f32_16x16x32_bf16 v[68:71], v[200:203], v[252:255], v[68:71]
  ds_read_b64_tr_b16 v[150:151], v178 offset:41664
  ds_read_b64_tr_b16 v[152:153], v179 offset:39104
  s_add_u32 s43, s43, 40960
  v_mfma_f32_16x16x32_bf16 v[88:91], v[200:203], v[192:195], v[88:91]
  ds_read_b64_tr_b16 v[154:155], v179 offset:41664
  buffer_load_dword v170, off, s[72:75], 0 offset:128 sc1
  v_mfma_f32_16x16x32_bf16 v[72:75], v[204:207], v[252:255], v[72:75]
  ds_read_b64_tr_b16 v[156:157], v179 offset:39168
  ds_read_b64_tr_b16 v[158:159], v179 offset:41728
  v_mfma_f32_16x16x32_bf16 v[92:95], v[204:207], v[192:195], v[92:95]
  v_mfma_f32_16x16x32_bf16 v[76:79], v[208:211], v[252:255], v[76:79]
  v_mfma_f32_16x16x32_bf16 v[96:99], v[208:211], v[192:195], v[96:99]
  v_mfma_f32_16x16x32_bf16 v[80:83], v[212:215], v[252:255], v[80:83]
  v_mfma_f32_16x16x32_bf16 v[100:103], v[212:215], v[192:195], v[100:103]
  s_waitcnt lgkmcnt(0)
  s_barrier
  v_mfma_f32_16x16x32_bf16 v[64:67], v[112:115], v[104:107], v[64:67]
  ds_read_b128 v[224:227], v180 offset:32768
  ds_read_b128 v[228:231], v180 offset:33792
  v_mfma_f32_16x16x32_bf16 v[84:87], v[112:115], v[108:111], v[84:87]
  ds_read_b64_tr_b16 v[232:233], v176 offset:128
  s_add_u32 m0, s49, 16384
  v_mfma_f32_16x16x32_bf16 v[68:71], v[116:119], v[104:107], v[68:71]
  ds_read_b64_tr_b16 v[234:235], v176 offset:2688
  ds_read_b64_tr_b16 v[236:237], v177 offset:128
  v_mfma_f32_16x16x32_bf16 v[88:91], v[116:119], v[108:111], v[88:91]
  ds_read_b64_tr_b16 v[238:239], v177 offset:2688
  buffer_load_dwordx4 v172, s[84:87], s44 offen offset:0 sc1 lds
  v_mfma_f32_16x16x32_bf16 v[72:75], v[120:123], v[104:107], v[72:75]
  ds_read_b64_tr_b16 v[240:241], v176 offset:192
  ds_read_b64_tr_b16 v[242:243], v176 offset:2752
  buffer_load_dwordx4 v172, s[84:87], s44 offen offset:1024 sc1 lds
  v_mfma_f32_16x16x32_bf16 v[92:95], v[120:123], v[108:111], v[92:95]
  ds_read_b64_tr_b16 v[244:245], v177 offset:192
  ds_read_b64_tr_b16 v[246:247], v177 offset:2752
  s_add_u32 s44, s44, 65536
  v_mfma_f32_16x16x32_bf16 v[76:79], v[124:127], v[104:107], v[76:79]
  ds_read_b64_tr_b16 v[248:249], v177 offset:256
  v_mfma_f32_16x16x32_bf16 v[96:99], v[124:127], v[108:111], v[96:99]
  ds_read_b64_tr_b16 v[250:251], v177 offset:2816
  ds_read_b128 v[252:255], v180 offset:40960
  s_add_u32 m0, s45, 143360
  v_mfma_f32_16x16x32_bf16 v[80:83], v[128:131], v[104:107], v[80:83]
  ds_read_b128 v[192:195], v180 offset:41984
  buffer_load_dwordx4 v188, s[36:39], s43 offen offset:0 lds
  v_mfma_f32_16x16x32_bf16 v[100:103], v[128:131], v[108:111], v[100:103]
  ds_read_b64_tr_b16 v[196:197], v176 offset:10368
  ds_read_b64_tr_b16 v[198:199], v176 offset:12928
  buffer_load_dwordx4 v189, s[36:39], s43 offen offset:1024 lds
  v_mfma_f32_16x16x32_bf16 v[64:67], v[140:143], v[132:135], v[64:67]
  ds_read_b64_tr_b16 v[200:201], v177 offset:10368
  ds_read_b64_tr_b16 v[202:203], v177 offset:12928
  v_mfma_f32_16x16x32_bf16 v[84:87], v[140:143], v[136:139], v[84:87]
  ds_read_b64_tr_b16 v[204:205], v176 offset:10432
  buffer_load_dwordx4 v190, s[36:39], s43 offen offset:2048 lds
  v_mfma_f32_16x16x32_bf16 v[68:71], v[144:147], v[132:135], v[68:71]
  ds_read_b64_tr_b16 v[206:207], v176 offset:12992
  ds_read_b64_tr_b16 v[208:209], v177 offset:10432
  s_add_u32 s43, s43, 40960
  v_mfma_f32_16x16x32_bf16 v[88:91], v[144:147], v[136:139], v[88:91]
  ds_read_b64_tr_b16 v[210:211], v177 offset:12992
  v_mfma_f32_16x16x32_bf16 v[72:75], v[148:151], v[132:135], v[72:75]
  ds_read_b64_tr_b16 v[212:213], v177 offset:10496
  ds_read_b64_tr_b16 v[214:215], v177 offset:13056
  v_mfma_f32_16x16x32_bf16 v[92:95], v[148:151], v[136:139], v[92:95]
  v_mfma_f32_16x16x32_bf16 v[76:79], v[152:155], v[132:135], v[76:79]
  v_mfma_f32_16x16x32_bf16 v[96:99], v[152:155], v[136:139], v[96:99]
  v_mfma_f32_16x16x32_bf16 v[80:83], v[156:159], v[132:135], v[80:83]
  v_mfma_f32_16x16x32_bf16 v[100:103], v[156:159], v[136:139], v[100:103]
  s_waitcnt lgkmcnt(0)
  s_waitcnt vmcnt(10)
  s_barrier
  v_mfma_f32_16x16x32_bf16 v[64:67], v[232:235], v[224:227], v[64:67]
  ds_read_b128 v[104:107], v181 offset:32768
  ds_read_b128 v[108:111], v181 offset:33792
  v_mfma_f32_16x16x32_bf16 v[84:87], v[232:235], v[228:231], v[84:87]
  ds_read_b64_tr_b16 v[112:113], v176 offset:20608
  s_add_u32 m0, s49, 32768
  v_mfma_f32_16x16x32_bf16 v[68:71], v[236:239], v[224:227], v[68:71]
  ds_read_b64_tr_b16 v[114:115], v176 offset:23168
  ds_read_b64_tr_b16 v[116:117], v177 offset:20608
  v_mfma_f32_16x16x32_bf16 v[88:91], v[236:239], v[228:231], v[88:91]
  ds_read_b64_tr_b16 v[118:119], v177 offset:23168
  buffer_load_dwordx4 v172, s[84:87], s44 offen offset:0 sc1 lds
  v_mfma_f32_16x16x32_bf16 v[72:75], v[240:243], v[224:227], v[72:75]
  ds_read_b64_tr_b16 v[120:121], v176 offset:20672
  ds_read_b64_tr_b16 v[122:123], v176 offset:23232
  buffer_load_dwordx4 v172, s[84:87], s44 offen offset:1024 sc1 lds
  v_mfma_f32_16x16x32_bf16 v[92:95], v[240:243], v[228:231], v[92:95]
  ds_read_b64_tr_b16 v[124:125], v177 offset:20672
  ds_read_b64_tr_b16 v[126:127], v177 offset:23232
  v_mfma_f32_16x16x32_bf16 v[76:79], v[244:247], v[224:227], v[76:79]
  ds_read_b64_tr_b16 v[128:129], v177 offset:20736
  s_add_u32 s44, s44, 65536
  v_mfma_f32_16x16x32_bf16 v[96:99], v[244:247], v[228:231], v[96:99]
  ds_read_b64_tr_b16 v[130:131], v177 offset:23296
  ds_read_b128 v[132:135], v181 offset:57344
  s_add_u32 m0, s45, 52224
  v_mfma_f32_16x16x32_bf16 v[80:83], v[248:251], v[224:227], v[80:83]
  ds_read_b128 v[136:139], v181 offset:58368
  v_mfma_f32_16x16x32_bf16 v[100:103], v[248:251], v[228:231], v[100:103]
  ds_read_b64_tr_b16 v[140:141], v176 offset:30848
  ds_read_b64_tr_b16 v[142:143], v176 offset:33408
  buffer_load_dwordx4 v191, s[36:39], s43 offen offset:0 lds
  v_mfma_f32_16x16x32_bf16 v[64:67], v[196:199], v[252:255], v[64:67]
  ds_read_b64_tr_b16 v[144:145], v177 offset:30848
  ds_read_b64_tr_b16 v[146:147], v177 offset:33408
  buffer_load_dwordx4 v160, s[36:39], s43 offen offset:1024 lds
  v_mfma_f32_16x16x32_bf16 v[84:87], v[196:199], v[192:195], v[84:87]
  ds_read_b64_tr_b16 v[148:149], v176 offset:30912
  v_mfma_f32_16x16x32_bf16 v[68:71], v[200:203], v[252:255], v[68:71]
  ds_read_b64_tr_b16 v[150:151], v176 offset:33472
  ds_read_b64_tr_b16 v[152:153], v177 offset:30912
  s_add_u32 s43, s43, 40960
  v_mfma_f32_16x16x32_bf16 v[88:91], v[200:203], v[192:195], v[88:91]
  ds_read_b64_tr_b16 v[154:155], v177 offset:33472
  v_mfma_f32_16x16x32_bf16 v[72:75], v[204:207], v[252:255], v[72:75]
  ds_read_b64_tr_b16 v[156:157], v177 offset:30976
  ds_read_b64_tr_b16 v[158:159], v177 offset:33536
  v_mfma_f32_16x16x32_bf16 v[92:95], v[204:207], v[192:195], v[92:95]
  v_mfma_f32_16x16x32_bf16 v[76:79], v[208:211], v[252:255], v[76:79]
  v_mfma_f32_16x16x32_bf16 v[96:99], v[208:211], v[192:195], v[96:99]
  v_mfma_f32_16x16x32_bf16 v[80:83], v[212:215], v[252:255], v[80:83]
  v_mfma_f32_16x16x32_bf16 v[100:103], v[212:215], v[192:195], v[100:103]
  s_waitcnt lgkmcnt(0)
  s_waitcnt vmcnt(10)
  s_barrier
  v_mfma_f32_16x16x32_bf16 v[0:3], v[112:115], v[104:107], 0
  ds_read_b128 v[224:227], v180 offset:0
  ds_read_b128 v[228:231], v180 offset:1024
  v_mfma_f32_16x16x32_bf16 v[20:23], v[112:115], v[108:111], 0
  ds_read_b64_tr_b16 v[232:233], v178 offset:8320
  s_add_u32 s97, s97, 1
  s_waitcnt vmcnt(9)
  v_cmp_ne_u32 vcc, 256, v170
  s_nop 1
  s_and_b32 s64, vcc_lo, 0x1
  s_cbranch_scc1 L_spin_d1
L_ok_d1:
  v_mfma_f32_16x16x32_bf16 v[4:7], v[116:119], v[104:107], 0
  ds_read_b64_tr_b16 v[234:235], v178 offset:10880
  ds_read_b64_tr_b16 v[236:237], v179 offset:8320
  s_and_b32 s97, s97, 3
  v_cvt_pk_bf16_f32 v64, v64, v65
  v_cvt_pk_bf16_f32 v65, v66, v67
  v_mfma_f32_16x16x32_bf16 v[24:27], v[116:119], v[108:111], 0
  ds_read_b64_tr_b16 v[238:239], v179 offset:10880
  v_cvt_pk_bf16_f32 v66, v68, v69
  v_cvt_pk_bf16_f32 v67, v70, v71
  v_mfma_f32_16x16x32_bf16 v[8:11], v[120:123], v[104:107], 0
  ds_read_b64_tr_b16 v[240:241], v178 offset:8384
  ds_read_b64_tr_b16 v[242:243], v178 offset:10944
  s_lshl2_add_u32 s43, s5, s97
  v_cvt_pk_bf16_f32 v68, v72, v73
  v_mfma_f32_16x16x32_bf16 v[28:31], v[120:123], v[108:111], 0
  ds_read_b64_tr_b16 v[244:245], v179 offset:8384
  ds_read_b64_tr_b16 v[246:247], v179 offset:10944
  s_mul_i32 s43, s43, 327680
  v_cvt_pk_bf16_f32 v69, v74, v75
  v_cvt_pk_bf16_f32 v70, v76, v77
  v_mfma_f32_16x16x32_bf16 v[12:15], v[124:127], v[104:107], 0
  ds_read_b64_tr_b16 v[248:249], v179 offset:8448
  s_add_u32 s43, s43, s47
  v_cvt_pk_bf16_f32 v71, v78, v79
  v_cvt_pk_bf16_f32 v72, v80, v81
  v_mfma_f32_16x16x32_bf16 v[32:35], v[124:127], v[108:111], 0
  ds_read_b64_tr_b16 v[250:251], v179 offset:11008
  ds_read_b128 v[252:255], v180 offset:8192
  s_add_u32 m0, s45, 69632
  v_cvt_pk_bf16_f32 v73, v82, v83
  v_cvt_pk_bf16_f32 v74, v84, v85
  v_mfma_f32_16x16x32_bf16 v[16:19], v[128:131], v[104:107], 0
  ds_read_b128 v[192:195], v180 offset:9216
  buffer_load_dwordx4 v188, s[36:39], s43 offen offset:0 lds
  v_cvt_pk_bf16_f32 v75, v86, v87
  v_cvt_pk_bf16_f32 v76, v88, v89
  v_mfma_f32_16x16x32_bf16 v[36:39], v[128:131], v[108:111], 0
  ds_read_b64_tr_b16 v[196:197], v178 offset:18560
  ds_read_b64_tr_b16 v[198:199], v178 offset:21120
  v_cvt_pk_bf16_f32 v77, v90, v91
  v_cvt_pk_bf16_f32 v78, v92, v93
  v_mfma_f32_16x16x32_bf16 v[0:3], v[140:143], v[132:135], v[0:3]
  ds_read_b64_tr_b16 v[200:201], v179 offset:18560
  ds_read_b64_tr_b16 v[202:203], v179 offset:21120
  buffer_load_dwordx4 v189, s[36:39], s43 offen offset:1024 lds
  v_cvt_pk_bf16_f32 v79, v94, v95
  v_mfma_f32_16x16x32_bf16 v[20:23], v[140:143], v[136:139], v[20:23]
  ds_read_b64_tr_b16 v[204:205], v178 offset:18624
  buffer_load_dwordx4 v190, s[36:39], s43 offen offset:2048 lds
  v_cvt_pk_bf16_f32 v80, v96, v97
  v_cvt_pk_bf16_f32 v81, v98, v99
  v_mfma_f32_16x16x32_bf16 v[4:7], v[144:147], v[132:135], v[4:7]
  ds_read_b64_tr_b16 v[206:207], v178 offset:21184
  ds_read_b64_tr_b16 v[208:209], v179 offset:18624
  s_add_u32 s43, s43, 40960
  v_cvt_pk_bf16_f32 v82, v100, v101
  v_cvt_pk_bf16_f32 v83, v102, v103
  v_mfma_f32_16x16x32_bf16 v[24:27], v[144:147], v[136:139], v[24:27]
  ds_read_b64_tr_b16 v[210:211], v179 offset:21184
  buffer_load_dword v171, v164, s[68:71], 0 offen sc1
  buffer_store_dwordx4 v[64:67], v184, s[88:91], 0 offen offset:0 sc1
  v_mfma_f32_16x16x32_bf16 v[8:11], v[148:151], v[132:135], v[8:11]
  ds_read_b64_tr_b16 v[212:213], v179 offset:18688
  ds_read_b64_tr_b16 v[214:215], v179 offset:21248
  v_mfma_f32_16x16x32_bf16 v[28:31], v[148:151], v[136:139], v[28:31]
  v_mfma_f32_16x16x32_bf16 v[12:15], v[152:155], v[132:135], v[12:15]
  v_mfma_f32_16x16x32_bf16 v[32:35], v[152:155], v[136:139], v[32:35]
  v_mfma_f32_16x16x32_bf16 v[16:19], v[156:159], v[132:135], v[16:19]
  v_mfma_f32_16x16x32_bf16 v[36:39], v[156:159], v[136:139], v[36:39]
  s_waitcnt lgkmcnt(0)
  s_waitcnt vmcnt(9)
  s_barrier
  v_mfma_f32_16x16x32_bf16 v[0:3], v[232:235], v[224:227], v[0:3]
  ds_read_b128 v[104:107], v180 offset:16384
  ds_read_b128 v[108:111], v180 offset:17408
  s_waitcnt vmcnt(1)
  v_cmp_gt_u32 vcc, 4, v171
  s_nop 1
  s_and_b32 s64, vcc_lo, 0xff00
  s_cbranch_scc1 L_spin_o1_9
L_ok_o1_9:
  v_mfma_f32_16x16x32_bf16 v[20:23], v[232:235], v[228:231], v[20:23]
  ds_read_b64_tr_b16 v[112:113], v178 offset:28800
  s_add_u32 s44, s44, 16384
  v_mfma_f32_16x16x32_bf16 v[4:7], v[236:239], v[224:227], v[4:7]
  ds_read_b64_tr_b16 v[114:115], v178 offset:31360
  ds_read_b64_tr_b16 v[116:117], v179 offset:28800
  s_bfe_u32 s44, s44, 0x2000e
  s_lshl4_add_u32 s44, s5, s44
  v_mfma_f32_16x16x32_bf16 v[24:27], v[236:239], v[228:231], v[24:27]
  ds_read_b64_tr_b16 v[118:119], v179 offset:31360
  s_lshl_b32 s44, s44, 14
  v_mfma_f32_16x16x32_bf16 v[8:11], v[240:243], v[224:227], v[8:11]
  ds_read_b64_tr_b16 v[120:121], v178 offset:28864
  ds_read_b64_tr_b16 v[122:123], v178 offset:31424
  s_add_u32 m0, s49, 106496
  v_mfma_f32_16x16x32_bf16 v[28:31], v[240:243], v[228:231], v[28:31]
  ds_read_b64_tr_b16 v[124:125], v179 offset:28864
  ds_read_b64_tr_b16 v[126:127], v179 offset:31424
  buffer_load_dwordx4 v172, s[84:87], s44 offen offset:0 sc1 lds
  buffer_load_dwordx4 v172, s[84:87], s44 offen offset:1024 sc1 lds
  v_mfma_f32_16x16x32_bf16 v[12:15], v[244:247], v[224:227], v[12:15]
  ds_read_b64_tr_b16 v[128:129], v179 offset:28928
  s_add_u32 s44, s44, 65536
  v_mfma_f32_16x16x32_bf16 v[32:35], v[244:247], v[228:231], v[32:35]
  ds_read_b64_tr_b16 v[130:131], v179 offset:31488
  ds_read_b128 v[132:135], v180 offset:24576
  s_add_u32 m0, s49, 0
  v_mfma_f32_16x16x32_bf16 v[16:19], v[248:251], v[224:227], v[16:19]
  ds_read_b128 v[136:139], v180 offset:25600
  buffer_load_dwordx4 v172, s[84:87], s44 offen offset:0 sc1 lds
  buffer_load_dwordx4 v172, s[84:87], s44 offen offset:1024 sc1 lds
  v_mfma_f32_16x16x32_bf16 v[36:39], v[248:251], v[228:231], v[36:39]
  ds_read_b64_tr_b16 v[140:141], v178 offset:39040
  ds_read_b64_tr_b16 v[142:143], v178 offset:41600
  s_add_u32 s44, s44, 65536
  v_mfma_f32_16x16x32_bf16 v[0:3], v[196:199], v[252:255], v[0:3]
  ds_read_b64_tr_b16 v[144:145], v179 offset:39040
  ds_read_b64_tr_b16 v[146:147], v179 offset:41600
  s_add_u32 m0, s45, 125952
  v_mfma_f32_16x16x32_bf16 v[20:23], v[196:199], v[192:195], v[20:23]
  ds_read_b64_tr_b16 v[148:149], v178 offset:39104
  buffer_load_dwordx4 v191, s[36:39], s43 offen offset:0 lds
  buffer_load_dwordx4 v160, s[36:39], s43 offen offset:1024 lds
  v_mfma_f32_16x16x32_bf16 v[4:7], v[200:203], v[252:255], v[4:7]
  ds_read_b64_tr_b16 v[150:151], v178 offset:41664
  ds_read_b64_tr_b16 v[152:153], v179 offset:39104
  s_add_u32 s43, s43, 40960
  v_mfma_f32_16x16x32_bf16 v[24:27], v[200:203], v[192:195], v[24:27]
  ds_read_b64_tr_b16 v[154:155], v179 offset:41664
  v_mfma_f32_16x16x32_bf16 v[8:11], v[204:207], v[252:255], v[8:11]
  ds_read_b64_tr_b16 v[156:157], v179 offset:39168
  ds_read_b64_tr_b16 v[158:159], v179 offset:41728
  v_mfma_f32_16x16x32_bf16 v[28:31], v[204:207], v[192:195], v[28:31]
  v_mfma_f32_16x16x32_bf16 v[12:15], v[208:211], v[252:255], v[12:15]
  v_mfma_f32_16x16x32_bf16 v[32:35], v[208:211], v[192:195], v[32:35]
  v_mfma_f32_16x16x32_bf16 v[16:19], v[212:215], v[252:255], v[16:19]
  v_mfma_f32_16x16x32_bf16 v[36:39], v[212:215], v[192:195], v[36:39]
  s_waitcnt lgkmcnt(0)
  s_barrier
  v_mfma_f32_16x16x32_bf16 v[0:3], v[112:115], v[104:107], v[0:3]
  ds_read_b128 v[224:227], v180 offset:32768
  ds_read_b128 v[228:231], v180 offset:33792
  v_mfma_f32_16x16x32_bf16 v[20:23], v[112:115], v[108:111], v[20:23]
  ds_read_b64_tr_b16 v[232:233], v176 offset:128
  s_add_u32 m0, s49, 16384
  v_mfma_f32_16x16x32_bf16 v[4:7], v[116:119], v[104:107], v[4:7]
  ds_read_b64_tr_b16 v[234:235], v176 offset:2688
  ds_read_b64_tr_b16 v[236:237], v177 offset:128
  v_mfma_f32_16x16x32_bf16 v[24:27], v[116:119], v[108:111], v[24:27]
  ds_read_b64_tr_b16 v[238:239], v177 offset:2688
  buffer_load_dwordx4 v172, s[84:87], s44 offen offset:0 sc1 lds
  v_mfma_f32_16x16x32_bf16 v[8:11], v[120:123], v[104:107], v[8:11]
  ds_read_b64_tr_b16 v[240:241], v176 offset:192
  ds_read_b64_tr_b16 v[242:243], v176 offset:2752
  buffer_load_dwordx4 v172, s[84:87], s44 offen offset:1024 sc1 lds
  v_mfma_f32_16x16x32_bf16 v[28:31], v[120:123], v[108:111], v[28:31]
  ds_read_b64_tr_b16 v[244:245], v177 offset:192
  ds_read_b64_tr_b16 v[246:247], v177 offset:2752
  s_add_u32 s44, s44, 65536
  v_mfma_f32_16x16x32_bf16 v[12:15], v[124:127], v[104:107], v[12:15]
  ds_read_b64_tr_b16 v[248:249], v177 offset:256
  v_mfma_f32_16x16x32_bf16 v[32:35], v[124:127], v[108:111], v[32:35]
  ds_read_b64_tr_b16 v[250:251], v177 offset:2816
  ds_read_b128 v[252:255], v180 offset:40960
  s_add_u32 m0, s45, 143360
  v_mfma_f32_16x16x32_bf16 v[16:19], v[128:131], v[104:107], v[16:19]
  ds_read_b128 v[192:195], v180 offset:41984
  buffer_load_dwordx4 v188, s[36:39], s43 offen offset:0 lds
  v_mfma_f32_16x16x32_bf16 v[36:39], v[128:131], v[108:111], v[36:39]
  ds_read_b64_tr_b16 v[196:197], v176 offset:10368
  ds_read_b64_tr_b16 v[198:199], v176 offset:12928
  buffer_load_dwordx4 v189, s[36:39], s43 offen offset:1024 lds
  v_mfma_f32_16x16x32_bf16 v[0:3], v[140:143], v[132:135], v[0:3]
  ds_read_b64_tr_b16 v[200:201], v177 offset:10368
  ds_read_b64_tr_b16 v[202:203], v177 offset:12928
  v_mfma_f32_16x16x32_bf16 v[20:23], v[140:143], v[136:139], v[20:23]
  ds_read_b64_tr_b16 v[204:205], v176 offset:10432
  buffer_load_dwordx4 v190, s[36:39], s43 offen offset:2048 lds
  v_mfma_f32_16x16x32_bf16 v[4:7], v[144:147], v[132:135], v[4:7]
  ds_read_b64_tr_b16 v[206:207], v176 offset:12992
  ds_read_b64_tr_b16 v[208:209], v177 offset:10432
  s_add_u32 s43, s43, 40960
  v_mfma_f32_16x16x32_bf16 v[24:27], v[144:147], v[136:139], v[24:27]
  ds_read_b64_tr_b16 v[210:211], v177 offset:12992
  buffer_store_dwordx4 v[68:71], v184, s[88:91], 0 offen offset:256 sc1
  v_mfma_f32_16x16x32_bf16 v[8:11], v[148:151], v[132:135], v[8:11]
  ds_read_b64_tr_b16 v[212:213], v177 offset:10496
  ds_read_b64_tr_b16 v[214:215], v177 offset:13056
  v_mfma_f32_16x16x32_bf16 v[28:31], v[148:151], v[136:139], v[28:31]
  v_mfma_f32_16x16x32_bf16 v[12:15], v[152:155], v[132:135], v[12:15]
  v_mfma_f32_16x16x32_bf16 v[32:35], v[152:155], v[136:139], v[32:35]
  v_mfma_f32_16x16x32_bf16 v[16:19], v[156:159], v[132:135], v[16:19]
  v_mfma_f32_16x16x32_bf16 v[36:39], v[156:159], v[136:139], v[36:39]
  s_waitcnt lgkmcnt(0)
  s_waitcnt vmcnt(10)
  s_barrier
  v_mfma_f32_16x16x32_bf16 v[0:3], v[232:235], v[224:227], v[0:3]
  ds_read_b128 v[104:107], v181 offset:32768
  ds_read_b128 v[108:111], v181 offset:33792
  v_mfma_f32_16x16x32_bf16 v[20:23], v[232:235], v[228:231], v[20:23]
  ds_read_b64_tr_b16 v[112:113], v176 offset:20608
  s_add_u32 m0, s49, 32768
  v_mfma_f32_16x16x32_bf16 v[4:7], v[236:239], v[224:227], v[4:7]
  ds_read_b64_tr_b16 v[114:115], v176 offset:23168
  ds_read_b64_tr_b16 v[116:117], v177 offset:20608
  v_mfma_f32_16x16x32_bf16 v[24:27], v[236:239], v[228:231], v[24:27]
  ds_read_b64_tr_b16 v[118:119], v177 offset:23168
  buffer_load_dwordx4 v172, s[84:87], s44 offen offset:0 sc1 lds
  v_mfma_f32_16x16x32_bf16 v[8:11], v[240:243], v[224:227], v[8:11]
  ds_read_b64_tr_b16 v[120:121], v176 offset:20672
  ds_read_b64_tr_b16 v[122:123], v176 offset:23232
  buffer_load_dwordx4 v172, s[84:87], s44 offen offset:1024 sc1 lds
  v_mfma_f32_16x16x32_bf16 v[28:31], v[240:243], v[228:231], v[28:31]
  ds_read_b64_tr_b16 v[124:125], v177 offset:20672
  ds_read_b64_tr_b16 v[126:127], v177 offset:23232
  v_mfma_f32_16x16x32_bf16 v[12:15], v[244:247], v[224:227], v[12:15]
  ds_read_b64_tr_b16 v[128:129], v177 offset:20736
  s_add_u32 s44, s44, 65536
  v_mfma_f32_16x16x32_bf16 v[32:35], v[244:247], v[228:231], v[32:35]
  ds_read_b64_tr_b16 v[130:131], v177 offset:23296
  ds_read_b128 v[132:135], v181 offset:57344
  s_add_u32 m0, s45, 52224
  v_mfma_f32_16x16x32_bf16 v[16:19], v[248:251], v[224:227], v[16:19]
  ds_read_b128 v[136:139], v181 offset:58368
  v_mfma_f32_16x16x32_bf16 v[36:39], v[248:251], v[228:231], v[36:39]
  ds_read_b64_tr_b16 v[140:141], v176 offset:30848
  ds_read_b64_tr_b16 v[142:143], v176 offset:33408
  buffer_load_dwordx4 v191, s[36:39], s43 offen offset:0 lds
  v_mfma_f32_16x16x32_bf16 v[0:3], v[196:199], v[252:255], v[0:3]
  ds_read_b64_tr_b16 v[144:145], v177 offset:30848
  ds_read_b64_tr_b16 v[146:147], v177 offset:33408
  buffer_load_dwordx4 v160, s[36:39], s43 offen offset:1024 lds
  v_mfma_f32_16x16x32_bf16 v[20:23], v[196:199], v[192:195], v[20:23]
  ds_read_b64_tr_b16 v[148:149], v176 offset:30912
  v_mfma_f32_16x16x32_bf16 v[4:7], v[200:203], v[252:255], v[4:7]
  ds_read_b64_tr_b16 v[150:151], v176 offset:33472
  ds_read_b64_tr_b16 v[152:153], v177 offset:30912
  s_add_u32 s43, s43, 40960
  v_mfma_f32_16x16x32_bf16 v[24:27], v[200:203], v[192:195], v[24:27]
  ds_read_b64_tr_b16 v[154:155], v177 offset:33472
  v_mfma_f32_16x16x32_bf16 v[8:11], v[204:207], v[252:255], v[8:11]
  ds_read_b64_tr_b16 v[156:157], v177 offset:30976
  ds_read_b64_tr_b16 v[158:159], v177 offset:33536
  v_mfma_f32_16x16x32_bf16 v[28:31], v[204:207], v[192:195], v[28:31]
  v_mfma_f32_16x16x32_bf16 v[12:15], v[208:211], v[252:255], v[12:15]
  v_mfma_f32_16x16x32_bf16 v[32:35], v[208:211], v[192:195], v[32:35]
  v_mfma_f32_16x16x32_bf16 v[16:19], v[212:215], v[252:255], v[16:19]
  v_mfma_f32_16x16x32_bf16 v[36:39], v[212:215], v[192:195], v[36:39]
  s_waitcnt lgkmcnt(0)
  s_waitcnt vmcnt(10)
  s_barrier
  v_mfma_f32_16x16x32_bf16 v[0:3], v[112:115], v[104:107], v[0:3]
  ds_read_b128 v[224:227], v180 offset:0
  ds_read_b128 v[228:231], v180 offset:1024
  v_mfma_f32_16x16x32_bf16 v[20:23], v[112:115], v[108:111], v[20:23]
  ds_read_b64_tr_b16 v[232:233], v178 offset:8320
  s_add_u32 s44, s44, 16384
  v_mfma_f32_16x16x32_bf16 v[4:7], v[116:119], v[104:107], v[4:7]
  ds_read_b64_tr_b16 v[234:235], v178 offset:10880
  ds_read_b64_tr_b16 v[236:237], v179 offset:8320
  s_bfe_u32 s44, s44, 0x2000e
  s_lshl4_add_u32 s44, s5, s44
  v_mfma_f32_16x16x32_bf16 v[24:27], v[116:119], v[108:111], v[24:27]
  ds_read_b64_tr_b16 v[238:239], v179 offset:10880
  s_lshl_b32 s44, s44, 14
  v_mfma_f32_16x16x32_bf16 v[8:11], v[120:123], v[104:107], v[8:11]
  ds_read_b64_tr_b16 v[240:241], v178 offset:8384
  ds_read_b64_tr_b16 v[242:243], v178 offset:10944
  s_add_u32 m0, s49, 106496
  s_nop 0
  buffer_load_dwordx4 v172, s[84:87], s44 offen offset:0 sc1 lds
  v_mfma_f32_16x16x32_bf16 v[28:31], v[120:123], v[108:111], v[28:31]
  ds_read_b64_tr_b16 v[244:245], v179 offset:8384
  ds_read_b64_tr_b16 v[246:247], v179 offset:10944
  buffer_load_dwordx4 v172, s[84:87], s44 offen offset:1024 sc1 lds
  v_mfma_f32_16x16x32_bf16 v[12:15], v[124:127], v[104:107], v[12:15]
  ds_read_b64_tr_b16 v[248:249], v179 offset:8448
  s_add_u32 s44, s44, 65536
  s_add_u32 s97, s97, 1
  v_mfma_f32_16x16x32_bf16 v[32:35], v[124:127], v[108:111], v[32:35]
  ds_read_b64_tr_b16 v[250:251], v179 offset:11008
  ds_read_b128 v[252:255], v180 offset:8192
  s_and_b32 s97, s97, 3
  v_mfma_f32_16x16x32_bf16 v[16:19], v[128:131], v[104:107], v[16:19]
  ds_read_b128 v[192:195], v180 offset:9216
  s_lshl2_add_u32 s43, s5, s97
  s_mul_i32 s43, s43, 327680
  v_mfma_f32_16x16x32_bf16 v[36:39], v[128:131], v[108:111], v[36:39]
  ds_read_b64_tr_b16 v[196:197], v178 offset:18560
  ds_read_b64_tr_b16 v[198:199], v178 offset:21120
  s_add_u32 s43, s43, s47
  v_mfma_f32_16x16x32_bf16 v[0:3], v[140:143], v[132:135], v[0:3]
  ds_read_b64_tr_b16 v[200:201], v179 offset:18560
  ds_read_b64_tr_b16 v[202:203], v179 offset:21120
  s_add_u32 m0, s45, 69632
  s_nop 0
  buffer_load_dwordx4 v188, s[36:39], s43 offen offset:0 lds
  v_mfma_f32_16x16x32_bf16 v[20:23], v[140:143], v[136:139], v[20:23]
  ds_read_b64_tr_b16 v[204:205], v178 offset:18624
  buffer_load_dwordx4 v189, s[36:39], s43 offen offset:1024 lds
  v_mfma_f32_16x16x32_bf16 v[4:7], v[144:147], v[132:135], v[4:7]
  ds_read_b64_tr_b16 v[206:207], v178 offset:21184
  ds_read_b64_tr_b16 v[208:209], v179 offset:18624
  buffer_load_dwordx4 v190, s[36:39], s43 offen offset:2048 lds
  s_add_u32 s43, s43, 40960
  v_mfma_f32_16x16x32_bf16 v[24:27], v[144:147], v[136:139], v[24:27]
  ds_read_b64_tr_b16 v[210:211], v179 offset:21184
  buffer_store_dwordx4 v[72:75], v184, s[88:91], 0 offen offset:512 sc1
  v_mfma_f32_16x16x32_bf16 v[8:11], v[148:151], v[132:135], v[8:11]
  ds_read_b64_tr_b16 v[212:213], v179 offset:18688
  ds_read_b64_tr_b16 v[214:215], v179 offset:21248
  v_mfma_f32_16x16x32_bf16 v[28:31], v[148:151], v[136:139], v[28:31]
  v_mfma_f32_16x16x32_bf16 v[12:15], v[152:155], v[132:135], v[12:15]
  v_mfma_f32_16x16x32_bf16 v[32:35], v[152:155], v[136:139], v[32:35]
  v_mfma_f32_16x16x32_bf16 v[16:19], v[156:159], v[132:135], v[16:19]
  v_mfma_f32_16x16x32_bf16 v[36:39], v[156:159], v[136:139], v[36:39]
  s_waitcnt lgkmcnt(0)
  s_waitcnt vmcnt(11)
  s_barrier
  v_mfma_f32_16x16x32_bf16 v[0:3], v[232:235], v[224:227], v[0:3]
  ds_read_b128 v[104:107], v180 offset:16384
  ds_read_b128 v[108:111], v180 offset:17408
  v_mfma_f32_16x16x32_bf16 v[20:23], v[232:235], v[228:231], v[20:23]
  ds_read_b64_tr_b16 v[112:113], v178 offset:28800
  s_add_u32 m0, s49, 0
  v_mfma_f32_16x16x32_bf16 v[4:7], v[236:239], v[224:227], v[4:7]
  ds_read_b64_tr_b16 v[114:115], v178 offset:31360
  ds_read_b64_tr_b16 v[116:117], v179 offset:28800
  v_mfma_f32_16x16x32_bf16 v[24:27], v[236:239], v[228:231], v[24:27]
  ds_read_b64_tr_b16 v[118:119], v179 offset:31360
  buffer_load_dwordx4 v172, s[84:87], s44 offen offset:0 sc1 lds
  v_mfma_f32_16x16x32_bf16 v[8:11], v[240:243], v[224:227], v[8:11]
  ds_read_b64_tr_b16 v[120:121], v178 offset:28864
  ds_read_b64_tr_b16 v[122:123], v178 offset:31424
  buffer_load_dwordx4 v172, s[84:87], s44 offen offset:1024 sc1 lds
  v_mfma_f32_16x16x32_bf16 v[28:31], v[240:243], v[228:231], v[28:31]
  ds_read_b64_tr_b16 v[124:125], v179 offset:28864
  ds_read_b64_tr_b16 v[126:127], v179 offset:31424
  v_mfma_f32_16x16x32_bf16 v[12:15], v[244:247], v[224:227], v[12:15]
  ds_read_b64_tr_b16 v[128:129], v179 offset:28928
  s_add_u32 s44, s44, 65536
  v_mfma_f32_16x16x32_bf16 v[32:35], v[244:247], v[228:231], v[32:35]
  ds_read_b64_tr_b16 v[130:131], v179 offset:31488
  ds_read_b128 v[132:135], v180 offset:24576
  s_add_u32 m0, s45, 125952
  v_mfma_f32_16x16x32_bf16 v[16:19], v[248:251], v[224:227], v[16:19]
  ds_read_b128 v[136:139], v180 offset:25600
  v_mfma_f32_16x16x32_bf16 v[36:39], v[248:251], v[228:231], v[36:39]
  ds_read_b64_tr_b16 v[140:141], v178 offset:39040
  ds_read_b64_tr_b16 v[142:143], v178 offset:41600
  buffer_load_dwordx4 v191, s[36:39], s43 offen offset:0 lds
  v_mfma_f32_16x16x32_bf16 v[0:3], v[196:199], v[252:255], v[0:3]
  ds_read_b64_tr_b16 v[144:145], v179 offset:39040
  ds_read_b64_tr_b16 v[146:147], v179 offset:41600
  buffer_load_dwordx4 v160, s[36:39], s43 offen offset:1024 lds
  v_mfma_f32_16x16x32_bf16 v[20:23], v[196:199], v[192:195], v[20:23]
  ds_read_b64_tr_b16 v[148:149], v178 offset:39104
  v_mfma_f32_16x16x32_bf16 v[4:7], v[200:203], v[252:255], v[4:7]
  ds_read_b64_tr_b16 v[150:151], v178 offset:41664
  ds_read_b64_tr_b16 v[152:153], v179 offset:39104
  s_add_u32 s43, s43, 40960
  v_mfma_f32_16x16x32_bf16 v[24:27], v[200:203], v[192:195], v[24:27]
  ds_read_b64_tr_b16 v[154:155], v179 offset:41664
  v_mfma_f32_16x16x32_bf16 v[8:11], v[204:207], v[252:255], v[8:11]
  ds_read_b64_tr_b16 v[156:157], v179 offset:39168
  ds_read_b64_tr_b16 v[158:159], v179 offset:41728
  v_mfma_f32_16x16x32_bf16 v[28:31], v[204:207], v[192:195], v[28:31]
  v_mfma_f32_16x16x32_bf16 v[12:15], v[208:211], v[252:255], v[12:15]
  v_mfma_f32_16x16x32_bf16 v[32:35], v[208:211], v[192:195], v[32:35]
  v_mfma_f32_16x16x32_bf16 v[16:19], v[212:215], v[252:255], v[16:19]
  v_mfma_f32_16x16x32_bf16 v[36:39], v[212:215], v[192:195], v[36:39]
  s_waitcnt lgkmcnt(0)
  s_waitcnt vmcnt(10)
  s_barrier
  v_mfma_f32_16x16x32_bf16 v[0:3], v[112:115], v[104:107], v[0:3]
  ds_read_b128 v[224:227], v180 offset:32768
  ds_read_b128 v[228:231], v180 offset:33792
  v_mfma_f32_16x16x32_bf16 v[20:23], v[112:115], v[108:111], v[20:23]
  ds_read_b64_tr_b16 v[232:233], v176 offset:128
  s_add_u32 m0, s49, 16384
  v_mfma_f32_16x16x32_bf16 v[4:7], v[116:119], v[104:107], v[4:7]
  ds_read_b64_tr_b16 v[234:235], v176 offset:2688
  ds_read_b64_tr_b16 v[236:237], v177 offset:128
  v_mfma_f32_16x16x32_bf16 v[24:27], v[116:119], v[108:111], v[24:27]
  ds_read_b64_tr_b16 v[238:239], v177 offset:2688
  buffer_load_dwordx4 v172, s[84:87], s44 offen offset:0 sc1 lds
  v_mfma_f32_16x16x32_bf16 v[8:11], v[120:123], v[104:107], v[8:11]
  ds_read_b64_tr_b16 v[240:241], v176 offset:192
  ds_read_b64_tr_b16 v[242:243], v176 offset:2752
  buffer_load_dwordx4 v172, s[84:87], s44 offen offset:1024 sc1 lds
  v_mfma_f32_16x16x32_bf16 v[28:31], v[120:123], v[108:111], v[28:31]
  ds_read_b64_tr_b16 v[244:245], v177 offset:192
  ds_read_b64_tr_b16 v[246:247], v177 offset:2752
  s_add_u32 s44, s44, 65536
  v_mfma_f32_16x16x32_bf16 v[12:15], v[124:127], v[104:107], v[12:15]
  ds_read_b64_tr_b16 v[248:249], v177 offset:256
  v_mfma_f32_16x16x32_bf16 v[32:35], v[124:127], v[108:111], v[32:35]
  ds_read_b64_tr_b16 v[250:251], v177 offset:2816
  ds_read_b128 v[252:255], v180 offset:40960
  s_add_u32 m0, s45, 143360
  v_mfma_f32_16x16x32_bf16 v[16:19], v[128:131], v[104:107], v[16:19]
  ds_read_b128 v[192:195], v180 offset:41984
  buffer_load_dwordx4 v188, s[36:39], s43 offen offset:0 lds
  v_mfma_f32_16x16x32_bf16 v[36:39], v[128:131], v[108:111], v[36:39]
  ds_read_b64_tr_b16 v[196:197], v176 offset:10368
  ds_read_b64_tr_b16 v[198:199], v176 offset:12928
  buffer_load_dwordx4 v189, s[36:39], s43 offen offset:1024 lds
  v_mfma_f32_16x16x32_bf16 v[0:3], v[140:143], v[132:135], v[0:3]
  ds_read_b64_tr_b16 v[200:201], v177 offset:10368
  ds_read_b64_tr_b16 v[202:203], v177 offset:12928
  v_mfma_f32_16x16x32_bf16 v[20:23], v[140:143], v[136:139], v[20:23]
  ds_read_b64_tr_b16 v[204:205], v176 offset:10432
  buffer_load_dwordx4 v190, s[36:39], s43 offen offset:2048 lds
  v_mfma_f32_16x16x32_bf16 v[4:7], v[144:147], v[132:135], v[4:7]
  ds_read_b64_tr_b16 v[206:207], v176 offset:12992
  ds_read_b64_tr_b16 v[208:209], v177 offset:10432
  s_add_u32 s43, s43, 40960
  v_mfma_f32_16x16x32_bf16 v[24:27], v[144:147], v[136:139], v[24:27]
  ds_read_b64_tr_b16 v[210:211], v177 offset:12992
  buffer_store_dwordx4 v[76:79], v184, s[88:91], 0 offen offset:768 sc1
  v_mfma_f32_16x16x32_bf16 v[8:11], v[148:151], v[132:135], v[8:11]
  ds_read_b64_tr_b16 v[212:213], v177 offset:10496
  ds_read_b64_tr_b16 v[214:215], v177 offset:13056
  v_mfma_f32_16x16x32_bf16 v[28:31], v[148:151], v[136:139], v[28:31]
  v_mfma_f32_16x16x32_bf16 v[12:15], v[152:155], v[132:135], v[12:15]
  v_mfma_f32_16x16x32_bf16 v[32:35], v[152:155], v[136:139], v[32:35]
  v_mfma_f32_16x16x32_bf16 v[16:19], v[156:159], v[132:135], v[16:19]
  v_mfma_f32_16x16x32_bf16 v[36:39], v[156:159], v[136:139], v[36:39]
  s_waitcnt lgkmcnt(0)
  s_waitcnt vmcnt(11)
  s_barrier
  v_mfma_f32_16x16x32_bf16 v[0:3], v[232:235], v[224:227], v[0:3]
  ds_read_b128 v[104:107], v181 offset:32768
  ds_read_b128 v[108:111], v181 offset:33792
  v_mfma_f32_16x16x32_bf16 v[20:23], v[232:235], v[228:231], v[20:23]
  ds_read_b64_tr_b16 v[112:113], v176 offset:20608
  s_add_u32 m0, s49, 32768
  v_mfma_f32_16x16x32_bf16 v[4:7], v[236:239], v[224:227], v[4:7]
  ds_read_b64_tr_b16 v[114:115], v176 offset:23168
  ds_read_b64_tr_b16 v[116:117], v177 offset:20608
  v_mfma_f32_16x16x32_bf16 v[24:27], v[236:239], v[228:231], v[24:27]
  ds_read_b64_tr_b16 v[118:119], v177 offset:23168
  buffer_load_dwordx4 v172, s[84:87], s44 offen offset:0 sc1 lds
  v_mfma_f32_16x16x32_bf16 v[8:11], v[240:243], v[224:227], v[8:11]
  ds_read_b64_tr_b16 v[120:121], v176 offset:20672
  ds_read_b64_tr_b16 v[122:123], v176 offset:23232
  buffer_load_dwordx4 v172, s[84:87], s44 offen offset:1024 sc1 lds
  v_mfma_f32_16x16x32_bf16 v[28:31], v[240:243], v[228:231], v[28:31]
  ds_read_b64_tr_b16 v[124:125], v177 offset:20672
  ds_read_b64_tr_b16 v[126:127], v177 offset:23232
  v_mfma_f32_16x16x32_bf16 v[12:15], v[244:247], v[224:227], v[12:15]
  ds_read_b64_tr_b16 v[128:129], v177 offset:20736
  s_add_u32 s44, s44, 65536
  v_mfma_f32_16x16x32_bf16 v[32:35], v[244:247], v[228:231], v[32:35]
  ds_read_b64_tr_b16 v[130:131], v177 offset:23296
  ds_read_b128 v[132:135], v181 offset:57344
  s_add_u32 m0, s45, 52224
  v_mfma_f32_16x16x32_bf16 v[16:19], v[248:251], v[224:227], v[16:19]
  ds_read_b128 v[136:139], v181 offset:58368
  v_mfma_f32_16x16x32_bf16 v[36:39], v[248:251], v[228:231], v[36:39]
  ds_read_b64_tr_b16 v[140:141], v176 offset:30848
  ds_read_b64_tr_b16 v[142:143], v176 offset:33408
  buffer_load_dwordx4 v191, s[36:39], s43 offen offset:0 lds
  v_mfma_f32_16x16x32_bf16 v[0:3], v[196:199], v[252:255], v[0:3]
  ds_read_b64_tr_b16 v[144:145], v177 offset:30848
  ds_read_b64_tr_b16 v[146:147], v177 offset:33408
  buffer_load_dwordx4 v160, s[36:39], s43 offen offset:1024 lds
  v_mfma_f32_16x16x32_bf16 v[20:23], v[196:199], v[192:195], v[20:23]
  ds_read_b64_tr_b16 v[148:149], v176 offset:30912
  v_mfma_f32_16x16x32_bf16 v[4:7], v[200:203], v[252:255], v[4:7]
  ds_read_b64_tr_b16 v[150:151], v176 offset:33472
  ds_read_b64_tr_b16 v[152:153], v177 offset:30912
  s_add_u32 s43, s43, 40960
  v_mfma_f32_16x16x32_bf16 v[24:27], v[200:203], v[192:195], v[24:27]
  ds_read_b64_tr_b16 v[154:155], v177 offset:33472
  v_mfma_f32_16x16x32_bf16 v[8:11], v[204:207], v[252:255], v[8:11]
  ds_read_b64_tr_b16 v[156:157], v177 offset:30976
  ds_read_b64_tr_b16 v[158:159], v177 offset:33536
  v_mfma_f32_16x16x32_bf16 v[28:31], v[204:207], v[192:195], v[28:31]
  v_mfma_f32_16x16x32_bf16 v[12:15], v[208:211], v[252:255], v[12:15]
  v_mfma_f32_16x16x32_bf16 v[32:35], v[208:211], v[192:195], v[32:35]
  v_mfma_f32_16x16x32_bf16 v[16:19], v[212:215], v[252:255], v[16:19]
  v_mfma_f32_16x16x32_bf16 v[36:39], v[212:215], v[192:195], v[36:39]
  s_waitcnt lgkmcnt(0)
  s_waitcnt vmcnt(10)
  s_barrier
  v_mfma_f32_16x16x32_bf16 v[0:3], v[112:115], v[104:107], v[0:3]
  ds_read_b128 v[224:227], v180 offset:0
  ds_read_b128 v[228:231], v180 offset:1024
  v_mfma_f32_16x16x32_bf16 v[20:23], v[112:115], v[108:111], v[20:23]
  ds_read_b64_tr_b16 v[232:233], v178 offset:8320
  s_add_u32 s44, s44, 16384
  v_mfma_f32_16x16x32_bf16 v[4:7], v[116:119], v[104:107], v[4:7]
  ds_read_b64_tr_b16 v[234:235], v178 offset:10880
  ds_read_b64_tr_b16 v[236:237], v179 offset:8320
  s_bfe_u32 s44, s44, 0x2000e
  s_lshl4_add_u32 s44, s5, s44
  v_mfma_f32_16x16x32_bf16 v[24:27], v[116:119], v[108:111], v[24:27]
  ds_read_b64_tr_b16 v[238:239], v179 offset:10880
  s_lshl_b32 s44, s44, 14
  v_mfma_f32_16x16x32_bf16 v[8:11], v[120:123], v[104:107], v[8:11]
  ds_read_b64_tr_b16 v[240:241], v178 offset:8384
  ds_read_b64_tr_b16 v[242:243], v178 offset:10944
  s_add_u32 m0, s49, 106496
  s_nop 0
  buffer_load_dwordx4 v172, s[84:87], s44 offen offset:0 sc1 lds
  v_mfma_f32_16x16x32_bf16 v[28:31], v[120:123], v[108:111], v[28:31]
  ds_read_b64_tr_b16 v[244:245], v179 offset:8384
  ds_read_b64_tr_b16 v[246:247], v179 offset:10944
  buffer_load_dwordx4 v172, s[84:87], s44 offen offset:1024 sc1 lds
  v_mfma_f32_16x16x32_bf16 v[12:15], v[124:127], v[104:107], v[12:15]
  ds_read_b64_tr_b16 v[248:249], v179 offset:8448
  s_add_u32 s44, s44, 65536
  s_add_u32 s97, s97, 1
  v_mfma_f32_16x16x32_bf16 v[32:35], v[124:127], v[108:111], v[32:35]
  ds_read_b64_tr_b16 v[250:251], v179 offset:11008
  ds_read_b128 v[252:255], v180 offset:8192
  s_and_b32 s97, s97, 3
  v_mfma_f32_16x16x32_bf16 v[16:19], v[128:131], v[104:107], v[16:19]
  ds_read_b128 v[192:195], v180 offset:9216
  s_lshl2_add_u32 s43, s5, s97
  s_mul_i32 s43, s43, 327680
  v_mfma_f32_16x16x32_bf16 v[36:39], v[128:131], v[108:111], v[36:39]
  ds_read_b64_tr_b16 v[196:197], v178 offset:18560
  ds_read_b64_tr_b16 v[198:199], v178 offset:21120
  s_add_u32 s43, s43, s47
  v_mfma_f32_16x16x32_bf16 v[0:3], v[140:143], v[132:135], v[0:3]
  ds_read_b64_tr_b16 v[200:201], v179 offset:18560
  ds_read_b64_tr_b16 v[202:203], v179 offset:21120
  s_add_u32 m0, s45, 69632
  s_nop 0
  buffer_load_dwordx4 v188, s[36:39], s43 offen offset:0 lds
  v_mfma_f32_16x16x32_bf16 v[20:23], v[140:143], v[136:139], v[20:23]
  ds_read_b64_tr_b16 v[204:205], v178 offset:18624
  buffer_load_dwordx4 v189, s[36:39], s43 offen offset:1024 lds
  v_mfma_f32_16x16x32_bf16 v[4:7], v[144:147], v[132:135], v[4:7]
  ds_read_b64_tr_b16 v[206:207], v178 offset:21184
  ds_read_b64_tr_b16 v[208:209], v179 offset:18624
  buffer_load_dwordx4 v190, s[36:39], s43 offen offset:2048 lds
  s_add_u32 s43, s43, 40960
  v_mfma_f32_16x16x32_bf16 v[24:27], v[144:147], v[136:139], v[24:27]
  ds_read_b64_tr_b16 v[210:211], v179 offset:21184
  buffer_store_dwordx4 v[80:83], v184, s[88:91], 0 offen offset:1024 sc1
  v_mfma_f32_16x16x32_bf16 v[8:11], v[148:151], v[132:135], v[8:11]
  ds_read_b64_tr_b16 v[212:213], v179 offset:18688
  ds_read_b64_tr_b16 v[214:215], v179 offset:21248
  v_mfma_f32_16x16x32_bf16 v[28:31], v[148:151], v[136:139], v[28:31]
  v_mfma_f32_16x16x32_bf16 v[12:15], v[152:155], v[132:135], v[12:15]
  v_mfma_f32_16x16x32_bf16 v[32:35], v[152:155], v[136:139], v[32:35]
  v_mfma_f32_16x16x32_bf16 v[16:19], v[156:159], v[132:135], v[16:19]
  v_mfma_f32_16x16x32_bf16 v[36:39], v[156:159], v[136:139], v[36:39]
  s_waitcnt lgkmcnt(0)
  s_waitcnt vmcnt(11)
  s_barrier
  v_mfma_f32_16x16x32_bf16 v[0:3], v[232:235], v[224:227], v[0:3]
  ds_read_b128 v[104:107], v180 offset:16384
  ds_read_b128 v[108:111], v180 offset:17408
  v_mfma_f32_16x16x32_bf16 v[20:23], v[232:235], v[228:231], v[20:23]
  ds_read_b64_tr_b16 v[112:113], v178 offset:28800
  s_add_u32 m0, s49, 0
  v_mfma_f32_16x16x32_bf16 v[4:7], v[236:239], v[224:227], v[4:7]
  ds_read_b64_tr_b16 v[114:115], v178 offset:31360
  ds_read_b64_tr_b16 v[116:117], v179 offset:28800
  v_mfma_f32_16x16x32_bf16 v[24:27], v[236:239], v[228:231], v[24:27]
  ds_read_b64_tr_b16 v[118:119], v179 offset:31360
  buffer_load_dwordx4 v172, s[84:87], s44 offen offset:0 sc1 lds
  v_mfma_f32_16x16x32_bf16 v[8:11], v[240:243], v[224:227], v[8:11]
  ds_read_b64_tr_b16 v[120:121], v178 offset:28864
  ds_read_b64_tr_b16 v[122:123], v178 offset:31424
  buffer_load_dwordx4 v172, s[84:87], s44 offen offset:1024 sc1 lds
  v_mfma_f32_16x16x32_bf16 v[28:31], v[240:243], v[228:231], v[28:31]
  ds_read_b64_tr_b16 v[124:125], v179 offset:28864
  ds_read_b64_tr_b16 v[126:127], v179 offset:31424
  v_mfma_f32_16x16x32_bf16 v[12:15], v[244:247], v[224:227], v[12:15]
  ds_read_b64_tr_b16 v[128:129], v179 offset:28928
  s_add_u32 s44, s44, 65536
  v_mfma_f32_16x16x32_bf16 v[32:35], v[244:247], v[228:231], v[32:35]
  ds_read_b64_tr_b16 v[130:131], v179 offset:31488
  ds_read_b128 v[132:135], v180 offset:24576
  s_add_u32 m0, s45, 125952
  v_mfma_f32_16x16x32_bf16 v[16:19], v[248:251], v[224:227], v[16:19]
  ds_read_b128 v[136:139], v180 offset:25600
  v_mfma_f32_16x16x32_bf16 v[36:39], v[248:251], v[228:231], v[36:39]
  ds_read_b64_tr_b16 v[140:141], v178 offset:39040
  ds_read_b64_tr_b16 v[142:143], v178 offset:41600
  buffer_load_dwordx4 v191, s[36:39], s43 offen offset:0 lds
  v_mfma_f32_16x16x32_bf16 v[0:3], v[196:199], v[252:255], v[0:3]
  ds_read_b64_tr_b16 v[144:145], v179 offset:39040
  ds_read_b64_tr_b16 v[146:147], v179 offset:41600
  buffer_load_dwordx4 v160, s[36:39], s43 offen offset:1024 lds
  v_mfma_f32_16x16x32_bf16 v[20:23], v[196:199], v[192:195], v[20:23]
  ds_read_b64_tr_b16 v[148:149], v178 offset:39104
  v_mfma_f32_16x16x32_bf16 v[4:7], v[200:203], v[252:255], v[4:7]
  ds_read_b64_tr_b16 v[150:151], v178 offset:41664
  ds_read_b64_tr_b16 v[152:153], v179 offset:39104
  s_add_u32 s43, s43, 40960
  v_mfma_f32_16x16x32_bf16 v[24:27], v[200:203], v[192:195], v[24:27]
  ds_read_b64_tr_b16 v[154:155], v179 offset:41664
  v_mfma_f32_16x16x32_bf16 v[8:11], v[204:207], v[252:255], v[8:11]
  ds_read_b64_tr_b16 v[156:157], v179 offset:39168
  ds_read_b64_tr_b16 v[158:159], v179 offset:41728
  v_mfma_f32_16x16x32_bf16 v[28:31], v[204:207], v[192:195], v[28:31]
  v_mfma_f32_16x16x32_bf16 v[12:15], v[208:211], v[252:255], v[12:15]
  v_mfma_f32_16x16x32_bf16 v[32:35], v[208:211], v[192:195], v[32:35]
  v_mfma_f32_16x16x32_bf16 v[16:19], v[212:215], v[252:255], v[16:19]
  v_mfma_f32_16x16x32_bf16 v[36:39], v[212:215], v[192:195], v[36:39]
  s_waitcnt lgkmcnt(0)
  s_waitcnt vmcnt(10)
  s_barrier
  v_mfma_f32_16x16x32_bf16 v[0:3], v[112:115], v[104:107], v[0:3]
  ds_read_b128 v[224:227], v180 offset:32768
  ds_read_b128 v[228:231], v180 offset:33792
  v_mfma_f32_16x16x32_bf16 v[20:23], v[112:115], v[108:111], v[20:23]
  ds_read_b64_tr_b16 v[232:233], v176 offset:128
  s_add_u32 m0, s49, 16384
  v_mfma_f32_16x16x32_bf16 v[4:7], v[116:119], v[104:107], v[4:7]
  ds_read_b64_tr_b16 v[234:235], v176 offset:2688
  ds_read_b64_tr_b16 v[236:237], v177 offset:128
  v_mfma_f32_16x16x32_bf16 v[24:27], v[116:119], v[108:111], v[24:27]
  ds_read_b64_tr_b16 v[238:239], v177 offset:2688
  buffer_load_dwordx4 v172, s[84:87], s44 offen offset:0 sc1 lds
  v_mfma_f32_16x16x32_bf16 v[8:11], v[120:123], v[104:107], v[8:11]
  ds_read_b64_tr_b16 v[240:241], v176 offset:192
  ds_read_b64_tr_b16 v[242:243], v176 offset:2752
  buffer_load_dwordx4 v172, s[84:87], s44 offen offset:1024 sc1 lds
  v_mfma_f32_16x16x32_bf16 v[28:31], v[120:123], v[108:111], v[28:31]
  ds_read_b64_tr_b16 v[244:245], v177 offset:192
  ds_read_b64_tr_b16 v[246:247], v177 offset:2752
  s_add_u32 s44, s44, 65536
  v_mfma_f32_16x16x32_bf16 v[12:15], v[124:127], v[104:107], v[12:15]
  ds_read_b64_tr_b16 v[248:249], v177 offset:256
  v_mfma_f32_16x16x32_bf16 v[32:35], v[124:127], v[108:111], v[32:35]
  ds_read_b64_tr_b16 v[250:251], v177 offset:2816
  ds_read_b128 v[252:255], v180 offset:40960
  s_add_u32 m0, s45, 143360
  v_mfma_f32_16x16x32_bf16 v[16:19], v[128:131], v[104:107], v[16:19]
  ds_read_b128 v[192:195], v180 offset:41984
  buffer_load_dwordx4 v188, s[36:39], s43 offen offset:0 lds
  v_mfma_f32_16x16x32_bf16 v[36:39], v[128:131], v[108:111], v[36:39]
  ds_read_b64_tr_b16 v[196:197], v176 offset:10368
  ds_read_b64_tr_b16 v[198:199], v176 offset:12928
  buffer_load_dwordx4 v189, s[36:39], s43 offen offset:1024 lds
  v_mfma_f32_16x16x32_bf16 v[0:3], v[140:143], v[132:135], v[0:3]
  ds_read_b64_tr_b16 v[200:201], v177 offset:10368
  ds_read_b64_tr_b16 v[202:203], v177 offset:12928
  v_mfma_f32_16x16x32_bf16 v[20:23], v[140:143], v[136:139], v[20:23]
  ds_read_b64_tr_b16 v[204:205], v176 offset:10432
  buffer_load_dwordx4 v190, s[36:39], s43 offen offset:2048 lds
  v_mfma_f32_16x16x32_bf16 v[4:7], v[144:147], v[132:135], v[4:7]
  ds_read_b64_tr_b16 v[206:207], v176 offset:12992
  ds_read_b64_tr_b16 v[208:209], v177 offset:10432
  s_add_u32 s43, s43, 40960
  v_mfma_f32_16x16x32_bf16 v[24:27], v[144:147], v[136:139], v[24:27]
  ds_read_b64_tr_b16 v[210:211], v177 offset:12992
  s_mov_b64 exec, s[56:57]
  buffer_load_dwordx4 v[64:67], v161, s[88:91], 0 offen offset:0 sc1
  s_mov_b64 exec, -1
  v_mfma_f32_16x16x32_bf16 v[8:11], v[148:151], v[132:135], v[8:11]
  ds_read_b64_tr_b16 v[212:213], v177 offset:10496
  ds_read_b64_tr_b16 v[214:215], v177 offset:13056
  v_mfma_f32_16x16x32_bf16 v[28:31], v[148:151], v[136:139], v[28:31]
  v_mfma_f32_16x16x32_bf16 v[12:15], v[152:155], v[132:135], v[12:15]
  v_mfma_f32_16x16x32_bf16 v[32:35], v[152:155], v[136:139], v[32:35]
  v_mfma_f32_16x16x32_bf16 v[16:19], v[156:159], v[132:135], v[16:19]
  v_mfma_f32_16x16x32_bf16 v[36:39], v[156:159], v[136:139], v[36:39]
  s_waitcnt lgkmcnt(0)
  s_waitcnt vmcnt(11)
  s_barrier
  v_mfma_f32_16x16x32_bf16 v[0:3], v[232:235], v[224:227], v[0:3]
  ds_read_b128 v[104:107], v181 offset:32768
  ds_read_b128 v[108:111], v181 offset:33792
  v_mfma_f32_16x16x32_bf16 v[20:23], v[232:235], v[228:231], v[20:23]
  ds_read_b64_tr_b16 v[112:113], v176 offset:20608
  s_add_u32 m0, s49, 32768
  v_mfma_f32_16x16x32_bf16 v[4:7], v[236:239], v[224:227], v[4:7]
  ds_read_b64_tr_b16 v[114:115], v176 offset:23168
  ds_read_b64_tr_b16 v[116:117], v177 offset:20608
  v_mfma_f32_16x16x32_bf16 v[24:27], v[236:239], v[228:231], v[24:27]
  ds_read_b64_tr_b16 v[118:119], v177 offset:23168
  buffer_load_dwordx4 v172, s[84:87], s44 offen offset:0 sc1 lds
  v_mfma_f32_16x16x32_bf16 v[8:11], v[240:243], v[224:227], v[8:11]
  ds_read_b64_tr_b16 v[120:121], v176 offset:20672
  ds_read_b64_tr_b16 v[122:123], v176 offset:23232
  buffer_load_dwordx4 v172, s[84:87], s44 offen offset:1024 sc1 lds
  v_mfma_f32_16x16x32_bf16 v[28:31], v[240:243], v[228:231], v[28:31]
  ds_read_b64_tr_b16 v[124:125], v177 offset:20672
  ds_read_b64_tr_b16 v[126:127], v177 offset:23232
  v_mfma_f32_16x16x32_bf16 v[12:15], v[244:247], v[224:227], v[12:15]
  ds_read_b64_tr_b16 v[128:129], v177 offset:20736
  s_add_u32 s44, s44, 65536
  v_mfma_f32_16x16x32_bf16 v[32:35], v[244:247], v[228:231], v[32:35]
  ds_read_b64_tr_b16 v[130:131], v177 offset:23296
  ds_read_b128 v[132:135], v181 offset:57344
  s_add_u32 m0, s45, 52224
  v_mfma_f32_16x16x32_bf16 v[16:19], v[248:251], v[224:227], v[16:19]
  ds_read_b128 v[136:139], v181 offset:58368
  v_mfma_f32_16x16x32_bf16 v[36:39], v[248:251], v[228:231], v[36:39]
  ds_read_b64_tr_b16 v[140:141], v176 offset:30848
  ds_read_b64_tr_b16 v[142:143], v176 offset:33408
  buffer_load_dwordx4 v191, s[36:39], s43 offen offset:0 lds
  v_mfma_f32_16x16x32_bf16 v[0:3], v[196:199], v[252:255], v[0:3]
  ds_read_b64_tr_b16 v[144:145], v177 offset:30848
  ds_read_b64_tr_b16 v[146:147], v177 offset:33408
  buffer_load_dwordx4 v160, s[36:39], s43 offen offset:1024 lds
  v_mfma_f32_16x16x32_bf16 v[20:23], v[196:199], v[192:195], v[20:23]
  ds_read_b64_tr_b16 v[148:149], v176 offset:30912
  v_mfma_f32_16x16x32_bf16 v[4:7], v[200:203], v[252:255], v[4:7]
  ds_read_b64_tr_b16 v[150:151], v176 offset:33472
  ds_read_b64_tr_b16 v[152:153], v177 offset:30912
  s_add_u32 s43, s43, 40960
  v_mfma_f32_16x16x32_bf16 v[24:27], v[200:203], v[192:195], v[24:27]
  ds_read_b64_tr_b16 v[154:155], v177 offset:33472
  s_mov_b64 exec, s[56:57]
  buffer_load_dwordx4 v[68:71], v161, s[88:91], 0 offen offset:256 sc1
  s_mov_b64 exec, -1
  buffer_load_dwordx4 v[40:43], v182, s[76:79], 0 offen offset:128
  buffer_load_dword v44, v183, s[76:79], 0 offen offset:256
  v_mfma_f32_16x16x32_bf16 v[8:11], v[204:207], v[252:255], v[8:11]
  ds_read_b64_tr_b16 v[156:157], v177 offset:30976
  ds_read_b64_tr_b16 v[158:159], v177 offset:33536
  v_mfma_f32_16x16x32_bf16 v[28:31], v[204:207], v[192:195], v[28:31]
  v_mfma_f32_16x16x32_bf16 v[12:15], v[208:211], v[252:255], v[12:15]
  v_mfma_f32_16x16x32_bf16 v[32:35], v[208:211], v[192:195], v[32:35]
  v_mfma_f32_16x16x32_bf16 v[16:19], v[212:215], v[252:255], v[16:19]
  v_mfma_f32_16x16x32_bf16 v[36:39], v[212:215], v[192:195], v[36:39]
  s_waitcnt lgkmcnt(0)
  s_waitcnt vmcnt(13)
  s_barrier
  v_mfma_f32_16x16x32_bf16 v[0:3], v[112:115], v[104:107], v[0:3]
  ds_read_b128 v[224:227], v180 offset:0
  ds_read_b128 v[228:231], v180 offset:1024
  v_mfma_f32_16x16x32_bf16 v[20:23], v[112:115], v[108:111], v[20:23]
  ds_read_b64_tr_b16 v[232:233], v178 offset:8320
  v_mfma_f32_16x16x32_bf16 v[4:7], v[116:119], v[104:107], v[4:7]
  ds_read_b64_tr_b16 v[234:235], v178 offset:10880
  ds_read_b64_tr_b16 v[236:237], v179 offset:8320
  v_mfma_f32_16x16x32_bf16 v[24:27], v[116:119], v[108:111], v[24:27]
  ds_read_b64_tr_b16 v[238:239], v179 offset:10880
  v_mfma_f32_16x16x32_bf16 v[8:11], v[120:123], v[104:107], v[8:11]
  ds_read_b64_tr_b16 v[240:241], v178 offset:8384
  ds_read_b64_tr_b16 v[242:243], v178 offset:10944
  v_mfma_f32_16x16x32_bf16 v[28:31], v[120:123], v[108:111], v[28:31]
  ds_read_b64_tr_b16 v[244:245], v179 offset:8384
  ds_read_b64_tr_b16 v[246:247], v179 offset:10944
  v_mfma_f32_16x16x32_bf16 v[12:15], v[124:127], v[104:107], v[12:15]
  ds_read_b64_tr_b16 v[248:249], v179 offset:8448
  v_mfma_f32_16x16x32_bf16 v[32:35], v[124:127], v[108:111], v[32:35]
  ds_read_b64_tr_b16 v[250:251], v179 offset:11008
  ds_read_b128 v[252:255], v180 offset:8192
  v_mfma_f32_16x16x32_bf16 v[16:19], v[128:131], v[104:107], v[16:19]
  ds_read_b128 v[192:195], v180 offset:9216
  v_mfma_f32_16x16x32_bf16 v[36:39], v[128:131], v[108:111], v[36:39]
  ds_read_b64_tr_b16 v[196:197], v178 offset:18560
  ds_read_b64_tr_b16 v[198:199], v178 offset:21120
  v_mfma_f32_16x16x32_bf16 v[0:3], v[140:143], v[132:135], v[0:3]
  ds_read_b64_tr_b16 v[200:201], v179 offset:18560
  ds_read_b64_tr_b16 v[202:203], v179 offset:21120
  v_mfma_f32_16x16x32_bf16 v[20:23], v[140:143], v[136:139], v[20:23]
  ds_read_b64_tr_b16 v[204:205], v178 offset:18624
  v_mfma_f32_16x16x32_bf16 v[4:7], v[144:147], v[132:135], v[4:7]
  ds_read_b64_tr_b16 v[206:207], v178 offset:21184
  ds_read_b64_tr_b16 v[208:209], v179 offset:18624
  v_mfma_f32_16x16x32_bf16 v[24:27], v[144:147], v[136:139], v[24:27]
  ds_read_b64_tr_b16 v[210:211], v179 offset:21184
  s_mov_b64 exec, s[56:57]
  buffer_load_dwordx4 v[72:75], v161, s[88:91], 0 offen offset:512 sc1
  s_mov_b64 exec, -1
  v_mfma_f32_16x16x32_bf16 v[8:11], v[148:151], v[132:135], v[8:11]
  ds_read_b64_tr_b16 v[212:213], v179 offset:18688
  ds_read_b64_tr_b16 v[214:215], v179 offset:21248
  v_mfma_f32_16x16x32_bf16 v[28:31], v[148:151], v[136:139], v[28:31]
  v_mfma_f32_16x16x32_bf16 v[12:15], v[152:155], v[132:135], v[12:15]
  v_mfma_f32_16x16x32_bf16 v[32:35], v[152:155], v[136:139], v[32:35]
  v_mfma_f32_16x16x32_bf16 v[16:19], v[156:159], v[132:135], v[16:19]
  v_mfma_f32_16x16x32_bf16 v[36:39], v[156:159], v[136:139], v[36:39]
  s_waitcnt lgkmcnt(0)
  s_waitcnt vmcnt(9)
  s_barrier
  v_mfma_f32_16x16x32_bf16 v[0:3], v[232:235], v[224:227], v[0:3]
  ds_read_b128 v[104:107], v180 offset:16384
  ds_read_b128 v[108:111], v180 offset:17408
  v_mfma_f32_16x16x32_bf16 v[20:23], v[232:235], v[228:231], v[20:23]
  ds_read_b64_tr_b16 v[112:113], v178 offset:28800
  v_mfma_f32_16x16x32_bf16 v[4:7], v[236:239], v[224:227], v[4:7]
  ds_read_b64_tr_b16 v[114:115], v178 offset:31360
  ds_read_b64_tr_b16 v[116:117], v179 offset:28800
  v_mfma_f32_16x16x32_bf16 v[24:27], v[236:239], v[228:231], v[24:27]
  ds_read_b64_tr_b16 v[118:119], v179 offset:31360
  v_mfma_f32_16x16x32_bf16 v[8:11], v[240:243], v[224:227], v[8:11]
  ds_read_b64_tr_b16 v[120:121], v178 offset:28864
  ds_read_b64_tr_b16 v[122:123], v178 offset:31424
  v_mfma_f32_16x16x32_bf16 v[28:31], v[240:243], v[228:231], v[28:31]
  ds_read_b64_tr_b16 v[124:125], v179 offset:28864
  ds_read_b64_tr_b16 v[126:127], v179 offset:31424
  v_mfma_f32_16x16x32_bf16 v[12:15], v[244:247], v[224:227], v[12:15]
  ds_read_b64_tr_b16 v[128:129], v179 offset:28928
  v_mfma_f32_16x16x32_bf16 v[32:35], v[244:247], v[228:231], v[32:35]
  ds_read_b64_tr_b16 v[130:131], v179 offset:31488
  ds_read_b128 v[132:135], v180 offset:24576
  v_mfma_f32_16x16x32_bf16 v[16:19], v[248:251], v[224:227], v[16:19]
  ds_read_b128 v[136:139], v180 offset:25600
  v_mfma_f32_16x16x32_bf16 v[36:39], v[248:251], v[228:231], v[36:39]
  ds_read_b64_tr_b16 v[140:141], v178 offset:39040
  ds_read_b64_tr_b16 v[142:143], v178 offset:41600
  v_mfma_f32_16x16x32_bf16 v[0:3], v[196:199], v[252:255], v[0:3]
  ds_read_b64_tr_b16 v[144:145], v179 offset:39040
  ds_read_b64_tr_b16 v[146:147], v179 offset:41600
  v_mfma_f32_16x16x32_bf16 v[20:23], v[196:199], v[192:195], v[20:23]
  ds_read_b64_tr_b16 v[148:149], v178 offset:39104
  v_mfma_f32_16x16x32_bf16 v[4:7], v[200:203], v[252:255], v[4:7]
  ds_read_b64_tr_b16 v[150:151], v178 offset:41664
  ds_read_b64_tr_b16 v[152:153], v179 offset:39104
  v_mfma_f32_16x16x32_bf16 v[24:27], v[200:203], v[192:195], v[24:27]
  ds_read_b64_tr_b16 v[154:155], v179 offset:41664
  s_mov_b64 exec, s[56:57]
  buffer_load_dwordx4 v[76:79], v161, s[88:91], 0 offen offset:768 sc1
  s_mov_b64 exec, -1
  v_mfma_f32_16x16x32_bf16 v[8:11], v[204:207], v[252:255], v[8:11]
  ds_read_b64_tr_b16 v[156:157], v179 offset:39168
  ds_read_b64_tr_b16 v[158:159], v179 offset:41728
  v_mfma_f32_16x16x32_bf16 v[28:31], v[204:207], v[192:195], v[28:31]
  v_mfma_f32_16x16x32_bf16 v[12:15], v[208:211], v[252:255], v[12:15]
  v_mfma_f32_16x16x32_bf16 v[32:35], v[208:211], v[192:195], v[32:35]
  v_mfma_f32_16x16x32_bf16 v[16:19], v[212:215], v[252:255], v[16:19]
  v_mfma_f32_16x16x32_bf16 v[36:39], v[212:215], v[192:195], v[36:39]
  s_waitcnt lgkmcnt(0)
  s_waitcnt vmcnt(5)
  s_barrier
  v_mfma_f32_16x16x32_bf16 v[0:3], v[112:115], v[104:107], v[0:3]
  ds_read_b128 v[224:227], v180 offset:32768
  ds_read_b128 v[228:231], v180 offset:33792
  v_mfma_f32_16x16x32_bf16 v[20:23], v[112:115], v[108:111], v[20:23]
  ds_read_b64_tr_b16 v[232:233], v176 offset:128
  v_mfma_f32_16x16x32_bf16 v[4:7], v[116:119], v[104:107], v[4:7]
  ds_read_b64_tr_b16 v[234:235], v176 offset:2688
  ds_read_b64_tr_b16 v[236:237], v177 offset:128
  v_mfma_f32_16x16x32_bf16 v[24:27], v[116:119], v[108:111], v[24:27]
  ds_read_b64_tr_b16 v[238:239], v177 offset:2688
  v_mfma_f32_16x16x32_bf16 v[8:11], v[120:123], v[104:107], v[8:11]
  ds_read_b64_tr_b16 v[240:241], v176 offset:192
  ds_read_b64_tr_b16 v[242:243], v176 offset:2752
  v_mfma_f32_16x16x32_bf16 v[28:31], v[120:123], v[108:111], v[28:31]
  ds_read_b64_tr_b16 v[244:245], v177 offset:192
  ds_read_b64_tr_b16 v[246:247], v177 offset:2752
  v_mfma_f32_16x16x32_bf16 v[12:15], v[124:127], v[104:107], v[12:15]
  ds_read_b64_tr_b16 v[248:249], v177 offset:256
  v_mfma_f32_16x16x32_bf16 v[32:35], v[124:127], v[108:111], v[32:35]
  ds_read_b64_tr_b16 v[250:251], v177 offset:2816
  ds_read_b128 v[252:255], v180 offset:40960
  v_mfma_f32_16x16x32_bf16 v[16:19], v[128:131], v[104:107], v[16:19]
  ds_read_b128 v[192:195], v180 offset:41984
  v_mfma_f32_16x16x32_bf16 v[36:39], v[128:131], v[108:111], v[36:39]
  ds_read_b64_tr_b16 v[196:197], v176 offset:10368
  ds_read_b64_tr_b16 v[198:199], v176 offset:12928
  v_mfma_f32_16x16x32_bf16 v[0:3], v[140:143], v[132:135], v[0:3]
  ds_read_b64_tr_b16 v[200:201], v177 offset:10368
  ds_read_b64_tr_b16 v[202:203], v177 offset:12928
  v_mfma_f32_16x16x32_bf16 v[20:23], v[140:143], v[136:139], v[20:23]
  ds_read_b64_tr_b16 v[204:205], v176 offset:10432
  v_mfma_f32_16x16x32_bf16 v[4:7], v[144:147], v[132:135], v[4:7]
  ds_read_b64_tr_b16 v[206:207], v176 offset:12992
  ds_read_b64_tr_b16 v[208:209], v177 offset:10432
  v_mfma_f32_16x16x32_bf16 v[24:27], v[144:147], v[136:139], v[24:27]
  ds_read_b64_tr_b16 v[210:211], v177 offset:12992
  s_mov_b64 exec, s[56:57]
  buffer_load_dwordx4 v[80:83], v161, s[88:91], 0 offen offset:1024 sc1
  s_mov_b64 exec, -1
  v_mfma_f32_16x16x32_bf16 v[8:11], v[148:151], v[132:135], v[8:11]
  ds_read_b64_tr_b16 v[212:213], v177 offset:10496
  ds_read_b64_tr_b16 v[214:215], v177 offset:13056
  v_mfma_f32_16x16x32_bf16 v[28:31], v[148:151], v[136:139], v[28:31]
  v_mfma_f32_16x16x32_bf16 v[12:15], v[152:155], v[132:135], v[12:15]
  v_mfma_f32_16x16x32_bf16 v[32:35], v[152:155], v[136:139], v[32:35]
  v_mfma_f32_16x16x32_bf16 v[16:19], v[156:159], v[132:135], v[16:19]
  v_mfma_f32_16x16x32_bf16 v[36:39], v[156:159], v[136:139], v[36:39]
  s_waitcnt lgkmcnt(15)
  v_mfma_f32_16x16x32_bf16 v[0:3], v[232:235], v[224:227], v[0:3]
  v_mfma_f32_16x16x32_bf16 v[20:23], v[232:235], v[228:231], v[20:23]
  v_mfma_f32_16x16x32_bf16 v[4:7], v[236:239], v[224:227], v[4:7]
  v_mfma_f32_16x16x32_bf16 v[24:27], v[236:239], v[228:231], v[24:27]
  v_mfma_f32_16x16x32_bf16 v[8:11], v[240:243], v[224:227], v[8:11]
  v_mfma_f32_16x16x32_bf16 v[28:31], v[240:243], v[228:231], v[28:31]
  s_waitcnt lgkmcnt(14)
  v_mfma_f32_16x16x32_bf16 v[12:15], v[244:247], v[224:227], v[12:15]
  v_mfma_f32_16x16x32_bf16 v[32:35], v[244:247], v[228:231], v[32:35]
  s_waitcnt lgkmcnt(12)
  v_mfma_f32_16x16x32_bf16 v[16:19], v[248:251], v[224:227], v[16:19]
  v_mfma_f32_16x16x32_bf16 v[36:39], v[248:251], v[228:231], v[36:39]
  s_waitcnt lgkmcnt(8)
  v_mfma_f32_16x16x32_bf16 v[0:3], v[196:199], v[252:255], v[0:3]
  s_waitcnt vmcnt(4)
  v_mov_b32 v170, v40
  s_mov_b32 exec_lo, s46
  s_mov_b32 exec_hi, s46
  v_swap_b32 v40, v42
  v_swap_b32 v41, v43
  s_mov_b64 exec, -1
  v_mfma_f32_16x16x32_bf16 v[20:23], v[196:199], v[192:195], v[20:23]
  s_waitcnt lgkmcnt(6)
  v_mfma_f32_16x16x32_bf16 v[4:7], v[200:203], v[252:255], v[4:7]
  v_mfma_f32_16x16x32_bf16 v[24:27], v[200:203], v[192:195], v[24:27]
  s_waitcnt lgkmcnt(4)
  v_mfma_f32_16x16x32_bf16 v[8:11], v[204:207], v[252:255], v[8:11]
  v_mfma_f32_16x16x32_bf16 v[28:31], v[204:207], v[192:195], v[28:31]
  s_waitcnt lgkmcnt(2)
  v_mfma_f32_16x16x32_bf16 v[12:15], v[208:211], v[252:255], v[12:15]
  v_mfma_f32_16x16x32_bf16 v[32:35], v[208:211], v[192:195], v[32:35]
  s_waitcnt lgkmcnt(0)
  v_mfma_f32_16x16x32_bf16 v[16:19], v[212:215], v[252:255], v[16:19]
  v_mfma_f32_16x16x32_bf16 v[36:39], v[212:215], v[192:195], v[36:39]
  v_cvt_pk_bf16_f32 v0, v0, v1
  v_cvt_pk_bf16_f32 v1, v2, v3
  v_cvt_pk_bf16_f32 v2, v4, v5
  v_cvt_pk_bf16_f32 v3, v6, v7
  buffer_store_dwordx4 v[0:3], v184, s[88:91], s3 offen offset:0 sc1
  v_cvt_pk_bf16_f32 v4, v8, v9
  v_cvt_pk_bf16_f32 v5, v10, v11
  v_cvt_pk_bf16_f32 v6, v12, v13
  v_cvt_pk_bf16_f32 v7, v14, v15
  buffer_store_dwordx4 v[4:7], v184, s[88:91], s3 offen offset:256 sc1
  v_cvt_pk_bf16_f32 v8, v16, v17
  v_cvt_pk_bf16_f32 v9, v18, v19
  v_cvt_pk_bf16_f32 v10, v20, v21
  v_cvt_pk_bf16_f32 v11, v22, v23
  buffer_store_dwordx4 v[8:11], v184, s[88:91], s3 offen offset:512 sc1
  v_cvt_pk_bf16_f32 v12, v24, v25
  v_cvt_pk_bf16_f32 v13, v26, v27
  v_cvt_pk_bf16_f32 v14, v28, v29
  v_cvt_pk_bf16_f32 v15, v30, v31
  buffer_store_dwordx4 v[12:15], v184, s[88:91], s3 offen offset:768 sc1
  v_cvt_pk_bf16_f32 v16, v32, v33
  v_cvt_pk_bf16_f32 v17, v34, v35
  v_cvt_pk_bf16_f32 v18, v36, v37
  v_cvt_pk_bf16_f32 v19, v38, v39
  buffer_store_dwordx4 v[16:19], v184, s[88:91], s3 offen offset:1024 sc1
  s_mov_b64 exec, s[56:57]
  buffer_load_dwordx4 v[0:3], v161, s[88:91], s3 offen offset:0 sc1
  buffer_load_dwordx4 v[4:7], v161, s[88:91], s3 offen offset:256 sc1
  buffer_load_dwordx4 v[8:11], v161, s[88:91], s3 offen offset:512 sc1
  buffer_load_dwordx4 v[12:15], v161, s[88:91], s3 offen offset:768 sc1
  buffer_load_dwordx4 v[16:19], v161, s[88:91], s3 offen offset:1024 sc1
  s_mov_b64 exec, -1
  v_max3_u32 v165, v64, v65, v66
  v_max3_u32 v165, v165, v67, v68
  v_max3_u32 v165, v165, v69, v70
  s_waitcnt vmcnt(12)
  v_max3_u32 v165, v165, v71, v72
  v_max3_u32 v165, v165, v73, v74
  s_waitcnt vmcnt(11)
  v_max3_u32 v165, v165, v75, v76
  v_max3_u32 v165, v165, v77, v78
  s_waitcnt vmcnt(10)
  v_max3_u32 v165, v165, v79, v80
  v_max3_u32 v165, v165, v81, v82
  v_max_u32 v165, v165, v83
  v_cmp_eq_u32 vcc, -1, v165
  s_nop 4
  s_cbranch_vccnz L_p3_spin_1_0
L_p3_ok_1_0:
  v_and_b32 v103, s46, v83
  v_lshlrev_b32 v102, 16, v83
  v_and_b32 v101, s46, v82
  v_lshlrev_b32 v100, 16, v82
  v_and_b32 v99, s46, v81
  v_lshlrev_b32 v98, 16, v81
  v_and_b32 v97, s46, v80
  v_lshlrev_b32 v96, 16, v80
  v_and_b32 v95, s46, v79
  v_lshlrev_b32 v94, 16, v79
  v_and_b32 v93, s46, v78
  v_lshlrev_b32 v92, 16, v78
  v_and_b32 v91, s46, v77
  v_lshlrev_b32 v90, 16, v77
  v_and_b32 v89, s46, v76
  v_lshlrev_b32 v88, 16, v76
  v_and_b32 v87, s46, v75
  v_lshlrev_b32 v86, 16, v75
  v_and_b32 v85, s46, v74
  v_lshlrev_b32 v84, 16, v74
  v_and_b32 v83, s46, v73
  v_lshlrev_b32 v82, 16, v73
  v_and_b32 v81, s46, v72
  v_lshlrev_b32 v80, 16, v72
  v_and_b32 v79, s46, v71
  v_lshlrev_b32 v78, 16, v71
  v_and_b32 v77, s46, v70
  v_lshlrev_b32 v76, 16, v70
  v_and_b32 v75, s46, v69
  v_lshlrev_b32 v74, 16, v69
  v_and_b32 v73, s46, v68
  v_lshlrev_b32 v72, 16, v68
  v_and_b32 v71, s46, v67
  v_lshlrev_b32 v70, 16, v67
  v_and_b32 v69, s46, v66
  v_lshlrev_b32 v68, 16, v66
  v_and_b32 v67, s46, v65
  v_lshlrev_b32 v66, 16, v65
  v_and_b32 v65, s46, v64
  v_lshlrev_b32 v64, 16, v64
  v_add_f32_dpp v83, v83, v83 row_ror:8 row_mask:0xf bank_mask:0x3
  v_add_f32_dpp v82, v82, v82 row_ror:8 row_mask:0xf bank_mask:0x3
  v_add_f32_dpp v81, v81, v81 row_ror:8 row_mask:0xf bank_mask:0x3
  v_add_f32_dpp v80, v80, v80 row_ror:8 row_mask:0xf bank_mask:0x3
  v_add_f32_dpp v79, v79, v79 row_ror:8 row_mask:0xf bank_mask:0x3
  v_add_f32_dpp v78, v78, v78 row_ror:8 row_mask:0xf bank_mask:0x3
  v_add_f32_dpp v77, v77, v77 row_ror:8 row_mask:0xf bank_mask:0x3
  v_add_f32_dpp v76, v76, v76 row_ror:8 row_mask:0xf bank_mask:0x3
  v_add_f32_dpp v75, v75, v75 row_ror:8 row_mask:0xf bank_mask:0x3
  v_add_f32_dpp v74, v74, v74 row_ror:8 row_mask:0xf bank_mask:0x3
  v_add_f32_dpp v73, v73, v73 row_ror:8 row_mask:0xf bank_mask:0x3
  v_add_f32_dpp v72, v72, v72 row_ror:8 row_mask:0xf bank_mask:0x3
  v_add_f32_dpp v71, v71, v71 row_ror:8 row_mask:0xf bank_mask:0x3
  v_add_f32_dpp v70, v70, v70 row_ror:8 row_mask:0xf bank_mask:0x3
  v_add_f32_dpp v69, v69, v69 row_ror:8 row_mask:0xf bank_mask:0x3
  v_add_f32_dpp v68, v68, v68 row_ror:8 row_mask:0xf bank_mask:0x3
  v_add_f32_dpp v67, v67, v67 row_ror:8 row_mask:0xf bank_mask:0x3
  v_add_f32_dpp v66, v66, v66 row_ror:8 row_mask:0xf bank_mask:0x3
  v_add_f32_dpp v65, v65, v65 row_ror:8 row_mask:0xf bank_mask:0x3
  v_add_f32_dpp v64, v64, v64 row_ror:8 row_mask:0xf bank_mask:0x3
  v_add_f32_dpp v83, v103, v103 row_ror:8 row_mask:0xf bank_mask:0xc
  v_add_f32_dpp v82, v102, v102 row_ror:8 row_mask:0xf bank_mask:0xc
  v_add_f32_dpp v81, v101, v101 row_ror:8 row_mask:0xf bank_mask:0xc
  v_add_f32_dpp v80, v100, v100 row_ror:8 row_mask:0xf bank_mask:0xc
  v_add_f32_dpp v79, v99, v99 row_ror:8 row_mask:0xf bank_mask:0xc
  v_add_f32_dpp v78, v98, v98 row_ror:8 row_mask:0xf bank_mask:0xc
  v_add_f32_dpp v77, v97, v97 row_ror:8 row_mask:0xf bank_mask:0xc
  v_add_f32_dpp v76, v96, v96 row_ror:8 row_mask:0xf bank_mask:0xc
  v_add_f32_dpp v75, v95, v95 row_ror:8 row_mask:0xf bank_mask:0xc
  v_add_f32_dpp v74, v94, v94 row_ror:8 row_mask:0xf bank_mask:0xc
  v_add_f32_dpp v73, v93, v93 row_ror:8 row_mask:0xf bank_mask:0xc
  v_add_f32_dpp v72, v92, v92 row_ror:8 row_mask:0xf bank_mask:0xc
  v_add_f32_dpp v71, v91, v91 row_ror:8 row_mask:0xf bank_mask:0xc
  v_add_f32_dpp v70, v90, v90 row_ror:8 row_mask:0xf bank_mask:0xc
  v_add_f32_dpp v69, v89, v89 row_ror:8 row_mask:0xf bank_mask:0xc
  v_add_f32_dpp v68, v88, v88 row_ror:8 row_mask:0xf bank_mask:0xc
  v_add_f32_dpp v67, v87, v87 row_ror:8 row_mask:0xf bank_mask:0xc
  v_add_f32_dpp v66, v86, v86 row_ror:8 row_mask:0xf bank_mask:0xc
  v_add_f32_dpp v65, v85, v85 row_ror:8 row_mask:0xf bank_mask:0xc
  v_add_f32_dpp v64, v84, v84 row_ror:8 row_mask:0xf bank_mask:0xc
  v_add_f32_dpp v81, v81, v81 row_shl:4 row_mask:0xf bank_mask:0x5
  v_add_f32_dpp v80, v80, v80 row_shl:4 row_mask:0xf bank_mask:0x5
  v_add_f32_dpp v71, v71, v71 row_shl:4 row_mask:0xf bank_mask:0x5
  v_add_f32_dpp v70, v70, v70 row_shl:4 row_mask:0xf bank_mask:0x5
  v_add_f32_dpp v69, v69, v69 row_shl:4 row_mask:0xf bank_mask:0x5
  v_add_f32_dpp v68, v68, v68 row_shl:4 row_mask:0xf bank_mask:0x5
  v_add_f32_dpp v67, v67, v67 row_shl:4 row_mask:0xf bank_mask:0x5
  v_add_f32_dpp v66, v66, v66 row_shl:4 row_mask:0xf bank_mask:0x5
  v_add_f32_dpp v65, v65, v65 row_shl:4 row_mask:0xf bank_mask:0x5
  v_add_f32_dpp v64, v64, v64 row_shl:4 row_mask:0xf bank_mask:0x5
  v_add_f32_dpp v81, v83, v83 row_shr:4 row_mask:0xf bank_mask:0xa
  v_add_f32_dpp v80, v82, v82 row_shr:4 row_mask:0xf bank_mask:0xa
  v_add_f32_dpp v71, v79, v79 row_shr:4 row_mask:0xf bank_mask:0xa
  v_add_f32_dpp v70, v78, v78 row_shr:4 row_mask:0xf bank_mask:0xa
  v_add_f32_dpp v69, v77, v77 row_shr:4 row_mask:0xf bank_mask:0xa
  v_add_f32_dpp v68, v76, v76 row_shr:4 row_mask:0xf bank_mask:0xa
  v_add_f32_dpp v67, v75, v75 row_shr:4 row_mask:0xf bank_mask:0xa
  v_add_f32_dpp v66, v74, v74 row_shr:4 row_mask:0xf bank_mask:0xa
  v_add_f32_dpp v65, v73, v73 row_shr:4 row_mask:0xf bank_mask:0xa
  v_add_f32_dpp v64, v72, v72 row_shr:4 row_mask:0xf bank_mask:0xa
  v_mul_f32 v165, 0xbfb8aa3b, v64
  v_mul_f32 v166, 0xbfb8aa3b, v65
  v_exp_f32 v165, v165
  v_exp_f32 v166, v166
  v_add_f32 v165, 1.0, v165
  v_add_f32 v166, 1.0, v166
  v_rcp_f32 v165, v165
  v_rcp_f32 v166, v166
  v_mul_f32 v64, v165, v64
  v_mul_f32 v65, v166, v65
  v_mul_f32 v165, 0xbfb8aa3b, v66
  v_mul_f32 v166, 0xbfb8aa3b, v67
  v_exp_f32 v165, v165
  v_exp_f32 v166, v166
  v_add_f32 v165, 1.0, v165
  v_add_f32 v166, 1.0, v166
  v_rcp_f32 v165, v165
  v_rcp_f32 v166, v166
  v_mul_f32 v66, v165, v66
  v_mul_f32 v67, v166, v67
  v_mul_f32 v165, 0xbfb8aa3b, v68
  v_mul_f32 v166, 0xbfb8aa3b, v69
  v_exp_f32 v165, v165
  v_exp_f32 v166, v166
  v_add_f32 v165, 1.0, v165
  v_add_f32 v166, 1.0, v166
  v_rcp_f32 v165, v165
  v_rcp_f32 v166, v166
  v_mul_f32 v68, v165, v68
  v_mul_f32 v69, v166, v69
  v_mul_f32 v165, 0xbfb8aa3b, v70
  v_mul_f32 v166, 0xbfb8aa3b, v71
  v_exp_f32 v165, v165
  v_exp_f32 v166, v166
  v_add_f32 v165, 1.0, v165
  v_add_f32 v166, 1.0, v166
  v_rcp_f32 v165, v165
  v_rcp_f32 v166, v166
  v_mul_f32 v70, v165, v70
  v_mul_f32 v71, v166, v71
  v_mul_f32 v165, 0xbfb8aa3b, v80
  v_mul_f32 v166, 0xbfb8aa3b, v81
  v_exp_f32 v165, v165
  v_exp_f32 v166, v166
  v_add_f32 v165, 1.0, v165
  v_add_f32 v166, 1.0, v166
  v_rcp_f32 v165, v165
  v_rcp_f32 v166, v166
  v_mul_f32 v80, v165, v80
  v_mul_f32 v81, v166, v81
  s_waitcnt vmcnt(4)
  v_max3_u32 v165, v0, v1, v2
  s_waitcnt vmcnt(3)
  v_max3_u32 v165, v165, v3, v4
  v_max3_u32 v165, v165, v5, v6
  s_waitcnt vmcnt(2)
  v_max3_u32 v165, v165, v7, v8
  v_max3_u32 v165, v165, v9, v10
  s_waitcnt vmcnt(1)
  v_max3_u32 v165, v165, v11, v12
  v_max3_u32 v165, v165, v13, v14
  s_waitcnt vmcnt(0)
  v_max3_u32 v165, v165, v15, v16
  v_max3_u32 v165, v165, v17, v18
  v_max_u32 v165, v165, v19
  v_cmp_eq_u32 vcc, -1, v165
  s_nop 4
  s_cbranch_vccnz L_p3_spin_1_1
L_p3_ok_1_1:
  v_and_b32 v39, s46, v19
  v_lshlrev_b32 v38, 16, v19
  v_and_b32 v37, s46, v18
  v_lshlrev_b32 v36, 16, v18
  v_and_b32 v35, s46, v17
  v_lshlrev_b32 v34, 16, v17
  v_and_b32 v33, s46, v16
  v_lshlrev_b32 v32, 16, v16
  v_and_b32 v31, s46, v15
  v_lshlrev_b32 v30, 16, v15
  v_and_b32 v29, s46, v14
  v_lshlrev_b32 v28, 16, v14
  v_and_b32 v27, s46, v13
  v_lshlrev_b32 v26, 16, v13
  v_and_b32 v25, s46, v12
  v_lshlrev_b32 v24, 16, v12
  v_and_b32 v23, s46, v11
  v_lshlrev_b32 v22, 16, v11
  v_and_b32 v21, s46, v10
  v_lshlrev_b32 v20, 16, v10
  v_and_b32 v19, s46, v9
  v_lshlrev_b32 v18, 16, v9
  v_and_b32 v17, s46, v8
  v_lshlrev_b32 v16, 16, v8
  v_and_b32 v15, s46, v7
  v_lshlrev_b32 v14, 16, v7
  v_and_b32 v13, s46, v6
  v_lshlrev_b32 v12, 16, v6
  v_and_b32 v11, s46, v5
  v_lshlrev_b32 v10, 16, v5
  v_and_b32 v9, s46, v4
  v_lshlrev_b32 v8, 16, v4
  v_and_b32 v7, s46, v3
  v_lshlrev_b32 v6, 16, v3
  v_and_b32 v5, s46, v2
  v_lshlrev_b32 v4, 16, v2
  v_and_b32 v3, s46, v1
  v_lshlrev_b32 v2, 16, v1
  v_and_b32 v1, s46, v0
  v_lshlrev_b32 v0, 16, v0
  v_add_f32_dpp v19, v19, v19 row_ror:8 row_mask:0xf bank_mask:0x3
  v_add_f32_dpp v18, v18, v18 row_ror:8 row_mask:0xf bank_mask:0x3
  v_add_f32_dpp v17, v17, v17 row_ror:8 row_mask:0xf bank_mask:0x3
  v_add_f32_dpp v16, v16, v16 row_ror:8 row_mask:0xf bank_mask:0x3
  v_add_f32_dpp v15, v15, v15 row_ror:8 row_mask:0xf bank_mask:0x3
  v_add_f32_dpp v14, v14, v14 row_ror:8 row_mask:0xf bank_mask:0x3
  v_add_f32_dpp v13, v13, v13 row_ror:8 row_mask:0xf bank_mask:0x3
  v_add_f32_dpp v12, v12, v12 row_ror:8 row_mask:0xf bank_mask:0x3
  v_add_f32_dpp v11, v11, v11 row_ror:8 row_mask:0xf bank_mask:0x3
  v_add_f32_dpp v10, v10, v10 row_ror:8 row_mask:0xf bank_mask:0x3
  v_add_f32_dpp v9, v9, v9 row_ror:8 row_mask:0xf bank_mask:0x3
  v_add_f32_dpp v8, v8, v8 row_ror:8 row_mask:0xf bank_mask:0x3
  v_add_f32_dpp v7, v7, v7 row_ror:8 row_mask:0xf bank_mask:0x3
  v_add_f32_dpp v6, v6, v6 row_ror:8 row_mask:0xf bank_mask:0x3
  v_add_f32_dpp v5, v5, v5 row_ror:8 row_mask:0xf bank_mask:0x3
  v_add_f32_dpp v4, v4, v4 row_ror:8 row_mask:0xf bank_mask:0x3
  v_add_f32_dpp v3, v3, v3 row_ror:8 row_mask:0xf bank_mask:0x3
  v_add_f32_dpp v2, v2, v2 row_ror:8 row_mask:0xf bank_mask:0x3
  v_add_f32_dpp v1, v1, v1 row_ror:8 row_mask:0xf bank_mask:0x3
  v_add_f32_dpp v0, v0, v0 row_ror:8 row_mask:0xf bank_mask:0x3
  v_add_f32_dpp v19, v39, v39 row_ror:8 row_mask:0xf bank_mask:0xc
  v_add_f32_dpp v18, v38, v38 row_ror:8 row_mask:0xf bank_mask:0xc
  v_add_f32_dpp v17, v37, v37 row_ror:8 row_mask:0xf bank_mask:0xc
  v_add_f32_dpp v16, v36, v36 row_ror:8 row_mask:0xf bank_mask:0xc
  v_add_f32_dpp v15, v35, v35 row_ror:8 row_mask:0xf bank_mask:0xc
  v_add_f32_dpp v14, v34, v34 row_ror:8 row_mask:0xf bank_mask:0xc
  v_add_f32_dpp v13, v33, v33 row_ror:8 row_mask:0xf bank_mask:0xc
  v_add_f32_dpp v12, v32, v32 row_ror:8 row_mask:0xf bank_mask:0xc
  v_add_f32_dpp v11, v31, v31 row_ror:8 row_mask:0xf bank_mask:0xc
  v_add_f32_dpp v10, v30, v30 row_ror:8 row_mask:0xf bank_mask:0xc
  v_add_f32_dpp v9, v29, v29 row_ror:8 row_mask:0xf bank_mask:0xc
  v_add_f32_dpp v8, v28, v28 row_ror:8 row_mask:0xf bank_mask:0xc
  v_add_f32_dpp v7, v27, v27 row_ror:8 row_mask:0xf bank_mask:0xc
  v_add_f32_dpp v6, v26, v26 row_ror:8 row_mask:0xf bank_mask:0xc
  v_add_f32_dpp v5, v25, v25 row_ror:8 row_mask:0xf bank_mask:0xc
  v_add_f32_dpp v4, v24, v24 row_ror:8 row_mask:0xf bank_mask:0xc
  v_add_f32_dpp v3, v23, v23 row_ror:8 row_mask:0xf bank_mask:0xc
  v_add_f32_dpp v2, v22, v22 row_ror:8 row_mask:0xf bank_mask:0xc
  v_add_f32_dpp v1, v21, v21 row_ror:8 row_mask:0xf bank_mask:0xc
  v_add_f32_dpp v0, v20, v20 row_ror:8 row_mask:0xf bank_mask:0xc
  v_add_f32_dpp v17, v17, v17 row_shl:4 row_mask:0xf bank_mask:0x5
  v_add_f32_dpp v16, v16, v16 row_shl:4 row_mask:0xf bank_mask:0x5
  v_add_f32_dpp v7, v7, v7 row_shl:4 row_mask:0xf bank_mask:0x5
  v_add_f32_dpp v6, v6, v6 row_shl:4 row_mask:0xf bank_mask:0x5
  v_add_f32_dpp v5, v5, v5 row_shl:4 row_mask:0xf bank_mask:0x5
  v_add_f32_dpp v4, v4, v4 row_shl:4 row_mask:0xf bank_mask:0x5
  v_add_f32_dpp v3, v3, v3 row_shl:4 row_mask:0xf bank_mask:0x5
  v_add_f32_dpp v2, v2, v2 row_shl:4 row_mask:0xf bank_mask:0x5
  v_add_f32_dpp v1, v1, v1 row_shl:4 row_mask:0xf bank_mask:0x5
  v_add_f32_dpp v0, v0, v0 row_shl:4 row_mask:0xf bank_mask:0x5
  v_add_f32_dpp v17, v19, v19 row_shr:4 row_mask:0xf bank_mask:0xa
  v_add_f32_dpp v16, v18, v18 row_shr:4 row_mask:0xf bank_mask:0xa
  v_add_f32_dpp v7, v15, v15 row_shr:4 row_mask:0xf bank_mask:0xa
  v_add_f32_dpp v6, v14, v14 row_shr:4 row_mask:0xf bank_mask:0xa
  v_add_f32_dpp v5, v13, v13 row_shr:4 row_mask:0xf bank_mask:0xa
  v_add_f32_dpp v4, v12, v12 row_shr:4 row_mask:0xf bank_mask:0xa
  v_add_f32_dpp v3, v11, v11 row_shr:4 row_mask:0xf bank_mask:0xa
  v_add_f32_dpp v2, v10, v10 row_shr:4 row_mask:0xf bank_mask:0xa
  v_add_f32_dpp v1, v9, v9 row_shr:4 row_mask:0xf bank_mask:0xa
  v_add_f32_dpp v0, v8, v8 row_shr:4 row_mask:0xf bank_mask:0xa
  v_lshlrev_b32 v165, 16, v40
  v_and_b32 v166, s46, v40
  v_fmac_f32 v165, v0, v64
  v_fmac_f32 v166, v1, v65
  v_cvt_pk_bf16_f32 v40, v165, v166
  v_lshlrev_b32 v165, 16, v41
  v_and_b32 v166, s46, v41
  v_fmac_f32 v165, v2, v66
  v_fmac_f32 v166, v3, v67
  v_cvt_pk_bf16_f32 v41, v165, v166
  v_lshlrev_b32 v165, 16, v42
  v_and_b32 v166, s46, v42
  v_fmac_f32 v165, v4, v68
  v_fmac_f32 v166, v5, v69
  v_cvt_pk_bf16_f32 v42, v165, v166
  v_lshlrev_b32 v165, 16, v43
  v_and_b32 v166, s46, v43
  v_fmac_f32 v165, v6, v70
  v_fmac_f32 v166, v7, v71
  v_cvt_pk_bf16_f32 v43, v165, v166
  v_lshlrev_b32 v165, 16, v44
  v_and_b32 v166, s46, v44
  v_fmac_f32 v165, v16, v80
  v_fmac_f32 v166, v17, v81
  v_cvt_pk_bf16_f32 v44, v165, v166
  buffer_store_dword v44, v183, s[92:95], 0 offen offset:256 sc1
  v_mov_b32 v170, v40
  s_mov_b32 exec_lo, s46
  s_mov_b32 exec_hi, s46
  v_swap_b32 v40, v42
  v_swap_b32 v41, v43
  s_mov_b64 exec, -1
  buffer_store_dwordx4 v[40:43], v182, s[92:95], 0 offen offset:128 sc1
  s_endpgm
L_fb_0_1:
  s_nop 15
  v_max3_f32 v169, v32, v33, v34
  v_max3_f32 v169, v169, v35, v36
  v_max3_f32 v169, v169, v37, v38
  v_max3_f32 v169, v169, v39, v40
  v_max3_f32 v169, v169, v41, v42
  v_max3_f32 v169, v169, v43, v44
  v_max3_f32 v169, v169, v45, v46
  v_max3_f32 v169, v169, v47, v48
  v_max3_f32 v169, v169, v49, v50
  v_max3_f32 v169, v169, v51, v52
  v_max3_f32 v169, v169, v53, v54
  v_max3_f32 v169, v169, v55, v56
  v_max3_f32 v169, v169, v57, v58
  v_max3_f32 v169, v169, v59, v60
  v_max3_f32 v169, v169, v61, v62
  v_max_f32 v169, v169, v63
  v_mov_b32 v170, v169
  s_nop 1
  v_permlane32_swap_b32 v170, v169
  v_max_f32 v169, v169, v170
  v_max_f32 v169, 0, v169
  v_exp_f32 v170, -v169
  v_sub_f32 v128, v128, v169
  v_sub_f32 v129, v129, v169
  v_sub_f32 v130, v130, v169
  v_sub_f32 v131, v131, v169
  v_sub_f32 v132, v132, v169
  v_sub_f32 v133, v133, v169
  v_sub_f32 v134, v134, v169
  v_sub_f32 v135, v135, v169
  v_sub_f32 v136, v136, v169
  v_sub_f32 v137, v137, v169
  v_sub_f32 v138, v138, v169
  v_sub_f32 v139, v139, v169
  v_sub_f32 v140, v140, v169
  v_sub_f32 v141, v141, v169
  v_sub_f32 v142, v142, v169
  v_sub_f32 v143, v143, v169
  v_sub_f32 v32, v32, v169
  v_sub_f32 v33, v33, v169
  v_sub_f32 v34, v34, v169
  v_sub_f32 v35, v35, v169
  v_sub_f32 v36, v36, v169
  v_sub_f32 v37, v37, v169
  v_sub_f32 v38, v38, v169
  v_sub_f32 v39, v39, v169
  v_sub_f32 v40, v40, v169
  v_sub_f32 v41, v41, v169
  v_sub_f32 v42, v42, v169
  v_sub_f32 v43, v43, v169
  v_sub_f32 v44, v44, v169
  v_sub_f32 v45, v45, v169
  v_sub_f32 v46, v46, v169
  v_sub_f32 v47, v47, v169
  v_sub_f32 v48, v48, v169
  v_sub_f32 v49, v49, v169
  v_sub_f32 v50, v50, v169
  v_sub_f32 v51, v51, v169
  v_sub_f32 v52, v52, v169
  v_sub_f32 v53, v53, v169
  v_sub_f32 v54, v54, v169
  v_sub_f32 v55, v55, v169
  v_sub_f32 v56, v56, v169
  v_sub_f32 v57, v57, v169
  v_sub_f32 v58, v58, v169
  v_sub_f32 v59, v59, v169
  v_sub_f32 v60, v60, v169
  v_sub_f32 v61, v61, v169
  v_sub_f32 v62, v62, v169
  v_sub_f32 v63, v63, v169
  v_sub_f32 v0, v0, v169
  v_sub_f32 v1, v1, v169
  v_sub_f32 v2, v2, v169
  v_sub_f32 v3, v3, v169
  v_sub_f32 v4, v4, v169
  v_sub_f32 v5, v5, v169
  v_sub_f32 v6, v6, v169
  v_sub_f32 v7, v7, v169
  v_sub_f32 v8, v8, v169
  v_sub_f32 v9, v9, v169
  v_sub_f32 v10, v10, v169
  v_sub_f32 v11, v11, v169
  v_sub_f32 v12, v12, v169
  v_sub_f32 v13, v13, v169
  v_sub_f32 v14, v14, v169
  v_sub_f32 v15, v15, v169
  v_sub_f32 v16, v16, v169
  v_sub_f32 v17, v17, v169
  v_sub_f32 v18, v18, v169
  v_sub_f32 v19, v19, v169
  v_sub_f32 v20, v20, v169
  v_sub_f32 v21, v21, v169
  v_sub_f32 v22, v22, v169
  v_sub_f32 v23, v23, v169
  v_sub_f32 v24, v24, v169
  v_sub_f32 v25, v25, v169
  v_sub_f32 v26, v26, v169
  v_sub_f32 v27, v27, v169
  v_sub_f32 v28, v28, v169
  v_sub_f32 v29, v29, v169
  v_sub_f32 v30, v30, v169
  v_sub_f32 v31, v31, v169
  v_mul_f32 v64, v170, v64
  v_mul_f32 v65, v170, v65
  v_mul_f32 v66, v170, v66
  v_mul_f32 v67, v170, v67
  v_mul_f32 v68, v170, v68
  v_mul_f32 v69, v170, v69
  v_mul_f32 v70, v170, v70
  v_mul_f32 v71, v170, v71
  v_mul_f32 v72, v170, v72
  v_mul_f32 v73, v170, v73
  v_mul_f32 v74, v170, v74
  v_mul_f32 v75, v170, v75
  v_mul_f32 v76, v170, v76
  v_mul_f32 v77, v170, v77
  v_mul_f32 v78, v170, v78
  v_mul_f32 v79, v170, v79
  v_mul_f32 v80, v170, v80
  v_mul_f32 v81, v170, v81
  v_mul_f32 v82, v170, v82
  v_mul_f32 v83, v170, v83
  v_mul_f32 v84, v170, v84
  v_mul_f32 v85, v170, v85
  v_mul_f32 v86, v170, v86
  v_mul_f32 v87, v170, v87
  v_mul_f32 v88, v170, v88
  v_mul_f32 v89, v170, v89
  v_mul_f32 v90, v170, v90
  v_mul_f32 v91, v170, v91
  v_mul_f32 v92, v170, v92
  v_mul_f32 v93, v170, v93
  v_mul_f32 v94, v170, v94
  v_mul_f32 v95, v170, v95
  v_mul_f32 v96, v170, v96
  v_mul_f32 v97, v170, v97
  v_mul_f32 v98, v170, v98
  v_mul_f32 v99, v170, v99
  v_mul_f32 v100, v170, v100
  v_mul_f32 v101, v170, v101
  v_mul_f32 v102, v170, v102
  v_mul_f32 v103, v170, v103
  v_mul_f32 v104, v170, v104
  v_mul_f32 v105, v170, v105
  v_mul_f32 v106, v170, v106
  v_mul_f32 v107, v170, v107
  v_mul_f32 v108, v170, v108
  v_mul_f32 v109, v170, v109
  v_mul_f32 v110, v170, v110
  v_mul_f32 v111, v170, v111
  v_mul_f32 v112, v170, v112
  v_mul_f32 v113, v170, v113
  v_mul_f32 v114, v170, v114
  v_mul_f32 v115, v170, v115
  v_mul_f32 v116, v170, v116
  v_mul_f32 v117, v170, v117
  v_mul_f32 v118, v170, v118
  v_mul_f32 v119, v170, v119
  v_mul_f32 v120, v170, v120
  v_mul_f32 v121, v170, v121
  v_mul_f32 v122, v170, v122
  v_mul_f32 v123, v170, v123
  v_mul_f32 v124, v170, v124
  v_mul_f32 v125, v170, v125
  v_mul_f32 v126, v170, v126
  v_mul_f32 v127, v170, v127
  v_mul_f32 v162, v170, v162
  v_exp_f32 v165, v32
  v_exp_f32 v166, v33
  s_nop 0
  v_add_f32 v163, v165, v166
  v_cvt_pk_bf16_f32 v144, v165, v166
  v_exp_f32 v167, v34
  v_exp_f32 v168, v35
  v_add_f32 v163, v163, v167
  v_add_f32 v163, v163, v168
  v_cvt_pk_bf16_f32 v145, v167, v168
  v_exp_f32 v165, v36
  v_exp_f32 v166, v37
  v_add_f32 v163, v163, v165
  v_add_f32 v163, v163, v166
  v_cvt_pk_bf16_f32 v146, v165, v166
  v_exp_f32 v167, v38
  v_exp_f32 v168, v39
  v_add_f32 v163, v163, v167
  v_add_f32 v163, v163, v168
  v_cvt_pk_bf16_f32 v147, v167, v168
  v_exp_f32 v165, v40
  v_exp_f32 v166, v41
  v_add_f32 v163, v163, v165
  v_add_f32 v163, v163, v166
  v_cvt_pk_bf16_f32 v148, v165, v166
  v_exp_f32 v167, v42
  v_exp_f32 v168, v43
  v_add_f32 v163, v163, v167
  v_add_f32 v163, v163, v168
  v_cvt_pk_bf16_f32 v149, v167, v168
  v_exp_f32 v165, v44
  v_exp_f32 v166, v45
  v_add_f32 v163, v163, v165
  v_add_f32 v163, v163, v166
  v_cvt_pk_bf16_f32 v150, v165, v166
  v_exp_f32 v167, v46
  v_exp_f32 v168, v47
  v_add_f32 v163, v163, v167
  v_add_f32 v163, v163, v168
  v_cvt_pk_bf16_f32 v151, v167, v168
  v_exp_f32 v165, v48
  v_exp_f32 v166, v49
  v_add_f32 v163, v163, v165
  v_add_f32 v163, v163, v166
  v_cvt_pk_bf16_f32 v152, v165, v166
  v_exp_f32 v167, v50
  v_exp_f32 v168, v51
  v_add_f32 v163, v163, v167
  v_add_f32 v163, v163, v168
  v_cvt_pk_bf16_f32 v153, v167, v168
  v_exp_f32 v165, v52
  v_exp_f32 v166, v53
  v_add_f32 v163, v163, v165
  v_add_f32 v163, v163, v166
  v_cvt_pk_bf16_f32 v154, v165, v166
  v_exp_f32 v167, v54
  v_exp_f32 v168, v55
  v_add_f32 v163, v163, v167
  v_add_f32 v163, v163, v168
  v_cvt_pk_bf16_f32 v155, v167, v168
  v_exp_f32 v165, v56
  v_exp_f32 v166, v57
  v_add_f32 v163, v163, v165
  v_add_f32 v163, v163, v166
  v_cvt_pk_bf16_f32 v156, v165, v166
  v_exp_f32 v167, v58
  v_exp_f32 v168, v59
  v_add_f32 v163, v163, v167
  v_add_f32 v163, v163, v168
  v_cvt_pk_bf16_f32 v157, v167, v168
  v_exp_f32 v165, v60
  v_exp_f32 v166, v61
  v_add_f32 v163, v163, v165
  v_add_f32 v163, v163, v166
  v_cvt_pk_bf16_f32 v158, v165, v166
  v_exp_f32 v167, v62
  v_exp_f32 v168, v63
  v_add_f32 v163, v163, v167
  v_add_f32 v163, v163, v168
  v_cvt_pk_bf16_f32 v159, v167, v168
  s_nop 3
  s_branch L_ret_0_1
L_fb_0_2:
  s_nop 15
  v_max3_f32 v169, v0, v1, v2
  v_max3_f32 v169, v169, v3, v4
  v_max3_f32 v169, v169, v5, v6
  v_max3_f32 v169, v169, v7, v8
  v_max3_f32 v169, v169, v9, v10
  v_max3_f32 v169, v169, v11, v12
  v_max3_f32 v169, v169, v13, v14
  v_max3_f32 v169, v169, v15, v16
  v_max3_f32 v169, v169, v17, v18
  v_max3_f32 v169, v169, v19, v20
  v_max3_f32 v169, v169, v21, v22
  v_max3_f32 v169, v169, v23, v24
  v_max3_f32 v169, v169, v25, v26
  v_max3_f32 v169, v169, v27, v28
  v_max3_f32 v169, v169, v29, v30
  v_max_f32 v169, v169, v31
  v_mov_b32 v170, v169
  s_nop 1
  v_permlane32_swap_b32 v170, v169
  v_max_f32 v169, v169, v170
  v_max_f32 v169, 0, v169
  v_exp_f32 v170, -v169
  v_sub_f32 v128, v128, v169
  v_sub_f32 v129, v129, v169
  v_sub_f32 v130, v130, v169
  v_sub_f32 v131, v131, v169
  v_sub_f32 v132, v132, v169
  v_sub_f32 v133, v133, v169
  v_sub_f32 v134, v134, v169
  v_sub_f32 v135, v135, v169
  v_sub_f32 v136, v136, v169
  v_sub_f32 v137, v137, v169
  v_sub_f32 v138, v138, v169
  v_sub_f32 v139, v139, v169
  v_sub_f32 v140, v140, v169
  v_sub_f32 v141, v141, v169
  v_sub_f32 v142, v142, v169
  v_sub_f32 v143, v143, v169
  v_sub_f32 v0, v0, v169
  v_sub_f32 v1, v1, v169
  v_sub_f32 v2, v2, v169
  v_sub_f32 v3, v3, v169
  v_sub_f32 v4, v4, v169
  v_sub_f32 v5, v5, v169
  v_sub_f32 v6, v6, v169
  v_sub_f32 v7, v7, v169
  v_sub_f32 v8, v8, v169
  v_sub_f32 v9, v9, v169
  v_sub_f32 v10, v10, v169
  v_sub_f32 v11, v11, v169
  v_sub_f32 v12, v12, v169
  v_sub_f32 v13, v13, v169
  v_sub_f32 v14, v14, v169
  v_sub_f32 v15, v15, v169
  v_sub_f32 v16, v16, v169
  v_sub_f32 v17, v17, v169
  v_sub_f32 v18, v18, v169
  v_sub_f32 v19, v19, v169
  v_sub_f32 v20, v20, v169
  v_sub_f32 v21, v21, v169
  v_sub_f32 v22, v22, v169
  v_sub_f32 v23, v23, v169
  v_sub_f32 v24, v24, v169
  v_sub_f32 v25, v25, v169
  v_sub_f32 v26, v26, v169
  v_sub_f32 v27, v27, v169
  v_sub_f32 v28, v28, v169
  v_sub_f32 v29, v29, v169
  v_sub_f32 v30, v30, v169
  v_sub_f32 v31, v31, v169
  v_sub_f32 v32, v32, v169
  v_sub_f32 v33, v33, v169
  v_sub_f32 v34, v34, v169
  v_sub_f32 v35, v35, v169
  v_sub_f32 v36, v36, v169
  v_sub_f32 v37, v37, v169
  v_sub_f32 v38, v38, v169
  v_sub_f32 v39, v39, v169
  v_sub_f32 v40, v40, v169
  v_sub_f32 v41, v41, v169
  v_sub_f32 v42, v42, v169
  v_sub_f32 v43, v43, v169
  v_sub_f32 v44, v44, v169
  v_sub_f32 v45, v45, v169
  v_sub_f32 v46, v46, v169
  v_sub_f32 v47, v47, v169
  v_sub_f32 v48, v48, v169
  v_sub_f32 v49, v49, v169
  v_sub_f32 v50, v50, v169
  v_sub_f32 v51, v51, v169
  v_sub_f32 v52, v52, v169
  v_sub_f32 v53, v53, v169
  v_sub_f32 v54, v54, v169
  v_sub_f32 v55, v55, v169
  v_sub_f32 v56, v56, v169
  v_sub_f32 v57, v57, v169
  v_sub_f32 v58, v58, v169
  v_sub_f32 v59, v59, v169
  v_sub_f32 v60, v60, v169
  v_sub_f32 v61, v61, v169
  v_sub_f32 v62, v62, v169
  v_sub_f32 v63, v63, v169
  v_mul_f32 v64, v170, v64
  v_mul_f32 v65, v170, v65
  v_mul_f32 v66, v170, v66
  v_mul_f32 v67, v170, v67
  v_mul_f32 v68, v170, v68
  v_mul_f32 v69, v170, v69
  v_mul_f32 v70, v170, v70
  v_mul_f32 v71, v170, v71
  v_mul_f32 v72, v170, v72
  v_mul_f32 v73, v170, v73
  v_mul_f32 v74, v170, v74
  v_mul_f32 v75, v170, v75
  v_mul_f32 v76, v170, v76
  v_mul_f32 v77, v170, v77
  v_mul_f32 v78, v170, v78
  v_mul_f32 v79, v170, v79
  v_mul_f32 v80, v170, v80
  v_mul_f32 v81, v170, v81
  v_mul_f32 v82, v170, v82
  v_mul_f32 v83, v170, v83
  v_mul_f32 v84, v170, v84
  v_mul_f32 v85, v170, v85
  v_mul_f32 v86, v170, v86
  v_mul_f32 v87, v170, v87
  v_mul_f32 v88, v170, v88
  v_mul_f32 v89, v170, v89
  v_mul_f32 v90, v170, v90
  v_mul_f32 v91, v170, v91
  v_mul_f32 v92, v170, v92
  v_mul_f32 v93, v170, v93
  v_mul_f32 v94, v170, v94
  v_mul_f32 v95, v170, v95
  v_mul_f32 v96, v170, v96
  v_mul_f32 v97, v170, v97
  v_mul_f32 v98, v170, v98
  v_mul_f32 v99, v170, v99
  v_mul_f32 v100, v170, v100
  v_mul_f32 v101, v170, v101
  v_mul_f32 v102, v170, v102
  v_mul_f32 v103, v170, v103
  v_mul_f32 v104, v170, v104
  v_mul_f32 v105, v170, v105
  v_mul_f32 v106, v170, v106
  v_mul_f32 v107, v170, v107
  v_mul_f32 v108, v170, v108
  v_mul_f32 v109, v170, v109
  v_mul_f32 v110, v170, v110
  v_mul_f32 v111, v170, v111
  v_mul_f32 v112, v170, v112
  v_mul_f32 v113, v170, v113
  v_mul_f32 v114, v170, v114
  v_mul_f32 v115, v170, v115
  v_mul_f32 v116, v170, v116
  v_mul_f32 v117, v170, v117
  v_mul_f32 v118, v170, v118
  v_mul_f32 v119, v170, v119
  v_mul_f32 v120, v170, v120
  v_mul_f32 v121, v170, v121
  v_mul_f32 v122, v170, v122
  v_mul_f32 v123, v170, v123
  v_mul_f32 v124, v170, v124
  v_mul_f32 v125, v170, v125
  v_mul_f32 v126, v170, v126
  v_mul_f32 v127, v170, v127
  v_mul_f32 v162, v170, v162
  v_exp_f32 v165, v0
  v_exp_f32 v166, v1
  s_nop 0
  v_add_f32 v163, v165, v166
  v_cvt_pk_bf16_f32 v144, v165, v166
  v_exp_f32 v167, v2
  v_exp_f32 v168, v3
  v_add_f32 v163, v163, v167
  v_add_f32 v163, v163, v168
  v_cvt_pk_bf16_f32 v145, v167, v168
  v_exp_f32 v165, v4
  v_exp_f32 v166, v5
  v_add_f32 v163, v163, v165
  v_add_f32 v163, v163, v166
  v_cvt_pk_bf16_f32 v146, v165, v166
  v_exp_f32 v167, v6
  v_exp_f32 v168, v7
  v_add_f32 v163, v163, v167
  v_add_f32 v163, v163, v168
  v_cvt_pk_bf16_f32 v147, v167, v168
  v_exp_f32 v165, v8
  v_exp_f32 v166, v9
  v_add_f32 v163, v163, v165
  v_add_f32 v163, v163, v166
  v_cvt_pk_bf16_f32 v148, v165, v166
  v_exp_f32 v167, v10
  v_exp_f32 v168, v11
  v_add_f32 v163, v163, v167
  v_add_f32 v163, v163, v168
  v_cvt_pk_bf16_f32 v149, v167, v168
  v_exp_f32 v165, v12
  v_exp_f32 v166, v13
  v_add_f32 v163, v163, v165
  v_add_f32 v163, v163, v166
  v_cvt_pk_bf16_f32 v150, v165, v166
  v_exp_f32 v167, v14
  v_exp_f32 v168, v15
  v_add_f32 v163, v163, v167
  v_add_f32 v163, v163, v168
  v_cvt_pk_bf16_f32 v151, v167, v168
  v_exp_f32 v165, v16
  v_exp_f32 v166, v17
  v_add_f32 v163, v163, v165
  v_add_f32 v163, v163, v166
  v_cvt_pk_bf16_f32 v152, v165, v166
  v_exp_f32 v167, v18
  v_exp_f32 v168, v19
  v_add_f32 v163, v163, v167
  v_add_f32 v163, v163, v168
  v_cvt_pk_bf16_f32 v153, v167, v168
  v_exp_f32 v165, v20
  v_exp_f32 v166, v21
  v_add_f32 v163, v163, v165
  v_add_f32 v163, v163, v166
  v_cvt_pk_bf16_f32 v154, v165, v166
  v_exp_f32 v167, v22
  v_exp_f32 v168, v23
  v_add_f32 v163, v163, v167
  v_add_f32 v163, v163, v168
  v_cvt_pk_bf16_f32 v155, v167, v168
  v_exp_f32 v165, v24
  v_exp_f32 v166, v25
  v_add_f32 v163, v163, v165
  v_add_f32 v163, v163, v166
  v_cvt_pk_bf16_f32 v156, v165, v166
  v_exp_f32 v167, v26
  v_exp_f32 v168, v27
  v_add_f32 v163, v163, v167
  v_add_f32 v163, v163, v168
  v_cvt_pk_bf16_f32 v157, v167, v168
  v_exp_f32 v165, v28
  v_exp_f32 v166, v29
  v_add_f32 v163, v163, v165
  v_add_f32 v163, v163, v166
  v_cvt_pk_bf16_f32 v158, v165, v166
  v_exp_f32 v167, v30
  v_exp_f32 v168, v31
  v_add_f32 v163, v163, v167
  v_add_f32 v163, v163, v168
  v_cvt_pk_bf16_f32 v159, v167, v168
  s_nop 3
  s_branch L_ret_0_2
L_fb_0_3:
  s_nop 15
  v_max3_f32 v169, v32, v33, v34
  v_max3_f32 v169, v169, v35, v36
  v_max3_f32 v169, v169, v37, v38
  v_max3_f32 v169, v169, v39, v40
  v_max3_f32 v169, v169, v41, v42
  v_max3_f32 v169, v169, v43, v44
  v_max3_f32 v169, v169, v45, v46
  v_max3_f32 v169, v169, v47, v48
  v_max3_f32 v169, v169, v49, v50
  v_max3_f32 v169, v169, v51, v52
  v_max3_f32 v169, v169, v53, v54
  v_max3_f32 v169, v169, v55, v56
  v_max3_f32 v169, v169, v57, v58
  v_max3_f32 v169, v169, v59, v60
  v_max3_f32 v169, v169, v61, v62
  v_max_f32 v169, v169, v63
  v_mov_b32 v170, v169
  s_nop 1
  v_permlane32_swap_b32 v170, v169
  v_max_f32 v169, v169, v170
  v_max_f32 v169, 0, v169
  v_exp_f32 v170, -v169
  v_sub_f32 v128, v128, v169
  v_sub_f32 v129, v129, v169
  v_sub_f32 v130, v130, v169
  v_sub_f32 v131, v131, v169
  v_sub_f32 v132, v132, v169
  v_sub_f32 v133, v133, v169
  v_sub_f32 v134, v134, v169
  v_sub_f32 v135, v135, v169
  v_sub_f32 v136, v136, v169
  v_sub_f32 v137, v137, v169
  v_sub_f32 v138, v138, v169
  v_sub_f32 v139, v139, v169
  v_sub_f32 v140, v140, v169
  v_sub_f32 v141, v141, v169
  v_sub_f32 v142, v142, v169
  v_sub_f32 v143, v143, v169
  v_sub_f32 v32, v32, v169
  v_sub_f32 v33, v33, v169
  v_sub_f32 v34, v34, v169
  v_sub_f32 v35, v35, v169
  v_sub_f32 v36, v36, v169
  v_sub_f32 v37, v37, v169
  v_sub_f32 v38, v38, v169
  v_sub_f32 v39, v39, v169
  v_sub_f32 v40, v40, v169
  v_sub_f32 v41, v41, v169
  v_sub_f32 v42, v42, v169
  v_sub_f32 v43, v43, v169
  v_sub_f32 v44, v44, v169
  v_sub_f32 v45, v45, v169
  v_sub_f32 v46, v46, v169
  v_sub_f32 v47, v47, v169
  v_sub_f32 v48, v48, v169
  v_sub_f32 v49, v49, v169
  v_sub_f32 v50, v50, v169
  v_sub_f32 v51, v51, v169
  v_sub_f32 v52, v52, v169
  v_sub_f32 v53, v53, v169
  v_sub_f32 v54, v54, v169
  v_sub_f32 v55, v55, v169
  v_sub_f32 v56, v56, v169
  v_sub_f32 v57, v57, v169
  v_sub_f32 v58, v58, v169
  v_sub_f32 v59, v59, v169
  v_sub_f32 v60, v60, v169
  v_sub_f32 v61, v61, v169
  v_sub_f32 v62, v62, v169
  v_sub_f32 v63, v63, v169
  v_sub_f32 v0, v0, v169
  v_sub_f32 v1, v1, v169
  v_sub_f32 v2, v2, v169
  v_sub_f32 v3, v3, v169
  v_sub_f32 v4, v4, v169
  v_sub_f32 v5, v5, v169
  v_sub_f32 v6, v6, v169
  v_sub_f32 v7, v7, v169
  v_sub_f32 v8, v8, v169
  v_sub_f32 v9, v9, v169
  v_sub_f32 v10, v10, v169
  v_sub_f32 v11, v11, v169
  v_sub_f32 v12, v12, v169
  v_sub_f32 v13, v13, v169
  v_sub_f32 v14, v14, v169
  v_sub_f32 v15, v15, v169
  v_sub_f32 v16, v16, v169
  v_sub_f32 v17, v17, v169
  v_sub_f32 v18, v18, v169
  v_sub_f32 v19, v19, v169
  v_sub_f32 v20, v20, v169
  v_sub_f32 v21, v21, v169
  v_sub_f32 v22, v22, v169
  v_sub_f32 v23, v23, v169
  v_sub_f32 v24, v24, v169
  v_sub_f32 v25, v25, v169
  v_sub_f32 v26, v26, v169
  v_sub_f32 v27, v27, v169
  v_sub_f32 v28, v28, v169
  v_sub_f32 v29, v29, v169
  v_sub_f32 v30, v30, v169
  v_sub_f32 v31, v31, v169
  v_mul_f32 v64, v170, v64
  v_mul_f32 v65, v170, v65
  v_mul_f32 v66, v170, v66
  v_mul_f32 v67, v170, v67
  v_mul_f32 v68, v170, v68
  v_mul_f32 v69, v170, v69
  v_mul_f32 v70, v170, v70
  v_mul_f32 v71, v170, v71
  v_mul_f32 v72, v170, v72
  v_mul_f32 v73, v170, v73
  v_mul_f32 v74, v170, v74
  v_mul_f32 v75, v170, v75
  v_mul_f32 v76, v170, v76
  v_mul_f32 v77, v170, v77
  v_mul_f32 v78, v170, v78
  v_mul_f32 v79, v170, v79
  v_mul_f32 v80, v170, v80
  v_mul_f32 v81, v170, v81
  v_mul_f32 v82, v170, v82
  v_mul_f32 v83, v170, v83
  v_mul_f32 v84, v170, v84
  v_mul_f32 v85, v170, v85
  v_mul_f32 v86, v170, v86
  v_mul_f32 v87, v170, v87
  v_mul_f32 v88, v170, v88
  v_mul_f32 v89, v170, v89
  v_mul_f32 v90, v170, v90
  v_mul_f32 v91, v170, v91
  v_mul_f32 v92, v170, v92
  v_mul_f32 v93, v170, v93
  v_mul_f32 v94, v170, v94
  v_mul_f32 v95, v170, v95
  v_mul_f32 v96, v170, v96
  v_mul_f32 v97, v170, v97
  v_mul_f32 v98, v170, v98
  v_mul_f32 v99, v170, v99
  v_mul_f32 v100, v170, v100
  v_mul_f32 v101, v170, v101
  v_mul_f32 v102, v170, v102
  v_mul_f32 v103, v170, v103
  v_mul_f32 v104, v170, v104
  v_mul_f32 v105, v170, v105
  v_mul_f32 v106, v170, v106
  v_mul_f32 v107, v170, v107
  v_mul_f32 v108, v170, v108
  v_mul_f32 v109, v170, v109
  v_mul_f32 v110, v170, v110
  v_mul_f32 v111, v170, v111
  v_mul_f32 v112, v170, v112
  v_mul_f32 v113, v170, v113
  v_mul_f32 v114, v170, v114
  v_mul_f32 v115, v170, v115
  v_mul_f32 v116, v170, v116
  v_mul_f32 v117, v170, v117
  v_mul_f32 v118, v170, v118
  v_mul_f32 v119, v170, v119
  v_mul_f32 v120, v170, v120
  v_mul_f32 v121, v170, v121
  v_mul_f32 v122, v170, v122
  v_mul_f32 v123, v170, v123
  v_mul_f32 v124, v170, v124
  v_mul_f32 v125, v170, v125
  v_mul_f32 v126, v170, v126
  v_mul_f32 v127, v170, v127
  v_mul_f32 v162, v170, v162
  v_exp_f32 v165, v32
  v_exp_f32 v166, v33
  s_nop 0
  v_add_f32 v163, v165, v166
  v_cvt_pk_bf16_f32 v144, v165, v166
  v_exp_f32 v167, v34
  v_exp_f32 v168, v35
  v_add_f32 v163, v163, v167
  v_add_f32 v163, v163, v168
  v_cvt_pk_bf16_f32 v145, v167, v168
  v_exp_f32 v165, v36
  v_exp_f32 v166, v37
  v_add_f32 v163, v163, v165
  v_add_f32 v163, v163, v166
  v_cvt_pk_bf16_f32 v146, v165, v166
  v_exp_f32 v167, v38
  v_exp_f32 v168, v39
  v_add_f32 v163, v163, v167
  v_add_f32 v163, v163, v168
  v_cvt_pk_bf16_f32 v147, v167, v168
  v_exp_f32 v165, v40
  v_exp_f32 v166, v41
  v_add_f32 v163, v163, v165
  v_add_f32 v163, v163, v166
  v_cvt_pk_bf16_f32 v148, v165, v166
  v_exp_f32 v167, v42
  v_exp_f32 v168, v43
  v_add_f32 v163, v163, v167
  v_add_f32 v163, v163, v168
  v_cvt_pk_bf16_f32 v149, v167, v168
  v_exp_f32 v165, v44
  v_exp_f32 v166, v45
  v_add_f32 v163, v163, v165
  v_add_f32 v163, v163, v166
  v_cvt_pk_bf16_f32 v150, v165, v166
  v_exp_f32 v167, v46
  v_exp_f32 v168, v47
  v_add_f32 v163, v163, v167
  v_add_f32 v163, v163, v168
  v_cvt_pk_bf16_f32 v151, v167, v168
  v_exp_f32 v165, v48
  v_exp_f32 v166, v49
  v_add_f32 v163, v163, v165
  v_add_f32 v163, v163, v166
  v_cvt_pk_bf16_f32 v152, v165, v166
  v_exp_f32 v167, v50
  v_exp_f32 v168, v51
  v_add_f32 v163, v163, v167
  v_add_f32 v163, v163, v168
  v_cvt_pk_bf16_f32 v153, v167, v168
  v_exp_f32 v165, v52
  v_exp_f32 v166, v53
  v_add_f32 v163, v163, v165
  v_add_f32 v163, v163, v166
  v_cvt_pk_bf16_f32 v154, v165, v166
  v_exp_f32 v167, v54
  v_exp_f32 v168, v55
  v_add_f32 v163, v163, v167
  v_add_f32 v163, v163, v168
  v_cvt_pk_bf16_f32 v155, v167, v168
  v_exp_f32 v165, v56
  v_exp_f32 v166, v57
  v_add_f32 v163, v163, v165
  v_add_f32 v163, v163, v166
  v_cvt_pk_bf16_f32 v156, v165, v166
  v_exp_f32 v167, v58
  v_exp_f32 v168, v59
  v_add_f32 v163, v163, v167
  v_add_f32 v163, v163, v168
  v_cvt_pk_bf16_f32 v157, v167, v168
  v_exp_f32 v165, v60
  v_exp_f32 v166, v61
  v_add_f32 v163, v163, v165
  v_add_f32 v163, v163, v166
  v_cvt_pk_bf16_f32 v158, v165, v166
  v_exp_f32 v167, v62
  v_exp_f32 v168, v63
  v_add_f32 v163, v163, v167
  v_add_f32 v163, v163, v168
  v_cvt_pk_bf16_f32 v159, v167, v168
  s_nop 3
  s_branch L_ret_0_3
L_fb_0_4:
  s_nop 15
  v_max3_f32 v169, v0, v1, v2
  v_max3_f32 v169, v169, v3, v4
  v_max3_f32 v169, v169, v5, v6
  v_max3_f32 v169, v169, v7, v8
  v_max3_f32 v169, v169, v9, v10
  v_max3_f32 v169, v169, v11, v12
  v_max3_f32 v169, v169, v13, v14
  v_max3_f32 v169, v169, v15, v16
  v_max3_f32 v169, v169, v17, v18
  v_max3_f32 v169, v169, v19, v20
  v_max3_f32 v169, v169, v21, v22
  v_max3_f32 v169, v169, v23, v24
  v_max3_f32 v169, v169, v25, v26
  v_max3_f32 v169, v169, v27, v28
  v_max3_f32 v169, v169, v29, v30
  v_max_f32 v169, v169, v31
  v_mov_b32 v170, v169
  s_nop 1
  v_permlane32_swap_b32 v170, v169
  v_max_f32 v169, v169, v170
  v_max_f32 v169, 0, v169
  v_exp_f32 v170, -v169
  v_sub_f32 v128, v128, v169
  v_sub_f32 v129, v129, v169
  v_sub_f32 v130, v130, v169
  v_sub_f32 v131, v131, v169
  v_sub_f32 v132, v132, v169
  v_sub_f32 v133, v133, v169
  v_sub_f32 v134, v134, v169
  v_sub_f32 v135, v135, v169
  v_sub_f32 v136, v136, v169
  v_sub_f32 v137, v137, v169
  v_sub_f32 v138, v138, v169
  v_sub_f32 v139, v139, v169
  v_sub_f32 v140, v140, v169
  v_sub_f32 v141, v141, v169
  v_sub_f32 v142, v142, v169
  v_sub_f32 v143, v143, v169
  v_sub_f32 v0, v0, v169
  v_sub_f32 v1, v1, v169
  v_sub_f32 v2, v2, v169
  v_sub_f32 v3, v3, v169
  v_sub_f32 v4, v4, v169
  v_sub_f32 v5, v5, v169
  v_sub_f32 v6, v6, v169
  v_sub_f32 v7, v7, v169
  v_sub_f32 v8, v8, v169
  v_sub_f32 v9, v9, v169
  v_sub_f32 v10, v10, v169
  v_sub_f32 v11, v11, v169
  v_sub_f32 v12, v12, v169
  v_sub_f32 v13, v13, v169
  v_sub_f32 v14, v14, v169
  v_sub_f32 v15, v15, v169
  v_sub_f32 v16, v16, v169
  v_sub_f32 v17, v17, v169
  v_sub_f32 v18, v18, v169
  v_sub_f32 v19, v19, v169
  v_sub_f32 v20, v20, v169
  v_sub_f32 v21, v21, v169
  v_sub_f32 v22, v22, v169
  v_sub_f32 v23, v23, v169
  v_sub_f32 v24, v24, v169
  v_sub_f32 v25, v25, v169
  v_sub_f32 v26, v26, v169
  v_sub_f32 v27, v27, v169
  v_sub_f32 v28, v28, v169
  v_sub_f32 v29, v29, v169
  v_sub_f32 v30, v30, v169
  v_sub_f32 v31, v31, v169
  v_sub_f32 v32, v32, v169
  v_sub_f32 v33, v33, v169
  v_sub_f32 v34, v34, v169
  v_sub_f32 v35, v35, v169
  v_sub_f32 v36, v36, v169
  v_sub_f32 v37, v37, v169
  v_sub_f32 v38, v38, v169
  v_sub_f32 v39, v39, v169
  v_sub_f32 v40, v40, v169
  v_sub_f32 v41, v41, v169
  v_sub_f32 v42, v42, v169
  v_sub_f32 v43, v43, v169
  v_sub_f32 v44, v44, v169
  v_sub_f32 v45, v45, v169
  v_sub_f32 v46, v46, v169
  v_sub_f32 v47, v47, v169
  v_sub_f32 v48, v48, v169
  v_sub_f32 v49, v49, v169
  v_sub_f32 v50, v50, v169
  v_sub_f32 v51, v51, v169
  v_sub_f32 v52, v52, v169
  v_sub_f32 v53, v53, v169
  v_sub_f32 v54, v54, v169
  v_sub_f32 v55, v55, v169
  v_sub_f32 v56, v56, v169
  v_sub_f32 v57, v57, v169
  v_sub_f32 v58, v58, v169
  v_sub_f32 v59, v59, v169
  v_sub_f32 v60, v60, v169
  v_sub_f32 v61, v61, v169
  v_sub_f32 v62, v62, v169
  v_sub_f32 v63, v63, v169
  v_mul_f32 v64, v170, v64
  v_mul_f32 v65, v170, v65
  v_mul_f32 v66, v170, v66
  v_mul_f32 v67, v170, v67
  v_mul_f32 v68, v170, v68
  v_mul_f32 v69, v170, v69
  v_mul_f32 v70, v170, v70
  v_mul_f32 v71, v170, v71
  v_mul_f32 v72, v170, v72
  v_mul_f32 v73, v170, v73
  v_mul_f32 v74, v170, v74
  v_mul_f32 v75, v170, v75
  v_mul_f32 v76, v170, v76
  v_mul_f32 v77, v170, v77
  v_mul_f32 v78, v170, v78
  v_mul_f32 v79, v170, v79
  v_mul_f32 v80, v170, v80
  v_mul_f32 v81, v170, v81
  v_mul_f32 v82, v170, v82
  v_mul_f32 v83, v170, v83
  v_mul_f32 v84, v170, v84
  v_mul_f32 v85, v170, v85
  v_mul_f32 v86, v170, v86
  v_mul_f32 v87, v170, v87
  v_mul_f32 v88, v170, v88
  v_mul_f32 v89, v170, v89
  v_mul_f32 v90, v170, v90
  v_mul_f32 v91, v170, v91
  v_mul_f32 v92, v170, v92
  v_mul_f32 v93, v170, v93
  v_mul_f32 v94, v170, v94
  v_mul_f32 v95, v170, v95
  v_mul_f32 v96, v170, v96
  v_mul_f32 v97, v170, v97
  v_mul_f32 v98, v170, v98
  v_mul_f32 v99, v170, v99
  v_mul_f32 v100, v170, v100
  v_mul_f32 v101, v170, v101
  v_mul_f32 v102, v170, v102
  v_mul_f32 v103, v170, v103
  v_mul_f32 v104, v170, v104
  v_mul_f32 v105, v170, v105
  v_mul_f32 v106, v170, v106
  v_mul_f32 v107, v170, v107
  v_mul_f32 v108, v170, v108
  v_mul_f32 v109, v170, v109
  v_mul_f32 v110, v170, v110
  v_mul_f32 v111, v170, v111
  v_mul_f32 v112, v170, v112
  v_mul_f32 v113, v170, v113
  v_mul_f32 v114, v170, v114
  v_mul_f32 v115, v170, v115
  v_mul_f32 v116, v170, v116
  v_mul_f32 v117, v170, v117
  v_mul_f32 v118, v170, v118
  v_mul_f32 v119, v170, v119
  v_mul_f32 v120, v170, v120
  v_mul_f32 v121, v170, v121
  v_mul_f32 v122, v170, v122
  v_mul_f32 v123, v170, v123
  v_mul_f32 v124, v170, v124
  v_mul_f32 v125, v170, v125
  v_mul_f32 v126, v170, v126
  v_mul_f32 v127, v170, v127
  v_mul_f32 v162, v170, v162
  v_exp_f32 v165, v0
  v_exp_f32 v166, v1
  s_nop 0
  v_add_f32 v163, v165, v166
  v_cvt_pk_bf16_f32 v144, v165, v166
  v_exp_f32 v167, v2
  v_exp_f32 v168, v3
  v_add_f32 v163, v163, v167
  v_add_f32 v163, v163, v168
  v_cvt_pk_bf16_f32 v145, v167, v168
  v_exp_f32 v165, v4
  v_exp_f32 v166, v5
  v_add_f32 v163, v163, v165
  v_add_f32 v163, v163, v166
  v_cvt_pk_bf16_f32 v146, v165, v166
  v_exp_f32 v167, v6
  v_exp_f32 v168, v7
  v_add_f32 v163, v163, v167
  v_add_f32 v163, v163, v168
  v_cvt_pk_bf16_f32 v147, v167, v168
  v_exp_f32 v165, v8
  v_exp_f32 v166, v9
  v_add_f32 v163, v163, v165
  v_add_f32 v163, v163, v166
  v_cvt_pk_bf16_f32 v148, v165, v166
  v_exp_f32 v167, v10
  v_exp_f32 v168, v11
  v_add_f32 v163, v163, v167
  v_add_f32 v163, v163, v168
  v_cvt_pk_bf16_f32 v149, v167, v168
  v_exp_f32 v165, v12
  v_exp_f32 v166, v13
  v_add_f32 v163, v163, v165
  v_add_f32 v163, v163, v166
  v_cvt_pk_bf16_f32 v150, v165, v166
  v_exp_f32 v167, v14
  v_exp_f32 v168, v15
  v_add_f32 v163, v163, v167
  v_add_f32 v163, v163, v168
  v_cvt_pk_bf16_f32 v151, v167, v168
  v_exp_f32 v165, v16
  v_exp_f32 v166, v17
  v_add_f32 v163, v163, v165
  v_add_f32 v163, v163, v166
  v_cvt_pk_bf16_f32 v152, v165, v166
  v_exp_f32 v167, v18
  v_exp_f32 v168, v19
  v_add_f32 v163, v163, v167
  v_add_f32 v163, v163, v168
  v_cvt_pk_bf16_f32 v153, v167, v168
  v_exp_f32 v165, v20
  v_exp_f32 v166, v21
  v_add_f32 v163, v163, v165
  v_add_f32 v163, v163, v166
  v_cvt_pk_bf16_f32 v154, v165, v166
  v_exp_f32 v167, v22
  v_exp_f32 v168, v23
  v_add_f32 v163, v163, v167
  v_add_f32 v163, v163, v168
  v_cvt_pk_bf16_f32 v155, v167, v168
  v_exp_f32 v165, v24
  v_exp_f32 v166, v25
  v_add_f32 v163, v163, v165
  v_add_f32 v163, v163, v166
  v_cvt_pk_bf16_f32 v156, v165, v166
  v_exp_f32 v167, v26
  v_exp_f32 v168, v27
  v_add_f32 v163, v163, v167
  v_add_f32 v163, v163, v168
  v_cvt_pk_bf16_f32 v157, v167, v168
  v_exp_f32 v165, v28
  v_exp_f32 v166, v29
  v_add_f32 v163, v163, v165
  v_add_f32 v163, v163, v166
  v_cvt_pk_bf16_f32 v158, v165, v166
  v_exp_f32 v167, v30
  v_exp_f32 v168, v31
  v_add_f32 v163, v163, v167
  v_add_f32 v163, v163, v168
  v_cvt_pk_bf16_f32 v159, v167, v168
  s_nop 3
  s_branch L_ret_0_4
L_fb_0_5:
  s_nop 15
  v_max3_f32 v169, v32, v33, v34
  v_max3_f32 v169, v169, v35, v36
  v_max3_f32 v169, v169, v37, v38
  v_max3_f32 v169, v169, v39, v40
  v_max3_f32 v169, v169, v41, v42
  v_max3_f32 v169, v169, v43, v44
  v_max3_f32 v169, v169, v45, v46
  v_max3_f32 v169, v169, v47, v48
  v_max3_f32 v169, v169, v49, v50
  v_max3_f32 v169, v169, v51, v52
  v_max3_f32 v169, v169, v53, v54
  v_max3_f32 v169, v169, v55, v56
  v_max3_f32 v169, v169, v57, v58
  v_max3_f32 v169, v169, v59, v60
  v_max3_f32 v169, v169, v61, v62
  v_max_f32 v169, v169, v63
  v_mov_b32 v170, v169
  s_nop 1
  v_permlane32_swap_b32 v170, v169
  v_max_f32 v169, v169, v170
  v_max_f32 v169, 0, v169
  v_exp_f32 v170, -v169
  v_sub_f32 v128, v128, v169
  v_sub_f32 v129, v129, v169
  v_sub_f32 v130, v130, v169
  v_sub_f32 v131, v131, v169
  v_sub_f32 v132, v132, v169
  v_sub_f32 v133, v133, v169
  v_sub_f32 v134, v134, v169
  v_sub_f32 v135, v135, v169
  v_sub_f32 v136, v136, v169
  v_sub_f32 v137, v137, v169
  v_sub_f32 v138, v138, v169
  v_sub_f32 v139, v139, v169
  v_sub_f32 v140, v140, v169
  v_sub_f32 v141, v141, v169
  v_sub_f32 v142, v142, v169
  v_sub_f32 v143, v143, v169
  v_sub_f32 v32, v32, v169
  v_sub_f32 v33, v33, v169
  v_sub_f32 v34, v34, v169
  v_sub_f32 v35, v35, v169
  v_sub_f32 v36, v36, v169
  v_sub_f32 v37, v37, v169
  v_sub_f32 v38, v38, v169
  v_sub_f32 v39, v39, v169
  v_sub_f32 v40, v40, v169
  v_sub_f32 v41, v41, v169
  v_sub_f32 v42, v42, v169
  v_sub_f32 v43, v43, v169
  v_sub_f32 v44, v44, v169
  v_sub_f32 v45, v45, v169
  v_sub_f32 v46, v46, v169
  v_sub_f32 v47, v47, v169
  v_sub_f32 v48, v48, v169
  v_sub_f32 v49, v49, v169
  v_sub_f32 v50, v50, v169
  v_sub_f32 v51, v51, v169
  v_sub_f32 v52, v52, v169
  v_sub_f32 v53, v53, v169
  v_sub_f32 v54, v54, v169
  v_sub_f32 v55, v55, v169
  v_sub_f32 v56, v56, v169
  v_sub_f32 v57, v57, v169
  v_sub_f32 v58, v58, v169
  v_sub_f32 v59, v59, v169
  v_sub_f32 v60, v60, v169
  v_sub_f32 v61, v61, v169
  v_sub_f32 v62, v62, v169
  v_sub_f32 v63, v63, v169
  v_sub_f32 v0, v0, v169
  v_sub_f32 v1, v1, v169
  v_sub_f32 v2, v2, v169
  v_sub_f32 v3, v3, v169
  v_sub_f32 v4, v4, v169
  v_sub_f32 v5, v5, v169
  v_sub_f32 v6, v6, v169
  v_sub_f32 v7, v7, v169
  v_sub_f32 v8, v8, v169
  v_sub_f32 v9, v9, v169
  v_sub_f32 v10, v10, v169
  v_sub_f32 v11, v11, v169
  v_sub_f32 v12, v12, v169
  v_sub_f32 v13, v13, v169
  v_sub_f32 v14, v14, v169
  v_sub_f32 v15, v15, v169
  v_sub_f32 v16, v16, v169
  v_sub_f32 v17, v17, v169
  v_sub_f32 v18, v18, v169
  v_sub_f32 v19, v19, v169
  v_sub_f32 v20, v20, v169
  v_sub_f32 v21, v21, v169
  v_sub_f32 v22, v22, v169
  v_sub_f32 v23, v23, v169
  v_sub_f32 v24, v24, v169
  v_sub_f32 v25, v25, v169
  v_sub_f32 v26, v26, v169
  v_sub_f32 v27, v27, v169
  v_sub_f32 v28, v28, v169
  v_sub_f32 v29, v29, v169
  v_sub_f32 v30, v30, v169
  v_sub_f32 v31, v31, v169
  v_mul_f32 v64, v170, v64
  v_mul_f32 v65, v170, v65
  v_mul_f32 v66, v170, v66
  v_mul_f32 v67, v170, v67
  v_mul_f32 v68, v170, v68
  v_mul_f32 v69, v170, v69
  v_mul_f32 v70, v170, v70
  v_mul_f32 v71, v170, v71
  v_mul_f32 v72, v170, v72
  v_mul_f32 v73, v170, v73
  v_mul_f32 v74, v170, v74
  v_mul_f32 v75, v170, v75
  v_mul_f32 v76, v170, v76
  v_mul_f32 v77, v170, v77
  v_mul_f32 v78, v170, v78
  v_mul_f32 v79, v170, v79
  v_mul_f32 v80, v170, v80
  v_mul_f32 v81, v170, v81
  v_mul_f32 v82, v170, v82
  v_mul_f32 v83, v170, v83
  v_mul_f32 v84, v170, v84
  v_mul_f32 v85, v170, v85
  v_mul_f32 v86, v170, v86
  v_mul_f32 v87, v170, v87
  v_mul_f32 v88, v170, v88
  v_mul_f32 v89, v170, v89
  v_mul_f32 v90, v170, v90
  v_mul_f32 v91, v170, v91
  v_mul_f32 v92, v170, v92
  v_mul_f32 v93, v170, v93
  v_mul_f32 v94, v170, v94
  v_mul_f32 v95, v170, v95
  v_mul_f32 v96, v170, v96
  v_mul_f32 v97, v170, v97
  v_mul_f32 v98, v170, v98
  v_mul_f32 v99, v170, v99
  v_mul_f32 v100, v170, v100
  v_mul_f32 v101, v170, v101
  v_mul_f32 v102, v170, v102
  v_mul_f32 v103, v170, v103
  v_mul_f32 v104, v170, v104
  v_mul_f32 v105, v170, v105
  v_mul_f32 v106, v170, v106
  v_mul_f32 v107, v170, v107
  v_mul_f32 v108, v170, v108
  v_mul_f32 v109, v170, v109
  v_mul_f32 v110, v170, v110
  v_mul_f32 v111, v170, v111
  v_mul_f32 v112, v170, v112
  v_mul_f32 v113, v170, v113
  v_mul_f32 v114, v170, v114
  v_mul_f32 v115, v170, v115
  v_mul_f32 v116, v170, v116
  v_mul_f32 v117, v170, v117
  v_mul_f32 v118, v170, v118
  v_mul_f32 v119, v170, v119
  v_mul_f32 v120, v170, v120
  v_mul_f32 v121, v170, v121
  v_mul_f32 v122, v170, v122
  v_mul_f32 v123, v170, v123
  v_mul_f32 v124, v170, v124
  v_mul_f32 v125, v170, v125
  v_mul_f32 v126, v170, v126
  v_mul_f32 v127, v170, v127
  v_mul_f32 v162, v170, v162
  v_exp_f32 v165, v32
  v_exp_f32 v166, v33
  s_nop 0
  v_add_f32 v163, v165, v166
  v_cvt_pk_bf16_f32 v144, v165, v166
  v_exp_f32 v167, v34
  v_exp_f32 v168, v35
  v_add_f32 v163, v163, v167
  v_add_f32 v163, v163, v168
  v_cvt_pk_bf16_f32 v145, v167, v168
  v_exp_f32 v165, v36
  v_exp_f32 v166, v37
  v_add_f32 v163, v163, v165
  v_add_f32 v163, v163, v166
  v_cvt_pk_bf16_f32 v146, v165, v166
  v_exp_f32 v167, v38
  v_exp_f32 v168, v39
  v_add_f32 v163, v163, v167
  v_add_f32 v163, v163, v168
  v_cvt_pk_bf16_f32 v147, v167, v168
  v_exp_f32 v165, v40
  v_exp_f32 v166, v41
  v_add_f32 v163, v163, v165
  v_add_f32 v163, v163, v166
  v_cvt_pk_bf16_f32 v148, v165, v166
  v_exp_f32 v167, v42
  v_exp_f32 v168, v43
  v_add_f32 v163, v163, v167
  v_add_f32 v163, v163, v168
  v_cvt_pk_bf16_f32 v149, v167, v168
  v_exp_f32 v165, v44
  v_exp_f32 v166, v45
  v_add_f32 v163, v163, v165
  v_add_f32 v163, v163, v166
  v_cvt_pk_bf16_f32 v150, v165, v166
  v_exp_f32 v167, v46
  v_exp_f32 v168, v47
  v_add_f32 v163, v163, v167
  v_add_f32 v163, v163, v168
  v_cvt_pk_bf16_f32 v151, v167, v168
  v_exp_f32 v165, v48
  v_exp_f32 v166, v49
  v_add_f32 v163, v163, v165
  v_add_f32 v163, v163, v166
  v_cvt_pk_bf16_f32 v152, v165, v166
  v_exp_f32 v167, v50
  v_exp_f32 v168, v51
  v_add_f32 v163, v163, v167
  v_add_f32 v163, v163, v168
  v_cvt_pk_bf16_f32 v153, v167, v168
  v_exp_f32 v165, v52
  v_exp_f32 v166, v53
  v_add_f32 v163, v163, v165
  v_add_f32 v163, v163, v166
  v_cvt_pk_bf16_f32 v154, v165, v166
  v_exp_f32 v167, v54
  v_exp_f32 v168, v55
  v_add_f32 v163, v163, v167
  v_add_f32 v163, v163, v168
  v_cvt_pk_bf16_f32 v155, v167, v168
  v_exp_f32 v165, v56
  v_exp_f32 v166, v57
  v_add_f32 v163, v163, v165
  v_add_f32 v163, v163, v166
  v_cvt_pk_bf16_f32 v156, v165, v166
  v_exp_f32 v167, v58
  v_exp_f32 v168, v59
  v_add_f32 v163, v163, v167
  v_add_f32 v163, v163, v168
  v_cvt_pk_bf16_f32 v157, v167, v168
  v_exp_f32 v165, v60
  v_exp_f32 v166, v61
  v_add_f32 v163, v163, v165
  v_add_f32 v163, v163, v166
  v_cvt_pk_bf16_f32 v158, v165, v166
  v_exp_f32 v167, v62
  v_exp_f32 v168, v63
  v_add_f32 v163, v163, v167
  v_add_f32 v163, v163, v168
  v_cvt_pk_bf16_f32 v159, v167, v168
  s_nop 3
  s_branch L_ret_0_5
L_fb_0_6:
  s_nop 15
  v_max3_f32 v169, v0, v1, v2
  v_max3_f32 v169, v169, v3, v4
  v_max3_f32 v169, v169, v5, v6
  v_max3_f32 v169, v169, v7, v8
  v_max3_f32 v169, v169, v9, v10
  v_max3_f32 v169, v169, v11, v12
  v_max3_f32 v169, v169, v13, v14
  v_max3_f32 v169, v169, v15, v16
  v_max3_f32 v169, v169, v17, v18
  v_max3_f32 v169, v169, v19, v20
  v_max3_f32 v169, v169, v21, v22
  v_max3_f32 v169, v169, v23, v24
  v_max3_f32 v169, v169, v25, v26
  v_max3_f32 v169, v169, v27, v28
  v_max3_f32 v169, v169, v29, v30
  v_max_f32 v169, v169, v31
  v_mov_b32 v170, v169
  s_nop 1
  v_permlane32_swap_b32 v170, v169
  v_max_f32 v169, v169, v170
  v_max_f32 v169, 0, v169
  v_exp_f32 v170, -v169
  v_sub_f32 v128, v128, v169
  v_sub_f32 v129, v129, v169
  v_sub_f32 v130, v130, v169
  v_sub_f32 v131, v131, v169
  v_sub_f32 v132, v132, v169
  v_sub_f32 v133, v133, v169
  v_sub_f32 v134, v134, v169
  v_sub_f32 v135, v135, v169
  v_sub_f32 v136, v136, v169
  v_sub_f32 v137, v137, v169
  v_sub_f32 v138, v138, v169
  v_sub_f32 v139, v139, v169
  v_sub_f32 v140, v140, v169
  v_sub_f32 v141, v141, v169
  v_sub_f32 v142, v142, v169
  v_sub_f32 v143, v143, v169
  v_sub_f32 v0, v0, v169
  v_sub_f32 v1, v1, v169
  v_sub_f32 v2, v2, v169
  v_sub_f32 v3, v3, v169
  v_sub_f32 v4, v4, v169
  v_sub_f32 v5, v5, v169
  v_sub_f32 v6, v6, v169
  v_sub_f32 v7, v7, v169
  v_sub_f32 v8, v8, v169
  v_sub_f32 v9, v9, v169
  v_sub_f32 v10, v10, v169
  v_sub_f32 v11, v11, v169
  v_sub_f32 v12, v12, v169
  v_sub_f32 v13, v13, v169
  v_sub_f32 v14, v14, v169
  v_sub_f32 v15, v15, v169
  v_sub_f32 v16, v16, v169
  v_sub_f32 v17, v17, v169
  v_sub_f32 v18, v18, v169
  v_sub_f32 v19, v19, v169
  v_sub_f32 v20, v20, v169
  v_sub_f32 v21, v21, v169
  v_sub_f32 v22, v22, v169
  v_sub_f32 v23, v23, v169
  v_sub_f32 v24, v24, v169
  v_sub_f32 v25, v25, v169
  v_sub_f32 v26, v26, v169
  v_sub_f32 v27, v27, v169
  v_sub_f32 v28, v28, v169
  v_sub_f32 v29, v29, v169
  v_sub_f32 v30, v30, v169
  v_sub_f32 v31, v31, v169
  v_sub_f32 v32, v32, v169
  v_sub_f32 v33, v33, v169
  v_sub_f32 v34, v34, v169
  v_sub_f32 v35, v35, v169
  v_sub_f32 v36, v36, v169
  v_sub_f32 v37, v37, v169
  v_sub_f32 v38, v38, v169
  v_sub_f32 v39, v39, v169
  v_sub_f32 v40, v40, v169
  v_sub_f32 v41, v41, v169
  v_sub_f32 v42, v42, v169
  v_sub_f32 v43, v43, v169
  v_sub_f32 v44, v44, v169
  v_sub_f32 v45, v45, v169
  v_sub_f32 v46, v46, v169
  v_sub_f32 v47, v47, v169
  v_sub_f32 v48, v48, v169
  v_sub_f32 v49, v49, v169
  v_sub_f32 v50, v50, v169
  v_sub_f32 v51, v51, v169
  v_sub_f32 v52, v52, v169
  v_sub_f32 v53, v53, v169
  v_sub_f32 v54, v54, v169
  v_sub_f32 v55, v55, v169
  v_sub_f32 v56, v56, v169
  v_sub_f32 v57, v57, v169
  v_sub_f32 v58, v58, v169
  v_sub_f32 v59, v59, v169
  v_sub_f32 v60, v60, v169
  v_sub_f32 v61, v61, v169
  v_sub_f32 v62, v62, v169
  v_sub_f32 v63, v63, v169
  v_mul_f32 v64, v170, v64
  v_mul_f32 v65, v170, v65
  v_mul_f32 v66, v170, v66
  v_mul_f32 v67, v170, v67
  v_mul_f32 v68, v170, v68
  v_mul_f32 v69, v170, v69
  v_mul_f32 v70, v170, v70
  v_mul_f32 v71, v170, v71
  v_mul_f32 v72, v170, v72
  v_mul_f32 v73, v170, v73
  v_mul_f32 v74, v170, v74
  v_mul_f32 v75, v170, v75
  v_mul_f32 v76, v170, v76
  v_mul_f32 v77, v170, v77
  v_mul_f32 v78, v170, v78
  v_mul_f32 v79, v170, v79
  v_mul_f32 v80, v170, v80
  v_mul_f32 v81, v170, v81
  v_mul_f32 v82, v170, v82
  v_mul_f32 v83, v170, v83
  v_mul_f32 v84, v170, v84
  v_mul_f32 v85, v170, v85
  v_mul_f32 v86, v170, v86
  v_mul_f32 v87, v170, v87
  v_mul_f32 v88, v170, v88
  v_mul_f32 v89, v170, v89
  v_mul_f32 v90, v170, v90
  v_mul_f32 v91, v170, v91
  v_mul_f32 v92, v170, v92
  v_mul_f32 v93, v170, v93
  v_mul_f32 v94, v170, v94
  v_mul_f32 v95, v170, v95
  v_mul_f32 v96, v170, v96
  v_mul_f32 v97, v170, v97
  v_mul_f32 v98, v170, v98
  v_mul_f32 v99, v170, v99
  v_mul_f32 v100, v170, v100
  v_mul_f32 v101, v170, v101
  v_mul_f32 v102, v170, v102
  v_mul_f32 v103, v170, v103
  v_mul_f32 v104, v170, v104
  v_mul_f32 v105, v170, v105
  v_mul_f32 v106, v170, v106
  v_mul_f32 v107, v170, v107
  v_mul_f32 v108, v170, v108
  v_mul_f32 v109, v170, v109
  v_mul_f32 v110, v170, v110
  v_mul_f32 v111, v170, v111
  v_mul_f32 v112, v170, v112
  v_mul_f32 v113, v170, v113
  v_mul_f32 v114, v170, v114
  v_mul_f32 v115, v170, v115
  v_mul_f32 v116, v170, v116
  v_mul_f32 v117, v170, v117
  v_mul_f32 v118, v170, v118
  v_mul_f32 v119, v170, v119
  v_mul_f32 v120, v170, v120
  v_mul_f32 v121, v170, v121
  v_mul_f32 v122, v170, v122
  v_mul_f32 v123, v170, v123
  v_mul_f32 v124, v170, v124
  v_mul_f32 v125, v170, v125
  v_mul_f32 v126, v170, v126
  v_mul_f32 v127, v170, v127
  v_mul_f32 v162, v170, v162
  v_exp_f32 v165, v0
  v_exp_f32 v166, v1
  s_nop 0
  v_add_f32 v163, v165, v166
  v_cvt_pk_bf16_f32 v144, v165, v166
  v_exp_f32 v167, v2
  v_exp_f32 v168, v3
  v_add_f32 v163, v163, v167
  v_add_f32 v163, v163, v168
  v_cvt_pk_bf16_f32 v145, v167, v168
  v_exp_f32 v165, v4
  v_exp_f32 v166, v5
  v_add_f32 v163, v163, v165
  v_add_f32 v163, v163, v166
  v_cvt_pk_bf16_f32 v146, v165, v166
  v_exp_f32 v167, v6
  v_exp_f32 v168, v7
  v_add_f32 v163, v163, v167
  v_add_f32 v163, v163, v168
  v_cvt_pk_bf16_f32 v147, v167, v168
  v_exp_f32 v165, v8
  v_exp_f32 v166, v9
  v_add_f32 v163, v163, v165
  v_add_f32 v163, v163, v166
  v_cvt_pk_bf16_f32 v148, v165, v166
  v_exp_f32 v167, v10
  v_exp_f32 v168, v11
  v_add_f32 v163, v163, v167
  v_add_f32 v163, v163, v168
  v_cvt_pk_bf16_f32 v149, v167, v168
  v_exp_f32 v165, v12
  v_exp_f32 v166, v13
  v_add_f32 v163, v163, v165
  v_add_f32 v163, v163, v166
  v_cvt_pk_bf16_f32 v150, v165, v166
  v_exp_f32 v167, v14
  v_exp_f32 v168, v15
  v_add_f32 v163, v163, v167
  v_add_f32 v163, v163, v168
  v_cvt_pk_bf16_f32 v151, v167, v168
  v_exp_f32 v165, v16
  v_exp_f32 v166, v17
  v_add_f32 v163, v163, v165
  v_add_f32 v163, v163, v166
  v_cvt_pk_bf16_f32 v152, v165, v166
  v_exp_f32 v167, v18
  v_exp_f32 v168, v19
  v_add_f32 v163, v163, v167
  v_add_f32 v163, v163, v168
  v_cvt_pk_bf16_f32 v153, v167, v168
  v_exp_f32 v165, v20
  v_exp_f32 v166, v21
  v_add_f32 v163, v163, v165
  v_add_f32 v163, v163, v166
  v_cvt_pk_bf16_f32 v154, v165, v166
  v_exp_f32 v167, v22
  v_exp_f32 v168, v23
  v_add_f32 v163, v163, v167
  v_add_f32 v163, v163, v168
  v_cvt_pk_bf16_f32 v155, v167, v168
  v_exp_f32 v165, v24
  v_exp_f32 v166, v25
  v_add_f32 v163, v163, v165
  v_add_f32 v163, v163, v166
  v_cvt_pk_bf16_f32 v156, v165, v166
  v_exp_f32 v167, v26
  v_exp_f32 v168, v27
  v_add_f32 v163, v163, v167
  v_add_f32 v163, v163, v168
  v_cvt_pk_bf16_f32 v157, v167, v168
  v_exp_f32 v165, v28
  v_exp_f32 v166, v29
  v_add_f32 v163, v163, v165
  v_add_f32 v163, v163, v166
  v_cvt_pk_bf16_f32 v158, v165, v166
  v_exp_f32 v167, v30
  v_exp_f32 v168, v31
  v_add_f32 v163, v163, v167
  v_add_f32 v163, v163, v168
  v_cvt_pk_bf16_f32 v159, v167, v168
  s_nop 3
  s_branch L_ret_0_6
L_fb_0_7:
  s_nop 15
  v_max3_f32 v169, v32, v33, v34
  v_max3_f32 v169, v169, v35, v36
  v_max3_f32 v169, v169, v37, v38
  v_max3_f32 v169, v169, v39, v40
  v_max3_f32 v169, v169, v41, v42
  v_max3_f32 v169, v169, v43, v44
  v_max3_f32 v169, v169, v45, v46
  v_max3_f32 v169, v169, v47, v48
  v_max3_f32 v169, v169, v49, v50
  v_max3_f32 v169, v169, v51, v52
  v_max3_f32 v169, v169, v53, v54
  v_max3_f32 v169, v169, v55, v56
  v_max3_f32 v169, v169, v57, v58
  v_max3_f32 v169, v169, v59, v60
  v_max3_f32 v169, v169, v61, v62
  v_max_f32 v169, v169, v63
  v_mov_b32 v170, v169
  s_nop 1
  v_permlane32_swap_b32 v170, v169
  v_max_f32 v169, v169, v170
  v_max_f32 v169, 0, v169
  v_exp_f32 v170, -v169
  v_sub_f32 v128, v128, v169
  v_sub_f32 v129, v129, v169
  v_sub_f32 v130, v130, v169
  v_sub_f32 v131, v131, v169
  v_sub_f32 v132, v132, v169
  v_sub_f32 v133, v133, v169
  v_sub_f32 v134, v134, v169
  v_sub_f32 v135, v135, v169
  v_sub_f32 v136, v136, v169
  v_sub_f32 v137, v137, v169
  v_sub_f32 v138, v138, v169
  v_sub_f32 v139, v139, v169
  v_sub_f32 v140, v140, v169
  v_sub_f32 v141, v141, v169
  v_sub_f32 v142, v142, v169
  v_sub_f32 v143, v143, v169
  v_sub_f32 v32, v32, v169
  v_sub_f32 v33, v33, v169
  v_sub_f32 v34, v34, v169
  v_sub_f32 v35, v35, v169
  v_sub_f32 v36, v36, v169
  v_sub_f32 v37, v37, v169
  v_sub_f32 v38, v38, v169
  v_sub_f32 v39, v39, v169
  v_sub_f32 v40, v40, v169
  v_sub_f32 v41, v41, v169
  v_sub_f32 v42, v42, v169
  v_sub_f32 v43, v43, v169
  v_sub_f32 v44, v44, v169
  v_sub_f32 v45, v45, v169
  v_sub_f32 v46, v46, v169
  v_sub_f32 v47, v47, v169
  v_sub_f32 v48, v48, v169
  v_sub_f32 v49, v49, v169
  v_sub_f32 v50, v50, v169
  v_sub_f32 v51, v51, v169
  v_sub_f32 v52, v52, v169
  v_sub_f32 v53, v53, v169
  v_sub_f32 v54, v54, v169
  v_sub_f32 v55, v55, v169
  v_sub_f32 v56, v56, v169
  v_sub_f32 v57, v57, v169
  v_sub_f32 v58, v58, v169
  v_sub_f32 v59, v59, v169
  v_sub_f32 v60, v60, v169
  v_sub_f32 v61, v61, v169
  v_sub_f32 v62, v62, v169
  v_sub_f32 v63, v63, v169
  v_mul_f32 v64, v170, v64
  v_mul_f32 v65, v170, v65
  v_mul_f32 v66, v170, v66
  v_mul_f32 v67, v170, v67
  v_mul_f32 v68, v170, v68
  v_mul_f32 v69, v170, v69
  v_mul_f32 v70, v170, v70
  v_mul_f32 v71, v170, v71
  v_mul_f32 v72, v170, v72
  v_mul_f32 v73, v170, v73
  v_mul_f32 v74, v170, v74
  v_mul_f32 v75, v170, v75
  v_mul_f32 v76, v170, v76
  v_mul_f32 v77, v170, v77
  v_mul_f32 v78, v170, v78
  v_mul_f32 v79, v170, v79
  v_mul_f32 v80, v170, v80
  v_mul_f32 v81, v170, v81
  v_mul_f32 v82, v170, v82
  v_mul_f32 v83, v170, v83
  v_mul_f32 v84, v170, v84
  v_mul_f32 v85, v170, v85
  v_mul_f32 v86, v170, v86
  v_mul_f32 v87, v170, v87
  v_mul_f32 v88, v170, v88
  v_mul_f32 v89, v170, v89
  v_mul_f32 v90, v170, v90
  v_mul_f32 v91, v170, v91
  v_mul_f32 v92, v170, v92
  v_mul_f32 v93, v170, v93
  v_mul_f32 v94, v170, v94
  v_mul_f32 v95, v170, v95
  v_mul_f32 v96, v170, v96
  v_mul_f32 v97, v170, v97
  v_mul_f32 v98, v170, v98
  v_mul_f32 v99, v170, v99
  v_mul_f32 v100, v170, v100
  v_mul_f32 v101, v170, v101
  v_mul_f32 v102, v170, v102
  v_mul_f32 v103, v170, v103
  v_mul_f32 v104, v170, v104
  v_mul_f32 v105, v170, v105
  v_mul_f32 v106, v170, v106
  v_mul_f32 v107, v170, v107
  v_mul_f32 v108, v170, v108
  v_mul_f32 v109, v170, v109
  v_mul_f32 v110, v170, v110
  v_mul_f32 v111, v170, v111
  v_mul_f32 v112, v170, v112
  v_mul_f32 v113, v170, v113
  v_mul_f32 v114, v170, v114
  v_mul_f32 v115, v170, v115
  v_mul_f32 v116, v170, v116
  v_mul_f32 v117, v170, v117
  v_mul_f32 v118, v170, v118
  v_mul_f32 v119, v170, v119
  v_mul_f32 v120, v170, v120
  v_mul_f32 v121, v170, v121
  v_mul_f32 v122, v170, v122
  v_mul_f32 v123, v170, v123
  v_mul_f32 v124, v170, v124
  v_mul_f32 v125, v170, v125
  v_mul_f32 v126, v170, v126
  v_mul_f32 v127, v170, v127
  v_mul_f32 v162, v170, v162
  v_exp_f32 v165, v32
  v_exp_f32 v166, v33
  s_nop 0
  v_add_f32 v163, v165, v166
  v_cvt_pk_bf16_f32 v144, v165, v166
  v_exp_f32 v167, v34
  v_exp_f32 v168, v35
  v_add_f32 v163, v163, v167
  v_add_f32 v163, v163, v168
  v_cvt_pk_bf16_f32 v145, v167, v168
  v_exp_f32 v165, v36
  v_exp_f32 v166, v37
  v_add_f32 v163, v163, v165
  v_add_f32 v163, v163, v166
  v_cvt_pk_bf16_f32 v146, v165, v166
  v_exp_f32 v167, v38
  v_exp_f32 v168, v39
  v_add_f32 v163, v163, v167
  v_add_f32 v163, v163, v168
  v_cvt_pk_bf16_f32 v147, v167, v168
  v_exp_f32 v165, v40
  v_exp_f32 v166, v41
  v_add_f32 v163, v163, v165
  v_add_f32 v163, v163, v166
  v_cvt_pk_bf16_f32 v148, v165, v166
  v_exp_f32 v167, v42
  v_exp_f32 v168, v43
  v_add_f32 v163, v163, v167
  v_add_f32 v163, v163, v168
  v_cvt_pk_bf16_f32 v149, v167, v168
  v_exp_f32 v165, v44
  v_exp_f32 v166, v45
  v_add_f32 v163, v163, v165
  v_add_f32 v163, v163, v166
  v_cvt_pk_bf16_f32 v150, v165, v166
  v_exp_f32 v167, v46
  v_exp_f32 v168, v47
  v_add_f32 v163, v163, v167
  v_add_f32 v163, v163, v168
  v_cvt_pk_bf16_f32 v151, v167, v168
  v_exp_f32 v165, v48
  v_exp_f32 v166, v49
  v_add_f32 v163, v163, v165
  v_add_f32 v163, v163, v166
  v_cvt_pk_bf16_f32 v152, v165, v166
  v_exp_f32 v167, v50
  v_exp_f32 v168, v51
  v_add_f32 v163, v163, v167
  v_add_f32 v163, v163, v168
  v_cvt_pk_bf16_f32 v153, v167, v168
  v_exp_f32 v165, v52
  v_exp_f32 v166, v53
  v_add_f32 v163, v163, v165
  v_add_f32 v163, v163, v166
  v_cvt_pk_bf16_f32 v154, v165, v166
  v_exp_f32 v167, v54
  v_exp_f32 v168, v55
  v_add_f32 v163, v163, v167
  v_add_f32 v163, v163, v168
  v_cvt_pk_bf16_f32 v155, v167, v168
  v_exp_f32 v165, v56
  v_exp_f32 v166, v57
  v_add_f32 v163, v163, v165
  v_add_f32 v163, v163, v166
  v_cvt_pk_bf16_f32 v156, v165, v166
  v_exp_f32 v167, v58
  v_exp_f32 v168, v59
  v_add_f32 v163, v163, v167
  v_add_f32 v163, v163, v168
  v_cvt_pk_bf16_f32 v157, v167, v168
  v_exp_f32 v165, v60
  v_exp_f32 v166, v61
  v_add_f32 v163, v163, v165
  v_add_f32 v163, v163, v166
  v_cvt_pk_bf16_f32 v158, v165, v166
  v_exp_f32 v167, v62
  v_exp_f32 v168, v63
  v_add_f32 v163, v163, v167
  v_add_f32 v163, v163, v168
  v_cvt_pk_bf16_f32 v159, v167, v168
  s_nop 3
  s_branch L_ret_0_7
L_fb_1_1:
  s_nop 15
  v_max3_f32 v169, v96, v97, v98
  v_max3_f32 v169, v169, v99, v100
  v_max3_f32 v169, v169, v101, v102
  v_max3_f32 v169, v169, v103, v104
  v_max3_f32 v169, v169, v105, v106
  v_max3_f32 v169, v169, v107, v108
  v_max3_f32 v169, v169, v109, v110
  v_max3_f32 v169, v169, v111, v112
  v_max3_f32 v169, v169, v113, v114
  v_max3_f32 v169, v169, v115, v116
  v_max3_f32 v169, v169, v117, v118
  v_max3_f32 v169, v169, v119, v120
  v_max3_f32 v169, v169, v121, v122
  v_max3_f32 v169, v169, v123, v124
  v_max3_f32 v169, v169, v125, v126
  v_max_f32 v169, v169, v127
  v_mov_b32 v170, v169
  s_nop 1
  v_permlane32_swap_b32 v170, v169
  v_max_f32 v169, v169, v170
  v_max_f32 v169, 0, v169
  v_exp_f32 v170, -v169
  v_sub_f32 v128, v128, v169
  v_sub_f32 v129, v129, v169
  v_sub_f32 v130, v130, v169
  v_sub_f32 v131, v131, v169
  v_sub_f32 v132, v132, v169
  v_sub_f32 v133, v133, v169
  v_sub_f32 v134, v134, v169
  v_sub_f32 v135, v135, v169
  v_sub_f32 v136, v136, v169
  v_sub_f32 v137, v137, v169
  v_sub_f32 v138, v138, v169
  v_sub_f32 v139, v139, v169
  v_sub_f32 v140, v140, v169
  v_sub_f32 v141, v141, v169
  v_sub_f32 v142, v142, v169
  v_sub_f32 v143, v143, v169
  v_sub_f32 v96, v96, v169
  v_sub_f32 v97, v97, v169
  v_sub_f32 v98, v98, v169
  v_sub_f32 v99, v99, v169
  v_sub_f32 v100, v100, v169
  v_sub_f32 v101, v101, v169
  v_sub_f32 v102, v102, v169
  v_sub_f32 v103, v103, v169
  v_sub_f32 v104, v104, v169
  v_sub_f32 v105, v105, v169
  v_sub_f32 v106, v106, v169
  v_sub_f32 v107, v107, v169
  v_sub_f32 v108, v108, v169
  v_sub_f32 v109, v109, v169
  v_sub_f32 v110, v110, v169
  v_sub_f32 v111, v111, v169
  v_sub_f32 v112, v112, v169
  v_sub_f32 v113, v113, v169
  v_sub_f32 v114, v114, v169
  v_sub_f32 v115, v115, v169
  v_sub_f32 v116, v116, v169
  v_sub_f32 v117, v117, v169
  v_sub_f32 v118, v118, v169
  v_sub_f32 v119, v119, v169
  v_sub_f32 v120, v120, v169
  v_sub_f32 v121, v121, v169
  v_sub_f32 v122, v122, v169
  v_sub_f32 v123, v123, v169
  v_sub_f32 v124, v124, v169
  v_sub_f32 v125, v125, v169
  v_sub_f32 v126, v126, v169
  v_sub_f32 v127, v127, v169
  v_sub_f32 v64, v64, v169
  v_sub_f32 v65, v65, v169
  v_sub_f32 v66, v66, v169
  v_sub_f32 v67, v67, v169
  v_sub_f32 v68, v68, v169
  v_sub_f32 v69, v69, v169
  v_sub_f32 v70, v70, v169
  v_sub_f32 v71, v71, v169
  v_sub_f32 v72, v72, v169
  v_sub_f32 v73, v73, v169
  v_sub_f32 v74, v74, v169
  v_sub_f32 v75, v75, v169
  v_sub_f32 v76, v76, v169
  v_sub_f32 v77, v77, v169
  v_sub_f32 v78, v78, v169
  v_sub_f32 v79, v79, v169
  v_sub_f32 v80, v80, v169
  v_sub_f32 v81, v81, v169
  v_sub_f32 v82, v82, v169
  v_sub_f32 v83, v83, v169
  v_sub_f32 v84, v84, v169
  v_sub_f32 v85, v85, v169
  v_sub_f32 v86, v86, v169
  v_sub_f32 v87, v87, v169
  v_sub_f32 v88, v88, v169
  v_sub_f32 v89, v89, v169
  v_sub_f32 v90, v90, v169
  v_sub_f32 v91, v91, v169
  v_sub_f32 v92, v92, v169
  v_sub_f32 v93, v93, v169
  v_sub_f32 v94, v94, v169
  v_sub_f32 v95, v95, v169
  v_mul_f32 v0, v170, v0
  v_mul_f32 v1, v170, v1
  v_mul_f32 v2, v170, v2
  v_mul_f32 v3, v170, v3
  v_mul_f32 v4, v170, v4
  v_mul_f32 v5, v170, v5
  v_mul_f32 v6, v170, v6
  v_mul_f32 v7, v170, v7
  v_mul_f32 v8, v170, v8
  v_mul_f32 v9, v170, v9
  v_mul_f32 v10, v170, v10
  v_mul_f32 v11, v170, v11
  v_mul_f32 v12, v170, v12
  v_mul_f32 v13, v170, v13
  v_mul_f32 v14, v170, v14
  v_mul_f32 v15, v170, v15
  v_mul_f32 v16, v170, v16
  v_mul_f32 v17, v170, v17
  v_mul_f32 v18, v170, v18
  v_mul_f32 v19, v170, v19
  v_mul_f32 v20, v170, v20
  v_mul_f32 v21, v170, v21
  v_mul_f32 v22, v170, v22
  v_mul_f32 v23, v170, v23
  v_mul_f32 v24, v170, v24
  v_mul_f32 v25, v170, v25
  v_mul_f32 v26, v170, v26
  v_mul_f32 v27, v170, v27
  v_mul_f32 v28, v170, v28
  v_mul_f32 v29, v170, v29
  v_mul_f32 v30, v170, v30
  v_mul_f32 v31, v170, v31
  v_mul_f32 v32, v170, v32
  v_mul_f32 v33, v170, v33
  v_mul_f32 v34, v170, v34
  v_mul_f32 v35, v170, v35
  v_mul_f32 v36, v170, v36
  v_mul_f32 v37, v170, v37
  v_mul_f32 v38, v170, v38
  v_mul_f32 v39, v170, v39
  v_mul_f32 v40, v170, v40
  v_mul_f32 v41, v170, v41
  v_mul_f32 v42, v170, v42
  v_mul_f32 v43, v170, v43
  v_mul_f32 v44, v170, v44
  v_mul_f32 v45, v170, v45
  v_mul_f32 v46, v170, v46
  v_mul_f32 v47, v170, v47
  v_mul_f32 v48, v170, v48
  v_mul_f32 v49, v170, v49
  v_mul_f32 v50, v170, v50
  v_mul_f32 v51, v170, v51
  v_mul_f32 v52, v170, v52
  v_mul_f32 v53, v170, v53
  v_mul_f32 v54, v170, v54
  v_mul_f32 v55, v170, v55
  v_mul_f32 v56, v170, v56
  v_mul_f32 v57, v170, v57
  v_mul_f32 v58, v170, v58
  v_mul_f32 v59, v170, v59
  v_mul_f32 v60, v170, v60
  v_mul_f32 v61, v170, v61
  v_mul_f32 v62, v170, v62
  v_mul_f32 v63, v170, v63
  v_mul_f32 v162, v170, v162
  v_exp_f32 v165, v96
  v_exp_f32 v166, v97
  s_nop 0
  v_add_f32 v163, v165, v166
  v_cvt_pk_bf16_f32 v144, v165, v166
  v_exp_f32 v167, v98
  v_exp_f32 v168, v99
  v_add_f32 v163, v163, v167
  v_add_f32 v163, v163, v168
  v_cvt_pk_bf16_f32 v145, v167, v168
  v_exp_f32 v165, v100
  v_exp_f32 v166, v101
  v_add_f32 v163, v163, v165
  v_add_f32 v163, v163, v166
  v_cvt_pk_bf16_f32 v146, v165, v166
  v_exp_f32 v167, v102
  v_exp_f32 v168, v103
  v_add_f32 v163, v163, v167
  v_add_f32 v163, v163, v168
  v_cvt_pk_bf16_f32 v147, v167, v168
  v_exp_f32 v165, v104
  v_exp_f32 v166, v105
  v_add_f32 v163, v163, v165
  v_add_f32 v163, v163, v166
  v_cvt_pk_bf16_f32 v148, v165, v166
  v_exp_f32 v167, v106
  v_exp_f32 v168, v107
  v_add_f32 v163, v163, v167
  v_add_f32 v163, v163, v168
  v_cvt_pk_bf16_f32 v149, v167, v168
  v_exp_f32 v165, v108
  v_exp_f32 v166, v109
  v_add_f32 v163, v163, v165
  v_add_f32 v163, v163, v166
  v_cvt_pk_bf16_f32 v150, v165, v166
  v_exp_f32 v167, v110
  v_exp_f32 v168, v111
  v_add_f32 v163, v163, v167
  v_add_f32 v163, v163, v168
  v_cvt_pk_bf16_f32 v151, v167, v168
  v_exp_f32 v165, v112
  v_exp_f32 v166, v113
  v_add_f32 v163, v163, v165
  v_add_f32 v163, v163, v166
  v_cvt_pk_bf16_f32 v152, v165, v166
  v_exp_f32 v167, v114
  v_exp_f32 v168, v115
  v_add_f32 v163, v163, v167
  v_add_f32 v163, v163, v168
  v_cvt_pk_bf16_f32 v153, v167, v168
  v_exp_f32 v165, v116
  v_exp_f32 v166, v117
  v_add_f32 v163, v163, v165
  v_add_f32 v163, v163, v166
  v_cvt_pk_bf16_f32 v154, v165, v166
  v_exp_f32 v167, v118
  v_exp_f32 v168, v119
  v_add_f32 v163, v163, v167
  v_add_f32 v163, v163, v168
  v_cvt_pk_bf16_f32 v155, v167, v168
  v_exp_f32 v165, v120
  v_exp_f32 v166, v121
  v_add_f32 v163, v163, v165
  v_add_f32 v163, v163, v166
  v_cvt_pk_bf16_f32 v156, v165, v166
  v_exp_f32 v167, v122
  v_exp_f32 v168, v123
  v_add_f32 v163, v163, v167
  v_add_f32 v163, v163, v168
  v_cvt_pk_bf16_f32 v157, v167, v168
  v_exp_f32 v165, v124
  v_exp_f32 v166, v125
  v_add_f32 v163, v163, v165
  v_add_f32 v163, v163, v166
  v_cvt_pk_bf16_f32 v158, v165, v166
  v_exp_f32 v167, v126
  v_exp_f32 v168, v127
  v_add_f32 v163, v163, v167
  v_add_f32 v163, v163, v168
  v_cvt_pk_bf16_f32 v159, v167, v168
  s_nop 3
  s_branch L_ret_1_1
L_fb_1_2:
  s_nop 15
  v_max3_f32 v169, v64, v65, v66
  v_max3_f32 v169, v169, v67, v68
  v_max3_f32 v169, v169, v69, v70
  v_max3_f32 v169, v169, v71, v72
  v_max3_f32 v169, v169, v73, v74
  v_max3_f32 v169, v169, v75, v76
  v_max3_f32 v169, v169, v77, v78
  v_max3_f32 v169, v169, v79, v80
  v_max3_f32 v169, v169, v81, v82
  v_max3_f32 v169, v169, v83, v84
  v_max3_f32 v169, v169, v85, v86
  v_max3_f32 v169, v169, v87, v88
  v_max3_f32 v169, v169, v89, v90
  v_max3_f32 v169, v169, v91, v92
  v_max3_f32 v169, v169, v93, v94
  v_max_f32 v169, v169, v95
  v_mov_b32 v170, v169
  s_nop 1
  v_permlane32_swap_b32 v170, v169
  v_max_f32 v169, v169, v170
  v_max_f32 v169, 0, v169
  v_exp_f32 v170, -v169
  v_sub_f32 v128, v128, v169
  v_sub_f32 v129, v129, v169
  v_sub_f32 v130, v130, v169
  v_sub_f32 v131, v131, v169
  v_sub_f32 v132, v132, v169
  v_sub_f32 v133, v133, v169
  v_sub_f32 v134, v134, v169
  v_sub_f32 v135, v135, v169
  v_sub_f32 v136, v136, v169
  v_sub_f32 v137, v137, v169
  v_sub_f32 v138, v138, v169
  v_sub_f32 v139, v139, v169
  v_sub_f32 v140, v140, v169
  v_sub_f32 v141, v141, v169
  v_sub_f32 v142, v142, v169
  v_sub_f32 v143, v143, v169
  v_sub_f32 v64, v64, v169
  v_sub_f32 v65, v65, v169
  v_sub_f32 v66, v66, v169
  v_sub_f32 v67, v67, v169
  v_sub_f32 v68, v68, v169
  v_sub_f32 v69, v69, v169
  v_sub_f32 v70, v70, v169
  v_sub_f32 v71, v71, v169
  v_sub_f32 v72, v72, v169
  v_sub_f32 v73, v73, v169
  v_sub_f32 v74, v74, v169
  v_sub_f32 v75, v75, v169
  v_sub_f32 v76, v76, v169
  v_sub_f32 v77, v77, v169
  v_sub_f32 v78, v78, v169
  v_sub_f32 v79, v79, v169
  v_sub_f32 v80, v80, v169
  v_sub_f32 v81, v81, v169
  v_sub_f32 v82, v82, v169
  v_sub_f32 v83, v83, v169
  v_sub_f32 v84, v84, v169
  v_sub_f32 v85, v85, v169
  v_sub_f32 v86, v86, v169
  v_sub_f32 v87, v87, v169
  v_sub_f32 v88, v88, v169
  v_sub_f32 v89, v89, v169
  v_sub_f32 v90, v90, v169
  v_sub_f32 v91, v91, v169
  v_sub_f32 v92, v92, v169
  v_sub_f32 v93, v93, v169
  v_sub_f32 v94, v94, v169
  v_sub_f32 v95, v95, v169
  v_sub_f32 v96, v96, v169
  v_sub_f32 v97, v97, v169
  v_sub_f32 v98, v98, v169
  v_sub_f32 v99, v99, v169
  v_sub_f32 v100, v100, v169
  v_sub_f32 v101, v101, v169
  v_sub_f32 v102, v102, v169
  v_sub_f32 v103, v103, v169
  v_sub_f32 v104, v104, v169
  v_sub_f32 v105, v105, v169
  v_sub_f32 v106, v106, v169
  v_sub_f32 v107, v107, v169
  v_sub_f32 v108, v108, v169
  v_sub_f32 v109, v109, v169
  v_sub_f32 v110, v110, v169
  v_sub_f32 v111, v111, v169
  v_sub_f32 v112, v112, v169
  v_sub_f32 v113, v113, v169
  v_sub_f32 v114, v114, v169
  v_sub_f32 v115, v115, v169
  v_sub_f32 v116, v116, v169
  v_sub_f32 v117, v117, v169
  v_sub_f32 v118, v118, v169
  v_sub_f32 v119, v119, v169
  v_sub_f32 v120, v120, v169
  v_sub_f32 v121, v121, v169
  v_sub_f32 v122, v122, v169
  v_sub_f32 v123, v123, v169
  v_sub_f32 v124, v124, v169
  v_sub_f32 v125, v125, v169
  v_sub_f32 v126, v126, v169
  v_sub_f32 v127, v127, v169
  v_mul_f32 v0, v170, v0
  v_mul_f32 v1, v170, v1
  v_mul_f32 v2, v170, v2
  v_mul_f32 v3, v170, v3
  v_mul_f32 v4, v170, v4
  v_mul_f32 v5, v170, v5
  v_mul_f32 v6, v170, v6
  v_mul_f32 v7, v170, v7
  v_mul_f32 v8, v170, v8
  v_mul_f32 v9, v170, v9
  v_mul_f32 v10, v170, v10
  v_mul_f32 v11, v170, v11
  v_mul_f32 v12, v170, v12
  v_mul_f32 v13, v170, v13
  v_mul_f32 v14, v170, v14
  v_mul_f32 v15, v170, v15
  v_mul_f32 v16, v170, v16
  v_mul_f32 v17, v170, v17
  v_mul_f32 v18, v170, v18
  v_mul_f32 v19, v170, v19
  v_mul_f32 v20, v170, v20
  v_mul_f32 v21, v170, v21
  v_mul_f32 v22, v170, v22
  v_mul_f32 v23, v170, v23
  v_mul_f32 v24, v170, v24
  v_mul_f32 v25, v170, v25
  v_mul_f32 v26, v170, v26
  v_mul_f32 v27, v170, v27
  v_mul_f32 v28, v170, v28
  v_mul_f32 v29, v170, v29
  v_mul_f32 v30, v170, v30
  v_mul_f32 v31, v170, v31
  v_mul_f32 v32, v170, v32
  v_mul_f32 v33, v170, v33
  v_mul_f32 v34, v170, v34
  v_mul_f32 v35, v170, v35
  v_mul_f32 v36, v170, v36
  v_mul_f32 v37, v170, v37
  v_mul_f32 v38, v170, v38
  v_mul_f32 v39, v170, v39
  v_mul_f32 v40, v170, v40
  v_mul_f32 v41, v170, v41
  v_mul_f32 v42, v170, v42
  v_mul_f32 v43, v170, v43
  v_mul_f32 v44, v170, v44
  v_mul_f32 v45, v170, v45
  v_mul_f32 v46, v170, v46
  v_mul_f32 v47, v170, v47
  v_mul_f32 v48, v170, v48
  v_mul_f32 v49, v170, v49
  v_mul_f32 v50, v170, v50
  v_mul_f32 v51, v170, v51
  v_mul_f32 v52, v170, v52
  v_mul_f32 v53, v170, v53
  v_mul_f32 v54, v170, v54
  v_mul_f32 v55, v170, v55
  v_mul_f32 v56, v170, v56
  v_mul_f32 v57, v170, v57
  v_mul_f32 v58, v170, v58
  v_mul_f32 v59, v170, v59
  v_mul_f32 v60, v170, v60
  v_mul_f32 v61, v170, v61
  v_mul_f32 v62, v170, v62
  v_mul_f32 v63, v170, v63
  v_mul_f32 v162, v170, v162
  v_exp_f32 v165, v64
  v_exp_f32 v166, v65
  s_nop 0
  v_add_f32 v163, v165, v166
  v_cvt_pk_bf16_f32 v144, v165, v166
  v_exp_f32 v167, v66
  v_exp_f32 v168, v67
  v_add_f32 v163, v163, v167
  v_add_f32 v163, v163, v168
  v_cvt_pk_bf16_f32 v145, v167, v168
  v_exp_f32 v165, v68
  v_exp_f32 v166, v69
  v_add_f32 v163, v163, v165
  v_add_f32 v163, v163, v166
  v_cvt_pk_bf16_f32 v146, v165, v166
  v_exp_f32 v167, v70
  v_exp_f32 v168, v71
  v_add_f32 v163, v163, v167
  v_add_f32 v163, v163, v168
  v_cvt_pk_bf16_f32 v147, v167, v168
  v_exp_f32 v165, v72
  v_exp_f32 v166, v73
  v_add_f32 v163, v163, v165
  v_add_f32 v163, v163, v166
  v_cvt_pk_bf16_f32 v148, v165, v166
  v_exp_f32 v167, v74
  v_exp_f32 v168, v75
  v_add_f32 v163, v163, v167
  v_add_f32 v163, v163, v168
  v_cvt_pk_bf16_f32 v149, v167, v168
  v_exp_f32 v165, v76
  v_exp_f32 v166, v77
  v_add_f32 v163, v163, v165
  v_add_f32 v163, v163, v166
  v_cvt_pk_bf16_f32 v150, v165, v166
  v_exp_f32 v167, v78
  v_exp_f32 v168, v79
  v_add_f32 v163, v163, v167
  v_add_f32 v163, v163, v168
  v_cvt_pk_bf16_f32 v151, v167, v168
  v_exp_f32 v165, v80
  v_exp_f32 v166, v81
  v_add_f32 v163, v163, v165
  v_add_f32 v163, v163, v166
  v_cvt_pk_bf16_f32 v152, v165, v166
  v_exp_f32 v167, v82
  v_exp_f32 v168, v83
  v_add_f32 v163, v163, v167
  v_add_f32 v163, v163, v168
  v_cvt_pk_bf16_f32 v153, v167, v168
  v_exp_f32 v165, v84
  v_exp_f32 v166, v85
  v_add_f32 v163, v163, v165
  v_add_f32 v163, v163, v166
  v_cvt_pk_bf16_f32 v154, v165, v166
  v_exp_f32 v167, v86
  v_exp_f32 v168, v87
  v_add_f32 v163, v163, v167
  v_add_f32 v163, v163, v168
  v_cvt_pk_bf16_f32 v155, v167, v168
  v_exp_f32 v165, v88
  v_exp_f32 v166, v89
  v_add_f32 v163, v163, v165
  v_add_f32 v163, v163, v166
  v_cvt_pk_bf16_f32 v156, v165, v166
  v_exp_f32 v167, v90
  v_exp_f32 v168, v91
  v_add_f32 v163, v163, v167
  v_add_f32 v163, v163, v168
  v_cvt_pk_bf16_f32 v157, v167, v168
  v_exp_f32 v165, v92
  v_exp_f32 v166, v93
  v_add_f32 v163, v163, v165
  v_add_f32 v163, v163, v166
  v_cvt_pk_bf16_f32 v158, v165, v166
  v_exp_f32 v167, v94
  v_exp_f32 v168, v95
  v_add_f32 v163, v163, v167
  v_add_f32 v163, v163, v168
  v_cvt_pk_bf16_f32 v159, v167, v168
  s_nop 3
  s_branch L_ret_1_2
L_fb_1_3:
  s_nop 15
  v_max3_f32 v169, v96, v97, v98
  v_max3_f32 v169, v169, v99, v100
  v_max3_f32 v169, v169, v101, v102
  v_max3_f32 v169, v169, v103, v104
  v_max3_f32 v169, v169, v105, v106
  v_max3_f32 v169, v169, v107, v108
  v_max3_f32 v169, v169, v109, v110
  v_max3_f32 v169, v169, v111, v112
  v_max3_f32 v169, v169, v113, v114
  v_max3_f32 v169, v169, v115, v116
  v_max3_f32 v169, v169, v117, v118
  v_max3_f32 v169, v169, v119, v120
  v_max3_f32 v169, v169, v121, v122
  v_max3_f32 v169, v169, v123, v124
  v_max3_f32 v169, v169, v125, v126
  v_max_f32 v169, v169, v127
  v_mov_b32 v170, v169
  s_nop 1
  v_permlane32_swap_b32 v170, v169
  v_max_f32 v169, v169, v170
  v_max_f32 v169, 0, v169
  v_exp_f32 v170, -v169
  v_sub_f32 v128, v128, v169
  v_sub_f32 v129, v129, v169
  v_sub_f32 v130, v130, v169
  v_sub_f32 v131, v131, v169
  v_sub_f32 v132, v132, v169
  v_sub_f32 v133, v133, v169
  v_sub_f32 v134, v134, v169
  v_sub_f32 v135, v135, v169
  v_sub_f32 v136, v136, v169
  v_sub_f32 v137, v137, v169
  v_sub_f32 v138, v138, v169
  v_sub_f32 v139, v139, v169
  v_sub_f32 v140, v140, v169
  v_sub_f32 v141, v141, v169
  v_sub_f32 v142, v142, v169
  v_sub_f32 v143, v143, v169
  v_sub_f32 v96, v96, v169
  v_sub_f32 v97, v97, v169
  v_sub_f32 v98, v98, v169
  v_sub_f32 v99, v99, v169
  v_sub_f32 v100, v100, v169
  v_sub_f32 v101, v101, v169
  v_sub_f32 v102, v102, v169
  v_sub_f32 v103, v103, v169
  v_sub_f32 v104, v104, v169
  v_sub_f32 v105, v105, v169
  v_sub_f32 v106, v106, v169
  v_sub_f32 v107, v107, v169
  v_sub_f32 v108, v108, v169
  v_sub_f32 v109, v109, v169
  v_sub_f32 v110, v110, v169
  v_sub_f32 v111, v111, v169
  v_sub_f32 v112, v112, v169
  v_sub_f32 v113, v113, v169
  v_sub_f32 v114, v114, v169
  v_sub_f32 v115, v115, v169
  v_sub_f32 v116, v116, v169
  v_sub_f32 v117, v117, v169
  v_sub_f32 v118, v118, v169
  v_sub_f32 v119, v119, v169
  v_sub_f32 v120, v120, v169
  v_sub_f32 v121, v121, v169
  v_sub_f32 v122, v122, v169
  v_sub_f32 v123, v123, v169
  v_sub_f32 v124, v124, v169
  v_sub_f32 v125, v125, v169
  v_sub_f32 v126, v126, v169
  v_sub_f32 v127, v127, v169
  v_sub_f32 v64, v64, v169
  v_sub_f32 v65, v65, v169
  v_sub_f32 v66, v66, v169
  v_sub_f32 v67, v67, v169
  v_sub_f32 v68, v68, v169
  v_sub_f32 v69, v69, v169
  v_sub_f32 v70, v70, v169
  v_sub_f32 v71, v71, v169
  v_sub_f32 v72, v72, v169
  v_sub_f32 v73, v73, v169
  v_sub_f32 v74, v74, v169
  v_sub_f32 v75, v75, v169
  v_sub_f32 v76, v76, v169
  v_sub_f32 v77, v77, v169
  v_sub_f32 v78, v78, v169
  v_sub_f32 v79, v79, v169
  v_sub_f32 v80, v80, v169
  v_sub_f32 v81, v81, v169
  v_sub_f32 v82, v82, v169
  v_sub_f32 v83, v83, v169
  v_sub_f32 v84, v84, v169
  v_sub_f32 v85, v85, v169
  v_sub_f32 v86, v86, v169
  v_sub_f32 v87, v87, v169
  v_sub_f32 v88, v88, v169
  v_sub_f32 v89, v89, v169
  v_sub_f32 v90, v90, v169
  v_sub_f32 v91, v91, v169
  v_sub_f32 v92, v92, v169
  v_sub_f32 v93, v93, v169
  v_sub_f32 v94, v94, v169
  v_sub_f32 v95, v95, v169
  v_mul_f32 v0, v170, v0
  v_mul_f32 v1, v170, v1
  v_mul_f32 v2, v170, v2
  v_mul_f32 v3, v170, v3
  v_mul_f32 v4, v170, v4
  v_mul_f32 v5, v170, v5
  v_mul_f32 v6, v170, v6
  v_mul_f32 v7, v170, v7
  v_mul_f32 v8, v170, v8
  v_mul_f32 v9, v170, v9
  v_mul_f32 v10, v170, v10
  v_mul_f32 v11, v170, v11
  v_mul_f32 v12, v170, v12
  v_mul_f32 v13, v170, v13
  v_mul_f32 v14, v170, v14
  v_mul_f32 v15, v170, v15
  v_mul_f32 v16, v170, v16
  v_mul_f32 v17, v170, v17
  v_mul_f32 v18, v170, v18
  v_mul_f32 v19, v170, v19
  v_mul_f32 v20, v170, v20
  v_mul_f32 v21, v170, v21
  v_mul_f32 v22, v170, v22
  v_mul_f32 v23, v170, v23
  v_mul_f32 v24, v170, v24
  v_mul_f32 v25, v170, v25
  v_mul_f32 v26, v170, v26
  v_mul_f32 v27, v170, v27
  v_mul_f32 v28, v170, v28
  v_mul_f32 v29, v170, v29
  v_mul_f32 v30, v170, v30
  v_mul_f32 v31, v170, v31
  v_mul_f32 v32, v170, v32
  v_mul_f32 v33, v170, v33
  v_mul_f32 v34, v170, v34
  v_mul_f32 v35, v170, v35
  v_mul_f32 v36, v170, v36
  v_mul_f32 v37, v170, v37
  v_mul_f32 v38, v170, v38
  v_mul_f32 v39, v170, v39
  v_mul_f32 v40, v170, v40
  v_mul_f32 v41, v170, v41
  v_mul_f32 v42, v170, v42
  v_mul_f32 v43, v170, v43
  v_mul_f32 v44, v170, v44
  v_mul_f32 v45, v170, v45
  v_mul_f32 v46, v170, v46
  v_mul_f32 v47, v170, v47
  v_mul_f32 v48, v170, v48
  v_mul_f32 v49, v170, v49
  v_mul_f32 v50, v170, v50
  v_mul_f32 v51, v170, v51
  v_mul_f32 v52, v170, v52
  v_mul_f32 v53, v170, v53
  v_mul_f32 v54, v170, v54
  v_mul_f32 v55, v170, v55
  v_mul_f32 v56, v170, v56
  v_mul_f32 v57, v170, v57
  v_mul_f32 v58, v170, v58
  v_mul_f32 v59, v170, v59
  v_mul_f32 v60, v170, v60
  v_mul_f32 v61, v170, v61
  v_mul_f32 v62, v170, v62
  v_mul_f32 v63, v170, v63
  v_mul_f32 v162, v170, v162
  v_exp_f32 v165, v96
  v_exp_f32 v166, v97
  s_nop 0
  v_add_f32 v163, v165, v166
  v_cvt_pk_bf16_f32 v144, v165, v166
  v_exp_f32 v167, v98
  v_exp_f32 v168, v99
  v_add_f32 v163, v163, v167
  v_add_f32 v163, v163, v168
  v_cvt_pk_bf16_f32 v145, v167, v168
  v_exp_f32 v165, v100
  v_exp_f32 v166, v101
  v_add_f32 v163, v163, v165
  v_add_f32 v163, v163, v166
  v_cvt_pk_bf16_f32 v146, v165, v166
  v_exp_f32 v167, v102
  v_exp_f32 v168, v103
  v_add_f32 v163, v163, v167
  v_add_f32 v163, v163, v168
  v_cvt_pk_bf16_f32 v147, v167, v168
  v_exp_f32 v165, v104
  v_exp_f32 v166, v105
  v_add_f32 v163, v163, v165
  v_add_f32 v163, v163, v166
  v_cvt_pk_bf16_f32 v148, v165, v166
  v_exp_f32 v167, v106
  v_exp_f32 v168, v107
  v_add_f32 v163, v163, v167
  v_add_f32 v163, v163, v168
  v_cvt_pk_bf16_f32 v149, v167, v168
  v_exp_f32 v165, v108
  v_exp_f32 v166, v109
  v_add_f32 v163, v163, v165
  v_add_f32 v163, v163, v166
  v_cvt_pk_bf16_f32 v150, v165, v166
  v_exp_f32 v167, v110
  v_exp_f32 v168, v111
  v_add_f32 v163, v163, v167
  v_add_f32 v163, v163, v168
  v_cvt_pk_bf16_f32 v151, v167, v168
  v_exp_f32 v165, v112
  v_exp_f32 v166, v113
  v_add_f32 v163, v163, v165
  v_add_f32 v163, v163, v166
  v_cvt_pk_bf16_f32 v152, v165, v166
  v_exp_f32 v167, v114
  v_exp_f32 v168, v115
  v_add_f32 v163, v163, v167
  v_add_f32 v163, v163, v168
  v_cvt_pk_bf16_f32 v153, v167, v168
  v_exp_f32 v165, v116
  v_exp_f32 v166, v117
  v_add_f32 v163, v163, v165
  v_add_f32 v163, v163, v166
  v_cvt_pk_bf16_f32 v154, v165, v166
  v_exp_f32 v167, v118
  v_exp_f32 v168, v119
  v_add_f32 v163, v163, v167
  v_add_f32 v163, v163, v168
  v_cvt_pk_bf16_f32 v155, v167, v168
  v_exp_f32 v165, v120
  v_exp_f32 v166, v121
  v_add_f32 v163, v163, v165
  v_add_f32 v163, v163, v166
  v_cvt_pk_bf16_f32 v156, v165, v166
  v_exp_f32 v167, v122
  v_exp_f32 v168, v123
  v_add_f32 v163, v163, v167
  v_add_f32 v163, v163, v168
  v_cvt_pk_bf16_f32 v157, v167, v168
  v_exp_f32 v165, v124
  v_exp_f32 v166, v125
  v_add_f32 v163, v163, v165
  v_add_f32 v163, v163, v166
  v_cvt_pk_bf16_f32 v158, v165, v166
  v_exp_f32 v167, v126
  v_exp_f32 v168, v127
  v_add_f32 v163, v163, v167
  v_add_f32 v163, v163, v168
  v_cvt_pk_bf16_f32 v159, v167, v168
  s_nop 3
  s_branch L_ret_1_3
L_fb_1_4:
  s_nop 15
  v_max3_f32 v169, v64, v65, v66
  v_max3_f32 v169, v169, v67, v68
  v_max3_f32 v169, v169, v69, v70
  v_max3_f32 v169, v169, v71, v72
  v_max3_f32 v169, v169, v73, v74
  v_max3_f32 v169, v169, v75, v76
  v_max3_f32 v169, v169, v77, v78
  v_max3_f32 v169, v169, v79, v80
  v_max3_f32 v169, v169, v81, v82
  v_max3_f32 v169, v169, v83, v84
  v_max3_f32 v169, v169, v85, v86
  v_max3_f32 v169, v169, v87, v88
  v_max3_f32 v169, v169, v89, v90
  v_max3_f32 v169, v169, v91, v92
  v_max3_f32 v169, v169, v93, v94
  v_max_f32 v169, v169, v95
  v_mov_b32 v170, v169
  s_nop 1
  v_permlane32_swap_b32 v170, v169
  v_max_f32 v169, v169, v170
  v_max_f32 v169, 0, v169
  v_exp_f32 v170, -v169
  v_sub_f32 v128, v128, v169
  v_sub_f32 v129, v129, v169
  v_sub_f32 v130, v130, v169
  v_sub_f32 v131, v131, v169
  v_sub_f32 v132, v132, v169
  v_sub_f32 v133, v133, v169
  v_sub_f32 v134, v134, v169
  v_sub_f32 v135, v135, v169
  v_sub_f32 v136, v136, v169
  v_sub_f32 v137, v137, v169
  v_sub_f32 v138, v138, v169
  v_sub_f32 v139, v139, v169
  v_sub_f32 v140, v140, v169
  v_sub_f32 v141, v141, v169
  v_sub_f32 v142, v142, v169
  v_sub_f32 v143, v143, v169
  v_sub_f32 v64, v64, v169
  v_sub_f32 v65, v65, v169
  v_sub_f32 v66, v66, v169
  v_sub_f32 v67, v67, v169
  v_sub_f32 v68, v68, v169
  v_sub_f32 v69, v69, v169
  v_sub_f32 v70, v70, v169
  v_sub_f32 v71, v71, v169
  v_sub_f32 v72, v72, v169
  v_sub_f32 v73, v73, v169
  v_sub_f32 v74, v74, v169
  v_sub_f32 v75, v75, v169
  v_sub_f32 v76, v76, v169
  v_sub_f32 v77, v77, v169
  v_sub_f32 v78, v78, v169
  v_sub_f32 v79, v79, v169
  v_sub_f32 v80, v80, v169
  v_sub_f32 v81, v81, v169
  v_sub_f32 v82, v82, v169
  v_sub_f32 v83, v83, v169
  v_sub_f32 v84, v84, v169
  v_sub_f32 v85, v85, v169
  v_sub_f32 v86, v86, v169
  v_sub_f32 v87, v87, v169
  v_sub_f32 v88, v88, v169
  v_sub_f32 v89, v89, v169
  v_sub_f32 v90, v90, v169
  v_sub_f32 v91, v91, v169
  v_sub_f32 v92, v92, v169
  v_sub_f32 v93, v93, v169
  v_sub_f32 v94, v94, v169
  v_sub_f32 v95, v95, v169
  v_sub_f32 v96, v96, v169
  v_sub_f32 v97, v97, v169
  v_sub_f32 v98, v98, v169
  v_sub_f32 v99, v99, v169
  v_sub_f32 v100, v100, v169
  v_sub_f32 v101, v101, v169
  v_sub_f32 v102, v102, v169
  v_sub_f32 v103, v103, v169
  v_sub_f32 v104, v104, v169
  v_sub_f32 v105, v105, v169
  v_sub_f32 v106, v106, v169
  v_sub_f32 v107, v107, v169
  v_sub_f32 v108, v108, v169
  v_sub_f32 v109, v109, v169
  v_sub_f32 v110, v110, v169
  v_sub_f32 v111, v111, v169
  v_sub_f32 v112, v112, v169
  v_sub_f32 v113, v113, v169
  v_sub_f32 v114, v114, v169
  v_sub_f32 v115, v115, v169
  v_sub_f32 v116, v116, v169
  v_sub_f32 v117, v117, v169
  v_sub_f32 v118, v118, v169
  v_sub_f32 v119, v119, v169
  v_sub_f32 v120, v120, v169
  v_sub_f32 v121, v121, v169
  v_sub_f32 v122, v122, v169
  v_sub_f32 v123, v123, v169
  v_sub_f32 v124, v124, v169
  v_sub_f32 v125, v125, v169
  v_sub_f32 v126, v126, v169
  v_sub_f32 v127, v127, v169
  v_mul_f32 v0, v170, v0
  v_mul_f32 v1, v170, v1
  v_mul_f32 v2, v170, v2
  v_mul_f32 v3, v170, v3
  v_mul_f32 v4, v170, v4
  v_mul_f32 v5, v170, v5
  v_mul_f32 v6, v170, v6
  v_mul_f32 v7, v170, v7
  v_mul_f32 v8, v170, v8
  v_mul_f32 v9, v170, v9
  v_mul_f32 v10, v170, v10
  v_mul_f32 v11, v170, v11
  v_mul_f32 v12, v170, v12
  v_mul_f32 v13, v170, v13
  v_mul_f32 v14, v170, v14
  v_mul_f32 v15, v170, v15
  v_mul_f32 v16, v170, v16
  v_mul_f32 v17, v170, v17
  v_mul_f32 v18, v170, v18
  v_mul_f32 v19, v170, v19
  v_mul_f32 v20, v170, v20
  v_mul_f32 v21, v170, v21
  v_mul_f32 v22, v170, v22
  v_mul_f32 v23, v170, v23
  v_mul_f32 v24, v170, v24
  v_mul_f32 v25, v170, v25
  v_mul_f32 v26, v170, v26
  v_mul_f32 v27, v170, v27
  v_mul_f32 v28, v170, v28
  v_mul_f32 v29, v170, v29
  v_mul_f32 v30, v170, v30
  v_mul_f32 v31, v170, v31
  v_mul_f32 v32, v170, v32
  v_mul_f32 v33, v170, v33
  v_mul_f32 v34, v170, v34
  v_mul_f32 v35, v170, v35
  v_mul_f32 v36, v170, v36
  v_mul_f32 v37, v170, v37
  v_mul_f32 v38, v170, v38
  v_mul_f32 v39, v170, v39
  v_mul_f32 v40, v170, v40
  v_mul_f32 v41, v170, v41
  v_mul_f32 v42, v170, v42
  v_mul_f32 v43, v170, v43
  v_mul_f32 v44, v170, v44
  v_mul_f32 v45, v170, v45
  v_mul_f32 v46, v170, v46
  v_mul_f32 v47, v170, v47
  v_mul_f32 v48, v170, v48
  v_mul_f32 v49, v170, v49
  v_mul_f32 v50, v170, v50
  v_mul_f32 v51, v170, v51
  v_mul_f32 v52, v170, v52
  v_mul_f32 v53, v170, v53
  v_mul_f32 v54, v170, v54
  v_mul_f32 v55, v170, v55
  v_mul_f32 v56, v170, v56
  v_mul_f32 v57, v170, v57
  v_mul_f32 v58, v170, v58
  v_mul_f32 v59, v170, v59
  v_mul_f32 v60, v170, v60
  v_mul_f32 v61, v170, v61
  v_mul_f32 v62, v170, v62
  v_mul_f32 v63, v170, v63
  v_mul_f32 v162, v170, v162
  v_exp_f32 v165, v64
  v_exp_f32 v166, v65
  s_nop 0
  v_add_f32 v163, v165, v166
  v_cvt_pk_bf16_f32 v144, v165, v166
  v_exp_f32 v167, v66
  v_exp_f32 v168, v67
  v_add_f32 v163, v163, v167
  v_add_f32 v163, v163, v168
  v_cvt_pk_bf16_f32 v145, v167, v168
  v_exp_f32 v165, v68
  v_exp_f32 v166, v69
  v_add_f32 v163, v163, v165
  v_add_f32 v163, v163, v166
  v_cvt_pk_bf16_f32 v146, v165, v166
  v_exp_f32 v167, v70
  v_exp_f32 v168, v71
  v_add_f32 v163, v163, v167
  v_add_f32 v163, v163, v168
  v_cvt_pk_bf16_f32 v147, v167, v168
  v_exp_f32 v165, v72
  v_exp_f32 v166, v73
  v_add_f32 v163, v163, v165
  v_add_f32 v163, v163, v166
  v_cvt_pk_bf16_f32 v148, v165, v166
  v_exp_f32 v167, v74
  v_exp_f32 v168, v75
  v_add_f32 v163, v163, v167
  v_add_f32 v163, v163, v168
  v_cvt_pk_bf16_f32 v149, v167, v168
  v_exp_f32 v165, v76
  v_exp_f32 v166, v77
  v_add_f32 v163, v163, v165
  v_add_f32 v163, v163, v166
  v_cvt_pk_bf16_f32 v150, v165, v166
  v_exp_f32 v167, v78
  v_exp_f32 v168, v79
  v_add_f32 v163, v163, v167
  v_add_f32 v163, v163, v168
  v_cvt_pk_bf16_f32 v151, v167, v168
  v_exp_f32 v165, v80
  v_exp_f32 v166, v81
  v_add_f32 v163, v163, v165
  v_add_f32 v163, v163, v166
  v_cvt_pk_bf16_f32 v152, v165, v166
  v_exp_f32 v167, v82
  v_exp_f32 v168, v83
  v_add_f32 v163, v163, v167
  v_add_f32 v163, v163, v168
  v_cvt_pk_bf16_f32 v153, v167, v168
  v_exp_f32 v165, v84
  v_exp_f32 v166, v85
  v_add_f32 v163, v163, v165
  v_add_f32 v163, v163, v166
  v_cvt_pk_bf16_f32 v154, v165, v166
  v_exp_f32 v167, v86
  v_exp_f32 v168, v87
  v_add_f32 v163, v163, v167
  v_add_f32 v163, v163, v168
  v_cvt_pk_bf16_f32 v155, v167, v168
  v_exp_f32 v165, v88
  v_exp_f32 v166, v89
  v_add_f32 v163, v163, v165
  v_add_f32 v163, v163, v166
  v_cvt_pk_bf16_f32 v156, v165, v166
  v_exp_f32 v167, v90
  v_exp_f32 v168, v91
  v_add_f32 v163, v163, v167
  v_add_f32 v163, v163, v168
  v_cvt_pk_bf16_f32 v157, v167, v168
  v_exp_f32 v165, v92
  v_exp_f32 v166, v93
  v_add_f32 v163, v163, v165
  v_add_f32 v163, v163, v166
  v_cvt_pk_bf16_f32 v158, v165, v166
  v_exp_f32 v167, v94
  v_exp_f32 v168, v95
  v_add_f32 v163, v163, v167
  v_add_f32 v163, v163, v168
  v_cvt_pk_bf16_f32 v159, v167, v168
  s_nop 3
  s_branch L_ret_1_4
L_fb_1_5:
  s_nop 15
  v_max3_f32 v169, v96, v97, v98
  v_max3_f32 v169, v169, v99, v100
  v_max3_f32 v169, v169, v101, v102
  v_max3_f32 v169, v169, v103, v104
  v_max3_f32 v169, v169, v105, v106
  v_max3_f32 v169, v169, v107, v108
  v_max3_f32 v169, v169, v109, v110
  v_max3_f32 v169, v169, v111, v112
  v_max3_f32 v169, v169, v113, v114
  v_max3_f32 v169, v169, v115, v116
  v_max3_f32 v169, v169, v117, v118
  v_max3_f32 v169, v169, v119, v120
  v_max3_f32 v169, v169, v121, v122
  v_max3_f32 v169, v169, v123, v124
  v_max3_f32 v169, v169, v125, v126
  v_max_f32 v169, v169, v127
  v_mov_b32 v170, v169
  s_nop 1
  v_permlane32_swap_b32 v170, v169
  v_max_f32 v169, v169, v170
  v_max_f32 v169, 0, v169
  v_exp_f32 v170, -v169
  v_sub_f32 v128, v128, v169
  v_sub_f32 v129, v129, v169
  v_sub_f32 v130, v130, v169
  v_sub_f32 v131, v131, v169
  v_sub_f32 v132, v132, v169
  v_sub_f32 v133, v133, v169
  v_sub_f32 v134, v134, v169
  v_sub_f32 v135, v135, v169
  v_sub_f32 v136, v136, v169
  v_sub_f32 v137, v137, v169
  v_sub_f32 v138, v138, v169
  v_sub_f32 v139, v139, v169
  v_sub_f32 v140, v140, v169
  v_sub_f32 v141, v141, v169
  v_sub_f32 v142, v142, v169
  v_sub_f32 v143, v143, v169
  v_sub_f32 v96, v96, v169
  v_sub_f32 v97, v97, v169
  v_sub_f32 v98, v98, v169
  v_sub_f32 v99, v99, v169
  v_sub_f32 v100, v100, v169
  v_sub_f32 v101, v101, v169
  v_sub_f32 v102, v102, v169
  v_sub_f32 v103, v103, v169
  v_sub_f32 v104, v104, v169
  v_sub_f32 v105, v105, v169
  v_sub_f32 v106, v106, v169
  v_sub_f32 v107, v107, v169
  v_sub_f32 v108, v108, v169
  v_sub_f32 v109, v109, v169
  v_sub_f32 v110, v110, v169
  v_sub_f32 v111, v111, v169
  v_sub_f32 v112, v112, v169
  v_sub_f32 v113, v113, v169
  v_sub_f32 v114, v114, v169
  v_sub_f32 v115, v115, v169
  v_sub_f32 v116, v116, v169
  v_sub_f32 v117, v117, v169
  v_sub_f32 v118, v118, v169
  v_sub_f32 v119, v119, v169
  v_sub_f32 v120, v120, v169
  v_sub_f32 v121, v121, v169
  v_sub_f32 v122, v122, v169
  v_sub_f32 v123, v123, v169
  v_sub_f32 v124, v124, v169
  v_sub_f32 v125, v125, v169
  v_sub_f32 v126, v126, v169
  v_sub_f32 v127, v127, v169
  v_sub_f32 v64, v64, v169
  v_sub_f32 v65, v65, v169
  v_sub_f32 v66, v66, v169
  v_sub_f32 v67, v67, v169
  v_sub_f32 v68, v68, v169
  v_sub_f32 v69, v69, v169
  v_sub_f32 v70, v70, v169
  v_sub_f32 v71, v71, v169
  v_sub_f32 v72, v72, v169
  v_sub_f32 v73, v73, v169
  v_sub_f32 v74, v74, v169
  v_sub_f32 v75, v75, v169
  v_sub_f32 v76, v76, v169
  v_sub_f32 v77, v77, v169
  v_sub_f32 v78, v78, v169
  v_sub_f32 v79, v79, v169
  v_sub_f32 v80, v80, v169
  v_sub_f32 v81, v81, v169
  v_sub_f32 v82, v82, v169
  v_sub_f32 v83, v83, v169
  v_sub_f32 v84, v84, v169
  v_sub_f32 v85, v85, v169
  v_sub_f32 v86, v86, v169
  v_sub_f32 v87, v87, v169
  v_sub_f32 v88, v88, v169
  v_sub_f32 v89, v89, v169
  v_sub_f32 v90, v90, v169
  v_sub_f32 v91, v91, v169
  v_sub_f32 v92, v92, v169
  v_sub_f32 v93, v93, v169
  v_sub_f32 v94, v94, v169
  v_sub_f32 v95, v95, v169
  v_mul_f32 v0, v170, v0
  v_mul_f32 v1, v170, v1
  v_mul_f32 v2, v170, v2
  v_mul_f32 v3, v170, v3
  v_mul_f32 v4, v170, v4
  v_mul_f32 v5, v170, v5
  v_mul_f32 v6, v170, v6
  v_mul_f32 v7, v170, v7
  v_mul_f32 v8, v170, v8
  v_mul_f32 v9, v170, v9
  v_mul_f32 v10, v170, v10
  v_mul_f32 v11, v170, v11
  v_mul_f32 v12, v170, v12
  v_mul_f32 v13, v170, v13
  v_mul_f32 v14, v170, v14
  v_mul_f32 v15, v170, v15
  v_mul_f32 v16, v170, v16
  v_mul_f32 v17, v170, v17
  v_mul_f32 v18, v170, v18
  v_mul_f32 v19, v170, v19
  v_mul_f32 v20, v170, v20
  v_mul_f32 v21, v170, v21
  v_mul_f32 v22, v170, v22
  v_mul_f32 v23, v170, v23
  v_mul_f32 v24, v170, v24
  v_mul_f32 v25, v170, v25
  v_mul_f32 v26, v170, v26
  v_mul_f32 v27, v170, v27
  v_mul_f32 v28, v170, v28
  v_mul_f32 v29, v170, v29
  v_mul_f32 v30, v170, v30
  v_mul_f32 v31, v170, v31
  v_mul_f32 v32, v170, v32
  v_mul_f32 v33, v170, v33
  v_mul_f32 v34, v170, v34
  v_mul_f32 v35, v170, v35
  v_mul_f32 v36, v170, v36
  v_mul_f32 v37, v170, v37
  v_mul_f32 v38, v170, v38
  v_mul_f32 v39, v170, v39
  v_mul_f32 v40, v170, v40
  v_mul_f32 v41, v170, v41
  v_mul_f32 v42, v170, v42
  v_mul_f32 v43, v170, v43
  v_mul_f32 v44, v170, v44
  v_mul_f32 v45, v170, v45
  v_mul_f32 v46, v170, v46
  v_mul_f32 v47, v170, v47
  v_mul_f32 v48, v170, v48
  v_mul_f32 v49, v170, v49
  v_mul_f32 v50, v170, v50
  v_mul_f32 v51, v170, v51
  v_mul_f32 v52, v170, v52
  v_mul_f32 v53, v170, v53
  v_mul_f32 v54, v170, v54
  v_mul_f32 v55, v170, v55
  v_mul_f32 v56, v170, v56
  v_mul_f32 v57, v170, v57
  v_mul_f32 v58, v170, v58
  v_mul_f32 v59, v170, v59
  v_mul_f32 v60, v170, v60
  v_mul_f32 v61, v170, v61
  v_mul_f32 v62, v170, v62
  v_mul_f32 v63, v170, v63
  v_mul_f32 v162, v170, v162
  v_exp_f32 v165, v96
  v_exp_f32 v166, v97
  s_nop 0
  v_add_f32 v163, v165, v166
  v_cvt_pk_bf16_f32 v144, v165, v166
  v_exp_f32 v167, v98
  v_exp_f32 v168, v99
  v_add_f32 v163, v163, v167
  v_add_f32 v163, v163, v168
  v_cvt_pk_bf16_f32 v145, v167, v168
  v_exp_f32 v165, v100
  v_exp_f32 v166, v101
  v_add_f32 v163, v163, v165
  v_add_f32 v163, v163, v166
  v_cvt_pk_bf16_f32 v146, v165, v166
  v_exp_f32 v167, v102
  v_exp_f32 v168, v103
  v_add_f32 v163, v163, v167
  v_add_f32 v163, v163, v168
  v_cvt_pk_bf16_f32 v147, v167, v168
  v_exp_f32 v165, v104
  v_exp_f32 v166, v105
  v_add_f32 v163, v163, v165
  v_add_f32 v163, v163, v166
  v_cvt_pk_bf16_f32 v148, v165, v166
  v_exp_f32 v167, v106
  v_exp_f32 v168, v107
  v_add_f32 v163, v163, v167
  v_add_f32 v163, v163, v168
  v_cvt_pk_bf16_f32 v149, v167, v168
  v_exp_f32 v165, v108
  v_exp_f32 v166, v109
  v_add_f32 v163, v163, v165
  v_add_f32 v163, v163, v166
  v_cvt_pk_bf16_f32 v150, v165, v166
  v_exp_f32 v167, v110
  v_exp_f32 v168, v111
  v_add_f32 v163, v163, v167
  v_add_f32 v163, v163, v168
  v_cvt_pk_bf16_f32 v151, v167, v168
  v_exp_f32 v165, v112
  v_exp_f32 v166, v113
  v_add_f32 v163, v163, v165
  v_add_f32 v163, v163, v166
  v_cvt_pk_bf16_f32 v152, v165, v166
  v_exp_f32 v167, v114
  v_exp_f32 v168, v115
  v_add_f32 v163, v163, v167
  v_add_f32 v163, v163, v168
  v_cvt_pk_bf16_f32 v153, v167, v168
  v_exp_f32 v165, v116
  v_exp_f32 v166, v117
  v_add_f32 v163, v163, v165
  v_add_f32 v163, v163, v166
  v_cvt_pk_bf16_f32 v154, v165, v166
  v_exp_f32 v167, v118
  v_exp_f32 v168, v119
  v_add_f32 v163, v163, v167
  v_add_f32 v163, v163, v168
  v_cvt_pk_bf16_f32 v155, v167, v168
  v_exp_f32 v165, v120
  v_exp_f32 v166, v121
  v_add_f32 v163, v163, v165
  v_add_f32 v163, v163, v166
  v_cvt_pk_bf16_f32 v156, v165, v166
  v_exp_f32 v167, v122
  v_exp_f32 v168, v123
  v_add_f32 v163, v163, v167
  v_add_f32 v163, v163, v168
  v_cvt_pk_bf16_f32 v157, v167, v168
  v_exp_f32 v165, v124
  v_exp_f32 v166, v125
  v_add_f32 v163, v163, v165
  v_add_f32 v163, v163, v166
  v_cvt_pk_bf16_f32 v158, v165, v166
  v_exp_f32 v167, v126
  v_exp_f32 v168, v127
  v_add_f32 v163, v163, v167
  v_add_f32 v163, v163, v168
  v_cvt_pk_bf16_f32 v159, v167, v168
  s_nop 3
  s_branch L_ret_1_5
L_fb_1_6:
  s_nop 15
  v_max3_f32 v169, v64, v65, v66
  v_max3_f32 v169, v169, v67, v68
  v_max3_f32 v169, v169, v69, v70
  v_max3_f32 v169, v169, v71, v72
  v_max3_f32 v169, v169, v73, v74
  v_max3_f32 v169, v169, v75, v76
  v_max3_f32 v169, v169, v77, v78
  v_max3_f32 v169, v169, v79, v80
  v_max3_f32 v169, v169, v81, v82
  v_max3_f32 v169, v169, v83, v84
  v_max3_f32 v169, v169, v85, v86
  v_max3_f32 v169, v169, v87, v88
  v_max3_f32 v169, v169, v89, v90
  v_max3_f32 v169, v169, v91, v92
  v_max3_f32 v169, v169, v93, v94
  v_max_f32 v169, v169, v95
  v_mov_b32 v170, v169
  s_nop 1
  v_permlane32_swap_b32 v170, v169
  v_max_f32 v169, v169, v170
  v_max_f32 v169, 0, v169
  v_exp_f32 v170, -v169
  v_sub_f32 v128, v128, v169
  v_sub_f32 v129, v129, v169
  v_sub_f32 v130, v130, v169
  v_sub_f32 v131, v131, v169
  v_sub_f32 v132, v132, v169
  v_sub_f32 v133, v133, v169
  v_sub_f32 v134, v134, v169
  v_sub_f32 v135, v135, v169
  v_sub_f32 v136, v136, v169
  v_sub_f32 v137, v137, v169
  v_sub_f32 v138, v138, v169
  v_sub_f32 v139, v139, v169
  v_sub_f32 v140, v140, v169
  v_sub_f32 v141, v141, v169
  v_sub_f32 v142, v142, v169
  v_sub_f32 v143, v143, v169
  v_sub_f32 v64, v64, v169
  v_sub_f32 v65, v65, v169
  v_sub_f32 v66, v66, v169
  v_sub_f32 v67, v67, v169
  v_sub_f32 v68, v68, v169
  v_sub_f32 v69, v69, v169
  v_sub_f32 v70, v70, v169
  v_sub_f32 v71, v71, v169
  v_sub_f32 v72, v72, v169
  v_sub_f32 v73, v73, v169
  v_sub_f32 v74, v74, v169
  v_sub_f32 v75, v75, v169
  v_sub_f32 v76, v76, v169
  v_sub_f32 v77, v77, v169
  v_sub_f32 v78, v78, v169
  v_sub_f32 v79, v79, v169
  v_sub_f32 v80, v80, v169
  v_sub_f32 v81, v81, v169
  v_sub_f32 v82, v82, v169
  v_sub_f32 v83, v83, v169
  v_sub_f32 v84, v84, v169
  v_sub_f32 v85, v85, v169
  v_sub_f32 v86, v86, v169
  v_sub_f32 v87, v87, v169
  v_sub_f32 v88, v88, v169
  v_sub_f32 v89, v89, v169
  v_sub_f32 v90, v90, v169
  v_sub_f32 v91, v91, v169
  v_sub_f32 v92, v92, v169
  v_sub_f32 v93, v93, v169
  v_sub_f32 v94, v94, v169
  v_sub_f32 v95, v95, v169
  v_sub_f32 v96, v96, v169
  v_sub_f32 v97, v97, v169
  v_sub_f32 v98, v98, v169
  v_sub_f32 v99, v99, v169
  v_sub_f32 v100, v100, v169
  v_sub_f32 v101, v101, v169
  v_sub_f32 v102, v102, v169
  v_sub_f32 v103, v103, v169
  v_sub_f32 v104, v104, v169
  v_sub_f32 v105, v105, v169
  v_sub_f32 v106, v106, v169
  v_sub_f32 v107, v107, v169
  v_sub_f32 v108, v108, v169
  v_sub_f32 v109, v109, v169
  v_sub_f32 v110, v110, v169
  v_sub_f32 v111, v111, v169
  v_sub_f32 v112, v112, v169
  v_sub_f32 v113, v113, v169
  v_sub_f32 v114, v114, v169
  v_sub_f32 v115, v115, v169
  v_sub_f32 v116, v116, v169
  v_sub_f32 v117, v117, v169
  v_sub_f32 v118, v118, v169
  v_sub_f32 v119, v119, v169
  v_sub_f32 v120, v120, v169
  v_sub_f32 v121, v121, v169
  v_sub_f32 v122, v122, v169
  v_sub_f32 v123, v123, v169
  v_sub_f32 v124, v124, v169
  v_sub_f32 v125, v125, v169
  v_sub_f32 v126, v126, v169
  v_sub_f32 v127, v127, v169
  v_mul_f32 v0, v170, v0
  v_mul_f32 v1, v170, v1
  v_mul_f32 v2, v170, v2
  v_mul_f32 v3, v170, v3
  v_mul_f32 v4, v170, v4
  v_mul_f32 v5, v170, v5
  v_mul_f32 v6, v170, v6
  v_mul_f32 v7, v170, v7
  v_mul_f32 v8, v170, v8
  v_mul_f32 v9, v170, v9
  v_mul_f32 v10, v170, v10
  v_mul_f32 v11, v170, v11
  v_mul_f32 v12, v170, v12
  v_mul_f32 v13, v170, v13
  v_mul_f32 v14, v170, v14
  v_mul_f32 v15, v170, v15
  v_mul_f32 v16, v170, v16
  v_mul_f32 v17, v170, v17
  v_mul_f32 v18, v170, v18
  v_mul_f32 v19, v170, v19
  v_mul_f32 v20, v170, v20
  v_mul_f32 v21, v170, v21
  v_mul_f32 v22, v170, v22
  v_mul_f32 v23, v170, v23
  v_mul_f32 v24, v170, v24
  v_mul_f32 v25, v170, v25
  v_mul_f32 v26, v170, v26
  v_mul_f32 v27, v170, v27
  v_mul_f32 v28, v170, v28
  v_mul_f32 v29, v170, v29
  v_mul_f32 v30, v170, v30
  v_mul_f32 v31, v170, v31
  v_mul_f32 v32, v170, v32
  v_mul_f32 v33, v170, v33
  v_mul_f32 v34, v170, v34
  v_mul_f32 v35, v170, v35
  v_mul_f32 v36, v170, v36
  v_mul_f32 v37, v170, v37
  v_mul_f32 v38, v170, v38
  v_mul_f32 v39, v170, v39
  v_mul_f32 v40, v170, v40
  v_mul_f32 v41, v170, v41
  v_mul_f32 v42, v170, v42
  v_mul_f32 v43, v170, v43
  v_mul_f32 v44, v170, v44
  v_mul_f32 v45, v170, v45
  v_mul_f32 v46, v170, v46
  v_mul_f32 v47, v170, v47
  v_mul_f32 v48, v170, v48
  v_mul_f32 v49, v170, v49
  v_mul_f32 v50, v170, v50
  v_mul_f32 v51, v170, v51
  v_mul_f32 v52, v170, v52
  v_mul_f32 v53, v170, v53
  v_mul_f32 v54, v170, v54
  v_mul_f32 v55, v170, v55
  v_mul_f32 v56, v170, v56
  v_mul_f32 v57, v170, v57
  v_mul_f32 v58, v170, v58
  v_mul_f32 v59, v170, v59
  v_mul_f32 v60, v170, v60
  v_mul_f32 v61, v170, v61
  v_mul_f32 v62, v170, v62
  v_mul_f32 v63, v170, v63
  v_mul_f32 v162, v170, v162
  v_exp_f32 v165, v64
  v_exp_f32 v166, v65
  s_nop 0
  v_add_f32 v163, v165, v166
  v_cvt_pk_bf16_f32 v144, v165, v166
  v_exp_f32 v167, v66
  v_exp_f32 v168, v67
  v_add_f32 v163, v163, v167
  v_add_f32 v163, v163, v168
  v_cvt_pk_bf16_f32 v145, v167, v168
  v_exp_f32 v165, v68
  v_exp_f32 v166, v69
  v_add_f32 v163, v163, v165
  v_add_f32 v163, v163, v166
  v_cvt_pk_bf16_f32 v146, v165, v166
  v_exp_f32 v167, v70
  v_exp_f32 v168, v71
  v_add_f32 v163, v163, v167
  v_add_f32 v163, v163, v168
  v_cvt_pk_bf16_f32 v147, v167, v168
  v_exp_f32 v165, v72
  v_exp_f32 v166, v73
  v_add_f32 v163, v163, v165
  v_add_f32 v163, v163, v166
  v_cvt_pk_bf16_f32 v148, v165, v166
  v_exp_f32 v167, v74
  v_exp_f32 v168, v75
  v_add_f32 v163, v163, v167
  v_add_f32 v163, v163, v168
  v_cvt_pk_bf16_f32 v149, v167, v168
  v_exp_f32 v165, v76
  v_exp_f32 v166, v77
  v_add_f32 v163, v163, v165
  v_add_f32 v163, v163, v166
  v_cvt_pk_bf16_f32 v150, v165, v166
  v_exp_f32 v167, v78
  v_exp_f32 v168, v79
  v_add_f32 v163, v163, v167
  v_add_f32 v163, v163, v168
  v_cvt_pk_bf16_f32 v151, v167, v168
  v_exp_f32 v165, v80
  v_exp_f32 v166, v81
  v_add_f32 v163, v163, v165
  v_add_f32 v163, v163, v166
  v_cvt_pk_bf16_f32 v152, v165, v166
  v_exp_f32 v167, v82
  v_exp_f32 v168, v83
  v_add_f32 v163, v163, v167
  v_add_f32 v163, v163, v168
  v_cvt_pk_bf16_f32 v153, v167, v168
  v_exp_f32 v165, v84
  v_exp_f32 v166, v85
  v_add_f32 v163, v163, v165
  v_add_f32 v163, v163, v166
  v_cvt_pk_bf16_f32 v154, v165, v166
  v_exp_f32 v167, v86
  v_exp_f32 v168, v87
  v_add_f32 v163, v163, v167
  v_add_f32 v163, v163, v168
  v_cvt_pk_bf16_f32 v155, v167, v168
  v_exp_f32 v165, v88
  v_exp_f32 v166, v89
  v_add_f32 v163, v163, v165
  v_add_f32 v163, v163, v166
  v_cvt_pk_bf16_f32 v156, v165, v166
  v_exp_f32 v167, v90
  v_exp_f32 v168, v91
  v_add_f32 v163, v163, v167
  v_add_f32 v163, v163, v168
  v_cvt_pk_bf16_f32 v157, v167, v168
  v_exp_f32 v165, v92
  v_exp_f32 v166, v93
  v_add_f32 v163, v163, v165
  v_add_f32 v163, v163, v166
  v_cvt_pk_bf16_f32 v158, v165, v166
  v_exp_f32 v167, v94
  v_exp_f32 v168, v95
  v_add_f32 v163, v163, v167
  v_add_f32 v163, v163, v168
  v_cvt_pk_bf16_f32 v159, v167, v168
  s_nop 3
  s_branch L_ret_1_6
L_fb_1_7:
  s_nop 15
  v_max3_f32 v169, v96, v97, v98
  v_max3_f32 v169, v169, v99, v100
  v_max3_f32 v169, v169, v101, v102
  v_max3_f32 v169, v169, v103, v104
  v_max3_f32 v169, v169, v105, v106
  v_max3_f32 v169, v169, v107, v108
  v_max3_f32 v169, v169, v109, v110
  v_max3_f32 v169, v169, v111, v112
  v_max3_f32 v169, v169, v113, v114
  v_max3_f32 v169, v169, v115, v116
  v_max3_f32 v169, v169, v117, v118
  v_max3_f32 v169, v169, v119, v120
  v_max3_f32 v169, v169, v121, v122
  v_max3_f32 v169, v169, v123, v124
  v_max3_f32 v169, v169, v125, v126
  v_max_f32 v169, v169, v127
  v_mov_b32 v170, v169
  s_nop 1
  v_permlane32_swap_b32 v170, v169
  v_max_f32 v169, v169, v170
  v_max_f32 v169, 0, v169
  v_exp_f32 v170, -v169
  v_sub_f32 v128, v128, v169
  v_sub_f32 v129, v129, v169
  v_sub_f32 v130, v130, v169
  v_sub_f32 v131, v131, v169
  v_sub_f32 v132, v132, v169
  v_sub_f32 v133, v133, v169
  v_sub_f32 v134, v134, v169
  v_sub_f32 v135, v135, v169
  v_sub_f32 v136, v136, v169
  v_sub_f32 v137, v137, v169
  v_sub_f32 v138, v138, v169
  v_sub_f32 v139, v139, v169
  v_sub_f32 v140, v140, v169
  v_sub_f32 v141, v141, v169
  v_sub_f32 v142, v142, v169
  v_sub_f32 v143, v143, v169
  v_sub_f32 v96, v96, v169
  v_sub_f32 v97, v97, v169
  v_sub_f32 v98, v98, v169
  v_sub_f32 v99, v99, v169
  v_sub_f32 v100, v100, v169
  v_sub_f32 v101, v101, v169
  v_sub_f32 v102, v102, v169
  v_sub_f32 v103, v103, v169
  v_sub_f32 v104, v104, v169
  v_sub_f32 v105, v105, v169
  v_sub_f32 v106, v106, v169
  v_sub_f32 v107, v107, v169
  v_sub_f32 v108, v108, v169
  v_sub_f32 v109, v109, v169
  v_sub_f32 v110, v110, v169
  v_sub_f32 v111, v111, v169
  v_sub_f32 v112, v112, v169
  v_sub_f32 v113, v113, v169
  v_sub_f32 v114, v114, v169
  v_sub_f32 v115, v115, v169
  v_sub_f32 v116, v116, v169
  v_sub_f32 v117, v117, v169
  v_sub_f32 v118, v118, v169
  v_sub_f32 v119, v119, v169
  v_sub_f32 v120, v120, v169
  v_sub_f32 v121, v121, v169
  v_sub_f32 v122, v122, v169
  v_sub_f32 v123, v123, v169
  v_sub_f32 v124, v124, v169
  v_sub_f32 v125, v125, v169
  v_sub_f32 v126, v126, v169
  v_sub_f32 v127, v127, v169
  v_mul_f32 v0, v170, v0
  v_mul_f32 v1, v170, v1
  v_mul_f32 v2, v170, v2
  v_mul_f32 v3, v170, v3
  v_mul_f32 v4, v170, v4
  v_mul_f32 v5, v170, v5
  v_mul_f32 v6, v170, v6
  v_mul_f32 v7, v170, v7
  v_mul_f32 v8, v170, v8
  v_mul_f32 v9, v170, v9
  v_mul_f32 v10, v170, v10
  v_mul_f32 v11, v170, v11
  v_mul_f32 v12, v170, v12
  v_mul_f32 v13, v170, v13
  v_mul_f32 v14, v170, v14
  v_mul_f32 v15, v170, v15
  v_mul_f32 v16, v170, v16
  v_mul_f32 v17, v170, v17
  v_mul_f32 v18, v170, v18
  v_mul_f32 v19, v170, v19
  v_mul_f32 v20, v170, v20
  v_mul_f32 v21, v170, v21
  v_mul_f32 v22, v170, v22
  v_mul_f32 v23, v170, v23
  v_mul_f32 v24, v170, v24
  v_mul_f32 v25, v170, v25
  v_mul_f32 v26, v170, v26
  v_mul_f32 v27, v170, v27
  v_mul_f32 v28, v170, v28
  v_mul_f32 v29, v170, v29
  v_mul_f32 v30, v170, v30
  v_mul_f32 v31, v170, v31
  v_mul_f32 v32, v170, v32
  v_mul_f32 v33, v170, v33
  v_mul_f32 v34, v170, v34
  v_mul_f32 v35, v170, v35
  v_mul_f32 v36, v170, v36
  v_mul_f32 v37, v170, v37
  v_mul_f32 v38, v170, v38
  v_mul_f32 v39, v170, v39
  v_mul_f32 v40, v170, v40
  v_mul_f32 v41, v170, v41
  v_mul_f32 v42, v170, v42
  v_mul_f32 v43, v170, v43
  v_mul_f32 v44, v170, v44
  v_mul_f32 v45, v170, v45
  v_mul_f32 v46, v170, v46
  v_mul_f32 v47, v170, v47
  v_mul_f32 v48, v170, v48
  v_mul_f32 v49, v170, v49
  v_mul_f32 v50, v170, v50
  v_mul_f32 v51, v170, v51
  v_mul_f32 v52, v170, v52
  v_mul_f32 v53, v170, v53
  v_mul_f32 v54, v170, v54
  v_mul_f32 v55, v170, v55
  v_mul_f32 v56, v170, v56
  v_mul_f32 v57, v170, v57
  v_mul_f32 v58, v170, v58
  v_mul_f32 v59, v170, v59
  v_mul_f32 v60, v170, v60
  v_mul_f32 v61, v170, v61
  v_mul_f32 v62, v170, v62
  v_mul_f32 v63, v170, v63
  v_mul_f32 v162, v170, v162
  v_exp_f32 v165, v96
  v_exp_f32 v166, v97
  s_nop 0
  v_add_f32 v163, v165, v166
  v_cvt_pk_bf16_f32 v144, v165, v166
  v_exp_f32 v167, v98
  v_exp_f32 v168, v99
  v_add_f32 v163, v163, v167
  v_add_f32 v163, v163, v168
  v_cvt_pk_bf16_f32 v145, v167, v168
  v_exp_f32 v165, v100
  v_exp_f32 v166, v101
  v_add_f32 v163, v163, v165
  v_add_f32 v163, v163, v166
  v_cvt_pk_bf16_f32 v146, v165, v166
  v_exp_f32 v167, v102
  v_exp_f32 v168, v103
  v_add_f32 v163, v163, v167
  v_add_f32 v163, v163, v168
  v_cvt_pk_bf16_f32 v147, v167, v168
  v_exp_f32 v165, v104
  v_exp_f32 v166, v105
  v_add_f32 v163, v163, v165
  v_add_f32 v163, v163, v166
  v_cvt_pk_bf16_f32 v148, v165, v166
  v_exp_f32 v167, v106
  v_exp_f32 v168, v107
  v_add_f32 v163, v163, v167
  v_add_f32 v163, v163, v168
  v_cvt_pk_bf16_f32 v149, v167, v168
  v_exp_f32 v165, v108
  v_exp_f32 v166, v109
  v_add_f32 v163, v163, v165
  v_add_f32 v163, v163, v166
  v_cvt_pk_bf16_f32 v150, v165, v166
  v_exp_f32 v167, v110
  v_exp_f32 v168, v111
  v_add_f32 v163, v163, v167
  v_add_f32 v163, v163, v168
  v_cvt_pk_bf16_f32 v151, v167, v168
  v_exp_f32 v165, v112
  v_exp_f32 v166, v113
  v_add_f32 v163, v163, v165
  v_add_f32 v163, v163, v166
  v_cvt_pk_bf16_f32 v152, v165, v166
  v_exp_f32 v167, v114
  v_exp_f32 v168, v115
  v_add_f32 v163, v163, v167
  v_add_f32 v163, v163, v168
  v_cvt_pk_bf16_f32 v153, v167, v168
  v_exp_f32 v165, v116
  v_exp_f32 v166, v117
  v_add_f32 v163, v163, v165
  v_add_f32 v163, v163, v166
  v_cvt_pk_bf16_f32 v154, v165, v166
  v_exp_f32 v167, v118
  v_exp_f32 v168, v119
  v_add_f32 v163, v163, v167
  v_add_f32 v163, v163, v168
  v_cvt_pk_bf16_f32 v155, v167, v168
  v_exp_f32 v165, v120
  v_exp_f32 v166, v121
  v_add_f32 v163, v163, v165
  v_add_f32 v163, v163, v166
  v_cvt_pk_bf16_f32 v156, v165, v166
  v_exp_f32 v167, v122
  v_exp_f32 v168, v123
  v_add_f32 v163, v163, v167
  v_add_f32 v163, v163, v168
  v_cvt_pk_bf16_f32 v157, v167, v168
  v_exp_f32 v165, v124
  v_exp_f32 v166, v125
  v_add_f32 v163, v163, v165
  v_add_f32 v163, v163, v166
  v_cvt_pk_bf16_f32 v158, v165, v166
  v_exp_f32 v167, v126
  v_exp_f32 v168, v127
  v_add_f32 v163, v163, v167
  v_add_f32 v163, v163, v168
  v_cvt_pk_bf16_f32 v159, v167, v168
  s_nop 3
  s_branch L_ret_1_7
L_spin_st:
  s_mov_b32 s59, 20000
L_spl_st:
  s_sleep 1
  buffer_load_dword v166, off, s[72:75], 0 offset:0 sc1
  s_sub_u32 s59, s59, 1
  s_cmp_eq_u32 s59, 0
  s_waitcnt vmcnt(0)
  s_cbranch_scc1 L_ok_st
  v_cmp_ne_u32 vcc, 256, v166
  s_nop 4
  s_and_b32 s64, vcc_lo, 0x1
  s_cbranch_scc1 L_spl_st
  s_branch L_ok_st
L_spin_h0:
  s_mov_b32 s59, 20000
L_spl_h0:
  s_sleep 1
  buffer_load_dword v171, v164, s[68:71], 0 offen sc1
  s_sub_u32 s59, s59, 1
  s_cmp_eq_u32 s59, 0
  s_waitcnt vmcnt(0)
  s_cbranch_scc1 L_ok_h0
  v_cmp_ne_u32 vcc, 1, v171
  s_nop 4
  s_and_b32 s64, vcc_lo, 0xff
  s_cbranch_scc1 L_spl_h0
  s_branch L_ok_h0
L_spin_o0_5:
  s_mov_b32 s59, 20000
L_spl_o0_5:
  s_sleep 1
  buffer_load_dword v171, v164, s[68:71], 0 offen sc1
  s_sub_u32 s59, s59, 1
  s_cmp_eq_u32 s59, 0
  s_waitcnt vmcnt(0)
  s_cbranch_scc1 L_ok_o0_5
  v_cmp_gt_u32 vcc, 4, v171
  s_nop 4
  s_and_b32 s64, vcc_lo, s96
  s_cbranch_scc1 L_spl_o0_5
  s_branch L_ok_o0_5
L_spin_d0:
  s_mov_b32 s59, 20000
L_spl_d0:
  s_sleep 1
  buffer_load_dword v170, off, s[72:75], 0 offset:128 sc1
  s_sub_u32 s59, s59, 1
  s_cmp_eq_u32 s59, 0
  s_waitcnt vmcnt(0)
  s_cbranch_scc1 L_ok_d0
  v_cmp_ne_u32 vcc, 256, v170
  s_nop 4
  s_and_b32 s64, vcc_lo, 0x1
  s_cbranch_scc1 L_spl_d0
  s_branch L_ok_d0
L_spin_o0_9:
  s_mov_b32 s59, 20000
L_spl_o0_9:
  s_sleep 1
  buffer_load_dword v171, v164, s[68:71], 0 offen sc1
  s_sub_u32 s59, s59, 1
  s_cmp_eq_u32 s59, 0
  s_waitcnt vmcnt(0)
  s_cbranch_scc1 L_ok_o0_9
  v_cmp_gt_u32 vcc, 4, v171
  s_nop 4
  s_and_b32 s64, vcc_lo, 0xff00
  s_cbranch_scc1 L_spl_o0_9
  s_branch L_ok_o0_9
L_p3_spin_0_0:
  s_mov_b32 s59, 20000
L_p3_spl_0_0:
  s_sleep 1
  s_and_b64 exec, vcc, s[56:57]
  buffer_load_dwordx4 v[0:3], v161, s[88:91], 0 offen offset:0 sc1
  buffer_load_dwordx4 v[4:7], v161, s[88:91], 0 offen offset:256 sc1
  buffer_load_dwordx4 v[8:11], v161, s[88:91], 0 offen offset:512 sc1
  buffer_load_dwordx4 v[12:15], v161, s[88:91], 0 offen offset:768 sc1
  buffer_load_dwordx4 v[16:19], v161, s[88:91], 0 offen offset:1024 sc1
  s_mov_b64 exec, -1
  s_waitcnt vmcnt(0)
  v_max3_u32 v165, v0, v1, v2
  v_max3_u32 v165, v165, v3, v4
  v_max3_u32 v165, v165, v5, v6
  v_max3_u32 v165, v165, v7, v8
  v_max3_u32 v165, v165, v9, v10
  v_max3_u32 v165, v165, v11, v12
  v_max3_u32 v165, v165, v13, v14
  v_max3_u32 v165, v165, v15, v16
  v_max3_u32 v165, v165, v17, v18
  v_max_u32 v165, v165, v19
  v_cmp_eq_u32 vcc, -1, v165
  s_sub_u32 s59, s59, 1
  s_cmp_eq_u32 s59, 0
  s_cbranch_scc1 L_p3_ok_0_0
  s_nop 2
  s_cbranch_vccnz L_p3_spl_0_0
  s_branch L_p3_ok_0_0
L_p3_spin_0_1:
  s_mov_b32 s59, 20000
L_p3_spl_0_1:
  s_sleep 1
  s_and_b64 exec, vcc, s[56:57]
  buffer_load_dwordx4 v[64:67], v161, s[88:91], s3 offen offset:0 sc1
  buffer_load_dwordx4 v[68:71], v161, s[88:91], s3 offen offset:256 sc1
  buffer_load_dwordx4 v[72:75], v161, s[88:91], s3 offen offset:512 sc1
  buffer_load_dwordx4 v[76:79], v161, s[88:91], s3 offen offset:768 sc1
  buffer_load_dwordx4 v[80:83], v161, s[88:91], s3 offen offset:1024 sc1
  s_mov_b64 exec, -1
  s_waitcnt vmcnt(0)
  v_max3_u32 v165, v64, v65, v66
  v_max3_u32 v165, v165, v67, v68
  v_max3_u32 v165, v165, v69, v70
  v_max3_u32 v165, v165, v71, v72
  v_max3_u32 v165, v165, v73, v74
  v_max3_u32 v165, v165, v75, v76
  v_max3_u32 v165, v165, v77, v78
  v_max3_u32 v165, v165, v79, v80
  v_max3_u32 v165, v165, v81, v82
  v_max_u32 v165, v165, v83
  v_cmp_eq_u32 vcc, -1, v165
  s_sub_u32 s59, s59, 1
  s_cmp_eq_u32 s59, 0
  s_cbranch_scc1 L_p3_ok_0_1
  s_nop 2
  s_cbranch_vccnz L_p3_spl_0_1
  s_branch L_p3_ok_0_1
L_spin_h1:
  s_mov_b32 s59, 20000
L_spl_h1:
  s_sleep 1
  buffer_load_dword v171, v164, s[68:71], 0 offen sc1
  s_sub_u32 s59, s59, 1
  s_cmp_eq_u32 s59, 0
  s_waitcnt vmcnt(0)
  s_cbranch_scc1 L_ok_h1
  v_cmp_ne_u32 vcc, 1, v171
  s_nop 4
  s_and_b32 s64, vcc_lo, 0xff
  s_cbranch_scc1 L_spl_h1
  s_branch L_ok_h1
L_spin_o1_5:
  s_mov_b32 s59, 20000
L_spl_o1_5:
  s_sleep 1
  buffer_load_dword v171, v164, s[68:71], 0 offen sc1
  s_sub_u32 s59, s59, 1
  s_cmp_eq_u32 s59, 0
  s_waitcnt vmcnt(0)
  s_cbranch_scc1 L_ok_o1_5
  v_cmp_gt_u32 vcc, 4, v171
  s_nop 4
  s_and_b32 s64, vcc_lo, s96
  s_cbranch_scc1 L_spl_o1_5
  s_branch L_ok_o1_5
L_spin_d1:
  s_mov_b32 s59, 20000
L_spl_d1:
  s_sleep 1
  buffer_load_dword v170, off, s[72:75], 0 offset:128 sc1
  s_sub_u32 s59, s59, 1
  s_cmp_eq_u32 s59, 0
  s_waitcnt vmcnt(0)
  s_cbranch_scc1 L_ok_d1
  v_cmp_ne_u32 vcc, 256, v170
  s_nop 4
  s_and_b32 s64, vcc_lo, 0x1
  s_cbranch_scc1 L_spl_d1
  s_branch L_ok_d1
L_spin_o1_9:
  s_mov_b32 s59, 20000
L_spl_o1_9:
  s_sleep 1
  buffer_load_dword v171, v164, s[68:71], 0 offen sc1
  s_sub_u32 s59, s59, 1
  s_cmp_eq_u32 s59, 0
  s_waitcnt vmcnt(0)
  s_cbranch_scc1 L_ok_o1_9
  v_cmp_gt_u32 vcc, 4, v171
  s_nop 4
  s_and_b32 s64, vcc_lo, 0xff00
  s_cbranch_scc1 L_spl_o1_9
  s_branch L_ok_o1_9
L_p3_spin_1_0:
  s_mov_b32 s59, 20000
L_p3_spl_1_0:
  s_sleep 1
  s_and_b64 exec, vcc, s[56:57]
  buffer_load_dwordx4 v[64:67], v161, s[88:91], 0 offen offset:0 sc1
  buffer_load_dwordx4 v[68:71], v161, s[88:91], 0 offen offset:256 sc1
  buffer_load_dwordx4 v[72:75], v161, s[88:91], 0 offen offset:512 sc1
  buffer_load_dwordx4 v[76:79], v161, s[88:91], 0 offen offset:768 sc1
  buffer_load_dwordx4 v[80:83], v161, s[88:91], 0 offen offset:1024 sc1
  s_mov_b64 exec, -1
  s_waitcnt vmcnt(0)
  v_max3_u32 v165, v64, v65, v66
  v_max3_u32 v165, v165, v67, v68
  v_max3_u32 v165, v165, v69, v70
  v_max3_u32 v165, v165, v71, v72
  v_max3_u32 v165, v165, v73, v74
  v_max3_u32 v165, v165, v75, v76
  v_max3_u32 v165, v165, v77, v78
  v_max3_u32 v165, v165, v79, v80
  v_max3_u32 v165, v165, v81, v82
  v_max_u32 v165, v165, v83
  v_cmp_eq_u32 vcc, -1, v165
  s_sub_u32 s59, s59, 1
  s_cmp_eq_u32 s59, 0
  s_cbranch_scc1 L_p3_ok_1_0
  s_nop 2
  s_cbranch_vccnz L_p3_spl_1_0
  s_branch L_p3_ok_1_0
L_p3_spin_1_1:
  s_mov_b32 s59, 20000
L_p3_spl_1_1:
  s_sleep 1
  s_and_b64 exec, vcc, s[56:57]
  buffer_load_dwordx4 v[0:3], v161, s[88:91], s3 offen offset:0 sc1
  buffer_load_dwordx4 v[4:7], v161, s[88:91], s3 offen offset:256 sc1
  buffer_load_dwordx4 v[8:11], v161, s[88:91], s3 offen offset:512 sc1
  buffer_load_dwordx4 v[12:15], v161, s[88:91], s3 offen offset:768 sc1
  buffer_load_dwordx4 v[16:19], v161, s[88:91], s3 offen offset:1024 sc1
  s_mov_b64 exec, -1
  s_waitcnt vmcnt(0)
  v_max3_u32 v165, v0, v1, v2
  v_max3_u32 v165, v165, v3, v4
  v_max3_u32 v165, v165, v5, v6
  v_max3_u32 v165, v165, v7, v8
  v_max3_u32 v165, v165, v9, v10
  v_max3_u32 v165, v165, v11, v12
  v_max3_u32 v165, v165, v13, v14
  v_max3_u32 v165, v165, v15, v16
  v_max3_u32 v165, v165, v17, v18
  v_max_u32 v165, v165, v19
  v_cmp_eq_u32 vcc, -1, v165
  s_sub_u32 s59, s59, 1
  s_cmp_eq_u32 s59, 0
  s_cbranch_scc1 L_p3_ok_1_1
  s_nop 2
  s_cbranch_vccnz L_p3_spl_1_1
  s_branch L_p3_ok_1_1
L_k1_end:
  s_endpgm
.section .rodata,"a"
.p2align 6
.amdhsa_kernel recurrent_scan__sliding_block_cached__swiglu_ffn__prompt_kernel
  .amdhsa_next_free_vgpr 256
  .amdhsa_next_free_sgpr 102
  .amdhsa_accum_offset 256
  .amdhsa_group_segment_fixed_size 0
  .amdhsa_kernarg_size 96
  .amdhsa_user_sgpr_count 2
  .amdhsa_user_sgpr_kernarg_segment_ptr 1
  .amdhsa_system_sgpr_workgroup_id_x 1
.end_amdhsa_kernel
```
